```python
import torch

def _softmax(x, axis=-1):
    return torch.softmax(x, dim=axis)

def _gelu(x):
    return torch.nn.functional.gelu(x, approximate='tanh')

def _silu(x):
    return torch.nn.functional.silu(x)

def _sigmoid(x):
    return torch.sigmoid(x)

def _layernorm(x, axis=-1, eps=1e-05):
    m = x.mean(dim=axis, keepdim=True)
    v = x.var(dim=axis, keepdim=True, unbiased=False)
    return (x - m) / torch.sqrt(v + eps)

def _scatter_add(tgt, idx, src, axis=0):
    return tgt.clone().index_add_(axis, idx, src)

def _segment_sum(src, seg, n):
    out = torch.zeros((n,) + src.shape[1:], dtype=src.dtype)
    return out.index_add_(0, seg, src)

def _pad(x, pw):
    flat = tuple((v for pair in reversed(pw) for v in pair))
    return torch.nn.functional.pad(x, flat)
kernel_name = 'recurrent_scan__memory_aug_recurrent_mem_tr__glu_gated_glu__prompt'

def setup_inputs():

    _w = lambda a: (lambda t: t.to(torch.bfloat16) if t.is_floating_point() else t)(torch.as_tensor(a))

    def _A_setup():
        B, S, Dm = (1, 2048, 640)
        H, Dh = (32, 192)
        M, seg = (8, 32)
        seg = min(seg, S)
        S = S // seg * seg
        return {'x': _w((lambda *s: torch.randn(*s, dtype=torch.bfloat16) * 0.05)(B, S, Dm)), 'mem0': _w((lambda *s: torch.randn(*s, dtype=torch.bfloat16) * 0.2)(B, M, Dm)), 'Wq': _w((lambda *s: torch.randn(*s, dtype=torch.bfloat16) * 0.8)(Dm, H, Dh) * Dm ** (-0.5)), 'Wk': _w((lambda *s: torch.randn(*s, dtype=torch.bfloat16) * 0.8)(Dm, H, Dh) * Dm ** (-0.5)), 'Wv': _w((lambda *s: torch.randn(*s, dtype=torch.bfloat16) * 0.2)(Dm, H, Dh) * Dm ** (-0.5)), 'Wo': _w((lambda *s: torch.randn(*s, dtype=torch.bfloat16) * 0.2)(H, Dh, Dm) * (H * Dh) ** (-0.5)), 'seg_len': seg}
    _A_in = _A_setup()

    def _B_setup():
        B, S, D, F = (1, 2048, 640, 1536)
        return {'x': _w((lambda *s: torch.randn(*s, dtype=torch.bfloat16) * 0.05)(B, S, D)), 'w_gate': _w((lambda *s: torch.randn(*s, dtype=torch.bfloat16) * 0.2)(D, F)), 'w_up': _w((lambda *s: torch.randn(*s, dtype=torch.bfloat16) * 0.1)(D, F)), 'w_down': _w((lambda *s: torch.randn(*s, dtype=torch.bfloat16) * 0.1)(F, D))}
    _B_in = _B_setup()
    return {'A_x': _A_in['x'], 'A_mem0': _A_in['mem0'], 'A_Wq': _A_in['Wq'], 'A_Wk': _A_in['Wk'], 'A_Wv': _A_in['Wv'], 'A_Wo': _A_in['Wo'], 'A_seg_len': _A_in['seg_len'], 'B_x': _B_in['x'], 'B_w_gate': _B_in['w_gate'], 'B_w_up': _B_in['w_up'], 'B_w_down': _B_in['w_down']}

def reference(A_x, A_mem0, A_Wq, A_Wk, A_Wv, A_Wo, A_seg_len, B_x, B_w_gate, B_w_up, B_w_down):

    def _A_ref(x, mem0, Wq, Wk, Wv, Wo, seg_len):
        B, S, Dm = x.shape
        H, Dh = (Wq.shape[1], Wq.shape[2])
        M = mem0.shape[1]
        scale = Dh ** (-0.5)
        n_seg = S // seg_len
        L = M + seg_len
        idx = torch.arange(L)
        mask = (idx[:, None] < M) | (idx[:, None] >= idx[None, :])
        mem = mem0
        outs = []
        for s in range(n_seg):
            xs = x[:, s * seg_len:(s + 1) * seg_len, :].clone()
            h = torch.concatenate([mem, xs], axis=1)
            q = torch.einsum('btd,dhe->bhte', h, Wq)
            k = torch.einsum('btd,dhe->bhte', h, Wk)
            v = torch.einsum('btd,dhe->bhte', h, Wv)
            scores = torch.einsum('bhqe,bhke->bhqk', q, k) * scale
            scores = torch.where(mask[None, None], scores, -1000000000.0)
            p = _softmax(scores, axis=-1)
            o = torch.einsum('bhqk,bhke->bhqe', p, v)
            o = torch.einsum('bhte,hed->btd', o, Wo)
            mem = o[:, :M, :].clone()
            outs.append(o[:, M:, :])
        return torch.concatenate(outs, axis=1)

    def _B_ref(x, w_gate, w_up, w_down):
        g = torch.einsum('bsd,df->bsf', x, w_gate)
        u = torch.einsum('bsd,df->bsf', x, w_up)
        h = _sigmoid(g) * u
        return torch.einsum('bsf,fd->bsd', h, w_down)
    x = A_x
    xn = _layernorm(x, axis=-1)
    s = _A_ref(xn, A_mem0, A_Wq, A_Wk, A_Wv, A_Wo, A_seg_len)
    g = _silu(_B_ref(xn, B_w_gate, B_w_up, B_w_down))
    return x + s * g
```

```asm
; @launch grid=(256,1,1) block=(256,1,1) lds=147456
.amdgcn_target "amdgcn-amd-amdhsa--gfx950"
.text
.globl recurrent_scan__memory_aug_recurrent_mem_tr__glu_gated_glu__prompt_kernel
.p2align 8
.type recurrent_scan__memory_aug_recurrent_mem_tr__glu_gated_glu__prompt_kernel,@function
recurrent_scan__memory_aug_recurrent_mem_tr__glu_gated_glu__prompt_kernel:
    s_cmp_ge_u32 s2, 256
    s_cbranch_scc1 L_end0_3
    s_load_dwordx2 s[40:41], s[0:1], 104
    s_load_dwordx2 s[42:43], s[0:1], 96
    s_getreg_b32 s17, hwreg(HW_REG_XCC_ID, 0, 4)
    s_waitcnt lgkmcnt(0)
    s_mov_b32 s4, s40
    s_and_b32 s5, s41, 0xffff
    s_mov_b32 s6, 268435456
    s_mov_b32 s7, 0x20000
    s_mov_b32 s12, s42
    s_and_b32 s13, s43, 0xffff
    s_mov_b32 s14, 256
    s_mov_b32 s15, 0x20000
    v_lshrrev_b32 v1, 6, v0
    s_nop 0
    v_readfirstlane_b32 s16, v1
    s_and_b32 s17, s17, 7
    s_cmp_lg_u32 s16, 0
    s_cbranch_scc1 L_tk_2
    v_mov_b32 v3, 1
    s_lshl_b32 s22, s17, 2
    v_mov_b32 v4, s22
    v_cmp_eq_u32 vcc, 0, v0
    s_and_saveexec_b64 s[28:29], vcc
    buffer_atomic_add v3, v4, s[12:15], 0 offen sc0 sc1
    s_waitcnt vmcnt(0)
    v_mov_b32 v5, 23552
    ds_write_b32 v5, v3
    s_waitcnt lgkmcnt(0)
    s_mov_b64 exec, s[28:29]
L_tk_2:
    s_barrier
    v_mov_b32 v5, 23552
    ds_read_b32 v3, v5
    s_waitcnt lgkmcnt(0)
    s_barrier
    s_nop 0
    v_readfirstlane_b32 s18, v3
    s_nop 3
    s_cmp_ge_u32 s18, 32
    s_cbranch_scc1 L_end0_3
    s_cmp_ge_u32 s17, 4
    s_cbranch_scc1 L_hi_7
    s_cmp_lt_u32 s18, 24
    s_cbranch_scc1 L_chain_4
    s_cmp_lt_u32 s18, 28
    s_cbranch_scc0 L_aux
    s_sub_u32 s18, s18, 24
    s_branch L_attn_5
L_aux:
    s_lshl_b32 s20, s17, 2
    s_add_u32 s20, s20, s18
    s_sub_u32 s20, s20, 28
    s_cmp_lt_u32 s20, 10
    s_cbranch_scc0 L_a2
    s_cmp_ge_u32 s20, 5
    s_cselect_b32 s17, 9, 8
    s_cselect_b32 s21, 5, 0
    s_sub_u32 s18, s20, s21
    s_branch L_wsg_9
L_a2:
    s_cmp_lt_u32 s20, 15
    s_cbranch_scc0 L_a3
    s_sub_u32 s17, s20, 10
    s_branch L_final_10
L_a3:
    v_mov_b32 v4, 0
    v_mov_b32 v5, 0
    v_mov_b32 v6, 0
    v_mov_b32 v7, 0
    v_lshlrev_b32 v8, 4, v0
    v_add_u32 v8, 2097152, v8
    s_mov_b32 s28, 0
    buffer_store_dwordx4 v[4:7], v8, s[4:7], s28 offen sc1
    s_mov_b32 s28, 4096
    buffer_store_dwordx4 v[4:7], v8, s[4:7], s28 offen sc1
    s_mov_b32 s28, 8192
    buffer_store_dwordx4 v[4:7], v8, s[4:7], s28 offen sc1
    s_mov_b32 s28, 12288
    buffer_store_dwordx4 v[4:7], v8, s[4:7], s28 offen sc1
    s_mov_b32 s28, 16384
    buffer_store_dwordx4 v[4:7], v8, s[4:7], s28 offen sc1
    s_mov_b32 s28, 20480
    buffer_store_dwordx4 v[4:7], v8, s[4:7], s28 offen sc1
    s_mov_b32 s28, 24576
    buffer_store_dwordx4 v[4:7], v8, s[4:7], s28 offen sc1
    s_mov_b32 s28, 28672
    buffer_store_dwordx4 v[4:7], v8, s[4:7], s28 offen sc1
    s_mov_b32 s28, 32768
    buffer_store_dwordx4 v[4:7], v8, s[4:7], s28 offen sc1
    s_mov_b32 s28, 36864
    buffer_store_dwordx4 v[4:7], v8, s[4:7], s28 offen sc1
    s_waitcnt vmcnt(0)
    s_barrier
    s_cmp_lg_u32 s16, 0
    s_cbranch_scc1 L_z_11
    v_mov_b32 v4, 1
    v_mov_b32 v5, 76
    s_mov_b64 exec, 1
    buffer_store_dword v4, v5, s[12:15], 0 offen sc1
    s_mov_b64 exec, -1
L_z_11:
    s_cmp_lg_u32 s16, 0
    s_cbranch_scc1 L_ncal_12
    v_mov_b32 v4, 0
    s_mov_b32 s46, -1
    s_mov_b32 s47, -1
    v_and_b32 v5, 15, v0
    v_lshlrev_b32 v5, 2, v5
    v_add_u32 v5, 917504, v5
    s_mov_b32 s43, 0
    s_waitcnt vmcnt(0) lgkmcnt(0)
    s_memtime s[48:49]
    s_waitcnt lgkmcnt(0)
    buffer_store_dword v4, v5, s[4:7], s43 offen sc1
    s_waitcnt vmcnt(0)
    s_memtime s[50:51]
    s_waitcnt lgkmcnt(0)
    s_sub_u32 s50, s50, s48
    s_min_u32 s46, s46, s50
    s_mov_b32 s43, 8192
    s_waitcnt vmcnt(0) lgkmcnt(0)
    s_memtime s[48:49]
    s_waitcnt lgkmcnt(0)
    buffer_store_dword v4, v5, s[4:7], s43 offen sc1
    s_waitcnt vmcnt(0)
    s_memtime s[50:51]
    s_waitcnt lgkmcnt(0)
    s_sub_u32 s50, s50, s48
    s_min_u32 s47, s47, s50
    s_mov_b32 s43, 256
    s_waitcnt vmcnt(0) lgkmcnt(0)
    s_memtime s[48:49]
    s_waitcnt lgkmcnt(0)
    buffer_store_dword v4, v5, s[4:7], s43 offen sc1
    s_waitcnt vmcnt(0)
    s_memtime s[50:51]
    s_waitcnt lgkmcnt(0)
    s_sub_u32 s50, s50, s48
    s_min_u32 s46, s46, s50
    s_mov_b32 s43, 8448
    s_waitcnt vmcnt(0) lgkmcnt(0)
    s_memtime s[48:49]
    s_waitcnt lgkmcnt(0)
    buffer_store_dword v4, v5, s[4:7], s43 offen sc1
    s_waitcnt vmcnt(0)
    s_memtime s[50:51]
    s_waitcnt lgkmcnt(0)
    s_sub_u32 s50, s50, s48
    s_min_u32 s47, s47, s50
    s_mov_b32 s43, 512
    s_waitcnt vmcnt(0) lgkmcnt(0)
    s_memtime s[48:49]
    s_waitcnt lgkmcnt(0)
    buffer_store_dword v4, v5, s[4:7], s43 offen sc1
    s_waitcnt vmcnt(0)
    s_memtime s[50:51]
    s_waitcnt lgkmcnt(0)
    s_sub_u32 s50, s50, s48
    s_min_u32 s46, s46, s50
    s_mov_b32 s43, 8704
    s_waitcnt vmcnt(0) lgkmcnt(0)
    s_memtime s[48:49]
    s_waitcnt lgkmcnt(0)
    buffer_store_dword v4, v5, s[4:7], s43 offen sc1
    s_waitcnt vmcnt(0)
    s_memtime s[50:51]
    s_waitcnt lgkmcnt(0)
    s_sub_u32 s50, s50, s48
    s_min_u32 s47, s47, s50
    s_mov_b32 s43, 768
    s_waitcnt vmcnt(0) lgkmcnt(0)
    s_memtime s[48:49]
    s_waitcnt lgkmcnt(0)
    buffer_store_dword v4, v5, s[4:7], s43 offen sc1
    s_waitcnt vmcnt(0)
    s_memtime s[50:51]
    s_waitcnt lgkmcnt(0)
    s_sub_u32 s50, s50, s48
    s_min_u32 s46, s46, s50
    s_mov_b32 s43, 8960
    s_waitcnt vmcnt(0) lgkmcnt(0)
    s_memtime s[48:49]
    s_waitcnt lgkmcnt(0)
    buffer_store_dword v4, v5, s[4:7], s43 offen sc1
    s_waitcnt vmcnt(0)
    s_memtime s[50:51]
    s_waitcnt lgkmcnt(0)
    s_sub_u32 s50, s50, s48
    s_min_u32 s47, s47, s50
    s_cmp_lt_u32 s47, s46
    s_cselect_b32 s43, 2, 1
    v_mov_b32 v4, s43
    v_mov_b32 v5, 64
    s_mov_b64 exec, 1
    buffer_store_dword v4, v5, s[12:15], 0 offen sc1
    s_mov_b64 exec, -1
L_ncal_12:
    s_mov_b32 s17, 5
    s_branch L_final_10
L_hi_7:
    s_sub_u32 s20, s17, 4
    s_lshl_b32 s21, s18, 2
    s_add_u32 s20, s20, s21
    s_cmp_lt_u32 s20, 84
    s_cbranch_scc0 L_notproj
    s_mov_b32 s17, s20
    s_branch L_proj_8
L_notproj:
    s_cmp_lt_u32 s20, 124
    s_cbranch_scc1 L_iswsg
    s_sub_u32 s17, s20, 118
    s_branch L_final_10
L_iswsg:
    s_sub_u32 s20, s20, 84
    s_mul_i32 s17, s20, 13108
    s_lshr_b32 s17, s17, 16
    s_mul_i32 s18, s17, 5
    s_sub_u32 s18, s20, s18
    s_branch L_wsg_9
L_chain_4:
    v_and_b32 v1, 63, v0
    v_and_b32 v2, 15, v0
    v_lshrrev_b32 v3, 4, v1
    s_mul_i32 s19, s18, 86
    s_lshr_b32 s19, s19, 8
    s_mul_i32 s20, s19, 3
    s_sub_u32 s20, s18, s20
    s_lshl_b32 s40, s17, 3
    s_add_u32 s19, s19, s40
    s_mul_i32 s41, s19, 192
    s_lshl_b32 s40, s20, 6
    s_add_u32 s41, s41, s40
    s_load_dwordx2 s[42:43], s[0:1], 8
    s_waitcnt lgkmcnt(0)
    s_mov_b32 s8, s42
    s_and_b32 s9, s43, 0xffff
    s_mov_b32 s10, 10240
    s_mov_b32 s11, 0x20000
    v_lshlrev_b32 v10, 2, v0
    v_add_u32 v10, 0, v10
    buffer_load_dword a240, v10, s[8:11], 0 offen
    v_lshlrev_b32 v10, 2, v0
    v_add_u32 v10, 1024, v10
    buffer_load_dword a241, v10, s[8:11], 0 offen
    v_lshlrev_b32 v10, 2, v0
    v_add_u32 v10, 2048, v10
    buffer_load_dword a242, v10, s[8:11], 0 offen
    v_lshlrev_b32 v10, 2, v0
    v_add_u32 v10, 3072, v10
    buffer_load_dword a243, v10, s[8:11], 0 offen
    v_lshlrev_b32 v10, 2, v0
    v_add_u32 v10, 4096, v10
    buffer_load_dword a244, v10, s[8:11], 0 offen
    v_lshlrev_b32 v10, 2, v0
    v_add_u32 v10, 5120, v10
    buffer_load_dword a245, v10, s[8:11], 0 offen
    v_lshlrev_b32 v10, 2, v0
    v_add_u32 v10, 6144, v10
    buffer_load_dword a246, v10, s[8:11], 0 offen
    v_lshlrev_b32 v10, 2, v0
    v_add_u32 v10, 7168, v10
    buffer_load_dword a247, v10, s[8:11], 0 offen
    v_lshlrev_b32 v10, 2, v0
    v_add_u32 v10, 8192, v10
    buffer_load_dword a248, v10, s[8:11], 0 offen
    v_lshlrev_b32 v10, 2, v0
    v_add_u32 v10, 9216, v10
    buffer_load_dword a249, v10, s[8:11], 0 offen
    v_mov_b32 v12, -1
    v_mov_b32 v13, -1
    v_mov_b32 v14, -1
    v_mov_b32 v15, -1
    v_lshlrev_b32 v10, 4, v0
    s_mul_i32 s43, s17, 73728
    s_add_u32 s43, s43, 1048576
    s_mul_i32 s44, s18, 1536
    s_add_u32 s43, s43, s44
    s_add_u32 s46, s43, 36864
    v_cmp_gt_u32 vcc, 96, v0
    s_and_saveexec_b64 s[44:45], vcc
    buffer_store_dwordx4 v[12:15], v10, s[4:7], s43 offen
    buffer_store_dwordx4 v[12:15], v10, s[4:7], s46 offen
    s_mov_b64 exec, s[44:45]
    s_mul_i32 s43, s17, 49152
    s_add_u32 s43, s43, 1572864
    s_lshl_b32 s44, s18, 10
    s_add_u32 s43, s43, s44
    s_add_u32 s46, s43, 24576
    v_cmp_gt_u32 vcc, 64, v0
    s_and_saveexec_b64 s[44:45], vcc
    buffer_store_dwordx4 v[12:15], v10, s[4:7], s43 offen
    buffer_store_dwordx4 v[12:15], v10, s[4:7], s46 offen
    s_mov_b64 exec, s[44:45]
    s_cmp_ge_u32 s18, 20
    s_cbranch_scc1 L_ni_13
    s_lshl_b32 s43, s17, 15
    s_add_u32 s43, s43, 1835008
    s_lshl_b32 s44, s18, 9
    s_add_u32 s43, s43, s44
    s_add_u32 s46, s43, 16384
    v_cmp_gt_u32 vcc, 32, v0
    s_and_saveexec_b64 s[44:45], vcc
    buffer_store_dwordx4 v[12:15], v10, s[4:7], s43 offen
    buffer_store_dwordx4 v[12:15], v10, s[4:7], s46 offen
    s_mov_b64 exec, s[44:45]
    v_mov_b32 v16, 0
    v_mov_b32 v17, 0
    v_mov_b32 v18, 0
    v_mov_b32 v19, 0
    s_lshr_b32 s43, s18, 1
    s_lshl_b32 s43, s43, 14
    s_and_b32 s44, s18, 1
    s_lshl_b32 s44, s44, 12
    s_add_u32 s43, s43, s44
    s_lshl_b32 s44, s17, 10
    s_add_u32 s43, s43, s44
    s_add_u32 s43, s43, 0
    v_cmp_gt_u32 vcc, 64, v0
    s_and_saveexec_b64 s[44:45], vcc
    s_add_u32 s46, s43, 0
    buffer_store_dwordx4 v[16:19], v10, s[4:7], s46 offen sc1
    s_add_u32 s46, s43, 8192
    buffer_store_dwordx4 v[16:19], v10, s[4:7], s46 offen sc1
    s_add_u32 s46, s43, 262144
    buffer_store_dwordx4 v[16:19], v10, s[4:7], s46 offen sc1
    s_add_u32 s46, s43, 270336
    buffer_store_dwordx4 v[16:19], v10, s[4:7], s46 offen sc1
    s_mov_b64 exec, s[44:45]
L_ni_13:
    s_nop 1
    v_lshrrev_b32 v192, 3, v0
    v_mul_u32_u24 v192, 12288, v192
    v_and_b32 v193, 7, v0
    v_lshlrev_b32 v193, 4, v193
    v_add_u32 v192, v192, v193
    s_lshl_b32 s40, s41, 1
    v_add_u32 v192, s40, v192
    v_lshrrev_b32 v194, 3, v0
    v_mul_u32_u24 v194, 144, v194
    v_add_u32 v194, v194, v193
    v_add_u32 v194, 24576, v194
    v_lshrrev_b32 v195, 2, v2
    v_lshlrev_b32 v196, 3, v3
    v_add_u32 v195, v195, v196
    v_mul_u32_u24 v195, 144, v195
    v_and_b32 v196, 3, v1
    v_lshlrev_b32 v196, 3, v196
    v_add_u32 v195, v195, v196
    s_lshl_b32 s40, s16, 5
    s_add_u32 s40, s40, 24576
    v_add_u32 v195, s40, v195
    v_add_u32 v197, 46080, v195
    s_load_dwordx2 s[42:43], s[0:1], 16
    s_waitcnt lgkmcnt(0)
    s_mov_b32 s8, s42
    s_and_b32 s9, s43, 0xffff
    s_mov_b32 s10, 7864320
    s_mov_b32 s11, 0x20000
    s_mov_b32 s44, 0
    buffer_load_dwordx4 v[32:35], v192, s[8:11], s44 offen
    s_add_u32 s44, s44, 393216
    buffer_load_dwordx4 v[36:39], v192, s[8:11], s44 offen
    s_add_u32 s44, s44, 393216
    buffer_load_dwordx4 v[40:43], v192, s[8:11], s44 offen
    s_add_u32 s44, s44, 393216
    buffer_load_dwordx4 v[44:47], v192, s[8:11], s44 offen
    s_add_u32 s44, s44, 393216
    buffer_load_dwordx4 v[48:51], v192, s[8:11], s44 offen
    s_add_u32 s44, s44, 393216
    buffer_load_dwordx4 v[52:55], v192, s[8:11], s44 offen
    s_add_u32 s44, s44, 393216
    buffer_load_dwordx4 v[56:59], v192, s[8:11], s44 offen
    s_add_u32 s44, s44, 393216
    buffer_load_dwordx4 v[60:63], v192, s[8:11], s44 offen
    s_add_u32 s44, s44, 393216
    buffer_load_dwordx4 v[64:67], v192, s[8:11], s44 offen
    s_add_u32 s44, s44, 393216
    buffer_load_dwordx4 v[68:71], v192, s[8:11], s44 offen
    s_add_u32 s44, s44, 393216
    buffer_load_dwordx4 v[72:75], v192, s[8:11], s44 offen
    s_add_u32 s44, s44, 393216
    buffer_load_dwordx4 v[76:79], v192, s[8:11], s44 offen
    s_add_u32 s44, s44, 393216
    buffer_load_dwordx4 v[80:83], v192, s[8:11], s44 offen
    s_add_u32 s44, s44, 393216
    buffer_load_dwordx4 v[84:87], v192, s[8:11], s44 offen
    s_add_u32 s44, s44, 393216
    buffer_load_dwordx4 v[88:91], v192, s[8:11], s44 offen
    s_add_u32 s44, s44, 393216
    buffer_load_dwordx4 v[92:95], v192, s[8:11], s44 offen
    s_add_u32 s44, s44, 393216
    buffer_load_dwordx4 v[96:99], v192, s[8:11], s44 offen
    s_add_u32 s44, s44, 393216
    buffer_load_dwordx4 v[100:103], v192, s[8:11], s44 offen
    s_add_u32 s44, s44, 393216
    buffer_load_dwordx4 v[104:107], v192, s[8:11], s44 offen
    s_add_u32 s44, s44, 393216
    buffer_load_dwordx4 v[108:111], v192, s[8:11], s44 offen
    s_load_dwordx2 s[42:43], s[0:1], 24
    s_waitcnt lgkmcnt(0)
    s_mov_b32 s8, s42
    s_and_b32 s9, s43, 0xffff
    s_mov_b32 s10, 7864320
    s_mov_b32 s11, 0x20000
    s_mov_b32 s44, 0
    buffer_load_dwordx4 v[112:115], v192, s[8:11], s44 offen
    s_add_u32 s44, s44, 393216
    buffer_load_dwordx4 v[116:119], v192, s[8:11], s44 offen
    s_add_u32 s44, s44, 393216
    buffer_load_dwordx4 v[120:123], v192, s[8:11], s44 offen
    s_add_u32 s44, s44, 393216
    buffer_load_dwordx4 v[124:127], v192, s[8:11], s44 offen
    s_add_u32 s44, s44, 393216
    buffer_load_dwordx4 v[128:131], v192, s[8:11], s44 offen
    s_add_u32 s44, s44, 393216
    buffer_load_dwordx4 v[132:135], v192, s[8:11], s44 offen
    s_add_u32 s44, s44, 393216
    buffer_load_dwordx4 v[136:139], v192, s[8:11], s44 offen
    s_add_u32 s44, s44, 393216
    buffer_load_dwordx4 v[140:143], v192, s[8:11], s44 offen
    s_add_u32 s44, s44, 393216
    buffer_load_dwordx4 v[144:147], v192, s[8:11], s44 offen
    s_add_u32 s44, s44, 393216
    buffer_load_dwordx4 v[148:151], v192, s[8:11], s44 offen
    s_add_u32 s44, s44, 393216
    buffer_load_dwordx4 v[152:155], v192, s[8:11], s44 offen
    s_add_u32 s44, s44, 393216
    buffer_load_dwordx4 v[156:159], v192, s[8:11], s44 offen
    s_add_u32 s44, s44, 393216
    buffer_load_dwordx4 v[160:163], v192, s[8:11], s44 offen
    s_add_u32 s44, s44, 393216
    buffer_load_dwordx4 v[164:167], v192, s[8:11], s44 offen
    s_add_u32 s44, s44, 393216
    buffer_load_dwordx4 v[168:171], v192, s[8:11], s44 offen
    s_add_u32 s44, s44, 393216
    buffer_load_dwordx4 v[172:175], v192, s[8:11], s44 offen
    s_add_u32 s44, s44, 393216
    buffer_load_dwordx4 v[176:179], v192, s[8:11], s44 offen
    s_add_u32 s44, s44, 393216
    buffer_load_dwordx4 v[180:183], v192, s[8:11], s44 offen
    s_add_u32 s44, s44, 393216
    buffer_load_dwordx4 v[184:187], v192, s[8:11], s44 offen
    s_add_u32 s44, s44, 393216
    buffer_load_dwordx4 v[188:191], v192, s[8:11], s44 offen
    s_load_dwordx2 s[42:43], s[0:1], 32
    s_waitcnt lgkmcnt(0)
    s_mov_b32 s8, s42
    s_and_b32 s9, s43, 0xffff
    s_mov_b32 s10, 7864320
    s_mov_b32 s11, 0x20000
    s_mov_b32 s44, 0
    buffer_load_dwordx4 a[160:163], v192, s[8:11], s44 offen
    s_add_u32 s44, s44, 393216
    buffer_load_dwordx4 a[164:167], v192, s[8:11], s44 offen
    s_add_u32 s44, s44, 393216
    buffer_load_dwordx4 a[168:171], v192, s[8:11], s44 offen
    s_add_u32 s44, s44, 393216
    buffer_load_dwordx4 a[172:175], v192, s[8:11], s44 offen
    s_add_u32 s44, s44, 393216
    buffer_load_dwordx4 a[176:179], v192, s[8:11], s44 offen
    s_add_u32 s44, s44, 393216
    buffer_load_dwordx4 a[180:183], v192, s[8:11], s44 offen
    s_add_u32 s44, s44, 393216
    buffer_load_dwordx4 a[184:187], v192, s[8:11], s44 offen
    s_add_u32 s44, s44, 393216
    buffer_load_dwordx4 a[188:191], v192, s[8:11], s44 offen
    s_add_u32 s44, s44, 393216
    buffer_load_dwordx4 a[192:195], v192, s[8:11], s44 offen
    s_add_u32 s44, s44, 393216
    buffer_load_dwordx4 a[196:199], v192, s[8:11], s44 offen
    s_add_u32 s44, s44, 393216
    buffer_load_dwordx4 a[200:203], v192, s[8:11], s44 offen
    s_add_u32 s44, s44, 393216
    buffer_load_dwordx4 a[204:207], v192, s[8:11], s44 offen
    s_add_u32 s44, s44, 393216
    buffer_load_dwordx4 a[208:211], v192, s[8:11], s44 offen
    s_add_u32 s44, s44, 393216
    buffer_load_dwordx4 a[212:215], v192, s[8:11], s44 offen
    s_add_u32 s44, s44, 393216
    buffer_load_dwordx4 a[216:219], v192, s[8:11], s44 offen
    s_add_u32 s44, s44, 393216
    buffer_load_dwordx4 a[220:223], v192, s[8:11], s44 offen
    s_add_u32 s44, s44, 393216
    buffer_load_dwordx4 a[224:227], v192, s[8:11], s44 offen
    s_add_u32 s44, s44, 393216
    buffer_load_dwordx4 a[228:231], v192, s[8:11], s44 offen
    s_add_u32 s44, s44, 393216
    buffer_load_dwordx4 a[232:235], v192, s[8:11], s44 offen
    s_add_u32 s44, s44, 393216
    buffer_load_dwordx4 a[236:239], v192, s[8:11], s44 offen
    v_lshrrev_b32 v198, 2, v0
    s_mul_i32 s40, s17, 1536
    v_add_u32 v198, s40, v198
    v_mul_u32_u24 v198, 1280, v198
    v_and_b32 v193, 3, v0
    v_lshlrev_b32 v193, 4, v193
    v_add_u32 v198, v198, v193
    s_lshl_b32 s40, s18, 6
    v_add_u32 v198, s40, v198
    v_lshrrev_b32 v199, 2, v0
    v_mul_u32_u24 v199, 80, v199
    v_add_u32 v199, v199, v193
    v_add_u32 v199, 24576, v199
    v_add_u32 v196, 65536, v194
    s_waitcnt vmcnt(60)
    s_barrier
    s_cmp_lg_u32 s16, 0
    s_cbranch_scc1 L_nc2_14
    v_mov_b32 v200, 1
    v_mov_b32 v201, 72
    s_mov_b64 exec, 1
    buffer_atomic_add v200, v201, s[12:15], 0 offen sc1
    s_mov_b64 exec, -1
L_nc2_14:
    v_lshrrev_b32 v8, 2, v2
    v_and_b32 v9, 1, v8
    v_lshrrev_b32 v10, 1, v8
    v_lshlrev_b32 v10, 2, v10
    v_add_u32 v9, v9, v10
    v_and_b32 v10, 3, v1
    v_lshrrev_b32 v11, 1, v10
    v_lshlrev_b32 v11, 1, v11
    v_add_u32 v9, v9, v11
    v_and_b32 v11, 1, v3
    v_lshlrev_b32 v11, 3, v11
    v_xor_b32 v9, v9, v11
    v_lshlrev_b32 v11, 4, v3
    v_add_u32 v9, v9, v11
    v_lshlrev_b32 v9, 4, v9
    v_and_b32 v10, 1, v10
    v_lshlrev_b32 v10, 3, v10
    v_add_u32 v4, v9, v10
    v_xor_b32 v5, 128, v4
    s_lshl_b32 s40, s17, 15
    s_add_u32 s40, s40, 1835008
    v_lshrrev_b32 v9, 4, v0
    v_and_b32 v9, 1, v9
    v_lshlrev_b32 v9, 3, v9
    v_xor_b32 v9, v9, v0
    v_lshlrev_b32 v6, 4, v9
    v_add_u32 v6, s40, v6
    v_add_u32 v7, 4096, v6
    v_add_u32 v8, 8192, v6
    v_lshrrev_b32 v9, 5, v1
    v_lshlrev_b32 v9, 10, v9
    v_lshlrev_b32 v10, 4, v2
    v_add_u32 v9, v9, v10
    v_and_b32 v10, 1, v3
    v_lshlrev_b32 v10, 3, v10
    v_add_u32 v9, v9, v10
    s_lshl_b32 s40, s16, 8
    s_add_u32 s40, s40, 15360
    v_add_u32 v9, s40, v9
    v_lshrrev_b32 v10, 2, v2
    v_lshlrev_b32 v11, 3, v3
    v_add_u32 v10, v10, v11
    v_lshlrev_b32 v10, 4, v10
    v_and_b32 v11, 1, v1
    v_lshlrev_b32 v11, 3, v11
    v_add_u32 v10, v10, v11
    v_add_u32 v10, 15360, v10
    s_mul_i32 s40, s17, 73728
    s_add_u32 s40, s40, 1048576
    s_mul_i32 s42, s18, 1536
    s_add_u32 s42, s42, s40
    s_sub_u32 s43, s18, s20
    s_mul_i32 s43, s43, 1536
    s_add_u32 s43, s43, s40
    s_cmp_eq_u32 s16, 1
    s_cselect_b32 s44, 32, 0
    s_cmp_eq_u32 s16, 2
    s_cselect_b32 s44, 96, s44
    s_add_u32 s44, s44, s42
    v_and_b32 v13, 7, v1
    v_mul_u32_u24 v11, 160, v13
    v_lshlrev_b32 v12, 4, v3
    v_add_u32 v11, v11, v12
    v_add_u32 v11, s44, v11
    v_lshrrev_b32 v12, 5, v1
    s_lshl_b32 s44, s16, 1
    v_add_u32 v12, s44, v12
    v_mul_u32_u24 v12, 160, v12
    v_and_b32 v14, 31, v1
    v_lshlrev_b32 v15, 3, v14
    v_add_u32 v12, v12, v15
    v_add_u32 v12, s43, v12
    v_lshrrev_b32 v13, 5, v1
    v_add_u32 v13, s44, v13
    v_mul_u32_u24 v13, 96, v13
    v_lshlrev_b32 v15, 2, v14
    v_add_u32 v13, v13, v15
    v_add_u32 v13, 17408, v13
    v_and_b32 v15, 7, v1
    v_mul_u32_u24 v15, 96, v15
    v_lshlrev_b32 v14, 4, v3
    v_add_u32 v14, v14, v15
    v_add_u32 v14, 17424, v14
    v_and_b32 v16, 1, v3
    v_lshlrev_b32 v16, 3, v16
    v_add_u32 v15, v15, v16
    v_add_u32 v15, 17408, v15
    s_mul_i32 s40, s17, 49152
    s_add_u32 s40, s40, 1572864
    s_lshl_b32 s42, s18, 10
    s_add_u32 s42, s42, s40
    s_lshl_b32 s43, s16, 8
    s_add_u32 s42, s42, s43
    v_lshrrev_b32 v16, 1, v3
    v_lshlrev_b32 v16, 3, v16
    v_add_u32 v16, v16, v2
    v_lshlrev_b32 v16, 4, v16
    v_add_u32 v16, s42, v16
    s_mul_i32 s43, s16, 6144
    s_add_u32 s43, s43, s40
    v_lshlrev_b32 v17, 4, v1
    v_add_u32 v17, s43, v17
    v_add_u32 v18, 4096, v17
    v_lshlrev_b32 v20, 4, v1
    v_add_u32 v20, 18432, v20
    s_lshl_b32 s43, s16, 10
    v_add_u32 v19, s43, v20
    s_lshr_b32 s43, s18, 1
    s_lshl_b32 s43, s43, 14
    s_and_b32 s44, s18, 1
    s_lshl_b32 s44, s44, 12
    s_add_u32 s43, s43, s44
    s_add_u32 s43, s43, 0
    v_lshlrev_b32 v22, 4, v1
    v_add_u32 v22, s43, v22
    s_lshl_b32 s43, s17, 10
    v_add_u32 v21, s43, v22
    s_lshl_b32 s40, s17, 15
    s_add_u32 s40, s40, 1835008
    s_lshl_b32 s43, s18, 9
    s_add_u32 s40, s40, s43
    v_lshrrev_b32 v23, 5, v1
    v_lshlrev_b32 v23, 4, v23
    v_add_u32 v23, v23, v2
    v_lshlrev_b32 v23, 4, v23
    v_add_u32 v23, s40, v23
    s_sub_u32 s43, s16, 1
    s_lshl_b32 s43, s43, 4
    v_add_u32 v24, s43, v2
    v_mul_u32_u24 v24, 12288, v24
    v_lshlrev_b32 v25, 4, v3
    v_add_u32 v24, v24, v25
    s_lshl_b32 s43, s41, 1
    s_add_u32 s43, s43, 4194304
    v_add_u32 v24, s43, v24
    v_lshlrev_b32 v26, 6, v2
    v_lshlrev_b32 v25, 4, v3
    v_add_u32 v26, v26, v25
    s_lshl_b32 s43, s41, 6
    s_add_u32 s43, s43, 29360128
    v_add_u32 v26, s43, v26
    s_lshl_b32 s43, s16, 10
    v_add_u32 v25, s43, v26
    v_mul_u32_u24 v27, 12288, v2
    v_lshlrev_b32 v28, 4, v3
    v_add_u32 v27, v27, v28
    s_lshl_b32 s43, s41, 1
    s_add_u32 s43, s43, 104857600
    v_add_u32 v27, s43, v27
    s_lshl_b32 s43, s16, 4
    s_add_u32 s43, s43, s41
    s_lshl_b32 s43, s43, 4
    s_add_u32 s43, s43, 111149056
    v_lshlrev_b32 v28, 4, v2
    v_add_u32 v28, s43, v28
    s_waitcnt vmcnt(59)
    ds_write_b128 v194, v[32:35] offset:0
    s_waitcnt vmcnt(58)
    ds_write_b128 v194, v[36:39] offset:4608
    s_waitcnt vmcnt(57)
    ds_write_b128 v194, v[40:43] offset:9216
    s_waitcnt vmcnt(56)
    ds_write_b128 v194, v[44:47] offset:13824
    s_waitcnt vmcnt(55)
    ds_write_b128 v194, v[48:51] offset:18432
    s_waitcnt vmcnt(54)
    ds_write_b128 v194, v[52:55] offset:23040
    s_waitcnt vmcnt(53)
    ds_write_b128 v194, v[56:59] offset:27648
    s_waitcnt vmcnt(52)
    ds_write_b128 v194, v[60:63] offset:32256
    s_waitcnt vmcnt(51)
    ds_write_b128 v194, v[64:67] offset:36864
    s_waitcnt vmcnt(50)
    ds_write_b128 v194, v[68:71] offset:41472
    s_waitcnt vmcnt(49)
    ds_write_b128 v194, v[72:75] offset:46080
    s_waitcnt vmcnt(48)
    ds_write_b128 v194, v[76:79] offset:50688
    s_waitcnt vmcnt(47)
    ds_write_b128 v194, v[80:83] offset:55296
    s_waitcnt vmcnt(46)
    ds_write_b128 v194, v[84:87] offset:59904
    s_waitcnt vmcnt(45)
    ds_write_b128 v194, v[88:91] offset:64512
    s_waitcnt vmcnt(44)
    ds_write_b128 v196, v[92:95] offset:3584
    s_waitcnt vmcnt(43)
    ds_write_b128 v196, v[96:99] offset:8192
    s_waitcnt vmcnt(42)
    ds_write_b128 v196, v[100:103] offset:12800
    s_waitcnt vmcnt(41)
    ds_write_b128 v196, v[104:107] offset:17408
    s_waitcnt vmcnt(40)
    ds_write_b128 v196, v[108:111] offset:22016
    s_waitcnt lgkmcnt(0)
    s_barrier
    ds_read_b64_tr_b16 a[0:1], v195 offset:0
    ds_read_b64_tr_b16 a[2:3], v195 offset:576
    ds_read_b64_tr_b16 a[4:5], v195 offset:4608
    ds_read_b64_tr_b16 a[6:7], v195 offset:5184
    s_waitcnt lgkmcnt(4)
    ds_read_b64_tr_b16 a[8:9], v195 offset:9216
    ds_read_b64_tr_b16 a[10:11], v195 offset:9792
    ds_read_b64_tr_b16 a[12:13], v195 offset:13824
    ds_read_b64_tr_b16 a[14:15], v195 offset:14400
    s_waitcnt lgkmcnt(4)
    ds_read_b64_tr_b16 a[16:17], v195 offset:18432
    ds_read_b64_tr_b16 a[18:19], v195 offset:19008
    ds_read_b64_tr_b16 a[20:21], v195 offset:23040
    ds_read_b64_tr_b16 a[22:23], v195 offset:23616
    s_waitcnt lgkmcnt(4)
    ds_read_b64_tr_b16 a[24:25], v195 offset:27648
    ds_read_b64_tr_b16 a[26:27], v195 offset:28224
    ds_read_b64_tr_b16 a[28:29], v195 offset:32256
    ds_read_b64_tr_b16 a[30:31], v195 offset:32832
    s_waitcnt lgkmcnt(4)
    ds_read_b64_tr_b16 a[32:33], v195 offset:36864
    ds_read_b64_tr_b16 a[34:35], v195 offset:37440
    ds_read_b64_tr_b16 a[36:37], v195 offset:41472
    ds_read_b64_tr_b16 a[38:39], v195 offset:42048
    s_waitcnt lgkmcnt(4)
    ds_read_b64_tr_b16 a[40:41], v197 offset:0
    ds_read_b64_tr_b16 a[42:43], v197 offset:576
    ds_read_b64_tr_b16 a[44:45], v197 offset:4608
    ds_read_b64_tr_b16 a[46:47], v197 offset:5184
    s_waitcnt lgkmcnt(4)
    ds_read_b64_tr_b16 a[48:49], v197 offset:9216
    ds_read_b64_tr_b16 a[50:51], v197 offset:9792
    ds_read_b64_tr_b16 a[52:53], v197 offset:13824
    ds_read_b64_tr_b16 a[54:55], v197 offset:14400
    s_waitcnt lgkmcnt(4)
    ds_read_b64_tr_b16 a[56:57], v197 offset:18432
    ds_read_b64_tr_b16 a[58:59], v197 offset:19008
    ds_read_b64_tr_b16 a[60:61], v197 offset:23040
    ds_read_b64_tr_b16 a[62:63], v197 offset:23616
    s_waitcnt lgkmcnt(4)
    ds_read_b64_tr_b16 a[64:65], v197 offset:27648
    ds_read_b64_tr_b16 a[66:67], v197 offset:28224
    ds_read_b64_tr_b16 a[68:69], v197 offset:32256
    ds_read_b64_tr_b16 a[70:71], v197 offset:32832
    s_waitcnt lgkmcnt(4)
    ds_read_b64_tr_b16 a[72:73], v197 offset:36864
    ds_read_b64_tr_b16 a[74:75], v197 offset:37440
    ds_read_b64_tr_b16 a[76:77], v197 offset:41472
    ds_read_b64_tr_b16 a[78:79], v197 offset:42048
    s_waitcnt lgkmcnt(0)
    s_barrier
    s_waitcnt vmcnt(39)
    ds_write_b128 v194, v[112:115] offset:0
    s_waitcnt vmcnt(38)
    ds_write_b128 v194, v[116:119] offset:4608
    s_waitcnt vmcnt(37)
    ds_write_b128 v194, v[120:123] offset:9216
    s_waitcnt vmcnt(36)
    ds_write_b128 v194, v[124:127] offset:13824
    s_waitcnt vmcnt(35)
    ds_write_b128 v194, v[128:131] offset:18432
    s_waitcnt vmcnt(34)
    ds_write_b128 v194, v[132:135] offset:23040
    s_waitcnt vmcnt(33)
    ds_write_b128 v194, v[136:139] offset:27648
    s_waitcnt vmcnt(32)
    ds_write_b128 v194, v[140:143] offset:32256
    s_waitcnt vmcnt(31)
    ds_write_b128 v194, v[144:147] offset:36864
    s_waitcnt vmcnt(30)
    ds_write_b128 v194, v[148:151] offset:41472
    s_waitcnt vmcnt(29)
    ds_write_b128 v194, v[152:155] offset:46080
    s_waitcnt vmcnt(28)
    ds_write_b128 v194, v[156:159] offset:50688
    s_waitcnt vmcnt(27)
    ds_write_b128 v194, v[160:163] offset:55296
    s_waitcnt vmcnt(26)
    ds_write_b128 v194, v[164:167] offset:59904
    s_waitcnt vmcnt(25)
    ds_write_b128 v194, v[168:171] offset:64512
    s_waitcnt vmcnt(24)
    ds_write_b128 v196, v[172:175] offset:3584
    s_waitcnt vmcnt(23)
    ds_write_b128 v196, v[176:179] offset:8192
    s_waitcnt vmcnt(22)
    ds_write_b128 v196, v[180:183] offset:12800
    s_waitcnt vmcnt(21)
    ds_write_b128 v196, v[184:187] offset:17408
    s_waitcnt vmcnt(20)
    ds_write_b128 v196, v[188:191] offset:22016
    s_waitcnt lgkmcnt(0)
    s_cmp_ge_u32 s18, 20
    s_cbranch_scc1 L_nw1_15
    s_load_dwordx2 s[42:43], s[0:1], 40
    s_waitcnt lgkmcnt(0)
    s_mov_b32 s8, s42
    s_and_b32 s9, s43, 0xffff
    s_mov_b32 s10, 7864320
    s_mov_b32 s11, 0x20000
    s_mov_b32 s44, 0
    buffer_load_dwordx4 v[32:35], v198, s[8:11], s44 offen
    s_add_u32 s44, s44, 81920
    buffer_load_dwordx4 v[36:39], v198, s[8:11], s44 offen
    s_add_u32 s44, s44, 81920
    buffer_load_dwordx4 v[40:43], v198, s[8:11], s44 offen
    s_add_u32 s44, s44, 81920
    buffer_load_dwordx4 v[44:47], v198, s[8:11], s44 offen
    s_add_u32 s44, s44, 81920
    buffer_load_dwordx4 v[48:51], v198, s[8:11], s44 offen
    s_add_u32 s44, s44, 81920
    buffer_load_dwordx4 v[52:55], v198, s[8:11], s44 offen
    s_add_u32 s44, s44, 81920
    buffer_load_dwordx4 v[56:59], v198, s[8:11], s44 offen
    s_add_u32 s44, s44, 81920
    buffer_load_dwordx4 v[60:63], v198, s[8:11], s44 offen
    s_add_u32 s44, s44, 81920
    buffer_load_dwordx4 v[64:67], v198, s[8:11], s44 offen
    s_add_u32 s44, s44, 81920
    buffer_load_dwordx4 v[68:71], v198, s[8:11], s44 offen
    s_add_u32 s44, s44, 81920
    buffer_load_dwordx4 v[72:75], v198, s[8:11], s44 offen
    s_add_u32 s44, s44, 81920
    buffer_load_dwordx4 v[76:79], v198, s[8:11], s44 offen
    s_add_u32 s44, s44, 81920
    buffer_load_dwordx4 v[80:83], v198, s[8:11], s44 offen
    s_add_u32 s44, s44, 81920
    buffer_load_dwordx4 v[84:87], v198, s[8:11], s44 offen
    s_add_u32 s44, s44, 81920
    buffer_load_dwordx4 v[88:91], v198, s[8:11], s44 offen
    s_add_u32 s44, s44, 81920
    buffer_load_dwordx4 v[92:95], v198, s[8:11], s44 offen
    s_add_u32 s44, s44, 81920
    buffer_load_dwordx4 v[96:99], v198, s[8:11], s44 offen
    s_add_u32 s44, s44, 81920
    buffer_load_dwordx4 v[100:103], v198, s[8:11], s44 offen
    s_add_u32 s44, s44, 81920
    buffer_load_dwordx4 v[104:107], v198, s[8:11], s44 offen
    s_add_u32 s44, s44, 81920
    buffer_load_dwordx4 v[108:111], v198, s[8:11], s44 offen
    s_add_u32 s44, s44, 81920
    buffer_load_dwordx4 v[112:115], v198, s[8:11], s44 offen
    s_add_u32 s44, s44, 81920
    buffer_load_dwordx4 v[116:119], v198, s[8:11], s44 offen
    s_add_u32 s44, s44, 81920
    buffer_load_dwordx4 v[120:123], v198, s[8:11], s44 offen
    s_add_u32 s44, s44, 81920
    buffer_load_dwordx4 v[124:127], v198, s[8:11], s44 offen
L_nw1_15:
    s_barrier
    ds_read_b64_tr_b16 a[80:81], v195 offset:0
    ds_read_b64_tr_b16 a[82:83], v195 offset:576
    ds_read_b64_tr_b16 a[84:85], v195 offset:4608
    ds_read_b64_tr_b16 a[86:87], v195 offset:5184
    s_waitcnt lgkmcnt(4)
    ds_read_b64_tr_b16 a[88:89], v195 offset:9216
    ds_read_b64_tr_b16 a[90:91], v195 offset:9792
    ds_read_b64_tr_b16 a[92:93], v195 offset:13824
    ds_read_b64_tr_b16 a[94:95], v195 offset:14400
    s_waitcnt lgkmcnt(4)
    ds_read_b64_tr_b16 a[96:97], v195 offset:18432
    ds_read_b64_tr_b16 a[98:99], v195 offset:19008
    ds_read_b64_tr_b16 a[100:101], v195 offset:23040
    ds_read_b64_tr_b16 a[102:103], v195 offset:23616
    s_waitcnt lgkmcnt(4)
    ds_read_b64_tr_b16 a[104:105], v195 offset:27648
    ds_read_b64_tr_b16 a[106:107], v195 offset:28224
    ds_read_b64_tr_b16 a[108:109], v195 offset:32256
    ds_read_b64_tr_b16 a[110:111], v195 offset:32832
    s_waitcnt lgkmcnt(4)
    ds_read_b64_tr_b16 a[112:113], v195 offset:36864
    ds_read_b64_tr_b16 a[114:115], v195 offset:37440
    ds_read_b64_tr_b16 a[116:117], v195 offset:41472
    ds_read_b64_tr_b16 a[118:119], v195 offset:42048
    s_waitcnt lgkmcnt(4)
    ds_read_b64_tr_b16 a[120:121], v197 offset:0
    ds_read_b64_tr_b16 a[122:123], v197 offset:576
    ds_read_b64_tr_b16 a[124:125], v197 offset:4608
    ds_read_b64_tr_b16 a[126:127], v197 offset:5184
    s_waitcnt lgkmcnt(4)
    ds_read_b64_tr_b16 a[128:129], v197 offset:9216
    ds_read_b64_tr_b16 a[130:131], v197 offset:9792
    ds_read_b64_tr_b16 a[132:133], v197 offset:13824
    ds_read_b64_tr_b16 a[134:135], v197 offset:14400
    s_waitcnt lgkmcnt(4)
    ds_read_b64_tr_b16 a[136:137], v197 offset:18432
    ds_read_b64_tr_b16 a[138:139], v197 offset:19008
    ds_read_b64_tr_b16 a[140:141], v197 offset:23040
    ds_read_b64_tr_b16 a[142:143], v197 offset:23616
    s_waitcnt lgkmcnt(4)
    ds_read_b64_tr_b16 a[144:145], v197 offset:27648
    ds_read_b64_tr_b16 a[146:147], v197 offset:28224
    ds_read_b64_tr_b16 a[148:149], v197 offset:32256
    ds_read_b64_tr_b16 a[150:151], v197 offset:32832
    s_waitcnt lgkmcnt(4)
    ds_read_b64_tr_b16 a[152:153], v197 offset:36864
    ds_read_b64_tr_b16 a[154:155], v197 offset:37440
    ds_read_b64_tr_b16 a[156:157], v197 offset:41472
    ds_read_b64_tr_b16 a[158:159], v197 offset:42048
    s_waitcnt lgkmcnt(0)
    s_barrier
    s_cmp_ge_u32 s18, 20
    s_cbranch_scc1 L_vw_16
    s_waitcnt vmcnt(24)
    s_branch L_vw_17
L_vw_16:
    s_waitcnt vmcnt(0)
L_vw_17:
    ds_write_b128 v194, a[160:163] offset:0
    ds_write_b128 v194, a[164:167] offset:4608
    ds_write_b128 v194, a[168:171] offset:9216
    ds_write_b128 v194, a[172:175] offset:13824
    ds_write_b128 v194, a[176:179] offset:18432
    ds_write_b128 v194, a[180:183] offset:23040
    ds_write_b128 v194, a[184:187] offset:27648
    ds_write_b128 v194, a[188:191] offset:32256
    ds_write_b128 v194, a[192:195] offset:36864
    ds_write_b128 v194, a[196:199] offset:41472
    ds_write_b128 v194, a[200:203] offset:46080
    ds_write_b128 v194, a[204:207] offset:50688
    ds_write_b128 v194, a[208:211] offset:55296
    ds_write_b128 v194, a[212:215] offset:59904
    ds_write_b128 v194, a[216:219] offset:64512
    ds_write_b128 v196, a[220:223] offset:3584
    ds_write_b128 v196, a[224:227] offset:8192
    ds_write_b128 v196, a[228:231] offset:12800
    ds_write_b128 v196, a[232:235] offset:17408
    ds_write_b128 v196, a[236:239] offset:22016
    s_waitcnt lgkmcnt(0)
    s_barrier
    ds_read_b64_tr_b16 a[160:161], v195 offset:0
    ds_read_b64_tr_b16 a[162:163], v195 offset:576
    ds_read_b64_tr_b16 a[164:165], v195 offset:4608
    ds_read_b64_tr_b16 a[166:167], v195 offset:5184
    s_waitcnt lgkmcnt(4)
    ds_read_b64_tr_b16 a[168:169], v195 offset:9216
    ds_read_b64_tr_b16 a[170:171], v195 offset:9792
    ds_read_b64_tr_b16 a[172:173], v195 offset:13824
    ds_read_b64_tr_b16 a[174:175], v195 offset:14400
    s_waitcnt lgkmcnt(4)
    ds_read_b64_tr_b16 a[176:177], v195 offset:18432
    ds_read_b64_tr_b16 a[178:179], v195 offset:19008
    ds_read_b64_tr_b16 a[180:181], v195 offset:23040
    ds_read_b64_tr_b16 a[182:183], v195 offset:23616
    s_waitcnt lgkmcnt(4)
    ds_read_b64_tr_b16 a[184:185], v195 offset:27648
    ds_read_b64_tr_b16 a[186:187], v195 offset:28224
    ds_read_b64_tr_b16 a[188:189], v195 offset:32256
    ds_read_b64_tr_b16 a[190:191], v195 offset:32832
    s_waitcnt lgkmcnt(4)
    ds_read_b64_tr_b16 a[192:193], v195 offset:36864
    ds_read_b64_tr_b16 a[194:195], v195 offset:37440
    ds_read_b64_tr_b16 a[196:197], v195 offset:41472
    ds_read_b64_tr_b16 a[198:199], v195 offset:42048
    s_waitcnt lgkmcnt(4)
    ds_read_b64_tr_b16 a[200:201], v197 offset:0
    ds_read_b64_tr_b16 a[202:203], v197 offset:576
    ds_read_b64_tr_b16 a[204:205], v197 offset:4608
    ds_read_b64_tr_b16 a[206:207], v197 offset:5184
    s_waitcnt lgkmcnt(4)
    ds_read_b64_tr_b16 a[208:209], v197 offset:9216
    ds_read_b64_tr_b16 a[210:211], v197 offset:9792
    ds_read_b64_tr_b16 a[212:213], v197 offset:13824
    ds_read_b64_tr_b16 a[214:215], v197 offset:14400
    s_waitcnt lgkmcnt(4)
    ds_read_b64_tr_b16 a[216:217], v197 offset:18432
    ds_read_b64_tr_b16 a[218:219], v197 offset:19008
    ds_read_b64_tr_b16 a[220:221], v197 offset:23040
    ds_read_b64_tr_b16 a[222:223], v197 offset:23616
    s_waitcnt lgkmcnt(4)
    ds_read_b64_tr_b16 a[224:225], v197 offset:27648
    ds_read_b64_tr_b16 a[226:227], v197 offset:28224
    ds_read_b64_tr_b16 a[228:229], v197 offset:32256
    ds_read_b64_tr_b16 a[230:231], v197 offset:32832
    s_waitcnt lgkmcnt(4)
    ds_read_b64_tr_b16 a[232:233], v197 offset:36864
    ds_read_b64_tr_b16 a[234:235], v197 offset:37440
    ds_read_b64_tr_b16 a[236:237], v197 offset:41472
    ds_read_b64_tr_b16 a[238:239], v197 offset:42048
    s_waitcnt lgkmcnt(0)
    s_barrier
    s_cmp_ge_u32 s18, 20
    s_cbranch_scc1 L_nowo_18
    v_add_u32 v196, 61440, v199
    s_waitcnt vmcnt(23)
    ds_write_b128 v199, v[32:35] offset:0
    s_waitcnt vmcnt(22)
    ds_write_b128 v199, v[36:39] offset:5120
    s_waitcnt vmcnt(21)
    ds_write_b128 v199, v[40:43] offset:10240
    s_waitcnt vmcnt(20)
    ds_write_b128 v199, v[44:47] offset:15360
    s_waitcnt vmcnt(19)
    ds_write_b128 v199, v[48:51] offset:20480
    s_waitcnt vmcnt(18)
    ds_write_b128 v199, v[52:55] offset:25600
    s_waitcnt vmcnt(17)
    ds_write_b128 v199, v[56:59] offset:30720
    s_waitcnt vmcnt(16)
    ds_write_b128 v199, v[60:63] offset:35840
    s_waitcnt vmcnt(15)
    ds_write_b128 v199, v[64:67] offset:40960
    s_waitcnt vmcnt(14)
    ds_write_b128 v199, v[68:71] offset:46080
    s_waitcnt vmcnt(13)
    ds_write_b128 v199, v[72:75] offset:51200
    s_waitcnt vmcnt(12)
    ds_write_b128 v199, v[76:79] offset:56320
    s_waitcnt vmcnt(11)
    ds_write_b128 v196, v[80:83] offset:0
    s_waitcnt vmcnt(10)
    ds_write_b128 v196, v[84:87] offset:5120
    s_waitcnt vmcnt(9)
    ds_write_b128 v196, v[88:91] offset:10240
    s_waitcnt vmcnt(8)
    ds_write_b128 v196, v[92:95] offset:15360
    s_waitcnt vmcnt(7)
    ds_write_b128 v196, v[96:99] offset:20480
    s_waitcnt vmcnt(6)
    ds_write_b128 v196, v[100:103] offset:25600
    s_waitcnt vmcnt(5)
    ds_write_b128 v196, v[104:107] offset:30720
    s_waitcnt vmcnt(4)
    ds_write_b128 v196, v[108:111] offset:35840
    s_waitcnt vmcnt(3)
    ds_write_b128 v196, v[112:115] offset:40960
    s_waitcnt vmcnt(2)
    ds_write_b128 v196, v[116:119] offset:46080
    s_waitcnt vmcnt(1)
    ds_write_b128 v196, v[120:123] offset:51200
    s_waitcnt vmcnt(0)
    ds_write_b128 v196, v[124:127] offset:56320
    s_waitcnt lgkmcnt(0)
L_nowo_18:
    s_barrier
    s_cmp_ge_u32 s18, 20
    s_cbranch_scc1 L_nowo_19
    v_lshrrev_b32 v128, 1, v3
    v_lshlrev_b32 v128, 4, v128
    v_and_b32 v129, 1, v3
    v_lshlrev_b32 v129, 2, v129
    v_add_u32 v128, v128, v129
    v_lshrrev_b32 v129, 2, v2
    v_add_u32 v128, v128, v129
    s_mul_i32 s40, s16, 384
    v_add_u32 v128, s40, v128
    v_mul_u32_u24 v128, 80, v128
    v_and_b32 v129, 3, v1
    v_lshlrev_b32 v129, 3, v129
    v_add_u32 v128, v128, v129
    v_add_u32 v128, 24576, v128
    ds_read_b64_tr_b16 v[32:33], v128 offset:0
    ds_read_b64_tr_b16 v[34:35], v128 offset:640
    s_waitcnt lgkmcnt(0)
    v_mov_b32 v160, v32
    v_mov_b32 v161, v34
    v_mov_b32 v162, v33
    v_mov_b32 v163, v35
    ds_read_b64_tr_b16 v[32:33], v128 offset:2560
    ds_read_b64_tr_b16 v[34:35], v128 offset:3200
    s_waitcnt lgkmcnt(0)
    v_mov_b32 v164, v32
    v_mov_b32 v165, v34
    v_mov_b32 v166, v33
    v_mov_b32 v167, v35
    ds_read_b64_tr_b16 v[32:33], v128 offset:32
    ds_read_b64_tr_b16 v[34:35], v128 offset:672
    s_waitcnt lgkmcnt(0)
    v_mov_b32 v168, v32
    v_mov_b32 v169, v34
    v_mov_b32 v170, v33
    v_mov_b32 v171, v35
    ds_read_b64_tr_b16 v[32:33], v128 offset:2592
    ds_read_b64_tr_b16 v[34:35], v128 offset:3232
    s_waitcnt lgkmcnt(0)
    v_mov_b32 v172, v32
    v_mov_b32 v173, v34
    v_mov_b32 v174, v33
    v_mov_b32 v175, v35
    ds_read_b64_tr_b16 v[32:33], v128 offset:5120
    ds_read_b64_tr_b16 v[34:35], v128 offset:5760
    s_waitcnt lgkmcnt(0)
    v_mov_b32 v176, v32
    v_mov_b32 v177, v34
    v_mov_b32 v178, v33
    v_mov_b32 v179, v35
    ds_read_b64_tr_b16 v[32:33], v128 offset:7680
    ds_read_b64_tr_b16 v[34:35], v128 offset:8320
    s_waitcnt lgkmcnt(0)
    v_mov_b32 v180, v32
    v_mov_b32 v181, v34
    v_mov_b32 v182, v33
    v_mov_b32 v183, v35
    ds_read_b64_tr_b16 v[32:33], v128 offset:5152
    ds_read_b64_tr_b16 v[34:35], v128 offset:5792
    s_waitcnt lgkmcnt(0)
    v_mov_b32 v184, v32
    v_mov_b32 v185, v34
    v_mov_b32 v186, v33
    v_mov_b32 v187, v35
    ds_read_b64_tr_b16 v[32:33], v128 offset:7712
    ds_read_b64_tr_b16 v[34:35], v128 offset:8352
    s_waitcnt lgkmcnt(0)
    v_mov_b32 v188, v32
    v_mov_b32 v189, v34
    v_mov_b32 v190, v33
    v_mov_b32 v191, v35
    ds_read_b64_tr_b16 v[32:33], v128 offset:10240
    ds_read_b64_tr_b16 v[34:35], v128 offset:10880
    s_waitcnt lgkmcnt(0)
    v_mov_b32 v192, v32
    v_mov_b32 v193, v34
    v_mov_b32 v194, v33
    v_mov_b32 v195, v35
    ds_read_b64_tr_b16 v[32:33], v128 offset:12800
    ds_read_b64_tr_b16 v[34:35], v128 offset:13440
    s_waitcnt lgkmcnt(0)
    v_mov_b32 v196, v32
    v_mov_b32 v197, v34
    v_mov_b32 v198, v33
    v_mov_b32 v199, v35
    ds_read_b64_tr_b16 v[32:33], v128 offset:10272
    ds_read_b64_tr_b16 v[34:35], v128 offset:10912
    s_waitcnt lgkmcnt(0)
    v_mov_b32 v200, v32
    v_mov_b32 v201, v34
    v_mov_b32 v202, v33
    v_mov_b32 v203, v35
    ds_read_b64_tr_b16 v[32:33], v128 offset:12832
    ds_read_b64_tr_b16 v[34:35], v128 offset:13472
    s_waitcnt lgkmcnt(0)
    v_mov_b32 v204, v32
    v_mov_b32 v205, v34
    v_mov_b32 v206, v33
    v_mov_b32 v207, v35
    ds_read_b64_tr_b16 v[32:33], v128 offset:15360
    ds_read_b64_tr_b16 v[34:35], v128 offset:16000
    s_waitcnt lgkmcnt(0)
    v_mov_b32 v208, v32
    v_mov_b32 v209, v34
    v_mov_b32 v210, v33
    v_mov_b32 v211, v35
    ds_read_b64_tr_b16 v[32:33], v128 offset:17920
    ds_read_b64_tr_b16 v[34:35], v128 offset:18560
    s_waitcnt lgkmcnt(0)
    v_mov_b32 v212, v32
    v_mov_b32 v213, v34
    v_mov_b32 v214, v33
    v_mov_b32 v215, v35
    ds_read_b64_tr_b16 v[32:33], v128 offset:15392
    ds_read_b64_tr_b16 v[34:35], v128 offset:16032
    s_waitcnt lgkmcnt(0)
    v_mov_b32 v216, v32
    v_mov_b32 v217, v34
    v_mov_b32 v218, v33
    v_mov_b32 v219, v35
    ds_read_b64_tr_b16 v[32:33], v128 offset:17952
    ds_read_b64_tr_b16 v[34:35], v128 offset:18592
    s_waitcnt lgkmcnt(0)
    v_mov_b32 v220, v32
    v_mov_b32 v221, v34
    v_mov_b32 v222, v33
    v_mov_b32 v223, v35
    ds_read_b64_tr_b16 v[32:33], v128 offset:20480
    ds_read_b64_tr_b16 v[34:35], v128 offset:21120
    s_waitcnt lgkmcnt(0)
    v_mov_b32 v224, v32
    v_mov_b32 v225, v34
    v_mov_b32 v226, v33
    v_mov_b32 v227, v35
    ds_read_b64_tr_b16 v[32:33], v128 offset:23040
    ds_read_b64_tr_b16 v[34:35], v128 offset:23680
    s_waitcnt lgkmcnt(0)
    v_mov_b32 v228, v32
    v_mov_b32 v229, v34
    v_mov_b32 v230, v33
    v_mov_b32 v231, v35
    ds_read_b64_tr_b16 v[32:33], v128 offset:20512
    ds_read_b64_tr_b16 v[34:35], v128 offset:21152
    s_waitcnt lgkmcnt(0)
    v_mov_b32 v232, v32
    v_mov_b32 v233, v34
    v_mov_b32 v234, v33
    v_mov_b32 v235, v35
    ds_read_b64_tr_b16 v[32:33], v128 offset:23072
    ds_read_b64_tr_b16 v[34:35], v128 offset:23712
    s_waitcnt lgkmcnt(0)
    v_mov_b32 v236, v32
    v_mov_b32 v237, v34
    v_mov_b32 v238, v33
    v_mov_b32 v239, v35
    ds_read_b64_tr_b16 v[32:33], v128 offset:25600
    ds_read_b64_tr_b16 v[34:35], v128 offset:26240
    s_waitcnt lgkmcnt(0)
    v_mov_b32 v240, v32
    v_mov_b32 v241, v34
    v_mov_b32 v242, v33
    v_mov_b32 v243, v35
    ds_read_b64_tr_b16 v[32:33], v128 offset:28160
    ds_read_b64_tr_b16 v[34:35], v128 offset:28800
    s_waitcnt lgkmcnt(0)
    v_mov_b32 v244, v32
    v_mov_b32 v245, v34
    v_mov_b32 v246, v33
    v_mov_b32 v247, v35
    ds_read_b64_tr_b16 v[32:33], v128 offset:25632
    ds_read_b64_tr_b16 v[34:35], v128 offset:26272
    s_waitcnt lgkmcnt(0)
    v_mov_b32 v248, v32
    v_mov_b32 v249, v34
    v_mov_b32 v250, v33
    v_mov_b32 v251, v35
    ds_read_b64_tr_b16 v[32:33], v128 offset:28192
    ds_read_b64_tr_b16 v[34:35], v128 offset:28832
    s_waitcnt lgkmcnt(0)
    v_mov_b32 v252, v32
    v_mov_b32 v253, v34
    v_mov_b32 v254, v33
    v_mov_b32 v255, v35
L_nowo_19:
    v_mov_b32 v29, 0x4444
    v_mov_b32 v30, 0xeeee
    v_cmp_gt_u32 vcc, 8, v2
    s_nop 1
    v_cndmask_b32 v29, v30, v29, vcc
    v_mov_b32 v30, 1
    v_mov_b32 v140, 0x3f803f80
    v_mov_b32 v141, 0x3f803f80
    v_mov_b32 v142, 0x3f803f80
    v_mov_b32 v143, 0x3f803f80
    v_mov_b32 v144, 0x3f803f80
    v_cmp_gt_u32 vcc, 2, v3
    s_nop 1
    v_cndmask_b32 v144, 0, v144, vcc
    v_mov_b32 v145, v144
    v_mov_b32 v150, -1
    v_mov_b32 v151, -1
    v_mov_b32 v152, -1
    v_mov_b32 v153, -1
    v_mov_b32 v104, 0xf149f2ca
    v_mov_b32 v105, 0xf149f2ca
    v_mov_b32 v106, 0
    v_mov_b32 v107, 0
    v_mov_b32 v108, 0
    v_mov_b32 v109, 0
    s_mov_b32 s33, 0x3dd53b95
    s_mov_b32 s39, -2
    s_cmp_eq_u32 s16, 0
    s_cselect_b32 s34, 0xff00ff, 0xff00ff
    s_cselect_b32 s35, 0x0, 0xff00ff
    s_mov_b32 s21, 0
    s_mov_b32 s22, 0
    s_mov_b32 s23, 36864
    s_mov_b32 s24, 0
    s_mov_b32 s25, 24576
    s_mov_b32 s26, 0
    s_mov_b32 s27, 16384
    s_mov_b32 s28, 0
    s_mov_b32 s29, 0
    s_mov_b32 s30, 0
    s_mov_b32 s31, 0
    s_mov_b32 s32, 0
    v_add_u32 v110, 0, v0
    v_mul_u32_u24 v111, 52429, v110
    v_lshrrev_b32 v111, 24, v111
    v_mul_u32_u24 v112, 320, v111
    v_sub_u32 v110, v110, v112
    v_lshlrev_b32 v110, 1, v110
    v_lshrrev_b32 v112, 4, v110
    v_and_b32 v112, 1, v112
    v_lshlrev_b32 v112, 3, v112
    v_xor_b32 v110, v110, v112
    v_lshlrev_b32 v110, 4, v110
    v_lshlrev_b32 v111, 1, v111
    v_add_u32 v110, v110, v111
    v_accvgpr_read_b32 v112, a240
    s_nop 0
    ds_write_b16 v110, v112 offset:0
    ds_write_b16_d16_hi v110, v112 offset:16
    v_add_u32 v110, 256, v0
    v_mul_u32_u24 v111, 52429, v110
    v_lshrrev_b32 v111, 24, v111
    v_mul_u32_u24 v112, 320, v111
    v_sub_u32 v110, v110, v112
    v_lshlrev_b32 v110, 1, v110
    v_lshrrev_b32 v112, 4, v110
    v_and_b32 v112, 1, v112
    v_lshlrev_b32 v112, 3, v112
    v_xor_b32 v110, v110, v112
    v_lshlrev_b32 v110, 4, v110
    v_lshlrev_b32 v111, 1, v111
    v_add_u32 v110, v110, v111
    v_accvgpr_read_b32 v112, a241
    s_nop 0
    ds_write_b16 v110, v112 offset:0
    ds_write_b16_d16_hi v110, v112 offset:16
    v_add_u32 v110, 512, v0
    v_mul_u32_u24 v111, 52429, v110
    v_lshrrev_b32 v111, 24, v111
    v_mul_u32_u24 v112, 320, v111
    v_sub_u32 v110, v110, v112
    v_lshlrev_b32 v110, 1, v110
    v_lshrrev_b32 v112, 4, v110
    v_and_b32 v112, 1, v112
    v_lshlrev_b32 v112, 3, v112
    v_xor_b32 v110, v110, v112
    v_lshlrev_b32 v110, 4, v110
    v_lshlrev_b32 v111, 1, v111
    v_add_u32 v110, v110, v111
    v_accvgpr_read_b32 v112, a242
    s_nop 0
    ds_write_b16 v110, v112 offset:0
    ds_write_b16_d16_hi v110, v112 offset:16
    v_add_u32 v110, 768, v0
    v_mul_u32_u24 v111, 52429, v110
    v_lshrrev_b32 v111, 24, v111
    v_mul_u32_u24 v112, 320, v111
    v_sub_u32 v110, v110, v112
    v_lshlrev_b32 v110, 1, v110
    v_lshrrev_b32 v112, 4, v110
    v_and_b32 v112, 1, v112
    v_lshlrev_b32 v112, 3, v112
    v_xor_b32 v110, v110, v112
    v_lshlrev_b32 v110, 4, v110
    v_lshlrev_b32 v111, 1, v111
    v_add_u32 v110, v110, v111
    v_accvgpr_read_b32 v112, a243
    s_nop 0
    ds_write_b16 v110, v112 offset:0
    ds_write_b16_d16_hi v110, v112 offset:16
    v_add_u32 v110, 1024, v0
    v_mul_u32_u24 v111, 52429, v110
    v_lshrrev_b32 v111, 24, v111
    v_mul_u32_u24 v112, 320, v111
    v_sub_u32 v110, v110, v112
    v_lshlrev_b32 v110, 1, v110
    v_lshrrev_b32 v112, 4, v110
    v_and_b32 v112, 1, v112
    v_lshlrev_b32 v112, 3, v112
    v_xor_b32 v110, v110, v112
    v_lshlrev_b32 v110, 4, v110
    v_lshlrev_b32 v111, 1, v111
    v_add_u32 v110, v110, v111
    v_accvgpr_read_b32 v112, a244
    s_nop 0
    ds_write_b16 v110, v112 offset:0
    ds_write_b16_d16_hi v110, v112 offset:16
    v_add_u32 v110, 1280, v0
    v_mul_u32_u24 v111, 52429, v110
    v_lshrrev_b32 v111, 24, v111
    v_mul_u32_u24 v112, 320, v111
    v_sub_u32 v110, v110, v112
    v_lshlrev_b32 v110, 1, v110
    v_lshrrev_b32 v112, 4, v110
    v_and_b32 v112, 1, v112
    v_lshlrev_b32 v112, 3, v112
    v_xor_b32 v110, v110, v112
    v_lshlrev_b32 v110, 4, v110
    v_lshlrev_b32 v111, 1, v111
    v_add_u32 v110, v110, v111
    v_accvgpr_read_b32 v112, a245
    s_nop 0
    ds_write_b16 v110, v112 offset:0
    ds_write_b16_d16_hi v110, v112 offset:16
    v_add_u32 v110, 1536, v0
    v_mul_u32_u24 v111, 52429, v110
    v_lshrrev_b32 v111, 24, v111
    v_mul_u32_u24 v112, 320, v111
    v_sub_u32 v110, v110, v112
    v_lshlrev_b32 v110, 1, v110
    v_lshrrev_b32 v112, 4, v110
    v_and_b32 v112, 1, v112
    v_lshlrev_b32 v112, 3, v112
    v_xor_b32 v110, v110, v112
    v_lshlrev_b32 v110, 4, v110
    v_lshlrev_b32 v111, 1, v111
    v_add_u32 v110, v110, v111
    v_accvgpr_read_b32 v112, a246
    s_nop 0
    ds_write_b16 v110, v112 offset:0
    ds_write_b16_d16_hi v110, v112 offset:16
    v_add_u32 v110, 1792, v0
    v_mul_u32_u24 v111, 52429, v110
    v_lshrrev_b32 v111, 24, v111
    v_mul_u32_u24 v112, 320, v111
    v_sub_u32 v110, v110, v112
    v_lshlrev_b32 v110, 1, v110
    v_lshrrev_b32 v112, 4, v110
    v_and_b32 v112, 1, v112
    v_lshlrev_b32 v112, 3, v112
    v_xor_b32 v110, v110, v112
    v_lshlrev_b32 v110, 4, v110
    v_lshlrev_b32 v111, 1, v111
    v_add_u32 v110, v110, v111
    v_accvgpr_read_b32 v112, a247
    s_nop 0
    ds_write_b16 v110, v112 offset:0
    ds_write_b16_d16_hi v110, v112 offset:16
    v_add_u32 v110, 2048, v0
    v_mul_u32_u24 v111, 52429, v110
    v_lshrrev_b32 v111, 24, v111
    v_mul_u32_u24 v112, 320, v111
    v_sub_u32 v110, v110, v112
    v_lshlrev_b32 v110, 1, v110
    v_lshrrev_b32 v112, 4, v110
    v_and_b32 v112, 1, v112
    v_lshlrev_b32 v112, 3, v112
    v_xor_b32 v110, v110, v112
    v_lshlrev_b32 v110, 4, v110
    v_lshlrev_b32 v111, 1, v111
    v_add_u32 v110, v110, v111
    v_accvgpr_read_b32 v112, a248
    s_nop 0
    ds_write_b16 v110, v112 offset:0
    ds_write_b16_d16_hi v110, v112 offset:16
    v_add_u32 v110, 2304, v0
    v_mul_u32_u24 v111, 52429, v110
    v_lshrrev_b32 v111, 24, v111
    v_mul_u32_u24 v112, 320, v111
    v_sub_u32 v110, v110, v112
    v_lshlrev_b32 v110, 1, v110
    v_lshrrev_b32 v112, 4, v110
    v_and_b32 v112, 1, v112
    v_lshlrev_b32 v112, 3, v112
    v_xor_b32 v110, v110, v112
    v_lshlrev_b32 v110, 4, v110
    v_lshlrev_b32 v111, 1, v111
    v_add_u32 v110, v110, v111
    v_accvgpr_read_b32 v112, a249
    s_nop 0
    ds_write_b16 v110, v112 offset:0
    ds_write_b16_d16_hi v110, v112 offset:16
    v_lshlrev_b32 v110, 2, v1
    v_mov_b32 v111, 64
    v_mov_b32 v112, 72
    v_cmp_eq_u32 vcc, 2, v1
    s_nop 1
    v_cndmask_b32 v110, v111, v112, vcc
    v_mov_b32 v112, 76
    v_cmp_eq_u32 vcc, 1, v1
    s_nop 1
    v_cndmask_b32 v110, v110, v112, vcc
    v_mov_b32 v111, 1
    v_mov_b32 v112, 96
    v_cmp_eq_u32 vcc, 2, v1
    s_nop 1
    v_cndmask_b32 v111, v111, v112, vcc
    s_mov_b32 s44, 0
    s_mov_b64 exec, 7
L_cp_20:
    buffer_load_dword v112, v110, s[12:15], 0 offen sc1
    s_waitcnt vmcnt(0)
    v_cmp_gt_u32 vcc, v111, v112
    s_cbranch_vccz L_co_21
    s_sleep 4
    s_add_u32 s44, s44, 1
    s_cmp_lt_u32 s44, 4194304
    s_cbranch_scc1 L_cp_20
L_co_21:
    s_nop 0
    v_readfirstlane_b32 s45, v112
    s_mov_b64 exec, -1
    s_nop 2
    s_and_b32 s45, s45, 2
    s_lshl_b32 s45, s45, 12
    v_add_u32 v21, s45, v21
    v_add_u32 v22, s45, v22
    s_lshr_b32 s43, s41, 8
    s_lshl_b32 s43, s43, 7
    s_add_u32 s43, s43, 2097152
    v_mov_b32 v31, s43
    v_add_u32 v155, 3072, v31
    v_cmp_eq_u32 vcc, 1, v1
    s_nop 1
    v_cndmask_b32 v31, v31, v155, vcc
    s_mul_i32 s43, s17, 24
    s_add_u32 s43, s43, s18
    s_lshl_b32 s43, s43, 7
    s_add_u32 s43, s43, 2107904
    v_mov_b32 v155, s43
    s_mov_b32 s56, 0
    s_mov_b32 s57, 1
    s_cmp_ge_u32 s56, s57
    s_cbranch_scc1 L_wtd_23
    s_mov_b32 s38, 0
    s_mov_b32 exec_lo, 0x3
    s_mov_b32 exec_hi, 0x0
L_wt_22:
    buffer_load_dword v113, v31, s[4:7], 0 offen sc1
    s_waitcnt vmcnt(0)
    v_cmp_gt_u32 vcc, s57, v113
    s_cbranch_vccz L_wtk_24
    s_sleep 2
    s_add_u32 s38, s38, 1
    s_cmp_lt_u32 s38, 4194304
    s_cbranch_scc1 L_wt_22
    s_mov_b64 exec, -1
    s_branch L_end_1
L_wtk_24:
    s_nop 0
    v_readlane_b32 s56, v113, 0
    v_readlane_b32 s38, v113, 1
    s_nop 3
    s_min_u32 s56, s56, s38
    s_mov_b64 exec, -1
L_wtd_23:
    s_cmp_eq_u32 s16, 0
    s_cbranch_scc1 L_k0_25
    s_cmp_eq_u32 s16, 3
    s_cbranch_scc1 L_k0_25
    buffer_load_dwordx4 v[92:95], v24, s[4:7], s29 offen sc1
    buffer_load_dwordx4 v[96:99], v24, s[4:7], s29 offen offset:64 sc1
L_k0_25:
    buffer_load_dwordx4 v[122:125], v25, s[4:7], s30 offen sc1
    buffer_load_dwordx4 v[126:129], v26, s[4:7], s30 offen sc1
    s_waitcnt vmcnt(0)
    v_lshlrev_b32 v154, 4, v1
    v_add_u32 v154, 22528, v154
    s_cmp_lg_u32 s16, 3
    s_cbranch_scc1 L_v0_26
    ds_write_b128 v154, v[126:129]
L_v0_26:
    v_mov_b32 v72, 0
    v_mov_b32 v73, 0
    v_mov_b32 v74, 0
    v_mov_b32 v75, 0
    v_mov_b32 v76, 0
    v_mov_b32 v77, 0
    v_mov_b32 v78, 0
    v_mov_b32 v79, 0
    v_mov_b32 v80, 0
    v_mov_b32 v81, 0
    v_mov_b32 v82, 0
    v_mov_b32 v83, 0
    s_add_u32 s29, s29, 393216
    s_add_u32 s30, s30, 393216
    s_waitcnt lgkmcnt(0)
    s_barrier
    v_lshlrev_b32 v2, 4, v1
    s_lshl_b32 s43, s16, 10
    s_add_u32 s43, s43, 0
    v_add_u32 v2, s43, v2
    s_mov_b32 s58, 1
    s_mov_b32 s46, 0xff
    s_mov_b32 s47, 0xff
    s_mov_b32 s48, 0xfffff
    s_mov_b32 s49, 0xfffff
    s_mov_b32 s50, 0xffff
    s_mov_b32 s51, 0xffff
    s_mov_b32 s52, 0xff00ff
    s_mov_b32 s53, 0xff00ff
    s_mov_b32 s54, 0xffff
    s_mov_b32 s55, 0x0
    s_cmp_ge_u32 s18, 20
    s_cbranch_scc1 L_nonred_36
    s_cmp_eq_u32 s16, 0
    s_cbranch_scc1 L_var10_28
    s_cmp_eq_u32 s16, 1
    s_cbranch_scc1 L_var11_29
    s_cmp_eq_u32 s16, 2
    s_cbranch_scc1 L_var12_30
    s_branch L_var13_31
L_nonred_36:
    s_cmp_eq_u32 s16, 0
    s_cbranch_scc1 L_var00_32
    s_cmp_eq_u32 s16, 1
    s_cbranch_scc1 L_var01_33
    s_cmp_eq_u32 s16, 2
    s_cbranch_scc1 L_var02_34
    s_branch L_var03_35
L_var10_28:
L_step_37:
    ds_read_b64_tr_b16 v[32:33], v4 offset:0
    ds_read_b64_tr_b16 v[34:35], v5 offset:0
    ds_read_b64_tr_b16 v[36:37], v4 offset:1024
    ds_read_b64_tr_b16 v[38:39], v5 offset:1024
    ds_read_b64_tr_b16 v[40:41], v4 offset:2048
    ds_read_b64_tr_b16 v[42:43], v5 offset:2048
    ds_read_b64_tr_b16 v[44:45], v4 offset:3072
    ds_read_b64_tr_b16 v[46:47], v5 offset:3072
    ds_read_b64_tr_b16 v[48:49], v4 offset:4096
    ds_read_b64_tr_b16 v[50:51], v5 offset:4096
    ds_read_b64_tr_b16 v[52:53], v4 offset:5120
    ds_read_b64_tr_b16 v[54:55], v5 offset:5120
    ds_read_b64_tr_b16 v[56:57], v4 offset:6144
    ds_read_b64_tr_b16 v[58:59], v5 offset:6144
    s_waitcnt lgkmcnt(12)
    v_smfmac_f32_16x16x64_bf16 v[72:75], v[32:35], a[0:7], v29
    v_smfmac_f32_16x16x64_bf16 v[76:79], v[32:35], a[80:87], v29
    ds_read_b64_tr_b16 v[60:61], v4 offset:7168
    ds_read_b64_tr_b16 v[62:63], v5 offset:7168
    s_waitcnt lgkmcnt(12)
    v_smfmac_f32_16x16x64_bf16 v[72:75], v[36:39], a[8:15], v29
    v_smfmac_f32_16x16x64_bf16 v[76:79], v[36:39], a[88:95], v29
    ds_read_b64_tr_b16 v[64:65], v4 offset:8192
    ds_read_b64_tr_b16 v[66:67], v5 offset:8192
    s_waitcnt lgkmcnt(12)
    v_smfmac_f32_16x16x64_bf16 v[72:75], v[40:43], a[16:23], v29
    v_smfmac_f32_16x16x64_bf16 v[76:79], v[40:43], a[96:103], v29
    ds_read_b64_tr_b16 v[68:69], v4 offset:9216
    ds_read_b64_tr_b16 v[70:71], v5 offset:9216
    s_waitcnt lgkmcnt(12)
    v_smfmac_f32_16x16x64_bf16 v[72:75], v[44:47], a[24:31], v29
    v_smfmac_f32_16x16x64_bf16 v[76:79], v[44:47], a[104:111], v29
    s_waitcnt lgkmcnt(10)
    v_smfmac_f32_16x16x64_bf16 v[72:75], v[48:51], a[32:39], v29
    v_smfmac_f32_16x16x64_bf16 v[76:79], v[48:51], a[112:119], v29
    s_waitcnt lgkmcnt(8)
    v_smfmac_f32_16x16x64_bf16 v[72:75], v[52:55], a[40:47], v29
    v_smfmac_f32_16x16x64_bf16 v[76:79], v[52:55], a[120:127], v29
    s_waitcnt lgkmcnt(6)
    v_smfmac_f32_16x16x64_bf16 v[72:75], v[56:59], a[48:55], v29
    v_smfmac_f32_16x16x64_bf16 v[76:79], v[56:59], a[128:135], v29
    s_waitcnt lgkmcnt(4)
    v_smfmac_f32_16x16x64_bf16 v[72:75], v[60:63], a[56:63], v29
    v_smfmac_f32_16x16x64_bf16 v[76:79], v[60:63], a[136:143], v29
    s_waitcnt lgkmcnt(2)
    v_smfmac_f32_16x16x64_bf16 v[72:75], v[64:67], a[64:71], v29
    v_smfmac_f32_16x16x64_bf16 v[76:79], v[64:67], a[144:151], v29
    s_waitcnt lgkmcnt(0)
    v_smfmac_f32_16x16x64_bf16 v[72:75], v[68:71], a[72:79], v29
    v_smfmac_f32_16x16x64_bf16 v[76:79], v[68:71], a[152:159], v29
    v_smfmac_f32_16x16x64_bf16 v[80:83], v[32:35], a[160:167], v29
    v_smfmac_f32_16x16x64_bf16 v[80:83], v[36:39], a[168:175], v29
    s_nop 0
    v_permlane32_swap_b32 v72, v76
    v_permlane32_swap_b32 v73, v77
    v_permlane32_swap_b32 v74, v78
    v_permlane32_swap_b32 v75, v79
    v_add_f32 v72, v72, v76
    v_add_f32 v73, v73, v77
    v_cvt_pk_bf16_f32 v156, v72, v73
    v_add_f32 v74, v74, v78
    v_add_f32 v75, v75, v79
    v_cvt_pk_bf16_f32 v157, v74, v75
    ds_write_b64 v9, v[156:157]
    v_cmp_u_f32 vcc, v72, v73
    s_cbranch_vccnz L_slow_39
L_cont_40:
    v_smfmac_f32_16x16x64_bf16 v[80:83], v[40:43], a[176:183], v29
    v_smfmac_f32_16x16x64_bf16 v[80:83], v[44:47], a[184:191], v29
    s_waitcnt lgkmcnt(0)
    s_barrier
    ds_read_b64_tr_b16 v[84:85], v10
    ds_read_b64_tr_b16 v[86:87], v10 offset:64
    ds_read_b64_tr_b16 v[92:93], v10 offset:1024
    ds_read_b64_tr_b16 v[94:95], v10 offset:1088
    ds_read_b64_tr_b16 v[88:89], v10 offset:512
    ds_read_b64_tr_b16 v[90:91], v10 offset:576
    ds_read_b64_tr_b16 v[96:97], v10 offset:1536
    ds_read_b64_tr_b16 v[98:99], v10 offset:1600
    v_smfmac_f32_16x16x64_bf16 v[80:83], v[48:51], a[192:199], v29
    v_smfmac_f32_16x16x64_bf16 v[80:83], v[52:55], a[200:207], v29
    s_waitcnt lgkmcnt(4)
    v_mfma_f32_16x16x32_bf16 v[100:103], v[92:95], v[84:87], 0
    s_waitcnt lgkmcnt(0)
    v_mfma_f32_16x16x32_bf16 v[100:103], v[96:99], v[88:91], v[100:103]
    v_smfmac_f32_16x16x64_bf16 v[80:83], v[56:59], a[208:215], v29
    v_smfmac_f32_16x16x64_bf16 v[80:83], v[60:63], a[216:223], v29
    s_cmp_eq_u32 s21, 63
    s_cbranch_scc1 L_exit_38
    s_mov_b64 exec, s[34:35]
    s_nop 0
    buffer_store_dwordx4 v[100:103], v11, s[4:7], s22 offen
    buffer_store_dwordx4 v[150:153], v11, s[4:7], s23 offen
    s_mov_b64 exec, s[46:47]
    buffer_store_dwordx4 v[150:153], v16, s[4:7], s25 offen
    s_mov_b64 exec, -1
    v_smfmac_f32_16x16x64_bf16 v[80:83], v[64:67], a[224:231], v29
    v_smfmac_f32_16x16x64_bf16 v[80:83], v[68:71], a[232:239], v29
    ds_read_b128 v[122:125], v154
    v_mov_b32 v72, 0
    v_mov_b32 v73, 0
    v_mov_b32 v74, 0
    v_mov_b32 v75, 0
    v_mov_b32 v76, 0
    v_mov_b32 v77, 0
    v_mov_b32 v78, 0
    v_mov_b32 v79, 0
    v_cvt_pk_bf16_f32 v130, v80, v81
    v_cvt_pk_bf16_f32 v131, v82, v83
    s_sleep 2
    s_mov_b64 exec, s[48:49]
    buffer_load_dwordx2 v[104:105], v12, s[4:7], s22 offen sc1
    buffer_load_dwordx2 v[106:107], v12, s[4:7], s22 offen offset:1536 sc1
    buffer_load_dwordx2 v[108:109], v12, s[4:7], s22 offen offset:3072 sc1
    s_mov_b64 exec, -1
    s_waitcnt vmcnt(0)
    v_max3_u32 v113, v104, v106, v108
    v_cmp_eq_u32 vcc, -1, v113
    s_cbranch_vccnz L_retry_41
L_ok_42:
    v_pk_add_f32 v[110:111], v[104:105], v[106:107]
    v_pk_add_f32 v[110:111], v[110:111], v[108:109]
    v_max_f32 v112, v110, v111
    s_nop 1
    v_max_f32_dpp v112, v112, v112 row_ror:8 row_mask:0xf bank_mask:0xf
    s_nop 1
    v_max_f32_dpp v112, v112, v112 row_ror:4 row_mask:0xf bank_mask:0xf
    s_nop 1
    v_max_f32_dpp v112, v112, v112 row_ror:2 row_mask:0xf bank_mask:0xf
    s_nop 1
    v_max_f32_dpp v112, v112, v112 row_ror:1 row_mask:0xf bank_mask:0xf
    v_mov_b32 v113, v112
    s_nop 1
    v_permlane16_swap_b32 v112, v113
    v_max_f32 v112, v112, v113
    v_mul_f32 v112, s33, v112
    v_fma_f32 v114, v110, s33, -v112
    v_fma_f32 v115, v111, s33, -v112
    v_exp_f32 v114, v114
    v_exp_f32 v115, v115
    s_mov_b64 exec, s[48:49]
    v_cvt_pk_bf16_f32 v114, v114, v115
    ds_write_b32 v13, v114
    s_mov_b64 exec, -1
    s_waitcnt lgkmcnt(0)
    s_barrier
    ds_read_b128 v[116:119], v14
    ds_read_b64 v[120:121], v15
    s_waitcnt lgkmcnt(1)
    v_mfma_f32_16x16x32_bf16 v[136:139], v[140:143], v[116:119], 0
    v_mfma_f32_16x16x32_bf16 v[132:135], v[122:125], v[116:119], 0
    s_waitcnt lgkmcnt(0)
    v_mfma_f32_16x16x16_bf16 v[136:139], v[144:145], v[120:121], v[136:139]
    v_mfma_f32_16x16x16_bf16 v[132:135], v[130:131], v[120:121], v[132:135]
    s_nop 6
    v_rcp_f32 v113, v136
    s_nop 0
    v_mul_f32 v132, v132, v113
    v_mul_f32 v133, v133, v113
    v_mul_f32 v134, v134, v113
    v_mul_f32 v135, v135, v113
    v_cvt_pk_bf16_f32 v146, v132, v133
    v_cvt_pk_bf16_f32 v147, v134, v135
    v_min_u32 v146, s39, v146
    s_nop 0
    v_permlane16_swap_b32 v147, v149
    v_permlane16_swap_b32 v146, v148
    s_mov_b64 exec, s[46:47]
    buffer_store_dwordx4 v[146:149], v16, s[4:7], s24 offen
    s_mov_b64 exec, -1
    v_mov_b32 v156, v80
    v_mov_b32 v157, v81
    v_mov_b32 v158, v82
    v_mov_b32 v159, v83
    s_nop 0
    v_permlane32_swap_b32 v80, v156
    v_permlane32_swap_b32 v81, v157
    v_permlane32_swap_b32 v82, v158
    v_permlane32_swap_b32 v83, v159
    v_add_f32 v80, v80, v156
    v_add_f32 v81, v81, v157
    v_add_f32 v82, v82, v158
    v_add_f32 v83, v83, v159
    v_cvt_pk_bf16_f32 v156, v80, v81
    v_cvt_pk_bf16_f32 v157, v82, v83
    s_nop 1
    v_permlane16_swap_b32 v156, v158
    v_permlane16_swap_b32 v157, v159
    s_mov_b64 exec, s[54:55]
    buffer_store_dwordx4 v[156:159], v28, s[4:7], s32 offen
    s_mov_b64 exec, -1
    v_mov_b32 v80, 0
    v_mov_b32 v81, 0
    v_mov_b32 v82, 0
    v_mov_b32 v83, 0
    buffer_load_dwordx4 v[32:35], v17, s[4:7], s24 offen offset:0 sc1
    buffer_load_dwordx4 v[36:39], v17, s[4:7], s24 offen offset:1024 sc1
    buffer_load_dwordx4 v[40:43], v17, s[4:7], s24 offen offset:2048 sc1
    buffer_load_dwordx4 v[44:47], v17, s[4:7], s24 offen offset:3072 sc1
    buffer_load_dwordx4 v[48:51], v18, s[4:7], s24 offen offset:0 sc1
    buffer_load_dwordx4 v[52:55], v18, s[4:7], s24 offen offset:1024 sc1
    s_waitcnt vmcnt(0)
    v_max3_u32 v113, v32, v36, v40
    v_max3_u32 v114, v44, v48, v52
    v_max_u32 v113, v113, v114
    v_cmp_eq_u32 vcc, -1, v113
    s_cbranch_vccnz L_retry_45
L_ok_46:
    v_smfmac_f32_16x16x64_bf16 v[72:75], v[32:35], v[160:167], v29
    v_smfmac_f32_16x16x64_bf16 v[76:79], v[32:35], v[168:175], v29
    v_smfmac_f32_16x16x64_bf16 v[72:75], v[36:39], v[176:183], v29
    v_smfmac_f32_16x16x64_bf16 v[76:79], v[36:39], v[184:191], v29
    v_smfmac_f32_16x16x64_bf16 v[72:75], v[40:43], v[192:199], v29
    v_smfmac_f32_16x16x64_bf16 v[76:79], v[40:43], v[200:207], v29
    v_smfmac_f32_16x16x64_bf16 v[72:75], v[44:47], v[208:215], v29
    v_smfmac_f32_16x16x64_bf16 v[76:79], v[44:47], v[216:223], v29
    v_smfmac_f32_16x16x64_bf16 v[72:75], v[48:51], v[224:231], v29
    v_smfmac_f32_16x16x64_bf16 v[76:79], v[48:51], v[232:239], v29
    v_smfmac_f32_16x16x64_bf16 v[72:75], v[52:55], v[240:247], v29
    v_smfmac_f32_16x16x64_bf16 v[76:79], v[52:55], v[248:255], v29
    s_nop 3
    s_nop 3
    v_permlane32_swap_b32 v72, v76
    v_permlane32_swap_b32 v73, v77
    v_permlane32_swap_b32 v74, v78
    v_permlane32_swap_b32 v75, v79
    v_pk_add_f32 v[72:73], v[72:73], v[76:77]
    v_pk_add_f32 v[74:75], v[74:75], v[78:79]
    s_barrier
    ds_read_b128 v[56:59], v20 offset:1024
    ds_read_b128 v[60:63], v20 offset:2048
    ds_read_b128 v[64:67], v20 offset:3072
    s_waitcnt lgkmcnt(2)
    v_pk_add_f32 v[72:73], v[72:73], v[56:57]
    v_pk_add_f32 v[74:75], v[74:75], v[58:59]
    s_waitcnt lgkmcnt(0)
    v_pk_add_f32 v[60:61], v[60:61], v[64:65]
    v_pk_add_f32 v[62:63], v[62:63], v[66:67]
    v_pk_add_f32 v[72:73], v[72:73], v[60:61]
    v_pk_add_f32 v[74:75], v[74:75], v[62:63]
    v_and_or_b32 v72, v72, s39, v30
    buffer_store_dwordx4 v[72:75], v21, s[4:7], s28 offen sc1
    s_mov_b64 exec, s[50:51]
    buffer_store_dwordx4 v[150:153], v23, s[4:7], s27 offen
    s_mov_b64 exec, -1
    s_xor_b32 s22, s22, s23
    s_xor_b32 s23, s22, s23
    s_xor_b32 s22, s22, s23
    s_xor_b32 s24, s24, s25
    s_xor_b32 s25, s24, s25
    s_xor_b32 s24, s24, s25
    s_add_u32 s29, s29, 393216
    s_add_u32 s30, s30, 393216
    s_add_u32 s31, s31, 98304
    s_add_u32 s32, s32, 98304
    s_nop 0
    v_mov_b32 v72, 0
    v_mov_b32 v73, 0
    v_mov_b32 v74, 0
    v_mov_b32 v75, 0
    v_mov_b32 v76, 0
    v_mov_b32 v77, 0
    v_mov_b32 v78, 0
    v_mov_b32 v79, 0
    s_sleep 12
    buffer_load_dwordx4 v[56:59], v22, s[4:7], s28 offen offset:0 sc1
    buffer_load_dwordx4 v[60:63], v22, s[4:7], s28 offen offset:1024 sc1
    buffer_load_dwordx4 v[64:67], v22, s[4:7], s28 offen offset:2048 sc1
    buffer_load_dwordx4 v[68:71], v22, s[4:7], s28 offen offset:3072 sc1
    s_waitcnt vmcnt(0)
    v_xor_b32 v113, v56, v30
    v_xor_b32 v114, v60, v30
    v_xor_b32 v115, v64, v30
    v_xor_b32 v116, v68, v30
    v_or3_b32 v113, v113, v114, v115
    v_or_b32 v113, v113, v116
    v_and_b32 v113, 1, v113
    v_cmp_eq_u32 vcc, 1, v113
    s_cbranch_vccnz L_retry_47
L_ok_48:
    v_pk_add_f32 v[56:57], v[56:57], v[60:61]
    v_pk_add_f32 v[58:59], v[58:59], v[62:63]
    v_pk_add_f32 v[64:65], v[64:65], v[68:69]
    v_pk_add_f32 v[66:67], v[66:67], v[70:71]
    v_pk_add_f32 v[56:57], v[56:57], v[64:65]
    v_pk_add_f32 v[58:59], v[58:59], v[66:67]
    v_cvt_pk_bf16_f32 v146, v56, v57
    v_cvt_pk_bf16_f32 v147, v58, v59
    v_min_u32 v146, s39, v146
    s_nop 0
    v_permlane16_swap_b32 v147, v149
    v_permlane16_swap_b32 v146, v148
    s_mov_b64 exec, s[50:51]
    buffer_store_dwordx4 v[146:149], v23, s[4:7], s26 offen
    s_mov_b64 exec, -1
    s_sleep 3
    buffer_load_dwordx4 v[56:59], v6, s[4:7], s26 offen sc1
    buffer_load_dwordx4 v[60:63], v7, s[4:7], s26 offen sc1
    buffer_load_dwordx4 v[64:67], v8, s[4:7], s26 offen sc1
    s_xor_b32 s26, s26, s27
    s_xor_b32 s27, s26, s27
    s_xor_b32 s26, s26, s27
    s_xor_b32 s28, s28, 262144
    s_add_u32 s21, s21, 1
    s_lshr_b32 s40, s21, 1
    s_and_b32 s40, s40, 1
    s_xor_b32 s40, s40, 1
    v_mov_b32 v30, s40
    s_mov_b32 s58, 1
    s_waitcnt vmcnt(0)
    v_max3_u32 v113, v56, v60, v64
    v_cmp_eq_u32 vcc, -1, v113
    s_cbranch_vccnz L_retry_49
L_ok_50:
    ds_write_b128 v2, v[56:59]
    ds_write_b128 v2, v[60:63] offset:4096
    ds_write_b128 v2, v[64:67] offset:8192
    s_waitcnt lgkmcnt(0)
    s_barrier
    s_branch L_step_37
L_slow_39:
    s_cmp_eq_u32 s58, 1
    s_cbranch_scc1 L_cont_40
    s_mov_b32 s58, 1
    s_mov_b32 s38, 0
L_sl_51:
    buffer_load_dwordx4 v[56:59], v6, s[4:7], s27 offen sc1
    buffer_load_dwordx4 v[60:63], v7, s[4:7], s27 offen sc1
    buffer_load_dwordx4 v[64:67], v8, s[4:7], s27 offen sc1
    s_waitcnt vmcnt(0)
    v_max3_u32 v113, v56, v60, v64
    v_cmp_eq_u32 vcc, -1, v113
    s_cbranch_vccz L_slk_52
    s_add_u32 s38, s38, 1
    s_cmp_lt_u32 s38, 4194304
    s_cbranch_scc1 L_sl_51
    s_branch L_end_1
L_slk_52:
    s_waitcnt lgkmcnt(0)
    s_barrier
    ds_write_b128 v2, v[56:59]
    ds_write_b128 v2, v[60:63] offset:4096
    ds_write_b128 v2, v[64:67] offset:8192
    s_nop 7
    s_nop 7
    v_mov_b32 v72, 0
    v_mov_b32 v73, 0
    v_mov_b32 v74, 0
    v_mov_b32 v75, 0
    v_mov_b32 v76, 0
    v_mov_b32 v77, 0
    v_mov_b32 v78, 0
    v_mov_b32 v79, 0
    v_mov_b32 v80, 0
    v_mov_b32 v81, 0
    v_mov_b32 v82, 0
    v_mov_b32 v83, 0
    s_waitcnt lgkmcnt(0)
    s_barrier
    s_branch L_step_37
L_retry_41:
    s_mov_b32 s38, 0
L_rl_53:
    s_mov_b64 exec, s[48:49]
    buffer_load_dwordx2 v[104:105], v12, s[4:7], s22 offen sc1
    buffer_load_dwordx2 v[106:107], v12, s[4:7], s22 offen offset:1536 sc1
    buffer_load_dwordx2 v[108:109], v12, s[4:7], s22 offen offset:3072 sc1
    s_mov_b64 exec, -1
    s_waitcnt vmcnt(0)
    v_max3_u32 v113, v104, v106, v108
    v_cmp_eq_u32 vcc, -1, v113
    s_cbranch_vccz L_ok_42
    s_add_u32 s38, s38, 1
    s_cmp_lt_u32 s38, 4194304
    s_cbranch_scc1 L_rl_53
    s_branch L_end_1
L_retry_45:
    s_mov_b32 s38, 0
L_rl_54:
    buffer_load_dwordx4 v[32:35], v17, s[4:7], s24 offen offset:0 sc1
    buffer_load_dwordx4 v[36:39], v17, s[4:7], s24 offen offset:1024 sc1
    buffer_load_dwordx4 v[40:43], v17, s[4:7], s24 offen offset:2048 sc1
    buffer_load_dwordx4 v[44:47], v17, s[4:7], s24 offen offset:3072 sc1
    buffer_load_dwordx4 v[48:51], v18, s[4:7], s24 offen offset:0 sc1
    buffer_load_dwordx4 v[52:55], v18, s[4:7], s24 offen offset:1024 sc1
    s_waitcnt vmcnt(0)
    v_max3_u32 v113, v32, v36, v40
    v_max3_u32 v114, v44, v48, v52
    v_max_u32 v113, v113, v114
    v_cmp_eq_u32 vcc, -1, v113
    s_cbranch_vccz L_ok_46
    s_add_u32 s38, s38, 1
    s_cmp_lt_u32 s38, 4194304
    s_cbranch_scc1 L_rl_54
    s_branch L_end_1
L_retry_47:
    s_mov_b32 s38, 0
L_rl_55:
    buffer_load_dwordx4 v[56:59], v22, s[4:7], s28 offen offset:0 sc1
    buffer_load_dwordx4 v[60:63], v22, s[4:7], s28 offen offset:1024 sc1
    buffer_load_dwordx4 v[64:67], v22, s[4:7], s28 offen offset:2048 sc1
    buffer_load_dwordx4 v[68:71], v22, s[4:7], s28 offen offset:3072 sc1
    s_waitcnt vmcnt(0)
    v_xor_b32 v113, v56, v30
    v_xor_b32 v114, v60, v30
    v_xor_b32 v115, v64, v30
    v_xor_b32 v116, v68, v30
    v_or3_b32 v113, v113, v114, v115
    v_or_b32 v113, v113, v116
    v_and_b32 v113, 1, v113
    v_cmp_eq_u32 vcc, 1, v113
    s_cbranch_vccz L_ok_48
    s_add_u32 s38, s38, 1
    s_cmp_lt_u32 s38, 4194304
    s_cbranch_scc1 L_rl_55
    s_branch L_end_1
L_retry_49:
    s_mov_b32 s38, 0
L_rl_56:
    buffer_load_dwordx4 v[56:59], v6, s[4:7], s27 offen sc1
    buffer_load_dwordx4 v[60:63], v7, s[4:7], s27 offen sc1
    buffer_load_dwordx4 v[64:67], v8, s[4:7], s27 offen sc1
    s_waitcnt vmcnt(0)
    v_max3_u32 v113, v56, v60, v64
    v_cmp_eq_u32 vcc, -1, v113
    s_cbranch_vccz L_ok_50
    s_add_u32 s38, s38, 1
    s_cmp_lt_u32 s38, 4194304
    s_cbranch_scc1 L_rl_56
    s_branch L_end_1
L_exit_38:
    v_smfmac_f32_16x16x64_bf16 v[80:83], v[64:67], a[224:231], v29
    v_smfmac_f32_16x16x64_bf16 v[80:83], v[68:71], a[232:239], v29
    s_nop 7
    s_nop 1
    v_mov_b32 v156, v80
    v_mov_b32 v157, v81
    v_mov_b32 v158, v82
    v_mov_b32 v159, v83
    s_nop 0
    v_permlane32_swap_b32 v80, v156
    v_permlane32_swap_b32 v81, v157
    v_permlane32_swap_b32 v82, v158
    v_permlane32_swap_b32 v83, v159
    v_add_f32 v80, v80, v156
    v_add_f32 v81, v81, v157
    v_add_f32 v82, v82, v158
    v_add_f32 v83, v83, v159
    v_cvt_pk_bf16_f32 v156, v80, v81
    v_cvt_pk_bf16_f32 v157, v82, v83
    s_nop 1
    v_permlane16_swap_b32 v156, v158
    v_permlane16_swap_b32 v157, v159
    s_mov_b64 exec, s[54:55]
    buffer_store_dwordx4 v[156:159], v28, s[4:7], s32 offen
    s_mov_b64 exec, -1
    v_mov_b32 v80, 0
    v_mov_b32 v81, 0
    v_mov_b32 v82, 0
    v_mov_b32 v83, 0
    s_waitcnt vmcnt(0)
    s_barrier
    s_branch L_done_27
L_var11_29:
L_step_57:
    ds_read_b64_tr_b16 v[32:33], v4 offset:0
    ds_read_b64_tr_b16 v[34:35], v5 offset:0
    ds_read_b64_tr_b16 v[36:37], v4 offset:1024
    ds_read_b64_tr_b16 v[38:39], v5 offset:1024
    ds_read_b64_tr_b16 v[40:41], v4 offset:2048
    ds_read_b64_tr_b16 v[42:43], v5 offset:2048
    ds_read_b64_tr_b16 v[44:45], v4 offset:3072
    ds_read_b64_tr_b16 v[46:47], v5 offset:3072
    ds_read_b64_tr_b16 v[48:49], v4 offset:4096
    ds_read_b64_tr_b16 v[50:51], v5 offset:4096
    ds_read_b64_tr_b16 v[52:53], v4 offset:5120
    ds_read_b64_tr_b16 v[54:55], v5 offset:5120
    ds_read_b64_tr_b16 v[56:57], v4 offset:6144
    ds_read_b64_tr_b16 v[58:59], v5 offset:6144
    s_waitcnt lgkmcnt(12)
    v_smfmac_f32_16x16x64_bf16 v[72:75], v[32:35], a[0:7], v29
    v_smfmac_f32_16x16x64_bf16 v[76:79], v[32:35], a[80:87], v29
    ds_read_b64_tr_b16 v[60:61], v4 offset:7168
    ds_read_b64_tr_b16 v[62:63], v5 offset:7168
    s_waitcnt lgkmcnt(12)
    v_smfmac_f32_16x16x64_bf16 v[72:75], v[36:39], a[8:15], v29
    v_smfmac_f32_16x16x64_bf16 v[76:79], v[36:39], a[88:95], v29
    ds_read_b64_tr_b16 v[64:65], v4 offset:8192
    ds_read_b64_tr_b16 v[66:67], v5 offset:8192
    s_waitcnt lgkmcnt(12)
    v_smfmac_f32_16x16x64_bf16 v[72:75], v[40:43], a[16:23], v29
    v_smfmac_f32_16x16x64_bf16 v[76:79], v[40:43], a[96:103], v29
    ds_read_b64_tr_b16 v[68:69], v4 offset:9216
    ds_read_b64_tr_b16 v[70:71], v5 offset:9216
    s_waitcnt lgkmcnt(12)
    v_smfmac_f32_16x16x64_bf16 v[72:75], v[44:47], a[24:31], v29
    v_smfmac_f32_16x16x64_bf16 v[76:79], v[44:47], a[104:111], v29
    s_waitcnt lgkmcnt(10)
    v_smfmac_f32_16x16x64_bf16 v[72:75], v[48:51], a[32:39], v29
    v_smfmac_f32_16x16x64_bf16 v[76:79], v[48:51], a[112:119], v29
    s_waitcnt lgkmcnt(8)
    v_smfmac_f32_16x16x64_bf16 v[72:75], v[52:55], a[40:47], v29
    v_smfmac_f32_16x16x64_bf16 v[76:79], v[52:55], a[120:127], v29
    s_waitcnt lgkmcnt(6)
    v_smfmac_f32_16x16x64_bf16 v[72:75], v[56:59], a[48:55], v29
    v_smfmac_f32_16x16x64_bf16 v[76:79], v[56:59], a[128:135], v29
    s_waitcnt lgkmcnt(4)
    v_smfmac_f32_16x16x64_bf16 v[72:75], v[60:63], a[56:63], v29
    v_smfmac_f32_16x16x64_bf16 v[76:79], v[60:63], a[136:143], v29
    s_waitcnt lgkmcnt(2)
    v_smfmac_f32_16x16x64_bf16 v[72:75], v[64:67], a[64:71], v29
    v_smfmac_f32_16x16x64_bf16 v[76:79], v[64:67], a[144:151], v29
    s_waitcnt lgkmcnt(0)
    v_smfmac_f32_16x16x64_bf16 v[72:75], v[68:71], a[72:79], v29
    v_smfmac_f32_16x16x64_bf16 v[76:79], v[68:71], a[152:159], v29
    v_smfmac_f32_16x16x64_bf16 v[80:83], v[32:35], a[160:167], v29
    v_smfmac_f32_16x16x64_bf16 v[80:83], v[36:39], a[168:175], v29
    s_nop 0
    v_permlane32_swap_b32 v72, v76
    v_permlane32_swap_b32 v73, v77
    v_permlane32_swap_b32 v74, v78
    v_permlane32_swap_b32 v75, v79
    v_add_f32 v72, v72, v76
    v_add_f32 v73, v73, v77
    v_cvt_pk_bf16_f32 v156, v72, v73
    v_add_f32 v74, v74, v78
    v_add_f32 v75, v75, v79
    v_cvt_pk_bf16_f32 v157, v74, v75
    ds_write_b64 v9, v[156:157]
    v_cmp_u_f32 vcc, v72, v73
    s_cbranch_vccnz L_slow_59
L_cont_60:
    v_smfmac_f32_16x16x64_bf16 v[80:83], v[40:43], a[176:183], v29
    v_smfmac_f32_16x16x64_bf16 v[80:83], v[44:47], a[184:191], v29
    s_waitcnt lgkmcnt(0)
    s_barrier
    ds_read_b64_tr_b16 v[84:85], v10
    ds_read_b64_tr_b16 v[86:87], v10 offset:64
    ds_read_b64_tr_b16 v[88:89], v10 offset:512
    ds_read_b64_tr_b16 v[90:91], v10 offset:576
    v_smfmac_f32_16x16x64_bf16 v[80:83], v[48:51], a[192:199], v29
    v_smfmac_f32_16x16x64_bf16 v[80:83], v[52:55], a[200:207], v29
    s_waitcnt lgkmcnt(2)
    v_mfma_f32_16x16x32_bf16 v[100:103], v[92:95], v[84:87], 0
    s_waitcnt lgkmcnt(0)
    v_mfma_f32_16x16x32_bf16 v[100:103], v[96:99], v[88:91], v[100:103]
    v_smfmac_f32_16x16x64_bf16 v[80:83], v[56:59], a[208:215], v29
    v_smfmac_f32_16x16x64_bf16 v[80:83], v[60:63], a[216:223], v29
    s_cmp_eq_u32 s21, 63
    s_cbranch_scc1 L_exit_58
    s_mov_b64 exec, s[34:35]
    s_nop 0
    buffer_store_dwordx4 v[100:103], v11, s[4:7], s22 offen
    buffer_store_dwordx4 v[150:153], v11, s[4:7], s23 offen
    s_mov_b64 exec, s[46:47]
    buffer_store_dwordx4 v[150:153], v16, s[4:7], s25 offen
    s_mov_b64 exec, -1
    v_smfmac_f32_16x16x64_bf16 v[80:83], v[64:67], a[224:231], v29
    v_smfmac_f32_16x16x64_bf16 v[80:83], v[68:71], a[232:239], v29
    v_mov_b32 v72, 0
    v_mov_b32 v73, 0
    v_mov_b32 v74, 0
    v_mov_b32 v75, 0
    v_mov_b32 v76, 0
    v_mov_b32 v77, 0
    v_mov_b32 v78, 0
    v_mov_b32 v79, 0
    v_cvt_pk_bf16_f32 v130, v80, v81
    v_cvt_pk_bf16_f32 v131, v82, v83
    s_sleep 2
    s_mov_b64 exec, s[48:49]
    buffer_load_dwordx2 v[104:105], v12, s[4:7], s22 offen sc1
    buffer_load_dwordx2 v[106:107], v12, s[4:7], s22 offen offset:1536 sc1
    buffer_load_dwordx2 v[108:109], v12, s[4:7], s22 offen offset:3072 sc1
    s_mov_b64 exec, -1
    s_waitcnt vmcnt(0)
    v_max3_u32 v113, v104, v106, v108
    v_cmp_eq_u32 vcc, -1, v113
    s_cbranch_vccnz L_retry_61
L_ok_62:
    v_pk_add_f32 v[110:111], v[104:105], v[106:107]
    v_pk_add_f32 v[110:111], v[110:111], v[108:109]
    v_max_f32 v112, v110, v111
    s_nop 1
    v_max_f32_dpp v112, v112, v112 row_ror:8 row_mask:0xf bank_mask:0xf
    s_nop 1
    v_max_f32_dpp v112, v112, v112 row_ror:4 row_mask:0xf bank_mask:0xf
    s_nop 1
    v_max_f32_dpp v112, v112, v112 row_ror:2 row_mask:0xf bank_mask:0xf
    s_nop 1
    v_max_f32_dpp v112, v112, v112 row_ror:1 row_mask:0xf bank_mask:0xf
    v_mov_b32 v113, v112
    s_nop 1
    v_permlane16_swap_b32 v112, v113
    v_max_f32 v112, v112, v113
    v_mul_f32 v112, s33, v112
    v_fma_f32 v114, v110, s33, -v112
    v_fma_f32 v115, v111, s33, -v112
    v_exp_f32 v114, v114
    v_exp_f32 v115, v115
    s_mov_b64 exec, s[48:49]
    v_cvt_pk_bf16_f32 v114, v114, v115
    ds_write_b32 v13, v114
    s_mov_b64 exec, -1
    s_waitcnt lgkmcnt(0)
    s_barrier
    ds_read_b128 v[116:119], v14
    ds_read_b64 v[120:121], v15
    s_waitcnt lgkmcnt(1)
    v_mfma_f32_16x16x32_bf16 v[136:139], v[140:143], v[116:119], 0
    v_mfma_f32_16x16x32_bf16 v[132:135], v[122:125], v[116:119], 0
    s_waitcnt lgkmcnt(0)
    v_mfma_f32_16x16x16_bf16 v[136:139], v[144:145], v[120:121], v[136:139]
    v_mfma_f32_16x16x16_bf16 v[132:135], v[130:131], v[120:121], v[132:135]
    s_nop 6
    v_rcp_f32 v113, v136
    s_nop 0
    v_mul_f32 v132, v132, v113
    v_mul_f32 v133, v133, v113
    v_mul_f32 v134, v134, v113
    v_mul_f32 v135, v135, v113
    v_cvt_pk_bf16_f32 v146, v132, v133
    v_cvt_pk_bf16_f32 v147, v134, v135
    v_min_u32 v146, s39, v146
    s_nop 0
    v_permlane16_swap_b32 v147, v149
    v_permlane16_swap_b32 v146, v148
    s_mov_b64 exec, s[46:47]
    buffer_store_dwordx4 v[146:149], v16, s[4:7], s24 offen
    s_mov_b64 exec, -1
    v_mov_b32 v156, v80
    v_mov_b32 v157, v81
    v_mov_b32 v158, v82
    v_mov_b32 v159, v83
    s_nop 0
    v_permlane32_swap_b32 v80, v156
    v_permlane32_swap_b32 v81, v157
    v_permlane32_swap_b32 v82, v158
    v_permlane32_swap_b32 v83, v159
    v_add_f32 v80, v80, v156
    v_add_f32 v81, v81, v157
    v_add_f32 v82, v82, v158
    v_add_f32 v83, v83, v159
    v_cvt_pk_bf16_f32 v156, v80, v81
    v_cvt_pk_bf16_f32 v157, v82, v83
    s_nop 1
    v_permlane16_swap_b32 v156, v158
    v_permlane16_swap_b32 v157, v159
    s_mov_b64 exec, s[54:55]
    buffer_store_dwordx4 v[156:159], v28, s[4:7], s32 offen
    s_mov_b64 exec, -1
    v_mov_b32 v80, 0
    v_mov_b32 v81, 0
    v_mov_b32 v82, 0
    v_mov_b32 v83, 0
    buffer_load_dwordx4 v[32:35], v17, s[4:7], s24 offen offset:0 sc1
    buffer_load_dwordx4 v[36:39], v17, s[4:7], s24 offen offset:1024 sc1
    buffer_load_dwordx4 v[40:43], v17, s[4:7], s24 offen offset:2048 sc1
    buffer_load_dwordx4 v[44:47], v17, s[4:7], s24 offen offset:3072 sc1
    buffer_load_dwordx4 v[48:51], v18, s[4:7], s24 offen offset:0 sc1
    buffer_load_dwordx4 v[52:55], v18, s[4:7], s24 offen offset:1024 sc1
    s_waitcnt vmcnt(0)
    v_max3_u32 v113, v32, v36, v40
    v_max3_u32 v114, v44, v48, v52
    v_max_u32 v113, v113, v114
    v_cmp_eq_u32 vcc, -1, v113
    s_cbranch_vccnz L_retry_65
L_ok_66:
    v_smfmac_f32_16x16x64_bf16 v[72:75], v[32:35], v[160:167], v29
    v_smfmac_f32_16x16x64_bf16 v[76:79], v[32:35], v[168:175], v29
    v_smfmac_f32_16x16x64_bf16 v[72:75], v[36:39], v[176:183], v29
    v_smfmac_f32_16x16x64_bf16 v[76:79], v[36:39], v[184:191], v29
    v_smfmac_f32_16x16x64_bf16 v[72:75], v[40:43], v[192:199], v29
    v_smfmac_f32_16x16x64_bf16 v[76:79], v[40:43], v[200:207], v29
    v_smfmac_f32_16x16x64_bf16 v[72:75], v[44:47], v[208:215], v29
    v_smfmac_f32_16x16x64_bf16 v[76:79], v[44:47], v[216:223], v29
    v_smfmac_f32_16x16x64_bf16 v[72:75], v[48:51], v[224:231], v29
    v_smfmac_f32_16x16x64_bf16 v[76:79], v[48:51], v[232:239], v29
    v_smfmac_f32_16x16x64_bf16 v[72:75], v[52:55], v[240:247], v29
    v_smfmac_f32_16x16x64_bf16 v[76:79], v[52:55], v[248:255], v29
    s_nop 3
    s_nop 3
    v_permlane32_swap_b32 v72, v76
    v_permlane32_swap_b32 v73, v77
    v_permlane32_swap_b32 v74, v78
    v_permlane32_swap_b32 v75, v79
    v_pk_add_f32 v[72:73], v[72:73], v[76:77]
    v_pk_add_f32 v[74:75], v[74:75], v[78:79]
    ds_write_b128 v19, v[72:75]
    s_waitcnt lgkmcnt(0)
    s_barrier
    s_add_u32 s57, s21, 2
    s_cmp_ge_u32 s56, s57
    s_cbranch_scc1 L_wtd_68
    s_mov_b32 s38, 0
    s_mov_b32 exec_lo, 0x3
    s_mov_b32 exec_hi, 0x0
L_wt_67:
    buffer_load_dword v113, v31, s[4:7], 0 offen sc1
    s_waitcnt vmcnt(0)
    v_cmp_gt_u32 vcc, s57, v113
    s_cbranch_vccz L_wtk_69
    s_sleep 2
    s_add_u32 s38, s38, 1
    s_cmp_lt_u32 s38, 4194304
    s_cbranch_scc1 L_wt_67
    s_mov_b64 exec, -1
    s_branch L_end_1
L_wtk_69:
    s_nop 0
    v_readlane_b32 s56, v113, 0
    v_readlane_b32 s38, v113, 1
    s_nop 3
    s_min_u32 s56, s56, s38
    s_mov_b64 exec, -1
L_wtd_68:
    buffer_load_dwordx4 v[122:125], v25, s[4:7], s30 offen sc1
    buffer_load_dwordx4 v[92:95], v24, s[4:7], s29 offen sc1
    buffer_load_dwordx4 v[96:99], v24, s[4:7], s29 offen offset:64 sc1
    s_xor_b32 s22, s22, s23
    s_xor_b32 s23, s22, s23
    s_xor_b32 s22, s22, s23
    s_xor_b32 s24, s24, s25
    s_xor_b32 s25, s24, s25
    s_xor_b32 s24, s24, s25
    s_add_u32 s29, s29, 393216
    s_add_u32 s30, s30, 393216
    s_add_u32 s31, s31, 98304
    s_add_u32 s32, s32, 98304
    s_nop 0
    v_mov_b32 v72, 0
    v_mov_b32 v73, 0
    v_mov_b32 v74, 0
    v_mov_b32 v75, 0
    v_mov_b32 v76, 0
    v_mov_b32 v77, 0
    v_mov_b32 v78, 0
    v_mov_b32 v79, 0
    s_sleep 24
    buffer_load_dwordx4 v[56:59], v6, s[4:7], s26 offen sc1
    buffer_load_dwordx4 v[60:63], v7, s[4:7], s26 offen sc1
    buffer_load_dwordx4 v[64:67], v8, s[4:7], s26 offen sc1
    s_xor_b32 s26, s26, s27
    s_xor_b32 s27, s26, s27
    s_xor_b32 s26, s26, s27
    s_xor_b32 s28, s28, 262144
    s_add_u32 s21, s21, 1
    s_lshr_b32 s40, s21, 1
    s_and_b32 s40, s40, 1
    s_xor_b32 s40, s40, 1
    v_mov_b32 v30, s40
    s_mov_b32 s58, 1
    s_waitcnt vmcnt(0)
    v_max3_u32 v113, v56, v60, v64
    v_cmp_eq_u32 vcc, -1, v113
    s_cbranch_vccnz L_retry_70
L_ok_71:
    ds_write_b128 v2, v[56:59]
    ds_write_b128 v2, v[60:63] offset:4096
    ds_write_b128 v2, v[64:67] offset:8192
    s_waitcnt lgkmcnt(0)
    s_barrier
    s_branch L_step_57
L_slow_59:
    s_cmp_eq_u32 s58, 1
    s_cbranch_scc1 L_cont_60
    s_mov_b32 s58, 1
    s_mov_b32 s38, 0
L_sl_72:
    buffer_load_dwordx4 v[56:59], v6, s[4:7], s27 offen sc1
    buffer_load_dwordx4 v[60:63], v7, s[4:7], s27 offen sc1
    buffer_load_dwordx4 v[64:67], v8, s[4:7], s27 offen sc1
    s_waitcnt vmcnt(0)
    v_max3_u32 v113, v56, v60, v64
    v_cmp_eq_u32 vcc, -1, v113
    s_cbranch_vccz L_slk_73
    s_add_u32 s38, s38, 1
    s_cmp_lt_u32 s38, 4194304
    s_cbranch_scc1 L_sl_72
    s_branch L_end_1
L_slk_73:
    s_waitcnt lgkmcnt(0)
    s_barrier
    ds_write_b128 v2, v[56:59]
    ds_write_b128 v2, v[60:63] offset:4096
    ds_write_b128 v2, v[64:67] offset:8192
    s_nop 7
    s_nop 7
    v_mov_b32 v72, 0
    v_mov_b32 v73, 0
    v_mov_b32 v74, 0
    v_mov_b32 v75, 0
    v_mov_b32 v76, 0
    v_mov_b32 v77, 0
    v_mov_b32 v78, 0
    v_mov_b32 v79, 0
    v_mov_b32 v80, 0
    v_mov_b32 v81, 0
    v_mov_b32 v82, 0
    v_mov_b32 v83, 0
    s_waitcnt lgkmcnt(0)
    s_barrier
    s_branch L_step_57
L_retry_61:
    s_mov_b32 s38, 0
L_rl_74:
    s_mov_b64 exec, s[48:49]
    buffer_load_dwordx2 v[104:105], v12, s[4:7], s22 offen sc1
    buffer_load_dwordx2 v[106:107], v12, s[4:7], s22 offen offset:1536 sc1
    buffer_load_dwordx2 v[108:109], v12, s[4:7], s22 offen offset:3072 sc1
    s_mov_b64 exec, -1
    s_waitcnt vmcnt(0)
    v_max3_u32 v113, v104, v106, v108
    v_cmp_eq_u32 vcc, -1, v113
    s_cbranch_vccz L_ok_62
    s_add_u32 s38, s38, 1
    s_cmp_lt_u32 s38, 4194304
    s_cbranch_scc1 L_rl_74
    s_branch L_end_1
L_retry_65:
    s_mov_b32 s38, 0
L_rl_75:
    buffer_load_dwordx4 v[32:35], v17, s[4:7], s24 offen offset:0 sc1
    buffer_load_dwordx4 v[36:39], v17, s[4:7], s24 offen offset:1024 sc1
    buffer_load_dwordx4 v[40:43], v17, s[4:7], s24 offen offset:2048 sc1
    buffer_load_dwordx4 v[44:47], v17, s[4:7], s24 offen offset:3072 sc1
    buffer_load_dwordx4 v[48:51], v18, s[4:7], s24 offen offset:0 sc1
    buffer_load_dwordx4 v[52:55], v18, s[4:7], s24 offen offset:1024 sc1
    s_waitcnt vmcnt(0)
    v_max3_u32 v113, v32, v36, v40
    v_max3_u32 v114, v44, v48, v52
    v_max_u32 v113, v113, v114
    v_cmp_eq_u32 vcc, -1, v113
    s_cbranch_vccz L_ok_66
    s_add_u32 s38, s38, 1
    s_cmp_lt_u32 s38, 4194304
    s_cbranch_scc1 L_rl_75
    s_branch L_end_1
L_retry_70:
    s_mov_b32 s38, 0
L_rl_76:
    buffer_load_dwordx4 v[56:59], v6, s[4:7], s27 offen sc1
    buffer_load_dwordx4 v[60:63], v7, s[4:7], s27 offen sc1
    buffer_load_dwordx4 v[64:67], v8, s[4:7], s27 offen sc1
    s_waitcnt vmcnt(0)
    v_max3_u32 v113, v56, v60, v64
    v_cmp_eq_u32 vcc, -1, v113
    s_cbranch_vccz L_ok_71
    s_add_u32 s38, s38, 1
    s_cmp_lt_u32 s38, 4194304
    s_cbranch_scc1 L_rl_76
    s_branch L_end_1
L_exit_58:
    v_smfmac_f32_16x16x64_bf16 v[80:83], v[64:67], a[224:231], v29
    v_smfmac_f32_16x16x64_bf16 v[80:83], v[68:71], a[232:239], v29
    s_nop 7
    s_nop 1
    v_mov_b32 v156, v80
    v_mov_b32 v157, v81
    v_mov_b32 v158, v82
    v_mov_b32 v159, v83
    s_nop 0
    v_permlane32_swap_b32 v80, v156
    v_permlane32_swap_b32 v81, v157
    v_permlane32_swap_b32 v82, v158
    v_permlane32_swap_b32 v83, v159
    v_add_f32 v80, v80, v156
    v_add_f32 v81, v81, v157
    v_add_f32 v82, v82, v158
    v_add_f32 v83, v83, v159
    v_cvt_pk_bf16_f32 v156, v80, v81
    v_cvt_pk_bf16_f32 v157, v82, v83
    s_nop 1
    v_permlane16_swap_b32 v156, v158
    v_permlane16_swap_b32 v157, v159
    s_mov_b64 exec, s[54:55]
    buffer_store_dwordx4 v[156:159], v28, s[4:7], s32 offen
    s_mov_b64 exec, -1
    v_mov_b32 v80, 0
    v_mov_b32 v81, 0
    v_mov_b32 v82, 0
    v_mov_b32 v83, 0
    s_waitcnt vmcnt(0)
    s_barrier
    s_branch L_done_27
L_var12_30:
L_step_77:
    ds_read_b64_tr_b16 v[32:33], v4 offset:0
    ds_read_b64_tr_b16 v[34:35], v5 offset:0
    ds_read_b64_tr_b16 v[36:37], v4 offset:1024
    ds_read_b64_tr_b16 v[38:39], v5 offset:1024
    ds_read_b64_tr_b16 v[40:41], v4 offset:2048
    ds_read_b64_tr_b16 v[42:43], v5 offset:2048
    ds_read_b64_tr_b16 v[44:45], v4 offset:3072
    ds_read_b64_tr_b16 v[46:47], v5 offset:3072
    ds_read_b64_tr_b16 v[48:49], v4 offset:4096
    ds_read_b64_tr_b16 v[50:51], v5 offset:4096
    ds_read_b64_tr_b16 v[52:53], v4 offset:5120
    ds_read_b64_tr_b16 v[54:55], v5 offset:5120
    ds_read_b64_tr_b16 v[56:57], v4 offset:6144
    ds_read_b64_tr_b16 v[58:59], v5 offset:6144
    s_waitcnt lgkmcnt(12)
    v_smfmac_f32_16x16x64_bf16 v[72:75], v[32:35], a[0:7], v29
    v_smfmac_f32_16x16x64_bf16 v[76:79], v[32:35], a[80:87], v29
    ds_read_b64_tr_b16 v[60:61], v4 offset:7168
    ds_read_b64_tr_b16 v[62:63], v5 offset:7168
    s_waitcnt lgkmcnt(12)
    v_smfmac_f32_16x16x64_bf16 v[72:75], v[36:39], a[8:15], v29
    v_smfmac_f32_16x16x64_bf16 v[76:79], v[36:39], a[88:95], v29
    ds_read_b64_tr_b16 v[64:65], v4 offset:8192
    ds_read_b64_tr_b16 v[66:67], v5 offset:8192
    s_waitcnt lgkmcnt(12)
    v_smfmac_f32_16x16x64_bf16 v[72:75], v[40:43], a[16:23], v29
    v_smfmac_f32_16x16x64_bf16 v[76:79], v[40:43], a[96:103], v29
    ds_read_b64_tr_b16 v[68:69], v4 offset:9216
    ds_read_b64_tr_b16 v[70:71], v5 offset:9216
    s_waitcnt lgkmcnt(12)
    v_smfmac_f32_16x16x64_bf16 v[72:75], v[44:47], a[24:31], v29
    v_smfmac_f32_16x16x64_bf16 v[76:79], v[44:47], a[104:111], v29
    s_waitcnt lgkmcnt(10)
    v_smfmac_f32_16x16x64_bf16 v[72:75], v[48:51], a[32:39], v29
    v_smfmac_f32_16x16x64_bf16 v[76:79], v[48:51], a[112:119], v29
    s_waitcnt lgkmcnt(8)
    v_smfmac_f32_16x16x64_bf16 v[72:75], v[52:55], a[40:47], v29
    v_smfmac_f32_16x16x64_bf16 v[76:79], v[52:55], a[120:127], v29
    s_waitcnt lgkmcnt(6)
    v_smfmac_f32_16x16x64_bf16 v[72:75], v[56:59], a[48:55], v29
    v_smfmac_f32_16x16x64_bf16 v[76:79], v[56:59], a[128:135], v29
    s_waitcnt lgkmcnt(4)
    v_smfmac_f32_16x16x64_bf16 v[72:75], v[60:63], a[56:63], v29
    v_smfmac_f32_16x16x64_bf16 v[76:79], v[60:63], a[136:143], v29
    s_waitcnt lgkmcnt(2)
    v_smfmac_f32_16x16x64_bf16 v[72:75], v[64:67], a[64:71], v29
    v_smfmac_f32_16x16x64_bf16 v[76:79], v[64:67], a[144:151], v29
    s_waitcnt lgkmcnt(0)
    v_smfmac_f32_16x16x64_bf16 v[72:75], v[68:71], a[72:79], v29
    v_smfmac_f32_16x16x64_bf16 v[76:79], v[68:71], a[152:159], v29
    v_smfmac_f32_16x16x64_bf16 v[80:83], v[32:35], a[160:167], v29
    v_smfmac_f32_16x16x64_bf16 v[80:83], v[36:39], a[168:175], v29
    s_nop 0
    v_permlane32_swap_b32 v72, v76
    v_permlane32_swap_b32 v73, v77
    v_permlane32_swap_b32 v74, v78
    v_permlane32_swap_b32 v75, v79
    v_add_f32 v72, v72, v76
    v_add_f32 v73, v73, v77
    v_cvt_pk_bf16_f32 v156, v72, v73
    v_add_f32 v74, v74, v78
    v_add_f32 v75, v75, v79
    v_cvt_pk_bf16_f32 v157, v74, v75
    ds_write_b64 v9, v[156:157]
    v_cmp_u_f32 vcc, v72, v73
    s_cbranch_vccnz L_slow_79
L_cont_80:
    v_smfmac_f32_16x16x64_bf16 v[80:83], v[40:43], a[176:183], v29
    v_smfmac_f32_16x16x64_bf16 v[80:83], v[44:47], a[184:191], v29
    s_waitcnt lgkmcnt(0)
    s_barrier
    ds_read_b64_tr_b16 v[84:85], v10
    ds_read_b64_tr_b16 v[86:87], v10 offset:64
    ds_read_b64_tr_b16 v[88:89], v10 offset:512
    ds_read_b64_tr_b16 v[90:91], v10 offset:576
    v_smfmac_f32_16x16x64_bf16 v[80:83], v[48:51], a[192:199], v29
    v_smfmac_f32_16x16x64_bf16 v[80:83], v[52:55], a[200:207], v29
    s_waitcnt lgkmcnt(2)
    v_mfma_f32_16x16x32_bf16 v[100:103], v[92:95], v[84:87], 0
    s_waitcnt lgkmcnt(0)
    v_mfma_f32_16x16x32_bf16 v[100:103], v[96:99], v[88:91], v[100:103]
    v_smfmac_f32_16x16x64_bf16 v[80:83], v[56:59], a[208:215], v29
    v_smfmac_f32_16x16x64_bf16 v[80:83], v[60:63], a[216:223], v29
    s_cmp_eq_u32 s21, 63
    s_cbranch_scc1 L_exit_78
    s_mov_b64 exec, s[34:35]
    s_nop 0
    buffer_store_dwordx4 v[100:103], v11, s[4:7], s22 offen
    buffer_store_dwordx4 v[150:153], v11, s[4:7], s23 offen
    s_mov_b64 exec, s[46:47]
    buffer_store_dwordx4 v[150:153], v16, s[4:7], s25 offen
    s_mov_b64 exec, -1
    v_smfmac_f32_16x16x64_bf16 v[80:83], v[64:67], a[224:231], v29
    v_smfmac_f32_16x16x64_bf16 v[80:83], v[68:71], a[232:239], v29
    v_mov_b32 v72, 0
    v_mov_b32 v73, 0
    v_mov_b32 v74, 0
    v_mov_b32 v75, 0
    v_mov_b32 v76, 0
    v_mov_b32 v77, 0
    v_mov_b32 v78, 0
    v_mov_b32 v79, 0
    v_cvt_pk_bf16_f32 v130, v80, v81
    v_cvt_pk_bf16_f32 v131, v82, v83
    s_sleep 2
    s_mov_b64 exec, s[48:49]
    buffer_load_dwordx2 v[104:105], v12, s[4:7], s22 offen sc1
    buffer_load_dwordx2 v[106:107], v12, s[4:7], s22 offen offset:1536 sc1
    buffer_load_dwordx2 v[108:109], v12, s[4:7], s22 offen offset:3072 sc1
    s_mov_b64 exec, -1
    s_waitcnt vmcnt(0)
    v_max3_u32 v113, v104, v106, v108
    v_cmp_eq_u32 vcc, -1, v113
    s_cbranch_vccnz L_retry_81
L_ok_82:
    v_pk_add_f32 v[110:111], v[104:105], v[106:107]
    v_pk_add_f32 v[110:111], v[110:111], v[108:109]
    v_max_f32 v112, v110, v111
    s_nop 1
    v_max_f32_dpp v112, v112, v112 row_ror:8 row_mask:0xf bank_mask:0xf
    s_nop 1
    v_max_f32_dpp v112, v112, v112 row_ror:4 row_mask:0xf bank_mask:0xf
    s_nop 1
    v_max_f32_dpp v112, v112, v112 row_ror:2 row_mask:0xf bank_mask:0xf
    s_nop 1
    v_max_f32_dpp v112, v112, v112 row_ror:1 row_mask:0xf bank_mask:0xf
    v_mov_b32 v113, v112
    s_nop 1
    v_permlane16_swap_b32 v112, v113
    v_max_f32 v112, v112, v113
    v_mul_f32 v112, s33, v112
    v_fma_f32 v114, v110, s33, -v112
    v_fma_f32 v115, v111, s33, -v112
    v_exp_f32 v114, v114
    v_exp_f32 v115, v115
    s_mov_b64 exec, s[48:49]
    v_cvt_pk_bf16_f32 v114, v114, v115
    ds_write_b32 v13, v114
    s_mov_b64 exec, -1
    s_waitcnt lgkmcnt(0)
    s_barrier
    ds_read_b128 v[116:119], v14
    ds_read_b64 v[120:121], v15
    s_waitcnt lgkmcnt(1)
    v_mfma_f32_16x16x32_bf16 v[136:139], v[140:143], v[116:119], 0
    v_mfma_f32_16x16x32_bf16 v[132:135], v[122:125], v[116:119], 0
    s_waitcnt lgkmcnt(0)
    v_mfma_f32_16x16x16_bf16 v[136:139], v[144:145], v[120:121], v[136:139]
    v_mfma_f32_16x16x16_bf16 v[132:135], v[130:131], v[120:121], v[132:135]
    s_nop 6
    v_rcp_f32 v113, v136
    s_nop 0
    v_mul_f32 v132, v132, v113
    v_mul_f32 v133, v133, v113
    v_mul_f32 v134, v134, v113
    v_mul_f32 v135, v135, v113
    v_cvt_pk_bf16_f32 v146, v132, v133
    v_cvt_pk_bf16_f32 v147, v134, v135
    v_min_u32 v146, s39, v146
    s_nop 0
    v_permlane16_swap_b32 v147, v149
    v_permlane16_swap_b32 v146, v148
    s_mov_b64 exec, s[46:47]
    buffer_store_dwordx4 v[146:149], v16, s[4:7], s24 offen
    s_mov_b64 exec, -1
    v_mov_b32 v156, v80
    v_mov_b32 v157, v81
    v_mov_b32 v158, v82
    v_mov_b32 v159, v83
    s_nop 0
    v_permlane32_swap_b32 v80, v156
    v_permlane32_swap_b32 v81, v157
    v_permlane32_swap_b32 v82, v158
    v_permlane32_swap_b32 v83, v159
    v_add_f32 v80, v80, v156
    v_add_f32 v81, v81, v157
    v_add_f32 v82, v82, v158
    v_add_f32 v83, v83, v159
    v_cvt_pk_bf16_f32 v156, v80, v81
    v_cvt_pk_bf16_f32 v157, v82, v83
    s_nop 1
    v_permlane16_swap_b32 v156, v158
    v_permlane16_swap_b32 v157, v159
    s_mov_b64 exec, s[54:55]
    buffer_store_dwordx4 v[156:159], v28, s[4:7], s32 offen
    s_mov_b64 exec, -1
    v_mov_b32 v80, 0
    v_mov_b32 v81, 0
    v_mov_b32 v82, 0
    v_mov_b32 v83, 0
    buffer_load_dwordx4 v[32:35], v17, s[4:7], s24 offen offset:0 sc1
    buffer_load_dwordx4 v[36:39], v17, s[4:7], s24 offen offset:1024 sc1
    buffer_load_dwordx4 v[40:43], v17, s[4:7], s24 offen offset:2048 sc1
    buffer_load_dwordx4 v[44:47], v17, s[4:7], s24 offen offset:3072 sc1
    buffer_load_dwordx4 v[48:51], v18, s[4:7], s24 offen offset:0 sc1
    buffer_load_dwordx4 v[52:55], v18, s[4:7], s24 offen offset:1024 sc1
    s_waitcnt vmcnt(0)
    v_max3_u32 v113, v32, v36, v40
    v_max3_u32 v114, v44, v48, v52
    v_max_u32 v113, v113, v114
    v_cmp_eq_u32 vcc, -1, v113
    s_cbranch_vccnz L_retry_85
L_ok_86:
    v_smfmac_f32_16x16x64_bf16 v[72:75], v[32:35], v[160:167], v29
    v_smfmac_f32_16x16x64_bf16 v[76:79], v[32:35], v[168:175], v29
    v_smfmac_f32_16x16x64_bf16 v[72:75], v[36:39], v[176:183], v29
    v_smfmac_f32_16x16x64_bf16 v[76:79], v[36:39], v[184:191], v29
    v_smfmac_f32_16x16x64_bf16 v[72:75], v[40:43], v[192:199], v29
    v_smfmac_f32_16x16x64_bf16 v[76:79], v[40:43], v[200:207], v29
    v_smfmac_f32_16x16x64_bf16 v[72:75], v[44:47], v[208:215], v29
    v_smfmac_f32_16x16x64_bf16 v[76:79], v[44:47], v[216:223], v29
    v_smfmac_f32_16x16x64_bf16 v[72:75], v[48:51], v[224:231], v29
    v_smfmac_f32_16x16x64_bf16 v[76:79], v[48:51], v[232:239], v29
    v_smfmac_f32_16x16x64_bf16 v[72:75], v[52:55], v[240:247], v29
    v_smfmac_f32_16x16x64_bf16 v[76:79], v[52:55], v[248:255], v29
    s_nop 3
    s_nop 3
    v_permlane32_swap_b32 v72, v76
    v_permlane32_swap_b32 v73, v77
    v_permlane32_swap_b32 v74, v78
    v_permlane32_swap_b32 v75, v79
    v_pk_add_f32 v[72:73], v[72:73], v[76:77]
    v_pk_add_f32 v[74:75], v[74:75], v[78:79]
    ds_write_b128 v19, v[72:75]
    s_waitcnt lgkmcnt(0)
    s_barrier
    s_add_u32 s57, s21, 2
    s_cmp_ge_u32 s56, s57
    s_cbranch_scc1 L_wtd_88
    s_mov_b32 s38, 0
    s_mov_b32 exec_lo, 0x3
    s_mov_b32 exec_hi, 0x0
L_wt_87:
    buffer_load_dword v113, v31, s[4:7], 0 offen sc1
    s_waitcnt vmcnt(0)
    v_cmp_gt_u32 vcc, s57, v113
    s_cbranch_vccz L_wtk_89
    s_sleep 2
    s_add_u32 s38, s38, 1
    s_cmp_lt_u32 s38, 4194304
    s_cbranch_scc1 L_wt_87
    s_mov_b64 exec, -1
    s_branch L_end_1
L_wtk_89:
    s_nop 0
    v_readlane_b32 s56, v113, 0
    v_readlane_b32 s38, v113, 1
    s_nop 3
    s_min_u32 s56, s56, s38
    s_mov_b64 exec, -1
L_wtd_88:
    buffer_load_dwordx4 v[122:125], v25, s[4:7], s30 offen sc1
    buffer_load_dwordx4 v[92:95], v24, s[4:7], s29 offen sc1
    buffer_load_dwordx4 v[96:99], v24, s[4:7], s29 offen offset:64 sc1
    s_xor_b32 s22, s22, s23
    s_xor_b32 s23, s22, s23
    s_xor_b32 s22, s22, s23
    s_xor_b32 s24, s24, s25
    s_xor_b32 s25, s24, s25
    s_xor_b32 s24, s24, s25
    s_add_u32 s29, s29, 393216
    s_add_u32 s30, s30, 393216
    s_add_u32 s31, s31, 98304
    s_add_u32 s32, s32, 98304
    s_nop 0
    v_mov_b32 v72, 0
    v_mov_b32 v73, 0
    v_mov_b32 v74, 0
    v_mov_b32 v75, 0
    v_mov_b32 v76, 0
    v_mov_b32 v77, 0
    v_mov_b32 v78, 0
    v_mov_b32 v79, 0
    s_sleep 24
    buffer_load_dwordx4 v[56:59], v6, s[4:7], s26 offen sc1
    buffer_load_dwordx4 v[60:63], v7, s[4:7], s26 offen sc1
    s_xor_b32 s26, s26, s27
    s_xor_b32 s27, s26, s27
    s_xor_b32 s26, s26, s27
    s_xor_b32 s28, s28, 262144
    s_add_u32 s21, s21, 1
    s_lshr_b32 s40, s21, 1
    s_and_b32 s40, s40, 1
    s_xor_b32 s40, s40, 1
    v_mov_b32 v30, s40
    s_mov_b32 s58, 1
    s_waitcnt vmcnt(0)
    v_max_u32 v113, v56, v60
    v_cmp_eq_u32 vcc, -1, v113
    s_cbranch_vccnz L_retry_90
L_ok_91:
    ds_write_b128 v2, v[56:59]
    ds_write_b128 v2, v[60:63] offset:4096
    s_waitcnt lgkmcnt(0)
    s_barrier
    s_branch L_step_77
L_slow_79:
    s_cmp_eq_u32 s58, 1
    s_cbranch_scc1 L_cont_80
    s_mov_b32 s58, 1
    s_mov_b32 s38, 0
L_sl_92:
    buffer_load_dwordx4 v[56:59], v6, s[4:7], s27 offen sc1
    buffer_load_dwordx4 v[60:63], v7, s[4:7], s27 offen sc1
    s_waitcnt vmcnt(0)
    v_max_u32 v113, v56, v60
    v_cmp_eq_u32 vcc, -1, v113
    s_cbranch_vccz L_slk_93
    s_add_u32 s38, s38, 1
    s_cmp_lt_u32 s38, 4194304
    s_cbranch_scc1 L_sl_92
    s_branch L_end_1
L_slk_93:
    s_waitcnt lgkmcnt(0)
    s_barrier
    ds_write_b128 v2, v[56:59]
    ds_write_b128 v2, v[60:63] offset:4096
    s_nop 7
    s_nop 7
    v_mov_b32 v72, 0
    v_mov_b32 v73, 0
    v_mov_b32 v74, 0
    v_mov_b32 v75, 0
    v_mov_b32 v76, 0
    v_mov_b32 v77, 0
    v_mov_b32 v78, 0
    v_mov_b32 v79, 0
    v_mov_b32 v80, 0
    v_mov_b32 v81, 0
    v_mov_b32 v82, 0
    v_mov_b32 v83, 0
    s_waitcnt lgkmcnt(0)
    s_barrier
    s_branch L_step_77
L_retry_81:
    s_mov_b32 s38, 0
L_rl_94:
    s_mov_b64 exec, s[48:49]
    buffer_load_dwordx2 v[104:105], v12, s[4:7], s22 offen sc1
    buffer_load_dwordx2 v[106:107], v12, s[4:7], s22 offen offset:1536 sc1
    buffer_load_dwordx2 v[108:109], v12, s[4:7], s22 offen offset:3072 sc1
    s_mov_b64 exec, -1
    s_waitcnt vmcnt(0)
    v_max3_u32 v113, v104, v106, v108
    v_cmp_eq_u32 vcc, -1, v113
    s_cbranch_vccz L_ok_82
    s_add_u32 s38, s38, 1
    s_cmp_lt_u32 s38, 4194304
    s_cbranch_scc1 L_rl_94
    s_branch L_end_1
L_retry_85:
    s_mov_b32 s38, 0
L_rl_95:
    buffer_load_dwordx4 v[32:35], v17, s[4:7], s24 offen offset:0 sc1
    buffer_load_dwordx4 v[36:39], v17, s[4:7], s24 offen offset:1024 sc1
    buffer_load_dwordx4 v[40:43], v17, s[4:7], s24 offen offset:2048 sc1
    buffer_load_dwordx4 v[44:47], v17, s[4:7], s24 offen offset:3072 sc1
    buffer_load_dwordx4 v[48:51], v18, s[4:7], s24 offen offset:0 sc1
    buffer_load_dwordx4 v[52:55], v18, s[4:7], s24 offen offset:1024 sc1
    s_waitcnt vmcnt(0)
    v_max3_u32 v113, v32, v36, v40
    v_max3_u32 v114, v44, v48, v52
    v_max_u32 v113, v113, v114
    v_cmp_eq_u32 vcc, -1, v113
    s_cbranch_vccz L_ok_86
    s_add_u32 s38, s38, 1
    s_cmp_lt_u32 s38, 4194304
    s_cbranch_scc1 L_rl_95
    s_branch L_end_1
L_retry_90:
    s_mov_b32 s38, 0
L_rl_96:
    buffer_load_dwordx4 v[56:59], v6, s[4:7], s27 offen sc1
    buffer_load_dwordx4 v[60:63], v7, s[4:7], s27 offen sc1
    s_waitcnt vmcnt(0)
    v_max_u32 v113, v56, v60
    v_cmp_eq_u32 vcc, -1, v113
    s_cbranch_vccz L_ok_91
    s_add_u32 s38, s38, 1
    s_cmp_lt_u32 s38, 4194304
    s_cbranch_scc1 L_rl_96
    s_branch L_end_1
L_exit_78:
    v_smfmac_f32_16x16x64_bf16 v[80:83], v[64:67], a[224:231], v29
    v_smfmac_f32_16x16x64_bf16 v[80:83], v[68:71], a[232:239], v29
    s_nop 7
    s_nop 1
    v_mov_b32 v156, v80
    v_mov_b32 v157, v81
    v_mov_b32 v158, v82
    v_mov_b32 v159, v83
    s_nop 0
    v_permlane32_swap_b32 v80, v156
    v_permlane32_swap_b32 v81, v157
    v_permlane32_swap_b32 v82, v158
    v_permlane32_swap_b32 v83, v159
    v_add_f32 v80, v80, v156
    v_add_f32 v81, v81, v157
    v_add_f32 v82, v82, v158
    v_add_f32 v83, v83, v159
    v_cvt_pk_bf16_f32 v156, v80, v81
    v_cvt_pk_bf16_f32 v157, v82, v83
    s_nop 1
    v_permlane16_swap_b32 v156, v158
    v_permlane16_swap_b32 v157, v159
    s_mov_b64 exec, s[54:55]
    buffer_store_dwordx4 v[156:159], v28, s[4:7], s32 offen
    s_mov_b64 exec, -1
    v_mov_b32 v80, 0
    v_mov_b32 v81, 0
    v_mov_b32 v82, 0
    v_mov_b32 v83, 0
    s_waitcnt vmcnt(0)
    s_barrier
    s_branch L_done_27
L_var13_31:
L_step_97:
    ds_read_b64_tr_b16 v[32:33], v4 offset:0
    ds_read_b64_tr_b16 v[34:35], v5 offset:0
    ds_read_b64_tr_b16 v[36:37], v4 offset:1024
    ds_read_b64_tr_b16 v[38:39], v5 offset:1024
    ds_read_b64_tr_b16 v[40:41], v4 offset:2048
    ds_read_b64_tr_b16 v[42:43], v5 offset:2048
    ds_read_b64_tr_b16 v[44:45], v4 offset:3072
    ds_read_b64_tr_b16 v[46:47], v5 offset:3072
    ds_read_b64_tr_b16 v[48:49], v4 offset:4096
    ds_read_b64_tr_b16 v[50:51], v5 offset:4096
    ds_read_b64_tr_b16 v[52:53], v4 offset:5120
    ds_read_b64_tr_b16 v[54:55], v5 offset:5120
    ds_read_b64_tr_b16 v[56:57], v4 offset:6144
    ds_read_b64_tr_b16 v[58:59], v5 offset:6144
    s_waitcnt lgkmcnt(12)
    v_smfmac_f32_16x16x64_bf16 v[72:75], v[32:35], a[0:7], v29
    v_smfmac_f32_16x16x64_bf16 v[76:79], v[32:35], a[80:87], v29
    ds_read_b64_tr_b16 v[60:61], v4 offset:7168
    ds_read_b64_tr_b16 v[62:63], v5 offset:7168
    s_waitcnt lgkmcnt(12)
    v_smfmac_f32_16x16x64_bf16 v[72:75], v[36:39], a[8:15], v29
    v_smfmac_f32_16x16x64_bf16 v[76:79], v[36:39], a[88:95], v29
    ds_read_b64_tr_b16 v[64:65], v4 offset:8192
    ds_read_b64_tr_b16 v[66:67], v5 offset:8192
    s_waitcnt lgkmcnt(12)
    v_smfmac_f32_16x16x64_bf16 v[72:75], v[40:43], a[16:23], v29
    v_smfmac_f32_16x16x64_bf16 v[76:79], v[40:43], a[96:103], v29
    ds_read_b64_tr_b16 v[68:69], v4 offset:9216
    ds_read_b64_tr_b16 v[70:71], v5 offset:9216
    s_waitcnt lgkmcnt(12)
    v_smfmac_f32_16x16x64_bf16 v[72:75], v[44:47], a[24:31], v29
    v_smfmac_f32_16x16x64_bf16 v[76:79], v[44:47], a[104:111], v29
    s_waitcnt lgkmcnt(10)
    v_smfmac_f32_16x16x64_bf16 v[72:75], v[48:51], a[32:39], v29
    v_smfmac_f32_16x16x64_bf16 v[76:79], v[48:51], a[112:119], v29
    s_waitcnt lgkmcnt(8)
    v_smfmac_f32_16x16x64_bf16 v[72:75], v[52:55], a[40:47], v29
    v_smfmac_f32_16x16x64_bf16 v[76:79], v[52:55], a[120:127], v29
    s_waitcnt lgkmcnt(6)
    v_smfmac_f32_16x16x64_bf16 v[72:75], v[56:59], a[48:55], v29
    v_smfmac_f32_16x16x64_bf16 v[76:79], v[56:59], a[128:135], v29
    s_waitcnt lgkmcnt(4)
    v_smfmac_f32_16x16x64_bf16 v[72:75], v[60:63], a[56:63], v29
    v_smfmac_f32_16x16x64_bf16 v[76:79], v[60:63], a[136:143], v29
    s_waitcnt lgkmcnt(2)
    v_smfmac_f32_16x16x64_bf16 v[72:75], v[64:67], a[64:71], v29
    v_smfmac_f32_16x16x64_bf16 v[76:79], v[64:67], a[144:151], v29
    s_waitcnt lgkmcnt(0)
    v_smfmac_f32_16x16x64_bf16 v[72:75], v[68:71], a[72:79], v29
    v_smfmac_f32_16x16x64_bf16 v[76:79], v[68:71], a[152:159], v29
    v_smfmac_f32_16x16x64_bf16 v[80:83], v[32:35], a[160:167], v29
    v_smfmac_f32_16x16x64_bf16 v[80:83], v[36:39], a[168:175], v29
    s_nop 0
    v_permlane32_swap_b32 v72, v76
    v_permlane32_swap_b32 v73, v77
    v_permlane32_swap_b32 v74, v78
    v_permlane32_swap_b32 v75, v79
    v_add_f32 v72, v72, v76
    v_add_f32 v73, v73, v77
    v_cvt_pk_bf16_f32 v156, v72, v73
    v_add_f32 v74, v74, v78
    v_add_f32 v75, v75, v79
    v_cvt_pk_bf16_f32 v157, v74, v75
    ds_write_b64 v9, v[156:157]
    v_cmp_u_f32 vcc, v72, v73
    s_cbranch_vccnz L_slow_99
L_cont_100:
    v_smfmac_f32_16x16x64_bf16 v[80:83], v[40:43], a[176:183], v29
    v_smfmac_f32_16x16x64_bf16 v[80:83], v[44:47], a[184:191], v29
    s_waitcnt lgkmcnt(0)
    s_barrier
    ds_read_b64_tr_b16 v[92:93], v10 offset:1024
    ds_read_b64_tr_b16 v[94:95], v10 offset:1088
    ds_read_b64_tr_b16 v[96:97], v10 offset:1536
    ds_read_b64_tr_b16 v[98:99], v10 offset:1600
    v_smfmac_f32_16x16x64_bf16 v[80:83], v[48:51], a[192:199], v29
    v_smfmac_f32_16x16x64_bf16 v[80:83], v[52:55], a[200:207], v29
    v_smfmac_f32_16x16x64_bf16 v[80:83], v[56:59], a[208:215], v29
    v_smfmac_f32_16x16x64_bf16 v[80:83], v[60:63], a[216:223], v29
    v_smfmac_f32_16x16x64_bf16 v[80:83], v[64:67], a[224:231], v29
    v_smfmac_f32_16x16x64_bf16 v[80:83], v[68:71], a[232:239], v29
    s_waitcnt lgkmcnt(0)
    s_cmp_eq_u32 s21, 63
    s_cbranch_scc1 L_exit_98
    s_mov_b64 exec, s[46:47]
    buffer_store_dwordx4 v[150:153], v16, s[4:7], s25 offen
    s_mov_b64 exec, -1
    v_mov_b32 v72, 0
    v_mov_b32 v73, 0
    v_mov_b32 v74, 0
    v_mov_b32 v75, 0
    v_mov_b32 v76, 0
    v_mov_b32 v77, 0
    v_mov_b32 v78, 0
    v_mov_b32 v79, 0
    v_cvt_pk_bf16_f32 v130, v80, v81
    v_cvt_pk_bf16_f32 v131, v82, v83
    s_sleep 2
    s_mov_b64 exec, s[48:49]
    buffer_load_dwordx2 v[104:105], v12, s[4:7], s22 offen sc1
    buffer_load_dwordx2 v[106:107], v12, s[4:7], s22 offen offset:1536 sc1
    buffer_load_dwordx2 v[108:109], v12, s[4:7], s22 offen offset:3072 sc1
    s_mov_b64 exec, -1
    s_waitcnt vmcnt(0)
    v_max3_u32 v113, v104, v106, v108
    v_cmp_eq_u32 vcc, -1, v113
    s_cbranch_vccnz L_retry_101
L_ok_102:
    v_pk_add_f32 v[110:111], v[104:105], v[106:107]
    v_pk_add_f32 v[110:111], v[110:111], v[108:109]
    v_max_f32 v112, v110, v111
    s_nop 1
    v_max_f32_dpp v112, v112, v112 row_ror:8 row_mask:0xf bank_mask:0xf
    s_nop 1
    v_max_f32_dpp v112, v112, v112 row_ror:4 row_mask:0xf bank_mask:0xf
    s_nop 1
    v_max_f32_dpp v112, v112, v112 row_ror:2 row_mask:0xf bank_mask:0xf
    s_nop 1
    v_max_f32_dpp v112, v112, v112 row_ror:1 row_mask:0xf bank_mask:0xf
    v_mov_b32 v113, v112
    s_nop 1
    v_permlane16_swap_b32 v112, v113
    v_max_f32 v112, v112, v113
    v_mul_f32 v112, s33, v112
    v_fma_f32 v114, v110, s33, -v112
    v_fma_f32 v115, v111, s33, -v112
    v_exp_f32 v114, v114
    v_exp_f32 v115, v115
    s_mov_b64 exec, s[48:49]
    v_cvt_pk_bf16_f32 v114, v114, v115
    ds_write_b32 v13, v114
    s_mov_b64 exec, -1
    s_waitcnt lgkmcnt(0)
    s_barrier
    ds_read_b128 v[116:119], v14
    ds_read_b64 v[120:121], v15
    s_waitcnt lgkmcnt(1)
    v_mfma_f32_16x16x32_bf16 v[136:139], v[140:143], v[116:119], 0
    v_mfma_f32_16x16x32_bf16 v[132:135], v[122:125], v[116:119], 0
    s_waitcnt lgkmcnt(0)
    v_mfma_f32_16x16x16_bf16 v[136:139], v[144:145], v[120:121], v[136:139]
    v_mfma_f32_16x16x16_bf16 v[132:135], v[130:131], v[120:121], v[132:135]
    s_nop 6
    v_rcp_f32 v113, v136
    s_nop 0
    v_mul_f32 v132, v132, v113
    v_mul_f32 v133, v133, v113
    v_mul_f32 v134, v134, v113
    v_mul_f32 v135, v135, v113
    v_cvt_pk_bf16_f32 v146, v132, v133
    v_cvt_pk_bf16_f32 v147, v134, v135
    v_min_u32 v146, s39, v146
    s_nop 0
    v_permlane16_swap_b32 v147, v149
    v_permlane16_swap_b32 v146, v148
    s_mov_b64 exec, s[46:47]
    buffer_store_dwordx4 v[146:149], v16, s[4:7], s24 offen
    s_mov_b64 exec, -1
    s_mov_b64 exec, s[52:53]
    buffer_store_dwordx4 v[92:95], v27, s[4:7], s31 offen
    buffer_store_dwordx4 v[96:99], v27, s[4:7], s31 offen offset:64
    s_mov_b64 exec, -1
    v_mov_b32 v156, v80
    v_mov_b32 v157, v81
    v_mov_b32 v158, v82
    v_mov_b32 v159, v83
    s_nop 0
    v_permlane32_swap_b32 v80, v156
    v_permlane32_swap_b32 v81, v157
    v_permlane32_swap_b32 v82, v158
    v_permlane32_swap_b32 v83, v159
    v_add_f32 v80, v80, v156
    v_add_f32 v81, v81, v157
    v_add_f32 v82, v82, v158
    v_add_f32 v83, v83, v159
    v_cvt_pk_bf16_f32 v156, v80, v81
    v_cvt_pk_bf16_f32 v157, v82, v83
    s_nop 1
    v_permlane16_swap_b32 v156, v158
    v_permlane16_swap_b32 v157, v159
    s_mov_b64 exec, s[54:55]
    buffer_store_dwordx4 v[156:159], v28, s[4:7], s32 offen
    s_mov_b64 exec, -1
    v_mov_b32 v80, 0
    v_mov_b32 v81, 0
    v_mov_b32 v82, 0
    v_mov_b32 v83, 0
    buffer_load_dwordx4 v[32:35], v17, s[4:7], s24 offen offset:0 sc1
    buffer_load_dwordx4 v[36:39], v17, s[4:7], s24 offen offset:1024 sc1
    buffer_load_dwordx4 v[40:43], v17, s[4:7], s24 offen offset:2048 sc1
    buffer_load_dwordx4 v[44:47], v17, s[4:7], s24 offen offset:3072 sc1
    buffer_load_dwordx4 v[48:51], v18, s[4:7], s24 offen offset:0 sc1
    buffer_load_dwordx4 v[52:55], v18, s[4:7], s24 offen offset:1024 sc1
    s_waitcnt vmcnt(0)
    v_max3_u32 v113, v32, v36, v40
    v_max3_u32 v114, v44, v48, v52
    v_max_u32 v113, v113, v114
    v_cmp_eq_u32 vcc, -1, v113
    s_cbranch_vccnz L_retry_105
L_ok_106:
    v_smfmac_f32_16x16x64_bf16 v[72:75], v[32:35], v[160:167], v29
    v_smfmac_f32_16x16x64_bf16 v[76:79], v[32:35], v[168:175], v29
    v_smfmac_f32_16x16x64_bf16 v[72:75], v[36:39], v[176:183], v29
    v_smfmac_f32_16x16x64_bf16 v[76:79], v[36:39], v[184:191], v29
    v_smfmac_f32_16x16x64_bf16 v[72:75], v[40:43], v[192:199], v29
    v_smfmac_f32_16x16x64_bf16 v[76:79], v[40:43], v[200:207], v29
    v_smfmac_f32_16x16x64_bf16 v[72:75], v[44:47], v[208:215], v29
    v_smfmac_f32_16x16x64_bf16 v[76:79], v[44:47], v[216:223], v29
    v_smfmac_f32_16x16x64_bf16 v[72:75], v[48:51], v[224:231], v29
    v_smfmac_f32_16x16x64_bf16 v[76:79], v[48:51], v[232:239], v29
    v_smfmac_f32_16x16x64_bf16 v[72:75], v[52:55], v[240:247], v29
    v_smfmac_f32_16x16x64_bf16 v[76:79], v[52:55], v[248:255], v29
    s_nop 3
    s_nop 3
    v_permlane32_swap_b32 v72, v76
    v_permlane32_swap_b32 v73, v77
    v_permlane32_swap_b32 v74, v78
    v_permlane32_swap_b32 v75, v79
    v_pk_add_f32 v[72:73], v[72:73], v[76:77]
    v_pk_add_f32 v[74:75], v[74:75], v[78:79]
    ds_write_b128 v19, v[72:75]
    s_waitcnt lgkmcnt(0)
    s_barrier
    s_add_u32 s40, s21, 1
    v_mov_b32 v112, s40
    s_mov_b64 exec, 1
    buffer_store_dword v112, v155, s[4:7], 0 offen
    s_mov_b64 exec, -1
    s_add_u32 s57, s21, 2
    s_cmp_ge_u32 s56, s57
    s_cbranch_scc1 L_wtd_108
    s_mov_b32 s38, 0
    s_mov_b32 exec_lo, 0x3
    s_mov_b32 exec_hi, 0x0
L_wt_107:
    buffer_load_dword v113, v31, s[4:7], 0 offen sc1
    s_waitcnt vmcnt(0)
    v_cmp_gt_u32 vcc, s57, v113
    s_cbranch_vccz L_wtk_109
    s_sleep 2
    s_add_u32 s38, s38, 1
    s_cmp_lt_u32 s38, 4194304
    s_cbranch_scc1 L_wt_107
    s_mov_b64 exec, -1
    s_branch L_end_1
L_wtk_109:
    s_nop 0
    v_readlane_b32 s56, v113, 0
    v_readlane_b32 s38, v113, 1
    s_nop 3
    s_min_u32 s56, s56, s38
    s_mov_b64 exec, -1
L_wtd_108:
    buffer_load_dwordx4 v[122:125], v25, s[4:7], s30 offen sc1
    buffer_load_dwordx4 v[126:129], v26, s[4:7], s30 offen sc1
    s_xor_b32 s22, s22, s23
    s_xor_b32 s23, s22, s23
    s_xor_b32 s22, s22, s23
    s_xor_b32 s24, s24, s25
    s_xor_b32 s25, s24, s25
    s_xor_b32 s24, s24, s25
    s_add_u32 s29, s29, 393216
    s_add_u32 s30, s30, 393216
    s_add_u32 s31, s31, 98304
    s_add_u32 s32, s32, 98304
    s_nop 0
    v_mov_b32 v72, 0
    v_mov_b32 v73, 0
    v_mov_b32 v74, 0
    v_mov_b32 v75, 0
    v_mov_b32 v76, 0
    v_mov_b32 v77, 0
    v_mov_b32 v78, 0
    v_mov_b32 v79, 0
    s_sleep 24
    buffer_load_dwordx4 v[56:59], v6, s[4:7], s26 offen sc1
    buffer_load_dwordx4 v[60:63], v7, s[4:7], s26 offen sc1
    s_xor_b32 s26, s26, s27
    s_xor_b32 s27, s26, s27
    s_xor_b32 s26, s26, s27
    s_xor_b32 s28, s28, 262144
    s_add_u32 s21, s21, 1
    s_lshr_b32 s40, s21, 1
    s_and_b32 s40, s40, 1
    s_xor_b32 s40, s40, 1
    v_mov_b32 v30, s40
    s_mov_b32 s58, 1
    s_waitcnt vmcnt(0)
    v_max_u32 v113, v56, v60
    v_cmp_eq_u32 vcc, -1, v113
    s_cbranch_vccnz L_retry_110
L_ok_111:
    ds_write_b128 v2, v[56:59]
    ds_write_b128 v2, v[60:63] offset:4096
    ds_write_b128 v154, v[126:129]
    s_waitcnt lgkmcnt(0)
    s_barrier
    s_branch L_step_97
L_slow_99:
    s_cmp_eq_u32 s58, 1
    s_cbranch_scc1 L_cont_100
    s_mov_b32 s58, 1
    s_mov_b32 s38, 0
L_sl_112:
    buffer_load_dwordx4 v[56:59], v6, s[4:7], s27 offen sc1
    buffer_load_dwordx4 v[60:63], v7, s[4:7], s27 offen sc1
    s_waitcnt vmcnt(0)
    v_max_u32 v113, v56, v60
    v_cmp_eq_u32 vcc, -1, v113
    s_cbranch_vccz L_slk_113
    s_add_u32 s38, s38, 1
    s_cmp_lt_u32 s38, 4194304
    s_cbranch_scc1 L_sl_112
    s_branch L_end_1
L_slk_113:
    s_waitcnt lgkmcnt(0)
    s_barrier
    ds_write_b128 v2, v[56:59]
    ds_write_b128 v2, v[60:63] offset:4096
    s_nop 7
    s_nop 7
    v_mov_b32 v72, 0
    v_mov_b32 v73, 0
    v_mov_b32 v74, 0
    v_mov_b32 v75, 0
    v_mov_b32 v76, 0
    v_mov_b32 v77, 0
    v_mov_b32 v78, 0
    v_mov_b32 v79, 0
    v_mov_b32 v80, 0
    v_mov_b32 v81, 0
    v_mov_b32 v82, 0
    v_mov_b32 v83, 0
    s_waitcnt lgkmcnt(0)
    s_barrier
    s_branch L_step_97
L_retry_101:
    s_mov_b32 s38, 0
L_rl_114:
    s_mov_b64 exec, s[48:49]
    buffer_load_dwordx2 v[104:105], v12, s[4:7], s22 offen sc1
    buffer_load_dwordx2 v[106:107], v12, s[4:7], s22 offen offset:1536 sc1
    buffer_load_dwordx2 v[108:109], v12, s[4:7], s22 offen offset:3072 sc1
    s_mov_b64 exec, -1
    s_waitcnt vmcnt(0)
    v_max3_u32 v113, v104, v106, v108
    v_cmp_eq_u32 vcc, -1, v113
    s_cbranch_vccz L_ok_102
    s_add_u32 s38, s38, 1
    s_cmp_lt_u32 s38, 4194304
    s_cbranch_scc1 L_rl_114
    s_branch L_end_1
L_retry_105:
    s_mov_b32 s38, 0
L_rl_115:
    buffer_load_dwordx4 v[32:35], v17, s[4:7], s24 offen offset:0 sc1
    buffer_load_dwordx4 v[36:39], v17, s[4:7], s24 offen offset:1024 sc1
    buffer_load_dwordx4 v[40:43], v17, s[4:7], s24 offen offset:2048 sc1
    buffer_load_dwordx4 v[44:47], v17, s[4:7], s24 offen offset:3072 sc1
    buffer_load_dwordx4 v[48:51], v18, s[4:7], s24 offen offset:0 sc1
    buffer_load_dwordx4 v[52:55], v18, s[4:7], s24 offen offset:1024 sc1
    s_waitcnt vmcnt(0)
    v_max3_u32 v113, v32, v36, v40
    v_max3_u32 v114, v44, v48, v52
    v_max_u32 v113, v113, v114
    v_cmp_eq_u32 vcc, -1, v113
    s_cbranch_vccz L_ok_106
    s_add_u32 s38, s38, 1
    s_cmp_lt_u32 s38, 4194304
    s_cbranch_scc1 L_rl_115
    s_branch L_end_1
L_retry_110:
    s_mov_b32 s38, 0
L_rl_116:
    buffer_load_dwordx4 v[56:59], v6, s[4:7], s27 offen sc1
    buffer_load_dwordx4 v[60:63], v7, s[4:7], s27 offen sc1
    s_waitcnt vmcnt(0)
    v_max_u32 v113, v56, v60
    v_cmp_eq_u32 vcc, -1, v113
    s_cbranch_vccz L_ok_111
    s_add_u32 s38, s38, 1
    s_cmp_lt_u32 s38, 4194304
    s_cbranch_scc1 L_rl_116
    s_branch L_end_1
L_exit_98:
    s_nop 7
    s_nop 1
    s_mov_b64 exec, s[52:53]
    buffer_store_dwordx4 v[92:95], v27, s[4:7], s31 offen
    buffer_store_dwordx4 v[96:99], v27, s[4:7], s31 offen offset:64
    s_mov_b64 exec, -1
    v_mov_b32 v156, v80
    v_mov_b32 v157, v81
    v_mov_b32 v158, v82
    v_mov_b32 v159, v83
    s_nop 0
    v_permlane32_swap_b32 v80, v156
    v_permlane32_swap_b32 v81, v157
    v_permlane32_swap_b32 v82, v158
    v_permlane32_swap_b32 v83, v159
    v_add_f32 v80, v80, v156
    v_add_f32 v81, v81, v157
    v_add_f32 v82, v82, v158
    v_add_f32 v83, v83, v159
    v_cvt_pk_bf16_f32 v156, v80, v81
    v_cvt_pk_bf16_f32 v157, v82, v83
    s_nop 1
    v_permlane16_swap_b32 v156, v158
    v_permlane16_swap_b32 v157, v159
    s_mov_b64 exec, s[54:55]
    buffer_store_dwordx4 v[156:159], v28, s[4:7], s32 offen
    s_mov_b64 exec, -1
    v_mov_b32 v80, 0
    v_mov_b32 v81, 0
    v_mov_b32 v82, 0
    v_mov_b32 v83, 0
    s_waitcnt vmcnt(0)
    s_barrier
    v_mov_b32 v113, 64
    s_mov_b64 exec, 1
    buffer_store_dword v113, v155, s[4:7], 0 offen
    s_mov_b64 exec, -1
    s_branch L_done_27
L_var00_32:
L_step_117:
    ds_read_b64_tr_b16 v[32:33], v4 offset:0
    ds_read_b64_tr_b16 v[34:35], v5 offset:0
    ds_read_b64_tr_b16 v[36:37], v4 offset:1024
    ds_read_b64_tr_b16 v[38:39], v5 offset:1024
    ds_read_b64_tr_b16 v[40:41], v4 offset:2048
    ds_read_b64_tr_b16 v[42:43], v5 offset:2048
    ds_read_b64_tr_b16 v[44:45], v4 offset:3072
    ds_read_b64_tr_b16 v[46:47], v5 offset:3072
    ds_read_b64_tr_b16 v[48:49], v4 offset:4096
    ds_read_b64_tr_b16 v[50:51], v5 offset:4096
    ds_read_b64_tr_b16 v[52:53], v4 offset:5120
    ds_read_b64_tr_b16 v[54:55], v5 offset:5120
    ds_read_b64_tr_b16 v[56:57], v4 offset:6144
    ds_read_b64_tr_b16 v[58:59], v5 offset:6144
    s_waitcnt lgkmcnt(12)
    v_smfmac_f32_16x16x64_bf16 v[72:75], v[32:35], a[0:7], v29
    v_smfmac_f32_16x16x64_bf16 v[76:79], v[32:35], a[80:87], v29
    ds_read_b64_tr_b16 v[60:61], v4 offset:7168
    ds_read_b64_tr_b16 v[62:63], v5 offset:7168
    s_waitcnt lgkmcnt(12)
    v_smfmac_f32_16x16x64_bf16 v[72:75], v[36:39], a[8:15], v29
    v_smfmac_f32_16x16x64_bf16 v[76:79], v[36:39], a[88:95], v29
    ds_read_b64_tr_b16 v[64:65], v4 offset:8192
    ds_read_b64_tr_b16 v[66:67], v5 offset:8192
    s_waitcnt lgkmcnt(12)
    v_smfmac_f32_16x16x64_bf16 v[72:75], v[40:43], a[16:23], v29
    v_smfmac_f32_16x16x64_bf16 v[76:79], v[40:43], a[96:103], v29
    ds_read_b64_tr_b16 v[68:69], v4 offset:9216
    ds_read_b64_tr_b16 v[70:71], v5 offset:9216
    s_waitcnt lgkmcnt(12)
    v_smfmac_f32_16x16x64_bf16 v[72:75], v[44:47], a[24:31], v29
    v_smfmac_f32_16x16x64_bf16 v[76:79], v[44:47], a[104:111], v29
    s_waitcnt lgkmcnt(10)
    v_smfmac_f32_16x16x64_bf16 v[72:75], v[48:51], a[32:39], v29
    v_smfmac_f32_16x16x64_bf16 v[76:79], v[48:51], a[112:119], v29
    s_waitcnt lgkmcnt(8)
    v_smfmac_f32_16x16x64_bf16 v[72:75], v[52:55], a[40:47], v29
    v_smfmac_f32_16x16x64_bf16 v[76:79], v[52:55], a[120:127], v29
    s_waitcnt lgkmcnt(6)
    v_smfmac_f32_16x16x64_bf16 v[72:75], v[56:59], a[48:55], v29
    v_smfmac_f32_16x16x64_bf16 v[76:79], v[56:59], a[128:135], v29
    s_waitcnt lgkmcnt(4)
    v_smfmac_f32_16x16x64_bf16 v[72:75], v[60:63], a[56:63], v29
    v_smfmac_f32_16x16x64_bf16 v[76:79], v[60:63], a[136:143], v29
    s_waitcnt lgkmcnt(2)
    v_smfmac_f32_16x16x64_bf16 v[72:75], v[64:67], a[64:71], v29
    v_smfmac_f32_16x16x64_bf16 v[76:79], v[64:67], a[144:151], v29
    s_waitcnt lgkmcnt(0)
    v_smfmac_f32_16x16x64_bf16 v[72:75], v[68:71], a[72:79], v29
    v_smfmac_f32_16x16x64_bf16 v[76:79], v[68:71], a[152:159], v29
    v_smfmac_f32_16x16x64_bf16 v[80:83], v[32:35], a[160:167], v29
    v_smfmac_f32_16x16x64_bf16 v[80:83], v[36:39], a[168:175], v29
    s_nop 0
    v_permlane32_swap_b32 v72, v76
    v_permlane32_swap_b32 v73, v77
    v_permlane32_swap_b32 v74, v78
    v_permlane32_swap_b32 v75, v79
    v_add_f32 v72, v72, v76
    v_add_f32 v73, v73, v77
    v_cvt_pk_bf16_f32 v156, v72, v73
    v_add_f32 v74, v74, v78
    v_add_f32 v75, v75, v79
    v_cvt_pk_bf16_f32 v157, v74, v75
    ds_write_b64 v9, v[156:157]
    v_cmp_u_f32 vcc, v72, v73
    s_cbranch_vccnz L_slow_119
L_cont_120:
    v_smfmac_f32_16x16x64_bf16 v[80:83], v[40:43], a[176:183], v29
    v_smfmac_f32_16x16x64_bf16 v[80:83], v[44:47], a[184:191], v29
    s_waitcnt lgkmcnt(0)
    s_barrier
    ds_read_b64_tr_b16 v[84:85], v10
    ds_read_b64_tr_b16 v[86:87], v10 offset:64
    ds_read_b64_tr_b16 v[92:93], v10 offset:1024
    ds_read_b64_tr_b16 v[94:95], v10 offset:1088
    ds_read_b64_tr_b16 v[88:89], v10 offset:512
    ds_read_b64_tr_b16 v[90:91], v10 offset:576
    ds_read_b64_tr_b16 v[96:97], v10 offset:1536
    ds_read_b64_tr_b16 v[98:99], v10 offset:1600
    v_smfmac_f32_16x16x64_bf16 v[80:83], v[48:51], a[192:199], v29
    v_smfmac_f32_16x16x64_bf16 v[80:83], v[52:55], a[200:207], v29
    s_waitcnt lgkmcnt(4)
    v_mfma_f32_16x16x32_bf16 v[100:103], v[92:95], v[84:87], 0
    s_waitcnt lgkmcnt(0)
    v_mfma_f32_16x16x32_bf16 v[100:103], v[96:99], v[88:91], v[100:103]
    v_smfmac_f32_16x16x64_bf16 v[80:83], v[56:59], a[208:215], v29
    v_smfmac_f32_16x16x64_bf16 v[80:83], v[60:63], a[216:223], v29
    s_cmp_eq_u32 s21, 63
    s_cbranch_scc1 L_exit_118
    s_mov_b64 exec, s[34:35]
    s_nop 0
    buffer_store_dwordx4 v[100:103], v11, s[4:7], s22 offen
    buffer_store_dwordx4 v[150:153], v11, s[4:7], s23 offen
    s_mov_b64 exec, s[46:47]
    buffer_store_dwordx4 v[150:153], v16, s[4:7], s25 offen
    s_mov_b64 exec, -1
    v_smfmac_f32_16x16x64_bf16 v[80:83], v[64:67], a[224:231], v29
    v_smfmac_f32_16x16x64_bf16 v[80:83], v[68:71], a[232:239], v29
    ds_read_b128 v[122:125], v154
    v_mov_b32 v72, 0
    v_mov_b32 v73, 0
    v_mov_b32 v74, 0
    v_mov_b32 v75, 0
    v_mov_b32 v76, 0
    v_mov_b32 v77, 0
    v_mov_b32 v78, 0
    v_mov_b32 v79, 0
    v_cvt_pk_bf16_f32 v130, v80, v81
    v_cvt_pk_bf16_f32 v131, v82, v83
    s_sleep 2
    s_mov_b64 exec, s[48:49]
    buffer_load_dwordx2 v[104:105], v12, s[4:7], s22 offen sc1
    buffer_load_dwordx2 v[106:107], v12, s[4:7], s22 offen offset:1536 sc1
    buffer_load_dwordx2 v[108:109], v12, s[4:7], s22 offen offset:3072 sc1
    s_mov_b64 exec, -1
    s_waitcnt vmcnt(0)
    v_max3_u32 v113, v104, v106, v108
    v_cmp_eq_u32 vcc, -1, v113
    s_cbranch_vccnz L_retry_121
L_ok_122:
    v_pk_add_f32 v[110:111], v[104:105], v[106:107]
    v_pk_add_f32 v[110:111], v[110:111], v[108:109]
    v_max_f32 v112, v110, v111
    s_nop 1
    v_max_f32_dpp v112, v112, v112 row_ror:8 row_mask:0xf bank_mask:0xf
    s_nop 1
    v_max_f32_dpp v112, v112, v112 row_ror:4 row_mask:0xf bank_mask:0xf
    s_nop 1
    v_max_f32_dpp v112, v112, v112 row_ror:2 row_mask:0xf bank_mask:0xf
    s_nop 1
    v_max_f32_dpp v112, v112, v112 row_ror:1 row_mask:0xf bank_mask:0xf
    v_mov_b32 v113, v112
    s_nop 1
    v_permlane16_swap_b32 v112, v113
    v_max_f32 v112, v112, v113
    v_mul_f32 v112, s33, v112
    v_fma_f32 v114, v110, s33, -v112
    v_fma_f32 v115, v111, s33, -v112
    v_exp_f32 v114, v114
    v_exp_f32 v115, v115
    s_mov_b64 exec, s[48:49]
    v_cvt_pk_bf16_f32 v114, v114, v115
    ds_write_b32 v13, v114
    s_mov_b64 exec, -1
    s_waitcnt lgkmcnt(0)
    s_barrier
    ds_read_b128 v[116:119], v14
    ds_read_b64 v[120:121], v15
    s_waitcnt lgkmcnt(1)
    v_mfma_f32_16x16x32_bf16 v[136:139], v[140:143], v[116:119], 0
    v_mfma_f32_16x16x32_bf16 v[132:135], v[122:125], v[116:119], 0
    s_waitcnt lgkmcnt(0)
    v_mfma_f32_16x16x16_bf16 v[136:139], v[144:145], v[120:121], v[136:139]
    v_mfma_f32_16x16x16_bf16 v[132:135], v[130:131], v[120:121], v[132:135]
    s_nop 6
    v_rcp_f32 v113, v136
    s_nop 0
    v_mul_f32 v132, v132, v113
    v_mul_f32 v133, v133, v113
    v_mul_f32 v134, v134, v113
    v_mul_f32 v135, v135, v113
    v_cvt_pk_bf16_f32 v146, v132, v133
    v_cvt_pk_bf16_f32 v147, v134, v135
    v_min_u32 v146, s39, v146
    s_nop 0
    v_permlane16_swap_b32 v147, v149
    v_permlane16_swap_b32 v146, v148
    s_mov_b64 exec, s[46:47]
    buffer_store_dwordx4 v[146:149], v16, s[4:7], s24 offen
    s_mov_b64 exec, -1
    v_mov_b32 v156, v80
    v_mov_b32 v157, v81
    v_mov_b32 v158, v82
    v_mov_b32 v159, v83
    s_nop 0
    v_permlane32_swap_b32 v80, v156
    v_permlane32_swap_b32 v81, v157
    v_permlane32_swap_b32 v82, v158
    v_permlane32_swap_b32 v83, v159
    v_add_f32 v80, v80, v156
    v_add_f32 v81, v81, v157
    v_add_f32 v82, v82, v158
    v_add_f32 v83, v83, v159
    v_cvt_pk_bf16_f32 v156, v80, v81
    v_cvt_pk_bf16_f32 v157, v82, v83
    s_nop 1
    v_permlane16_swap_b32 v156, v158
    v_permlane16_swap_b32 v157, v159
    s_mov_b64 exec, s[54:55]
    buffer_store_dwordx4 v[156:159], v28, s[4:7], s32 offen
    s_mov_b64 exec, -1
    v_mov_b32 v80, 0
    v_mov_b32 v81, 0
    v_mov_b32 v82, 0
    v_mov_b32 v83, 0
    s_waitcnt vmcnt(0)
    s_barrier
    s_xor_b32 s22, s22, s23
    s_xor_b32 s23, s22, s23
    s_xor_b32 s22, s22, s23
    s_xor_b32 s24, s24, s25
    s_xor_b32 s25, s24, s25
    s_xor_b32 s24, s24, s25
    s_add_u32 s29, s29, 393216
    s_add_u32 s30, s30, 393216
    s_add_u32 s31, s31, 98304
    s_add_u32 s32, s32, 98304
    s_nop 0
    v_mov_b32 v72, 0
    v_mov_b32 v73, 0
    v_mov_b32 v74, 0
    v_mov_b32 v75, 0
    v_mov_b32 v76, 0
    v_mov_b32 v77, 0
    v_mov_b32 v78, 0
    v_mov_b32 v79, 0
    s_sleep 28
    buffer_load_dwordx4 v[56:59], v6, s[4:7], s26 offen sc1
    buffer_load_dwordx4 v[60:63], v7, s[4:7], s26 offen sc1
    buffer_load_dwordx4 v[64:67], v8, s[4:7], s26 offen sc1
    s_xor_b32 s26, s26, s27
    s_xor_b32 s27, s26, s27
    s_xor_b32 s26, s26, s27
    s_xor_b32 s28, s28, 262144
    s_add_u32 s21, s21, 1
    s_lshr_b32 s40, s21, 1
    s_and_b32 s40, s40, 1
    s_xor_b32 s40, s40, 1
    v_mov_b32 v30, s40
    s_mov_b32 s58, 1
    s_waitcnt vmcnt(0)
    v_max3_u32 v113, v56, v60, v64
    v_cmp_eq_u32 vcc, -1, v113
    s_cbranch_vccnz L_retry_123
L_ok_124:
    ds_write_b128 v2, v[56:59]
    ds_write_b128 v2, v[60:63] offset:4096
    ds_write_b128 v2, v[64:67] offset:8192
    s_waitcnt lgkmcnt(0)
    s_barrier
    s_branch L_step_117
L_slow_119:
    s_cmp_eq_u32 s58, 1
    s_cbranch_scc1 L_cont_120
    s_mov_b32 s58, 1
    s_mov_b32 s38, 0
L_sl_125:
    buffer_load_dwordx4 v[56:59], v6, s[4:7], s27 offen sc1
    buffer_load_dwordx4 v[60:63], v7, s[4:7], s27 offen sc1
    buffer_load_dwordx4 v[64:67], v8, s[4:7], s27 offen sc1
    s_waitcnt vmcnt(0)
    v_max3_u32 v113, v56, v60, v64
    v_cmp_eq_u32 vcc, -1, v113
    s_cbranch_vccz L_slk_126
    s_add_u32 s38, s38, 1
    s_cmp_lt_u32 s38, 4194304
    s_cbranch_scc1 L_sl_125
    s_branch L_end_1
L_slk_126:
    s_waitcnt lgkmcnt(0)
    s_barrier
    ds_write_b128 v2, v[56:59]
    ds_write_b128 v2, v[60:63] offset:4096
    ds_write_b128 v2, v[64:67] offset:8192
    s_nop 7
    s_nop 7
    v_mov_b32 v72, 0
    v_mov_b32 v73, 0
    v_mov_b32 v74, 0
    v_mov_b32 v75, 0
    v_mov_b32 v76, 0
    v_mov_b32 v77, 0
    v_mov_b32 v78, 0
    v_mov_b32 v79, 0
    v_mov_b32 v80, 0
    v_mov_b32 v81, 0
    v_mov_b32 v82, 0
    v_mov_b32 v83, 0
    s_waitcnt lgkmcnt(0)
    s_barrier
    s_branch L_step_117
L_retry_121:
    s_mov_b32 s38, 0
L_rl_127:
    s_mov_b64 exec, s[48:49]
    buffer_load_dwordx2 v[104:105], v12, s[4:7], s22 offen sc1
    buffer_load_dwordx2 v[106:107], v12, s[4:7], s22 offen offset:1536 sc1
    buffer_load_dwordx2 v[108:109], v12, s[4:7], s22 offen offset:3072 sc1
    s_mov_b64 exec, -1
    s_waitcnt vmcnt(0)
    v_max3_u32 v113, v104, v106, v108
    v_cmp_eq_u32 vcc, -1, v113
    s_cbranch_vccz L_ok_122
    s_add_u32 s38, s38, 1
    s_cmp_lt_u32 s38, 4194304
    s_cbranch_scc1 L_rl_127
    s_branch L_end_1
L_retry_123:
    s_mov_b32 s38, 0
L_rl_128:
    buffer_load_dwordx4 v[56:59], v6, s[4:7], s27 offen sc1
    buffer_load_dwordx4 v[60:63], v7, s[4:7], s27 offen sc1
    buffer_load_dwordx4 v[64:67], v8, s[4:7], s27 offen sc1
    s_waitcnt vmcnt(0)
    v_max3_u32 v113, v56, v60, v64
    v_cmp_eq_u32 vcc, -1, v113
    s_cbranch_vccz L_ok_124
    s_add_u32 s38, s38, 1
    s_cmp_lt_u32 s38, 4194304
    s_cbranch_scc1 L_rl_128
    s_branch L_end_1
L_exit_118:
    v_smfmac_f32_16x16x64_bf16 v[80:83], v[64:67], a[224:231], v29
    v_smfmac_f32_16x16x64_bf16 v[80:83], v[68:71], a[232:239], v29
    s_nop 7
    s_nop 1
    v_mov_b32 v156, v80
    v_mov_b32 v157, v81
    v_mov_b32 v158, v82
    v_mov_b32 v159, v83
    s_nop 0
    v_permlane32_swap_b32 v80, v156
    v_permlane32_swap_b32 v81, v157
    v_permlane32_swap_b32 v82, v158
    v_permlane32_swap_b32 v83, v159
    v_add_f32 v80, v80, v156
    v_add_f32 v81, v81, v157
    v_add_f32 v82, v82, v158
    v_add_f32 v83, v83, v159
    v_cvt_pk_bf16_f32 v156, v80, v81
    v_cvt_pk_bf16_f32 v157, v82, v83
    s_nop 1
    v_permlane16_swap_b32 v156, v158
    v_permlane16_swap_b32 v157, v159
    s_mov_b64 exec, s[54:55]
    buffer_store_dwordx4 v[156:159], v28, s[4:7], s32 offen
    s_mov_b64 exec, -1
    v_mov_b32 v80, 0
    v_mov_b32 v81, 0
    v_mov_b32 v82, 0
    v_mov_b32 v83, 0
    s_waitcnt vmcnt(0)
    s_barrier
    s_branch L_done_27
L_var01_33:
L_step_129:
    ds_read_b64_tr_b16 v[32:33], v4 offset:0
    ds_read_b64_tr_b16 v[34:35], v5 offset:0
    ds_read_b64_tr_b16 v[36:37], v4 offset:1024
    ds_read_b64_tr_b16 v[38:39], v5 offset:1024
    ds_read_b64_tr_b16 v[40:41], v4 offset:2048
    ds_read_b64_tr_b16 v[42:43], v5 offset:2048
    ds_read_b64_tr_b16 v[44:45], v4 offset:3072
    ds_read_b64_tr_b16 v[46:47], v5 offset:3072
    ds_read_b64_tr_b16 v[48:49], v4 offset:4096
    ds_read_b64_tr_b16 v[50:51], v5 offset:4096
    ds_read_b64_tr_b16 v[52:53], v4 offset:5120
    ds_read_b64_tr_b16 v[54:55], v5 offset:5120
    ds_read_b64_tr_b16 v[56:57], v4 offset:6144
    ds_read_b64_tr_b16 v[58:59], v5 offset:6144
    s_waitcnt lgkmcnt(12)
    v_smfmac_f32_16x16x64_bf16 v[72:75], v[32:35], a[0:7], v29
    v_smfmac_f32_16x16x64_bf16 v[76:79], v[32:35], a[80:87], v29
    ds_read_b64_tr_b16 v[60:61], v4 offset:7168
    ds_read_b64_tr_b16 v[62:63], v5 offset:7168
    s_waitcnt lgkmcnt(12)
    v_smfmac_f32_16x16x64_bf16 v[72:75], v[36:39], a[8:15], v29
    v_smfmac_f32_16x16x64_bf16 v[76:79], v[36:39], a[88:95], v29
    ds_read_b64_tr_b16 v[64:65], v4 offset:8192
    ds_read_b64_tr_b16 v[66:67], v5 offset:8192
    s_waitcnt lgkmcnt(12)
    v_smfmac_f32_16x16x64_bf16 v[72:75], v[40:43], a[16:23], v29
    v_smfmac_f32_16x16x64_bf16 v[76:79], v[40:43], a[96:103], v29
    ds_read_b64_tr_b16 v[68:69], v4 offset:9216
    ds_read_b64_tr_b16 v[70:71], v5 offset:9216
    s_waitcnt lgkmcnt(12)
    v_smfmac_f32_16x16x64_bf16 v[72:75], v[44:47], a[24:31], v29
    v_smfmac_f32_16x16x64_bf16 v[76:79], v[44:47], a[104:111], v29
    s_waitcnt lgkmcnt(10)
    v_smfmac_f32_16x16x64_bf16 v[72:75], v[48:51], a[32:39], v29
    v_smfmac_f32_16x16x64_bf16 v[76:79], v[48:51], a[112:119], v29
    s_waitcnt lgkmcnt(8)
    v_smfmac_f32_16x16x64_bf16 v[72:75], v[52:55], a[40:47], v29
    v_smfmac_f32_16x16x64_bf16 v[76:79], v[52:55], a[120:127], v29
    s_waitcnt lgkmcnt(6)
    v_smfmac_f32_16x16x64_bf16 v[72:75], v[56:59], a[48:55], v29
    v_smfmac_f32_16x16x64_bf16 v[76:79], v[56:59], a[128:135], v29
    s_waitcnt lgkmcnt(4)
    v_smfmac_f32_16x16x64_bf16 v[72:75], v[60:63], a[56:63], v29
    v_smfmac_f32_16x16x64_bf16 v[76:79], v[60:63], a[136:143], v29
    s_waitcnt lgkmcnt(2)
    v_smfmac_f32_16x16x64_bf16 v[72:75], v[64:67], a[64:71], v29
    v_smfmac_f32_16x16x64_bf16 v[76:79], v[64:67], a[144:151], v29
    s_waitcnt lgkmcnt(0)
    v_smfmac_f32_16x16x64_bf16 v[72:75], v[68:71], a[72:79], v29
    v_smfmac_f32_16x16x64_bf16 v[76:79], v[68:71], a[152:159], v29
    v_smfmac_f32_16x16x64_bf16 v[80:83], v[32:35], a[160:167], v29
    v_smfmac_f32_16x16x64_bf16 v[80:83], v[36:39], a[168:175], v29
    s_nop 0
    v_permlane32_swap_b32 v72, v76
    v_permlane32_swap_b32 v73, v77
    v_permlane32_swap_b32 v74, v78
    v_permlane32_swap_b32 v75, v79
    v_add_f32 v72, v72, v76
    v_add_f32 v73, v73, v77
    v_cvt_pk_bf16_f32 v156, v72, v73
    v_add_f32 v74, v74, v78
    v_add_f32 v75, v75, v79
    v_cvt_pk_bf16_f32 v157, v74, v75
    ds_write_b64 v9, v[156:157]
    v_cmp_u_f32 vcc, v72, v73
    s_cbranch_vccnz L_slow_131
L_cont_132:
    v_smfmac_f32_16x16x64_bf16 v[80:83], v[40:43], a[176:183], v29
    v_smfmac_f32_16x16x64_bf16 v[80:83], v[44:47], a[184:191], v29
    s_waitcnt lgkmcnt(0)
    s_barrier
    ds_read_b64_tr_b16 v[84:85], v10
    ds_read_b64_tr_b16 v[86:87], v10 offset:64
    ds_read_b64_tr_b16 v[88:89], v10 offset:512
    ds_read_b64_tr_b16 v[90:91], v10 offset:576
    v_smfmac_f32_16x16x64_bf16 v[80:83], v[48:51], a[192:199], v29
    v_smfmac_f32_16x16x64_bf16 v[80:83], v[52:55], a[200:207], v29
    s_waitcnt lgkmcnt(2)
    v_mfma_f32_16x16x32_bf16 v[100:103], v[92:95], v[84:87], 0
    s_waitcnt lgkmcnt(0)
    v_mfma_f32_16x16x32_bf16 v[100:103], v[96:99], v[88:91], v[100:103]
    v_smfmac_f32_16x16x64_bf16 v[80:83], v[56:59], a[208:215], v29
    v_smfmac_f32_16x16x64_bf16 v[80:83], v[60:63], a[216:223], v29
    s_cmp_eq_u32 s21, 63
    s_cbranch_scc1 L_exit_130
    s_mov_b64 exec, s[34:35]
    s_nop 0
    buffer_store_dwordx4 v[100:103], v11, s[4:7], s22 offen
    buffer_store_dwordx4 v[150:153], v11, s[4:7], s23 offen
    s_mov_b64 exec, s[46:47]
    buffer_store_dwordx4 v[150:153], v16, s[4:7], s25 offen
    s_mov_b64 exec, -1
    v_smfmac_f32_16x16x64_bf16 v[80:83], v[64:67], a[224:231], v29
    v_smfmac_f32_16x16x64_bf16 v[80:83], v[68:71], a[232:239], v29
    v_mov_b32 v72, 0
    v_mov_b32 v73, 0
    v_mov_b32 v74, 0
    v_mov_b32 v75, 0
    v_mov_b32 v76, 0
    v_mov_b32 v77, 0
    v_mov_b32 v78, 0
    v_mov_b32 v79, 0
    v_cvt_pk_bf16_f32 v130, v80, v81
    v_cvt_pk_bf16_f32 v131, v82, v83
    s_sleep 2
    s_mov_b64 exec, s[48:49]
    buffer_load_dwordx2 v[104:105], v12, s[4:7], s22 offen sc1
    buffer_load_dwordx2 v[106:107], v12, s[4:7], s22 offen offset:1536 sc1
    buffer_load_dwordx2 v[108:109], v12, s[4:7], s22 offen offset:3072 sc1
    s_mov_b64 exec, -1
    s_waitcnt vmcnt(0)
    v_max3_u32 v113, v104, v106, v108
    v_cmp_eq_u32 vcc, -1, v113
    s_cbranch_vccnz L_retry_133
L_ok_134:
    v_pk_add_f32 v[110:111], v[104:105], v[106:107]
    v_pk_add_f32 v[110:111], v[110:111], v[108:109]
    v_max_f32 v112, v110, v111
    s_nop 1
    v_max_f32_dpp v112, v112, v112 row_ror:8 row_mask:0xf bank_mask:0xf
    s_nop 1
    v_max_f32_dpp v112, v112, v112 row_ror:4 row_mask:0xf bank_mask:0xf
    s_nop 1
    v_max_f32_dpp v112, v112, v112 row_ror:2 row_mask:0xf bank_mask:0xf
    s_nop 1
    v_max_f32_dpp v112, v112, v112 row_ror:1 row_mask:0xf bank_mask:0xf
    v_mov_b32 v113, v112
    s_nop 1
    v_permlane16_swap_b32 v112, v113
    v_max_f32 v112, v112, v113
    v_mul_f32 v112, s33, v112
    v_fma_f32 v114, v110, s33, -v112
    v_fma_f32 v115, v111, s33, -v112
    v_exp_f32 v114, v114
    v_exp_f32 v115, v115
    s_mov_b64 exec, s[48:49]
    v_cvt_pk_bf16_f32 v114, v114, v115
    ds_write_b32 v13, v114
    s_mov_b64 exec, -1
    s_waitcnt lgkmcnt(0)
    s_barrier
    ds_read_b128 v[116:119], v14
    ds_read_b64 v[120:121], v15
    s_waitcnt lgkmcnt(1)
    v_mfma_f32_16x16x32_bf16 v[136:139], v[140:143], v[116:119], 0
    v_mfma_f32_16x16x32_bf16 v[132:135], v[122:125], v[116:119], 0
    s_waitcnt lgkmcnt(0)
    v_mfma_f32_16x16x16_bf16 v[136:139], v[144:145], v[120:121], v[136:139]
    v_mfma_f32_16x16x16_bf16 v[132:135], v[130:131], v[120:121], v[132:135]
    s_nop 6
    v_rcp_f32 v113, v136
    s_nop 0
    v_mul_f32 v132, v132, v113
    v_mul_f32 v133, v133, v113
    v_mul_f32 v134, v134, v113
    v_mul_f32 v135, v135, v113
    v_cvt_pk_bf16_f32 v146, v132, v133
    v_cvt_pk_bf16_f32 v147, v134, v135
    v_min_u32 v146, s39, v146
    s_nop 0
    v_permlane16_swap_b32 v147, v149
    v_permlane16_swap_b32 v146, v148
    s_mov_b64 exec, s[46:47]
    buffer_store_dwordx4 v[146:149], v16, s[4:7], s24 offen
    s_mov_b64 exec, -1
    v_mov_b32 v156, v80
    v_mov_b32 v157, v81
    v_mov_b32 v158, v82
    v_mov_b32 v159, v83
    s_nop 0
    v_permlane32_swap_b32 v80, v156
    v_permlane32_swap_b32 v81, v157
    v_permlane32_swap_b32 v82, v158
    v_permlane32_swap_b32 v83, v159
    v_add_f32 v80, v80, v156
    v_add_f32 v81, v81, v157
    v_add_f32 v82, v82, v158
    v_add_f32 v83, v83, v159
    v_cvt_pk_bf16_f32 v156, v80, v81
    v_cvt_pk_bf16_f32 v157, v82, v83
    s_nop 1
    v_permlane16_swap_b32 v156, v158
    v_permlane16_swap_b32 v157, v159
    s_mov_b64 exec, s[54:55]
    buffer_store_dwordx4 v[156:159], v28, s[4:7], s32 offen
    s_mov_b64 exec, -1
    v_mov_b32 v80, 0
    v_mov_b32 v81, 0
    v_mov_b32 v82, 0
    v_mov_b32 v83, 0
    s_waitcnt vmcnt(0)
    s_barrier
    s_add_u32 s57, s21, 2
    s_cmp_ge_u32 s56, s57
    s_cbranch_scc1 L_wtd_136
    s_mov_b32 s38, 0
    s_mov_b32 exec_lo, 0x3
    s_mov_b32 exec_hi, 0x0
L_wt_135:
    buffer_load_dword v113, v31, s[4:7], 0 offen sc1
    s_waitcnt vmcnt(0)
    v_cmp_gt_u32 vcc, s57, v113
    s_cbranch_vccz L_wtk_137
    s_sleep 2
    s_add_u32 s38, s38, 1
    s_cmp_lt_u32 s38, 4194304
    s_cbranch_scc1 L_wt_135
    s_mov_b64 exec, -1
    s_branch L_end_1
L_wtk_137:
    s_nop 0
    v_readlane_b32 s56, v113, 0
    v_readlane_b32 s38, v113, 1
    s_nop 3
    s_min_u32 s56, s56, s38
    s_mov_b64 exec, -1
L_wtd_136:
    buffer_load_dwordx4 v[122:125], v25, s[4:7], s30 offen sc1
    buffer_load_dwordx4 v[92:95], v24, s[4:7], s29 offen sc1
    buffer_load_dwordx4 v[96:99], v24, s[4:7], s29 offen offset:64 sc1
    s_xor_b32 s22, s22, s23
    s_xor_b32 s23, s22, s23
    s_xor_b32 s22, s22, s23
    s_xor_b32 s24, s24, s25
    s_xor_b32 s25, s24, s25
    s_xor_b32 s24, s24, s25
    s_add_u32 s29, s29, 393216
    s_add_u32 s30, s30, 393216
    s_add_u32 s31, s31, 98304
    s_add_u32 s32, s32, 98304
    s_nop 0
    v_mov_b32 v72, 0
    v_mov_b32 v73, 0
    v_mov_b32 v74, 0
    v_mov_b32 v75, 0
    v_mov_b32 v76, 0
    v_mov_b32 v77, 0
    v_mov_b32 v78, 0
    v_mov_b32 v79, 0
    s_sleep 28
    buffer_load_dwordx4 v[56:59], v6, s[4:7], s26 offen sc1
    buffer_load_dwordx4 v[60:63], v7, s[4:7], s26 offen sc1
    buffer_load_dwordx4 v[64:67], v8, s[4:7], s26 offen sc1
    s_xor_b32 s26, s26, s27
    s_xor_b32 s27, s26, s27
    s_xor_b32 s26, s26, s27
    s_xor_b32 s28, s28, 262144
    s_add_u32 s21, s21, 1
    s_lshr_b32 s40, s21, 1
    s_and_b32 s40, s40, 1
    s_xor_b32 s40, s40, 1
    v_mov_b32 v30, s40
    s_mov_b32 s58, 1
    s_waitcnt vmcnt(0)
    v_max3_u32 v113, v56, v60, v64
    v_cmp_eq_u32 vcc, -1, v113
    s_cbranch_vccnz L_retry_138
L_ok_139:
    ds_write_b128 v2, v[56:59]
    ds_write_b128 v2, v[60:63] offset:4096
    ds_write_b128 v2, v[64:67] offset:8192
    s_waitcnt lgkmcnt(0)
    s_barrier
    s_branch L_step_129
L_slow_131:
    s_cmp_eq_u32 s58, 1
    s_cbranch_scc1 L_cont_132
    s_mov_b32 s58, 1
    s_mov_b32 s38, 0
L_sl_140:
    buffer_load_dwordx4 v[56:59], v6, s[4:7], s27 offen sc1
    buffer_load_dwordx4 v[60:63], v7, s[4:7], s27 offen sc1
    buffer_load_dwordx4 v[64:67], v8, s[4:7], s27 offen sc1
    s_waitcnt vmcnt(0)
    v_max3_u32 v113, v56, v60, v64
    v_cmp_eq_u32 vcc, -1, v113
    s_cbranch_vccz L_slk_141
    s_add_u32 s38, s38, 1
    s_cmp_lt_u32 s38, 4194304
    s_cbranch_scc1 L_sl_140
    s_branch L_end_1
L_slk_141:
    s_waitcnt lgkmcnt(0)
    s_barrier
    ds_write_b128 v2, v[56:59]
    ds_write_b128 v2, v[60:63] offset:4096
    ds_write_b128 v2, v[64:67] offset:8192
    s_nop 7
    s_nop 7
    v_mov_b32 v72, 0
    v_mov_b32 v73, 0
    v_mov_b32 v74, 0
    v_mov_b32 v75, 0
    v_mov_b32 v76, 0
    v_mov_b32 v77, 0
    v_mov_b32 v78, 0
    v_mov_b32 v79, 0
    v_mov_b32 v80, 0
    v_mov_b32 v81, 0
    v_mov_b32 v82, 0
    v_mov_b32 v83, 0
    s_waitcnt lgkmcnt(0)
    s_barrier
    s_branch L_step_129
L_retry_133:
    s_mov_b32 s38, 0
L_rl_142:
    s_mov_b64 exec, s[48:49]
    buffer_load_dwordx2 v[104:105], v12, s[4:7], s22 offen sc1
    buffer_load_dwordx2 v[106:107], v12, s[4:7], s22 offen offset:1536 sc1
    buffer_load_dwordx2 v[108:109], v12, s[4:7], s22 offen offset:3072 sc1
    s_mov_b64 exec, -1
    s_waitcnt vmcnt(0)
    v_max3_u32 v113, v104, v106, v108
    v_cmp_eq_u32 vcc, -1, v113
    s_cbranch_vccz L_ok_134
    s_add_u32 s38, s38, 1
    s_cmp_lt_u32 s38, 4194304
    s_cbranch_scc1 L_rl_142
    s_branch L_end_1
L_retry_138:
    s_mov_b32 s38, 0
L_rl_143:
    buffer_load_dwordx4 v[56:59], v6, s[4:7], s27 offen sc1
    buffer_load_dwordx4 v[60:63], v7, s[4:7], s27 offen sc1
    buffer_load_dwordx4 v[64:67], v8, s[4:7], s27 offen sc1
    s_waitcnt vmcnt(0)
    v_max3_u32 v113, v56, v60, v64
    v_cmp_eq_u32 vcc, -1, v113
    s_cbranch_vccz L_ok_139
    s_add_u32 s38, s38, 1
    s_cmp_lt_u32 s38, 4194304
    s_cbranch_scc1 L_rl_143
    s_branch L_end_1
L_exit_130:
    v_smfmac_f32_16x16x64_bf16 v[80:83], v[64:67], a[224:231], v29
    v_smfmac_f32_16x16x64_bf16 v[80:83], v[68:71], a[232:239], v29
    s_nop 7
    s_nop 1
    v_mov_b32 v156, v80
    v_mov_b32 v157, v81
    v_mov_b32 v158, v82
    v_mov_b32 v159, v83
    s_nop 0
    v_permlane32_swap_b32 v80, v156
    v_permlane32_swap_b32 v81, v157
    v_permlane32_swap_b32 v82, v158
    v_permlane32_swap_b32 v83, v159
    v_add_f32 v80, v80, v156
    v_add_f32 v81, v81, v157
    v_add_f32 v82, v82, v158
    v_add_f32 v83, v83, v159
    v_cvt_pk_bf16_f32 v156, v80, v81
    v_cvt_pk_bf16_f32 v157, v82, v83
    s_nop 1
    v_permlane16_swap_b32 v156, v158
    v_permlane16_swap_b32 v157, v159
    s_mov_b64 exec, s[54:55]
    buffer_store_dwordx4 v[156:159], v28, s[4:7], s32 offen
    s_mov_b64 exec, -1
    v_mov_b32 v80, 0
    v_mov_b32 v81, 0
    v_mov_b32 v82, 0
    v_mov_b32 v83, 0
    s_waitcnt vmcnt(0)
    s_barrier
    s_branch L_done_27
L_var02_34:
L_step_144:
    ds_read_b64_tr_b16 v[32:33], v4 offset:0
    ds_read_b64_tr_b16 v[34:35], v5 offset:0
    ds_read_b64_tr_b16 v[36:37], v4 offset:1024
    ds_read_b64_tr_b16 v[38:39], v5 offset:1024
    ds_read_b64_tr_b16 v[40:41], v4 offset:2048
    ds_read_b64_tr_b16 v[42:43], v5 offset:2048
    ds_read_b64_tr_b16 v[44:45], v4 offset:3072
    ds_read_b64_tr_b16 v[46:47], v5 offset:3072
    ds_read_b64_tr_b16 v[48:49], v4 offset:4096
    ds_read_b64_tr_b16 v[50:51], v5 offset:4096
    ds_read_b64_tr_b16 v[52:53], v4 offset:5120
    ds_read_b64_tr_b16 v[54:55], v5 offset:5120
    ds_read_b64_tr_b16 v[56:57], v4 offset:6144
    ds_read_b64_tr_b16 v[58:59], v5 offset:6144
    s_waitcnt lgkmcnt(12)
    v_smfmac_f32_16x16x64_bf16 v[72:75], v[32:35], a[0:7], v29
    v_smfmac_f32_16x16x64_bf16 v[76:79], v[32:35], a[80:87], v29
    ds_read_b64_tr_b16 v[60:61], v4 offset:7168
    ds_read_b64_tr_b16 v[62:63], v5 offset:7168
    s_waitcnt lgkmcnt(12)
    v_smfmac_f32_16x16x64_bf16 v[72:75], v[36:39], a[8:15], v29
    v_smfmac_f32_16x16x64_bf16 v[76:79], v[36:39], a[88:95], v29
    ds_read_b64_tr_b16 v[64:65], v4 offset:8192
    ds_read_b64_tr_b16 v[66:67], v5 offset:8192
    s_waitcnt lgkmcnt(12)
    v_smfmac_f32_16x16x64_bf16 v[72:75], v[40:43], a[16:23], v29
    v_smfmac_f32_16x16x64_bf16 v[76:79], v[40:43], a[96:103], v29
    ds_read_b64_tr_b16 v[68:69], v4 offset:9216
    ds_read_b64_tr_b16 v[70:71], v5 offset:9216
    s_waitcnt lgkmcnt(12)
    v_smfmac_f32_16x16x64_bf16 v[72:75], v[44:47], a[24:31], v29
    v_smfmac_f32_16x16x64_bf16 v[76:79], v[44:47], a[104:111], v29
    s_waitcnt lgkmcnt(10)
    v_smfmac_f32_16x16x64_bf16 v[72:75], v[48:51], a[32:39], v29
    v_smfmac_f32_16x16x64_bf16 v[76:79], v[48:51], a[112:119], v29
    s_waitcnt lgkmcnt(8)
    v_smfmac_f32_16x16x64_bf16 v[72:75], v[52:55], a[40:47], v29
    v_smfmac_f32_16x16x64_bf16 v[76:79], v[52:55], a[120:127], v29
    s_waitcnt lgkmcnt(6)
    v_smfmac_f32_16x16x64_bf16 v[72:75], v[56:59], a[48:55], v29
    v_smfmac_f32_16x16x64_bf16 v[76:79], v[56:59], a[128:135], v29
    s_waitcnt lgkmcnt(4)
    v_smfmac_f32_16x16x64_bf16 v[72:75], v[60:63], a[56:63], v29
    v_smfmac_f32_16x16x64_bf16 v[76:79], v[60:63], a[136:143], v29
    s_waitcnt lgkmcnt(2)
    v_smfmac_f32_16x16x64_bf16 v[72:75], v[64:67], a[64:71], v29
    v_smfmac_f32_16x16x64_bf16 v[76:79], v[64:67], a[144:151], v29
    s_waitcnt lgkmcnt(0)
    v_smfmac_f32_16x16x64_bf16 v[72:75], v[68:71], a[72:79], v29
    v_smfmac_f32_16x16x64_bf16 v[76:79], v[68:71], a[152:159], v29
    v_smfmac_f32_16x16x64_bf16 v[80:83], v[32:35], a[160:167], v29
    v_smfmac_f32_16x16x64_bf16 v[80:83], v[36:39], a[168:175], v29
    s_nop 0
    v_permlane32_swap_b32 v72, v76
    v_permlane32_swap_b32 v73, v77
    v_permlane32_swap_b32 v74, v78
    v_permlane32_swap_b32 v75, v79
    v_add_f32 v72, v72, v76
    v_add_f32 v73, v73, v77
    v_cvt_pk_bf16_f32 v156, v72, v73
    v_add_f32 v74, v74, v78
    v_add_f32 v75, v75, v79
    v_cvt_pk_bf16_f32 v157, v74, v75
    ds_write_b64 v9, v[156:157]
    v_cmp_u_f32 vcc, v72, v73
    s_cbranch_vccnz L_slow_146
L_cont_147:
    v_smfmac_f32_16x16x64_bf16 v[80:83], v[40:43], a[176:183], v29
    v_smfmac_f32_16x16x64_bf16 v[80:83], v[44:47], a[184:191], v29
    s_waitcnt lgkmcnt(0)
    s_barrier
    ds_read_b64_tr_b16 v[84:85], v10
    ds_read_b64_tr_b16 v[86:87], v10 offset:64
    ds_read_b64_tr_b16 v[88:89], v10 offset:512
    ds_read_b64_tr_b16 v[90:91], v10 offset:576
    v_smfmac_f32_16x16x64_bf16 v[80:83], v[48:51], a[192:199], v29
    v_smfmac_f32_16x16x64_bf16 v[80:83], v[52:55], a[200:207], v29
    s_waitcnt lgkmcnt(2)
    v_mfma_f32_16x16x32_bf16 v[100:103], v[92:95], v[84:87], 0
    s_waitcnt lgkmcnt(0)
    v_mfma_f32_16x16x32_bf16 v[100:103], v[96:99], v[88:91], v[100:103]
    v_smfmac_f32_16x16x64_bf16 v[80:83], v[56:59], a[208:215], v29
    v_smfmac_f32_16x16x64_bf16 v[80:83], v[60:63], a[216:223], v29
    s_cmp_eq_u32 s21, 63
    s_cbranch_scc1 L_exit_145
    s_mov_b64 exec, s[34:35]
    s_nop 0
    buffer_store_dwordx4 v[100:103], v11, s[4:7], s22 offen
    buffer_store_dwordx4 v[150:153], v11, s[4:7], s23 offen
    s_mov_b64 exec, s[46:47]
    buffer_store_dwordx4 v[150:153], v16, s[4:7], s25 offen
    s_mov_b64 exec, -1
    v_smfmac_f32_16x16x64_bf16 v[80:83], v[64:67], a[224:231], v29
    v_smfmac_f32_16x16x64_bf16 v[80:83], v[68:71], a[232:239], v29
    v_mov_b32 v72, 0
    v_mov_b32 v73, 0
    v_mov_b32 v74, 0
    v_mov_b32 v75, 0
    v_mov_b32 v76, 0
    v_mov_b32 v77, 0
    v_mov_b32 v78, 0
    v_mov_b32 v79, 0
    v_cvt_pk_bf16_f32 v130, v80, v81
    v_cvt_pk_bf16_f32 v131, v82, v83
    s_sleep 2
    s_mov_b64 exec, s[48:49]
    buffer_load_dwordx2 v[104:105], v12, s[4:7], s22 offen sc1
    buffer_load_dwordx2 v[106:107], v12, s[4:7], s22 offen offset:1536 sc1
    buffer_load_dwordx2 v[108:109], v12, s[4:7], s22 offen offset:3072 sc1
    s_mov_b64 exec, -1
    s_waitcnt vmcnt(0)
    v_max3_u32 v113, v104, v106, v108
    v_cmp_eq_u32 vcc, -1, v113
    s_cbranch_vccnz L_retry_148
L_ok_149:
    v_pk_add_f32 v[110:111], v[104:105], v[106:107]
    v_pk_add_f32 v[110:111], v[110:111], v[108:109]
    v_max_f32 v112, v110, v111
    s_nop 1
    v_max_f32_dpp v112, v112, v112 row_ror:8 row_mask:0xf bank_mask:0xf
    s_nop 1
    v_max_f32_dpp v112, v112, v112 row_ror:4 row_mask:0xf bank_mask:0xf
    s_nop 1
    v_max_f32_dpp v112, v112, v112 row_ror:2 row_mask:0xf bank_mask:0xf
    s_nop 1
    v_max_f32_dpp v112, v112, v112 row_ror:1 row_mask:0xf bank_mask:0xf
    v_mov_b32 v113, v112
    s_nop 1
    v_permlane16_swap_b32 v112, v113
    v_max_f32 v112, v112, v113
    v_mul_f32 v112, s33, v112
    v_fma_f32 v114, v110, s33, -v112
    v_fma_f32 v115, v111, s33, -v112
    v_exp_f32 v114, v114
    v_exp_f32 v115, v115
    s_mov_b64 exec, s[48:49]
    v_cvt_pk_bf16_f32 v114, v114, v115
    ds_write_b32 v13, v114
    s_mov_b64 exec, -1
    s_waitcnt lgkmcnt(0)
    s_barrier
    ds_read_b128 v[116:119], v14
    ds_read_b64 v[120:121], v15
    s_waitcnt lgkmcnt(1)
    v_mfma_f32_16x16x32_bf16 v[136:139], v[140:143], v[116:119], 0
    v_mfma_f32_16x16x32_bf16 v[132:135], v[122:125], v[116:119], 0
    s_waitcnt lgkmcnt(0)
    v_mfma_f32_16x16x16_bf16 v[136:139], v[144:145], v[120:121], v[136:139]
    v_mfma_f32_16x16x16_bf16 v[132:135], v[130:131], v[120:121], v[132:135]
    s_nop 6
    v_rcp_f32 v113, v136
    s_nop 0
    v_mul_f32 v132, v132, v113
    v_mul_f32 v133, v133, v113
    v_mul_f32 v134, v134, v113
    v_mul_f32 v135, v135, v113
    v_cvt_pk_bf16_f32 v146, v132, v133
    v_cvt_pk_bf16_f32 v147, v134, v135
    v_min_u32 v146, s39, v146
    s_nop 0
    v_permlane16_swap_b32 v147, v149
    v_permlane16_swap_b32 v146, v148
    s_mov_b64 exec, s[46:47]
    buffer_store_dwordx4 v[146:149], v16, s[4:7], s24 offen
    s_mov_b64 exec, -1
    v_mov_b32 v156, v80
    v_mov_b32 v157, v81
    v_mov_b32 v158, v82
    v_mov_b32 v159, v83
    s_nop 0
    v_permlane32_swap_b32 v80, v156
    v_permlane32_swap_b32 v81, v157
    v_permlane32_swap_b32 v82, v158
    v_permlane32_swap_b32 v83, v159
    v_add_f32 v80, v80, v156
    v_add_f32 v81, v81, v157
    v_add_f32 v82, v82, v158
    v_add_f32 v83, v83, v159
    v_cvt_pk_bf16_f32 v156, v80, v81
    v_cvt_pk_bf16_f32 v157, v82, v83
    s_nop 1
    v_permlane16_swap_b32 v156, v158
    v_permlane16_swap_b32 v157, v159
    s_mov_b64 exec, s[54:55]
    buffer_store_dwordx4 v[156:159], v28, s[4:7], s32 offen
    s_mov_b64 exec, -1
    v_mov_b32 v80, 0
    v_mov_b32 v81, 0
    v_mov_b32 v82, 0
    v_mov_b32 v83, 0
    s_waitcnt vmcnt(0)
    s_barrier
    s_add_u32 s57, s21, 2
    s_cmp_ge_u32 s56, s57
    s_cbranch_scc1 L_wtd_151
    s_mov_b32 s38, 0
    s_mov_b32 exec_lo, 0x3
    s_mov_b32 exec_hi, 0x0
L_wt_150:
    buffer_load_dword v113, v31, s[4:7], 0 offen sc1
    s_waitcnt vmcnt(0)
    v_cmp_gt_u32 vcc, s57, v113
    s_cbranch_vccz L_wtk_152
    s_sleep 2
    s_add_u32 s38, s38, 1
    s_cmp_lt_u32 s38, 4194304
    s_cbranch_scc1 L_wt_150
    s_mov_b64 exec, -1
    s_branch L_end_1
L_wtk_152:
    s_nop 0
    v_readlane_b32 s56, v113, 0
    v_readlane_b32 s38, v113, 1
    s_nop 3
    s_min_u32 s56, s56, s38
    s_mov_b64 exec, -1
L_wtd_151:
    buffer_load_dwordx4 v[122:125], v25, s[4:7], s30 offen sc1
    buffer_load_dwordx4 v[92:95], v24, s[4:7], s29 offen sc1
    buffer_load_dwordx4 v[96:99], v24, s[4:7], s29 offen offset:64 sc1
    s_xor_b32 s22, s22, s23
    s_xor_b32 s23, s22, s23
    s_xor_b32 s22, s22, s23
    s_xor_b32 s24, s24, s25
    s_xor_b32 s25, s24, s25
    s_xor_b32 s24, s24, s25
    s_add_u32 s29, s29, 393216
    s_add_u32 s30, s30, 393216
    s_add_u32 s31, s31, 98304
    s_add_u32 s32, s32, 98304
    s_nop 0
    v_mov_b32 v72, 0
    v_mov_b32 v73, 0
    v_mov_b32 v74, 0
    v_mov_b32 v75, 0
    v_mov_b32 v76, 0
    v_mov_b32 v77, 0
    v_mov_b32 v78, 0
    v_mov_b32 v79, 0
    s_sleep 28
    buffer_load_dwordx4 v[56:59], v6, s[4:7], s26 offen sc1
    buffer_load_dwordx4 v[60:63], v7, s[4:7], s26 offen sc1
    s_xor_b32 s26, s26, s27
    s_xor_b32 s27, s26, s27
    s_xor_b32 s26, s26, s27
    s_xor_b32 s28, s28, 262144
    s_add_u32 s21, s21, 1
    s_lshr_b32 s40, s21, 1
    s_and_b32 s40, s40, 1
    s_xor_b32 s40, s40, 1
    v_mov_b32 v30, s40
    s_mov_b32 s58, 1
    s_waitcnt vmcnt(0)
    v_max_u32 v113, v56, v60
    v_cmp_eq_u32 vcc, -1, v113
    s_cbranch_vccnz L_retry_153
L_ok_154:
    ds_write_b128 v2, v[56:59]
    ds_write_b128 v2, v[60:63] offset:4096
    s_waitcnt lgkmcnt(0)
    s_barrier
    s_branch L_step_144
L_slow_146:
    s_cmp_eq_u32 s58, 1
    s_cbranch_scc1 L_cont_147
    s_mov_b32 s58, 1
    s_mov_b32 s38, 0
L_sl_155:
    buffer_load_dwordx4 v[56:59], v6, s[4:7], s27 offen sc1
    buffer_load_dwordx4 v[60:63], v7, s[4:7], s27 offen sc1
    s_waitcnt vmcnt(0)
    v_max_u32 v113, v56, v60
    v_cmp_eq_u32 vcc, -1, v113
    s_cbranch_vccz L_slk_156
    s_add_u32 s38, s38, 1
    s_cmp_lt_u32 s38, 4194304
    s_cbranch_scc1 L_sl_155
    s_branch L_end_1
L_slk_156:
    s_waitcnt lgkmcnt(0)
    s_barrier
    ds_write_b128 v2, v[56:59]
    ds_write_b128 v2, v[60:63] offset:4096
    s_nop 7
    s_nop 7
    v_mov_b32 v72, 0
    v_mov_b32 v73, 0
    v_mov_b32 v74, 0
    v_mov_b32 v75, 0
    v_mov_b32 v76, 0
    v_mov_b32 v77, 0
    v_mov_b32 v78, 0
    v_mov_b32 v79, 0
    v_mov_b32 v80, 0
    v_mov_b32 v81, 0
    v_mov_b32 v82, 0
    v_mov_b32 v83, 0
    s_waitcnt lgkmcnt(0)
    s_barrier
    s_branch L_step_144
L_retry_148:
    s_mov_b32 s38, 0
L_rl_157:
    s_mov_b64 exec, s[48:49]
    buffer_load_dwordx2 v[104:105], v12, s[4:7], s22 offen sc1
    buffer_load_dwordx2 v[106:107], v12, s[4:7], s22 offen offset:1536 sc1
    buffer_load_dwordx2 v[108:109], v12, s[4:7], s22 offen offset:3072 sc1
    s_mov_b64 exec, -1
    s_waitcnt vmcnt(0)
    v_max3_u32 v113, v104, v106, v108
    v_cmp_eq_u32 vcc, -1, v113
    s_cbranch_vccz L_ok_149
    s_add_u32 s38, s38, 1
    s_cmp_lt_u32 s38, 4194304
    s_cbranch_scc1 L_rl_157
    s_branch L_end_1
L_retry_153:
    s_mov_b32 s38, 0
L_rl_158:
    buffer_load_dwordx4 v[56:59], v6, s[4:7], s27 offen sc1
    buffer_load_dwordx4 v[60:63], v7, s[4:7], s27 offen sc1
    s_waitcnt vmcnt(0)
    v_max_u32 v113, v56, v60
    v_cmp_eq_u32 vcc, -1, v113
    s_cbranch_vccz L_ok_154
    s_add_u32 s38, s38, 1
    s_cmp_lt_u32 s38, 4194304
    s_cbranch_scc1 L_rl_158
    s_branch L_end_1
L_exit_145:
    v_smfmac_f32_16x16x64_bf16 v[80:83], v[64:67], a[224:231], v29
    v_smfmac_f32_16x16x64_bf16 v[80:83], v[68:71], a[232:239], v29
    s_nop 7
    s_nop 1
    v_mov_b32 v156, v80
    v_mov_b32 v157, v81
    v_mov_b32 v158, v82
    v_mov_b32 v159, v83
    s_nop 0
    v_permlane32_swap_b32 v80, v156
    v_permlane32_swap_b32 v81, v157
    v_permlane32_swap_b32 v82, v158
    v_permlane32_swap_b32 v83, v159
    v_add_f32 v80, v80, v156
    v_add_f32 v81, v81, v157
    v_add_f32 v82, v82, v158
    v_add_f32 v83, v83, v159
    v_cvt_pk_bf16_f32 v156, v80, v81
    v_cvt_pk_bf16_f32 v157, v82, v83
    s_nop 1
    v_permlane16_swap_b32 v156, v158
    v_permlane16_swap_b32 v157, v159
    s_mov_b64 exec, s[54:55]
    buffer_store_dwordx4 v[156:159], v28, s[4:7], s32 offen
    s_mov_b64 exec, -1
    v_mov_b32 v80, 0
    v_mov_b32 v81, 0
    v_mov_b32 v82, 0
    v_mov_b32 v83, 0
    s_waitcnt vmcnt(0)
    s_barrier
    s_branch L_done_27
L_var03_35:
L_step_159:
    ds_read_b64_tr_b16 v[32:33], v4 offset:0
    ds_read_b64_tr_b16 v[34:35], v5 offset:0
    ds_read_b64_tr_b16 v[36:37], v4 offset:1024
    ds_read_b64_tr_b16 v[38:39], v5 offset:1024
    ds_read_b64_tr_b16 v[40:41], v4 offset:2048
    ds_read_b64_tr_b16 v[42:43], v5 offset:2048
    ds_read_b64_tr_b16 v[44:45], v4 offset:3072
    ds_read_b64_tr_b16 v[46:47], v5 offset:3072
    ds_read_b64_tr_b16 v[48:49], v4 offset:4096
    ds_read_b64_tr_b16 v[50:51], v5 offset:4096
    ds_read_b64_tr_b16 v[52:53], v4 offset:5120
    ds_read_b64_tr_b16 v[54:55], v5 offset:5120
    ds_read_b64_tr_b16 v[56:57], v4 offset:6144
    ds_read_b64_tr_b16 v[58:59], v5 offset:6144
    s_waitcnt lgkmcnt(12)
    v_smfmac_f32_16x16x64_bf16 v[72:75], v[32:35], a[0:7], v29
    v_smfmac_f32_16x16x64_bf16 v[76:79], v[32:35], a[80:87], v29
    ds_read_b64_tr_b16 v[60:61], v4 offset:7168
    ds_read_b64_tr_b16 v[62:63], v5 offset:7168
    s_waitcnt lgkmcnt(12)
    v_smfmac_f32_16x16x64_bf16 v[72:75], v[36:39], a[8:15], v29
    v_smfmac_f32_16x16x64_bf16 v[76:79], v[36:39], a[88:95], v29
    ds_read_b64_tr_b16 v[64:65], v4 offset:8192
    ds_read_b64_tr_b16 v[66:67], v5 offset:8192
    s_waitcnt lgkmcnt(12)
    v_smfmac_f32_16x16x64_bf16 v[72:75], v[40:43], a[16:23], v29
    v_smfmac_f32_16x16x64_bf16 v[76:79], v[40:43], a[96:103], v29
    ds_read_b64_tr_b16 v[68:69], v4 offset:9216
    ds_read_b64_tr_b16 v[70:71], v5 offset:9216
    s_waitcnt lgkmcnt(12)
    v_smfmac_f32_16x16x64_bf16 v[72:75], v[44:47], a[24:31], v29
    v_smfmac_f32_16x16x64_bf16 v[76:79], v[44:47], a[104:111], v29
    s_waitcnt lgkmcnt(10)
    v_smfmac_f32_16x16x64_bf16 v[72:75], v[48:51], a[32:39], v29
    v_smfmac_f32_16x16x64_bf16 v[76:79], v[48:51], a[112:119], v29
    s_waitcnt lgkmcnt(8)
    v_smfmac_f32_16x16x64_bf16 v[72:75], v[52:55], a[40:47], v29
    v_smfmac_f32_16x16x64_bf16 v[76:79], v[52:55], a[120:127], v29
    s_waitcnt lgkmcnt(6)
    v_smfmac_f32_16x16x64_bf16 v[72:75], v[56:59], a[48:55], v29
    v_smfmac_f32_16x16x64_bf16 v[76:79], v[56:59], a[128:135], v29
    s_waitcnt lgkmcnt(4)
    v_smfmac_f32_16x16x64_bf16 v[72:75], v[60:63], a[56:63], v29
    v_smfmac_f32_16x16x64_bf16 v[76:79], v[60:63], a[136:143], v29
    s_waitcnt lgkmcnt(2)
    v_smfmac_f32_16x16x64_bf16 v[72:75], v[64:67], a[64:71], v29
    v_smfmac_f32_16x16x64_bf16 v[76:79], v[64:67], a[144:151], v29
    s_waitcnt lgkmcnt(0)
    v_smfmac_f32_16x16x64_bf16 v[72:75], v[68:71], a[72:79], v29
    v_smfmac_f32_16x16x64_bf16 v[76:79], v[68:71], a[152:159], v29
    v_smfmac_f32_16x16x64_bf16 v[80:83], v[32:35], a[160:167], v29
    v_smfmac_f32_16x16x64_bf16 v[80:83], v[36:39], a[168:175], v29
    s_nop 0
    v_permlane32_swap_b32 v72, v76
    v_permlane32_swap_b32 v73, v77
    v_permlane32_swap_b32 v74, v78
    v_permlane32_swap_b32 v75, v79
    v_add_f32 v72, v72, v76
    v_add_f32 v73, v73, v77
    v_cvt_pk_bf16_f32 v156, v72, v73
    v_add_f32 v74, v74, v78
    v_add_f32 v75, v75, v79
    v_cvt_pk_bf16_f32 v157, v74, v75
    ds_write_b64 v9, v[156:157]
    v_cmp_u_f32 vcc, v72, v73
    s_cbranch_vccnz L_slow_161
L_cont_162:
    v_smfmac_f32_16x16x64_bf16 v[80:83], v[40:43], a[176:183], v29
    v_smfmac_f32_16x16x64_bf16 v[80:83], v[44:47], a[184:191], v29
    s_waitcnt lgkmcnt(0)
    s_barrier
    ds_read_b64_tr_b16 v[92:93], v10 offset:1024
    ds_read_b64_tr_b16 v[94:95], v10 offset:1088
    ds_read_b64_tr_b16 v[96:97], v10 offset:1536
    ds_read_b64_tr_b16 v[98:99], v10 offset:1600
    v_smfmac_f32_16x16x64_bf16 v[80:83], v[48:51], a[192:199], v29
    v_smfmac_f32_16x16x64_bf16 v[80:83], v[52:55], a[200:207], v29
    v_smfmac_f32_16x16x64_bf16 v[80:83], v[56:59], a[208:215], v29
    v_smfmac_f32_16x16x64_bf16 v[80:83], v[60:63], a[216:223], v29
    v_smfmac_f32_16x16x64_bf16 v[80:83], v[64:67], a[224:231], v29
    v_smfmac_f32_16x16x64_bf16 v[80:83], v[68:71], a[232:239], v29
    s_waitcnt lgkmcnt(0)
    s_cmp_eq_u32 s21, 63
    s_cbranch_scc1 L_exit_160
    s_mov_b64 exec, s[46:47]
    buffer_store_dwordx4 v[150:153], v16, s[4:7], s25 offen
    s_mov_b64 exec, -1
    v_mov_b32 v72, 0
    v_mov_b32 v73, 0
    v_mov_b32 v74, 0
    v_mov_b32 v75, 0
    v_mov_b32 v76, 0
    v_mov_b32 v77, 0
    v_mov_b32 v78, 0
    v_mov_b32 v79, 0
    v_cvt_pk_bf16_f32 v130, v80, v81
    v_cvt_pk_bf16_f32 v131, v82, v83
    s_sleep 2
    s_mov_b64 exec, s[48:49]
    buffer_load_dwordx2 v[104:105], v12, s[4:7], s22 offen sc1
    buffer_load_dwordx2 v[106:107], v12, s[4:7], s22 offen offset:1536 sc1
    buffer_load_dwordx2 v[108:109], v12, s[4:7], s22 offen offset:3072 sc1
    s_mov_b64 exec, -1
    s_waitcnt vmcnt(0)
    v_max3_u32 v113, v104, v106, v108
    v_cmp_eq_u32 vcc, -1, v113
    s_cbranch_vccnz L_retry_163
L_ok_164:
    v_pk_add_f32 v[110:111], v[104:105], v[106:107]
    v_pk_add_f32 v[110:111], v[110:111], v[108:109]
    v_max_f32 v112, v110, v111
    s_nop 1
    v_max_f32_dpp v112, v112, v112 row_ror:8 row_mask:0xf bank_mask:0xf
    s_nop 1
    v_max_f32_dpp v112, v112, v112 row_ror:4 row_mask:0xf bank_mask:0xf
    s_nop 1
    v_max_f32_dpp v112, v112, v112 row_ror:2 row_mask:0xf bank_mask:0xf
    s_nop 1
    v_max_f32_dpp v112, v112, v112 row_ror:1 row_mask:0xf bank_mask:0xf
    v_mov_b32 v113, v112
    s_nop 1
    v_permlane16_swap_b32 v112, v113
    v_max_f32 v112, v112, v113
    v_mul_f32 v112, s33, v112
    v_fma_f32 v114, v110, s33, -v112
    v_fma_f32 v115, v111, s33, -v112
    v_exp_f32 v114, v114
    v_exp_f32 v115, v115
    s_mov_b64 exec, s[48:49]
    v_cvt_pk_bf16_f32 v114, v114, v115
    ds_write_b32 v13, v114
    s_mov_b64 exec, -1
    s_waitcnt lgkmcnt(0)
    s_barrier
    ds_read_b128 v[116:119], v14
    ds_read_b64 v[120:121], v15
    s_waitcnt lgkmcnt(1)
    v_mfma_f32_16x16x32_bf16 v[136:139], v[140:143], v[116:119], 0
    v_mfma_f32_16x16x32_bf16 v[132:135], v[122:125], v[116:119], 0
    s_waitcnt lgkmcnt(0)
    v_mfma_f32_16x16x16_bf16 v[136:139], v[144:145], v[120:121], v[136:139]
    v_mfma_f32_16x16x16_bf16 v[132:135], v[130:131], v[120:121], v[132:135]
    s_nop 6
    v_rcp_f32 v113, v136
    s_nop 0
    v_mul_f32 v132, v132, v113
    v_mul_f32 v133, v133, v113
    v_mul_f32 v134, v134, v113
    v_mul_f32 v135, v135, v113
    v_cvt_pk_bf16_f32 v146, v132, v133
    v_cvt_pk_bf16_f32 v147, v134, v135
    v_min_u32 v146, s39, v146
    s_nop 0
    v_permlane16_swap_b32 v147, v149
    v_permlane16_swap_b32 v146, v148
    s_mov_b64 exec, s[46:47]
    buffer_store_dwordx4 v[146:149], v16, s[4:7], s24 offen
    s_mov_b64 exec, -1
    s_mov_b64 exec, s[52:53]
    buffer_store_dwordx4 v[92:95], v27, s[4:7], s31 offen
    buffer_store_dwordx4 v[96:99], v27, s[4:7], s31 offen offset:64
    s_mov_b64 exec, -1
    v_mov_b32 v156, v80
    v_mov_b32 v157, v81
    v_mov_b32 v158, v82
    v_mov_b32 v159, v83
    s_nop 0
    v_permlane32_swap_b32 v80, v156
    v_permlane32_swap_b32 v81, v157
    v_permlane32_swap_b32 v82, v158
    v_permlane32_swap_b32 v83, v159
    v_add_f32 v80, v80, v156
    v_add_f32 v81, v81, v157
    v_add_f32 v82, v82, v158
    v_add_f32 v83, v83, v159
    v_cvt_pk_bf16_f32 v156, v80, v81
    v_cvt_pk_bf16_f32 v157, v82, v83
    s_nop 1
    v_permlane16_swap_b32 v156, v158
    v_permlane16_swap_b32 v157, v159
    s_mov_b64 exec, s[54:55]
    buffer_store_dwordx4 v[156:159], v28, s[4:7], s32 offen
    s_mov_b64 exec, -1
    v_mov_b32 v80, 0
    v_mov_b32 v81, 0
    v_mov_b32 v82, 0
    v_mov_b32 v83, 0
    s_waitcnt vmcnt(0)
    s_barrier
    s_add_u32 s40, s21, 1
    v_mov_b32 v112, s40
    s_mov_b64 exec, 1
    buffer_store_dword v112, v155, s[4:7], 0 offen
    s_mov_b64 exec, -1
    s_add_u32 s57, s21, 2
    s_cmp_ge_u32 s56, s57
    s_cbranch_scc1 L_wtd_166
    s_mov_b32 s38, 0
    s_mov_b32 exec_lo, 0x3
    s_mov_b32 exec_hi, 0x0
L_wt_165:
    buffer_load_dword v113, v31, s[4:7], 0 offen sc1
    s_waitcnt vmcnt(0)
    v_cmp_gt_u32 vcc, s57, v113
    s_cbranch_vccz L_wtk_167
    s_sleep 2
    s_add_u32 s38, s38, 1
    s_cmp_lt_u32 s38, 4194304
    s_cbranch_scc1 L_wt_165
    s_mov_b64 exec, -1
    s_branch L_end_1
L_wtk_167:
    s_nop 0
    v_readlane_b32 s56, v113, 0
    v_readlane_b32 s38, v113, 1
    s_nop 3
    s_min_u32 s56, s56, s38
    s_mov_b64 exec, -1
L_wtd_166:
    buffer_load_dwordx4 v[122:125], v25, s[4:7], s30 offen sc1
    buffer_load_dwordx4 v[126:129], v26, s[4:7], s30 offen sc1
    s_xor_b32 s22, s22, s23
    s_xor_b32 s23, s22, s23
    s_xor_b32 s22, s22, s23
    s_xor_b32 s24, s24, s25
    s_xor_b32 s25, s24, s25
    s_xor_b32 s24, s24, s25
    s_add_u32 s29, s29, 393216
    s_add_u32 s30, s30, 393216
    s_add_u32 s31, s31, 98304
    s_add_u32 s32, s32, 98304
    s_nop 0
    v_mov_b32 v72, 0
    v_mov_b32 v73, 0
    v_mov_b32 v74, 0
    v_mov_b32 v75, 0
    v_mov_b32 v76, 0
    v_mov_b32 v77, 0
    v_mov_b32 v78, 0
    v_mov_b32 v79, 0
    s_sleep 28
    buffer_load_dwordx4 v[56:59], v6, s[4:7], s26 offen sc1
    buffer_load_dwordx4 v[60:63], v7, s[4:7], s26 offen sc1
    s_xor_b32 s26, s26, s27
    s_xor_b32 s27, s26, s27
    s_xor_b32 s26, s26, s27
    s_xor_b32 s28, s28, 262144
    s_add_u32 s21, s21, 1
    s_lshr_b32 s40, s21, 1
    s_and_b32 s40, s40, 1
    s_xor_b32 s40, s40, 1
    v_mov_b32 v30, s40
    s_mov_b32 s58, 1
    s_waitcnt vmcnt(0)
    v_max_u32 v113, v56, v60
    v_cmp_eq_u32 vcc, -1, v113
    s_cbranch_vccnz L_retry_168
L_ok_169:
    ds_write_b128 v2, v[56:59]
    ds_write_b128 v2, v[60:63] offset:4096
    ds_write_b128 v154, v[126:129]
    s_waitcnt lgkmcnt(0)
    s_barrier
    s_branch L_step_159
L_slow_161:
    s_cmp_eq_u32 s58, 1
    s_cbranch_scc1 L_cont_162
    s_mov_b32 s58, 1
    s_mov_b32 s38, 0
L_sl_170:
    buffer_load_dwordx4 v[56:59], v6, s[4:7], s27 offen sc1
    buffer_load_dwordx4 v[60:63], v7, s[4:7], s27 offen sc1
    s_waitcnt vmcnt(0)
    v_max_u32 v113, v56, v60
    v_cmp_eq_u32 vcc, -1, v113
    s_cbranch_vccz L_slk_171
    s_add_u32 s38, s38, 1
    s_cmp_lt_u32 s38, 4194304
    s_cbranch_scc1 L_sl_170
    s_branch L_end_1
L_slk_171:
    s_waitcnt lgkmcnt(0)
    s_barrier
    ds_write_b128 v2, v[56:59]
    ds_write_b128 v2, v[60:63] offset:4096
    s_nop 7
    s_nop 7
    v_mov_b32 v72, 0
    v_mov_b32 v73, 0
    v_mov_b32 v74, 0
    v_mov_b32 v75, 0
    v_mov_b32 v76, 0
    v_mov_b32 v77, 0
    v_mov_b32 v78, 0
    v_mov_b32 v79, 0
    v_mov_b32 v80, 0
    v_mov_b32 v81, 0
    v_mov_b32 v82, 0
    v_mov_b32 v83, 0
    s_waitcnt lgkmcnt(0)
    s_barrier
    s_branch L_step_159
L_retry_163:
    s_mov_b32 s38, 0
L_rl_172:
    s_mov_b64 exec, s[48:49]
    buffer_load_dwordx2 v[104:105], v12, s[4:7], s22 offen sc1
    buffer_load_dwordx2 v[106:107], v12, s[4:7], s22 offen offset:1536 sc1
    buffer_load_dwordx2 v[108:109], v12, s[4:7], s22 offen offset:3072 sc1
    s_mov_b64 exec, -1
    s_waitcnt vmcnt(0)
    v_max3_u32 v113, v104, v106, v108
    v_cmp_eq_u32 vcc, -1, v113
    s_cbranch_vccz L_ok_164
    s_add_u32 s38, s38, 1
    s_cmp_lt_u32 s38, 4194304
    s_cbranch_scc1 L_rl_172
    s_branch L_end_1
L_retry_168:
    s_mov_b32 s38, 0
L_rl_173:
    buffer_load_dwordx4 v[56:59], v6, s[4:7], s27 offen sc1
    buffer_load_dwordx4 v[60:63], v7, s[4:7], s27 offen sc1
    s_waitcnt vmcnt(0)
    v_max_u32 v113, v56, v60
    v_cmp_eq_u32 vcc, -1, v113
    s_cbranch_vccz L_ok_169
    s_add_u32 s38, s38, 1
    s_cmp_lt_u32 s38, 4194304
    s_cbranch_scc1 L_rl_173
    s_branch L_end_1
L_exit_160:
    s_nop 7
    s_nop 1
    s_mov_b64 exec, s[52:53]
    buffer_store_dwordx4 v[92:95], v27, s[4:7], s31 offen
    buffer_store_dwordx4 v[96:99], v27, s[4:7], s31 offen offset:64
    s_mov_b64 exec, -1
    v_mov_b32 v156, v80
    v_mov_b32 v157, v81
    v_mov_b32 v158, v82
    v_mov_b32 v159, v83
    s_nop 0
    v_permlane32_swap_b32 v80, v156
    v_permlane32_swap_b32 v81, v157
    v_permlane32_swap_b32 v82, v158
    v_permlane32_swap_b32 v83, v159
    v_add_f32 v80, v80, v156
    v_add_f32 v81, v81, v157
    v_add_f32 v82, v82, v158
    v_add_f32 v83, v83, v159
    v_cvt_pk_bf16_f32 v156, v80, v81
    v_cvt_pk_bf16_f32 v157, v82, v83
    s_nop 1
    v_permlane16_swap_b32 v156, v158
    v_permlane16_swap_b32 v157, v159
    s_mov_b64 exec, s[54:55]
    buffer_store_dwordx4 v[156:159], v28, s[4:7], s32 offen
    s_mov_b64 exec, -1
    v_mov_b32 v80, 0
    v_mov_b32 v81, 0
    v_mov_b32 v82, 0
    v_mov_b32 v83, 0
    s_waitcnt vmcnt(0)
    s_barrier
    v_mov_b32 v113, 64
    s_mov_b64 exec, 1
    buffer_store_dword v113, v155, s[4:7], 0 offen
    s_mov_b64 exec, -1
    s_branch L_done_27
L_done_27:
    s_branch L_end_1
L_proj_8:
    s_mov_b32 s18, 0
    s_mov_b32 s19, 64
    s_sub_u32 s44, s17, 8
    s_cmp_lt_u32 s17, 48
    s_cselect_b32 s44, 64, s44
    s_cmp_ge_u32 s17, 72
    s_cselect_b32 s44, 64, s44
    s_cmp_ge_u32 s44, 64
    s_cbranch_scc1 L_nln_174
    s_load_dwordx2 s[24:25], s[0:1], 0
    s_waitcnt lgkmcnt(0)
    s_mov_b32 s8, s24
    s_and_b32 s9, s25, 0xffff
    s_mov_b32 s10, 2621440
    s_mov_b32 s11, 0x20000
    v_and_b32 v7, 63, v0
    v_lshlrev_b32 v7, 2, v7
    s_lshl_b32 s28, s44, 5
    s_lshl_b32 s29, s16, 3
    s_add_u32 s28, s28, s29
    s_mul_i32 s28, s28, 1280
    buffer_load_dword v40, v7, s[8:11], s28 offen offset:0
    buffer_load_dword v41, v7, s[8:11], s28 offen offset:256
    buffer_load_dword v42, v7, s[8:11], s28 offen offset:512
    buffer_load_dword v43, v7, s[8:11], s28 offen offset:768
    buffer_load_dword v44, v7, s[8:11], s28 offen offset:1024
    s_add_u32 s28, s28, 1280
    buffer_load_dword v45, v7, s[8:11], s28 offen offset:0
    buffer_load_dword v46, v7, s[8:11], s28 offen offset:256
    buffer_load_dword v47, v7, s[8:11], s28 offen offset:512
    buffer_load_dword v48, v7, s[8:11], s28 offen offset:768
    buffer_load_dword v49, v7, s[8:11], s28 offen offset:1024
    s_add_u32 s28, s28, 1280
    buffer_load_dword v50, v7, s[8:11], s28 offen offset:0
    buffer_load_dword v51, v7, s[8:11], s28 offen offset:256
    buffer_load_dword v52, v7, s[8:11], s28 offen offset:512
    buffer_load_dword v53, v7, s[8:11], s28 offen offset:768
    buffer_load_dword v54, v7, s[8:11], s28 offen offset:1024
    s_add_u32 s28, s28, 1280
    buffer_load_dword v55, v7, s[8:11], s28 offen offset:0
    buffer_load_dword v56, v7, s[8:11], s28 offen offset:256
    buffer_load_dword v57, v7, s[8:11], s28 offen offset:512
    buffer_load_dword v58, v7, s[8:11], s28 offen offset:768
    buffer_load_dword v59, v7, s[8:11], s28 offen offset:1024
    s_add_u32 s28, s28, 1280
    buffer_load_dword v60, v7, s[8:11], s28 offen offset:0
    buffer_load_dword v61, v7, s[8:11], s28 offen offset:256
    buffer_load_dword v62, v7, s[8:11], s28 offen offset:512
    buffer_load_dword v63, v7, s[8:11], s28 offen offset:768
    buffer_load_dword v64, v7, s[8:11], s28 offen offset:1024
    s_add_u32 s28, s28, 1280
    buffer_load_dword v65, v7, s[8:11], s28 offen offset:0
    buffer_load_dword v66, v7, s[8:11], s28 offen offset:256
    buffer_load_dword v67, v7, s[8:11], s28 offen offset:512
    buffer_load_dword v68, v7, s[8:11], s28 offen offset:768
    buffer_load_dword v69, v7, s[8:11], s28 offen offset:1024
    s_add_u32 s28, s28, 1280
    buffer_load_dword v70, v7, s[8:11], s28 offen offset:0
    buffer_load_dword v71, v7, s[8:11], s28 offen offset:256
    buffer_load_dword v72, v7, s[8:11], s28 offen offset:512
    buffer_load_dword v73, v7, s[8:11], s28 offen offset:768
    buffer_load_dword v74, v7, s[8:11], s28 offen offset:1024
    s_add_u32 s28, s28, 1280
    buffer_load_dword v75, v7, s[8:11], s28 offen offset:0
    buffer_load_dword v76, v7, s[8:11], s28 offen offset:256
    buffer_load_dword v77, v7, s[8:11], s28 offen offset:512
    buffer_load_dword v78, v7, s[8:11], s28 offen offset:768
    buffer_load_dword v79, v7, s[8:11], s28 offen offset:1024
    s_sub_u32 s28, s28, 8960
    v_add_u32 v6, 117440512, v7
    s_waitcnt vmcnt(35)
    v_lshlrev_b32 v20, 16, v40
    v_and_b32 v21, 0xffff0000, v40
    v_lshlrev_b32 v22, 16, v41
    v_and_b32 v23, 0xffff0000, v41
    v_lshlrev_b32 v24, 16, v42
    v_and_b32 v25, 0xffff0000, v42
    v_lshlrev_b32 v26, 16, v43
    v_and_b32 v27, 0xffff0000, v43
    v_lshlrev_b32 v28, 16, v44
    v_and_b32 v29, 0xffff0000, v44
    v_add_f32 v30, v20, v21
    v_add_f32 v30, v30, v22
    v_add_f32 v30, v30, v23
    v_add_f32 v30, v30, v24
    v_add_f32 v30, v30, v25
    v_add_f32 v30, v30, v26
    v_add_f32 v30, v30, v27
    v_add_f32 v30, v30, v28
    v_add_f32 v30, v30, v29
    s_nop 1
    v_add_f32_dpp v30, v30, v30 row_ror:8 row_mask:0xf bank_mask:0xf
    s_nop 1
    v_add_f32_dpp v30, v30, v30 row_ror:4 row_mask:0xf bank_mask:0xf
    s_nop 1
    v_add_f32_dpp v30, v30, v30 row_ror:2 row_mask:0xf bank_mask:0xf
    s_nop 1
    v_add_f32_dpp v30, v30, v30 row_ror:1 row_mask:0xf bank_mask:0xf
    v_mov_b32 v31, v30
    s_nop 1
    v_permlane16_swap_b32 v30, v31
    v_add_f32 v30, v30, v31
    v_mov_b32 v31, v30
    s_nop 1
    v_permlane32_swap_b32 v30, v31
    v_add_f32 v30, v30, v31
    v_mul_f32 v30, 0x3acccccd, v30
    v_sub_f32 v32, v20, v30
    v_mul_f32 v33, v32, v32
    v_sub_f32 v32, v21, v30
    v_fmac_f32 v33, v32, v32
    v_sub_f32 v32, v22, v30
    v_fmac_f32 v33, v32, v32
    v_sub_f32 v32, v23, v30
    v_fmac_f32 v33, v32, v32
    v_sub_f32 v32, v24, v30
    v_fmac_f32 v33, v32, v32
    v_sub_f32 v32, v25, v30
    v_fmac_f32 v33, v32, v32
    v_sub_f32 v32, v26, v30
    v_fmac_f32 v33, v32, v32
    v_sub_f32 v32, v27, v30
    v_fmac_f32 v33, v32, v32
    v_sub_f32 v32, v28, v30
    v_fmac_f32 v33, v32, v32
    v_sub_f32 v32, v29, v30
    v_fmac_f32 v33, v32, v32
    s_nop 1
    v_add_f32_dpp v33, v33, v33 row_ror:8 row_mask:0xf bank_mask:0xf
    s_nop 1
    v_add_f32_dpp v33, v33, v33 row_ror:4 row_mask:0xf bank_mask:0xf
    s_nop 1
    v_add_f32_dpp v33, v33, v33 row_ror:2 row_mask:0xf bank_mask:0xf
    s_nop 1
    v_add_f32_dpp v33, v33, v33 row_ror:1 row_mask:0xf bank_mask:0xf
    v_mov_b32 v31, v33
    s_nop 1
    v_permlane16_swap_b32 v33, v31
    v_add_f32 v33, v33, v31
    v_mov_b32 v31, v33
    s_nop 1
    v_permlane32_swap_b32 v33, v31
    v_add_f32 v33, v33, v31
    v_mul_f32 v33, 0x3acccccd, v33
    v_cvt_pk_bf16_f32 v30, v30, v30
    v_lshlrev_b32 v30, 16, v30
    v_cvt_pk_bf16_f32 v33, v33, v33
    v_lshlrev_b32 v33, 16, v33
    v_add_f32 v33, 0x3727c5ac, v33
    v_cvt_pk_bf16_f32 v33, v33, v33
    v_lshlrev_b32 v33, 16, v33
    v_sqrt_f32 v33, v33
    s_nop 0
    v_cvt_pk_bf16_f32 v33, v33, v33
    v_lshlrev_b32 v33, 16, v33
    v_rcp_f32 v34, v33
    v_sub_f32 v20, v20, v30
    v_sub_f32 v21, v21, v30
    v_sub_f32 v22, v22, v30
    v_sub_f32 v23, v23, v30
    v_sub_f32 v24, v24, v30
    v_sub_f32 v25, v25, v30
    v_sub_f32 v26, v26, v30
    v_sub_f32 v27, v27, v30
    v_sub_f32 v28, v28, v30
    v_sub_f32 v29, v29, v30
    v_cvt_pk_bf16_f32 v40, v20, v21
    v_lshlrev_b32 v20, 16, v40
    v_and_b32 v21, 0xffff0000, v40
    v_cvt_pk_bf16_f32 v41, v22, v23
    v_lshlrev_b32 v22, 16, v41
    v_and_b32 v23, 0xffff0000, v41
    v_cvt_pk_bf16_f32 v42, v24, v25
    v_lshlrev_b32 v24, 16, v42
    v_and_b32 v25, 0xffff0000, v42
    v_cvt_pk_bf16_f32 v43, v26, v27
    v_lshlrev_b32 v26, 16, v43
    v_and_b32 v27, 0xffff0000, v43
    v_cvt_pk_bf16_f32 v44, v28, v29
    v_lshlrev_b32 v28, 16, v44
    v_and_b32 v29, 0xffff0000, v44
    v_mul_f32 v35, v20, v34
    v_fma_f32 v36, -v35, v33, v20
    v_fma_f32 v20, v36, v34, v35
    v_mul_f32 v35, v21, v34
    v_fma_f32 v36, -v35, v33, v21
    v_fma_f32 v21, v36, v34, v35
    v_mul_f32 v35, v22, v34
    v_fma_f32 v36, -v35, v33, v22
    v_fma_f32 v22, v36, v34, v35
    v_mul_f32 v35, v23, v34
    v_fma_f32 v36, -v35, v33, v23
    v_fma_f32 v23, v36, v34, v35
    v_mul_f32 v35, v24, v34
    v_fma_f32 v36, -v35, v33, v24
    v_fma_f32 v24, v36, v34, v35
    v_mul_f32 v35, v25, v34
    v_fma_f32 v36, -v35, v33, v25
    v_fma_f32 v25, v36, v34, v35
    v_mul_f32 v35, v26, v34
    v_fma_f32 v36, -v35, v33, v26
    v_fma_f32 v26, v36, v34, v35
    v_mul_f32 v35, v27, v34
    v_fma_f32 v36, -v35, v33, v27
    v_fma_f32 v27, v36, v34, v35
    v_mul_f32 v35, v28, v34
    v_fma_f32 v36, -v35, v33, v28
    v_fma_f32 v28, v36, v34, v35
    v_mul_f32 v35, v29, v34
    v_fma_f32 v36, -v35, v33, v29
    v_fma_f32 v29, v36, v34, v35
    v_cvt_pk_bf16_f32 v40, v20, v21
    v_cvt_pk_bf16_f32 v41, v22, v23
    v_cvt_pk_bf16_f32 v42, v24, v25
    v_cvt_pk_bf16_f32 v43, v26, v27
    v_cvt_pk_bf16_f32 v44, v28, v29
    buffer_store_dword v40, v6, s[4:7], s28 offen offset:0 sc1
    buffer_store_dword v41, v6, s[4:7], s28 offen offset:256 sc1
    buffer_store_dword v42, v6, s[4:7], s28 offen offset:512 sc1
    buffer_store_dword v43, v6, s[4:7], s28 offen offset:768 sc1
    buffer_store_dword v44, v6, s[4:7], s28 offen offset:1024 sc1
    s_add_u32 s28, s28, 1280
    s_waitcnt vmcnt(35)
    v_lshlrev_b32 v20, 16, v45
    v_and_b32 v21, 0xffff0000, v45
    v_lshlrev_b32 v22, 16, v46
    v_and_b32 v23, 0xffff0000, v46
    v_lshlrev_b32 v24, 16, v47
    v_and_b32 v25, 0xffff0000, v47
    v_lshlrev_b32 v26, 16, v48
    v_and_b32 v27, 0xffff0000, v48
    v_lshlrev_b32 v28, 16, v49
    v_and_b32 v29, 0xffff0000, v49
    v_add_f32 v30, v20, v21
    v_add_f32 v30, v30, v22
    v_add_f32 v30, v30, v23
    v_add_f32 v30, v30, v24
    v_add_f32 v30, v30, v25
    v_add_f32 v30, v30, v26
    v_add_f32 v30, v30, v27
    v_add_f32 v30, v30, v28
    v_add_f32 v30, v30, v29
    s_nop 1
    v_add_f32_dpp v30, v30, v30 row_ror:8 row_mask:0xf bank_mask:0xf
    s_nop 1
    v_add_f32_dpp v30, v30, v30 row_ror:4 row_mask:0xf bank_mask:0xf
    s_nop 1
    v_add_f32_dpp v30, v30, v30 row_ror:2 row_mask:0xf bank_mask:0xf
    s_nop 1
    v_add_f32_dpp v30, v30, v30 row_ror:1 row_mask:0xf bank_mask:0xf
    v_mov_b32 v31, v30
    s_nop 1
    v_permlane16_swap_b32 v30, v31
    v_add_f32 v30, v30, v31
    v_mov_b32 v31, v30
    s_nop 1
    v_permlane32_swap_b32 v30, v31
    v_add_f32 v30, v30, v31
    v_mul_f32 v30, 0x3acccccd, v30
    v_sub_f32 v32, v20, v30
    v_mul_f32 v33, v32, v32
    v_sub_f32 v32, v21, v30
    v_fmac_f32 v33, v32, v32
    v_sub_f32 v32, v22, v30
    v_fmac_f32 v33, v32, v32
    v_sub_f32 v32, v23, v30
    v_fmac_f32 v33, v32, v32
    v_sub_f32 v32, v24, v30
    v_fmac_f32 v33, v32, v32
    v_sub_f32 v32, v25, v30
    v_fmac_f32 v33, v32, v32
    v_sub_f32 v32, v26, v30
    v_fmac_f32 v33, v32, v32
    v_sub_f32 v32, v27, v30
    v_fmac_f32 v33, v32, v32
    v_sub_f32 v32, v28, v30
    v_fmac_f32 v33, v32, v32
    v_sub_f32 v32, v29, v30
    v_fmac_f32 v33, v32, v32
    s_nop 1
    v_add_f32_dpp v33, v33, v33 row_ror:8 row_mask:0xf bank_mask:0xf
    s_nop 1
    v_add_f32_dpp v33, v33, v33 row_ror:4 row_mask:0xf bank_mask:0xf
    s_nop 1
    v_add_f32_dpp v33, v33, v33 row_ror:2 row_mask:0xf bank_mask:0xf
    s_nop 1
    v_add_f32_dpp v33, v33, v33 row_ror:1 row_mask:0xf bank_mask:0xf
    v_mov_b32 v31, v33
    s_nop 1
    v_permlane16_swap_b32 v33, v31
    v_add_f32 v33, v33, v31
    v_mov_b32 v31, v33
    s_nop 1
    v_permlane32_swap_b32 v33, v31
    v_add_f32 v33, v33, v31
    v_mul_f32 v33, 0x3acccccd, v33
    v_cvt_pk_bf16_f32 v30, v30, v30
    v_lshlrev_b32 v30, 16, v30
    v_cvt_pk_bf16_f32 v33, v33, v33
    v_lshlrev_b32 v33, 16, v33
    v_add_f32 v33, 0x3727c5ac, v33
    v_cvt_pk_bf16_f32 v33, v33, v33
    v_lshlrev_b32 v33, 16, v33
    v_sqrt_f32 v33, v33
    s_nop 0
    v_cvt_pk_bf16_f32 v33, v33, v33
    v_lshlrev_b32 v33, 16, v33
    v_rcp_f32 v34, v33
    v_sub_f32 v20, v20, v30
    v_sub_f32 v21, v21, v30
    v_sub_f32 v22, v22, v30
    v_sub_f32 v23, v23, v30
    v_sub_f32 v24, v24, v30
    v_sub_f32 v25, v25, v30
    v_sub_f32 v26, v26, v30
    v_sub_f32 v27, v27, v30
    v_sub_f32 v28, v28, v30
    v_sub_f32 v29, v29, v30
    v_cvt_pk_bf16_f32 v45, v20, v21
    v_lshlrev_b32 v20, 16, v45
    v_and_b32 v21, 0xffff0000, v45
    v_cvt_pk_bf16_f32 v46, v22, v23
    v_lshlrev_b32 v22, 16, v46
    v_and_b32 v23, 0xffff0000, v46
    v_cvt_pk_bf16_f32 v47, v24, v25
    v_lshlrev_b32 v24, 16, v47
    v_and_b32 v25, 0xffff0000, v47
    v_cvt_pk_bf16_f32 v48, v26, v27
    v_lshlrev_b32 v26, 16, v48
    v_and_b32 v27, 0xffff0000, v48
    v_cvt_pk_bf16_f32 v49, v28, v29
    v_lshlrev_b32 v28, 16, v49
    v_and_b32 v29, 0xffff0000, v49
    v_mul_f32 v35, v20, v34
    v_fma_f32 v36, -v35, v33, v20
    v_fma_f32 v20, v36, v34, v35
    v_mul_f32 v35, v21, v34
    v_fma_f32 v36, -v35, v33, v21
    v_fma_f32 v21, v36, v34, v35
    v_mul_f32 v35, v22, v34
    v_fma_f32 v36, -v35, v33, v22
    v_fma_f32 v22, v36, v34, v35
    v_mul_f32 v35, v23, v34
    v_fma_f32 v36, -v35, v33, v23
    v_fma_f32 v23, v36, v34, v35
    v_mul_f32 v35, v24, v34
    v_fma_f32 v36, -v35, v33, v24
    v_fma_f32 v24, v36, v34, v35
    v_mul_f32 v35, v25, v34
    v_fma_f32 v36, -v35, v33, v25
    v_fma_f32 v25, v36, v34, v35
    v_mul_f32 v35, v26, v34
    v_fma_f32 v36, -v35, v33, v26
    v_fma_f32 v26, v36, v34, v35
    v_mul_f32 v35, v27, v34
    v_fma_f32 v36, -v35, v33, v27
    v_fma_f32 v27, v36, v34, v35
    v_mul_f32 v35, v28, v34
    v_fma_f32 v36, -v35, v33, v28
    v_fma_f32 v28, v36, v34, v35
    v_mul_f32 v35, v29, v34
    v_fma_f32 v36, -v35, v33, v29
    v_fma_f32 v29, v36, v34, v35
    v_cvt_pk_bf16_f32 v45, v20, v21
    v_cvt_pk_bf16_f32 v46, v22, v23
    v_cvt_pk_bf16_f32 v47, v24, v25
    v_cvt_pk_bf16_f32 v48, v26, v27
    v_cvt_pk_bf16_f32 v49, v28, v29
    buffer_store_dword v45, v6, s[4:7], s28 offen offset:0 sc1
    buffer_store_dword v46, v6, s[4:7], s28 offen offset:256 sc1
    buffer_store_dword v47, v6, s[4:7], s28 offen offset:512 sc1
    buffer_store_dword v48, v6, s[4:7], s28 offen offset:768 sc1
    buffer_store_dword v49, v6, s[4:7], s28 offen offset:1024 sc1
    s_add_u32 s28, s28, 1280
    s_waitcnt vmcnt(35)
    v_lshlrev_b32 v20, 16, v50
    v_and_b32 v21, 0xffff0000, v50
    v_lshlrev_b32 v22, 16, v51
    v_and_b32 v23, 0xffff0000, v51
    v_lshlrev_b32 v24, 16, v52
    v_and_b32 v25, 0xffff0000, v52
    v_lshlrev_b32 v26, 16, v53
    v_and_b32 v27, 0xffff0000, v53
    v_lshlrev_b32 v28, 16, v54
    v_and_b32 v29, 0xffff0000, v54
    v_add_f32 v30, v20, v21
    v_add_f32 v30, v30, v22
    v_add_f32 v30, v30, v23
    v_add_f32 v30, v30, v24
    v_add_f32 v30, v30, v25
    v_add_f32 v30, v30, v26
    v_add_f32 v30, v30, v27
    v_add_f32 v30, v30, v28
    v_add_f32 v30, v30, v29
    s_nop 1
    v_add_f32_dpp v30, v30, v30 row_ror:8 row_mask:0xf bank_mask:0xf
    s_nop 1
    v_add_f32_dpp v30, v30, v30 row_ror:4 row_mask:0xf bank_mask:0xf
    s_nop 1
    v_add_f32_dpp v30, v30, v30 row_ror:2 row_mask:0xf bank_mask:0xf
    s_nop 1
    v_add_f32_dpp v30, v30, v30 row_ror:1 row_mask:0xf bank_mask:0xf
    v_mov_b32 v31, v30
    s_nop 1
    v_permlane16_swap_b32 v30, v31
    v_add_f32 v30, v30, v31
    v_mov_b32 v31, v30
    s_nop 1
    v_permlane32_swap_b32 v30, v31
    v_add_f32 v30, v30, v31
    v_mul_f32 v30, 0x3acccccd, v30
    v_sub_f32 v32, v20, v30
    v_mul_f32 v33, v32, v32
    v_sub_f32 v32, v21, v30
    v_fmac_f32 v33, v32, v32
    v_sub_f32 v32, v22, v30
    v_fmac_f32 v33, v32, v32
    v_sub_f32 v32, v23, v30
    v_fmac_f32 v33, v32, v32
    v_sub_f32 v32, v24, v30
    v_fmac_f32 v33, v32, v32
    v_sub_f32 v32, v25, v30
    v_fmac_f32 v33, v32, v32
    v_sub_f32 v32, v26, v30
    v_fmac_f32 v33, v32, v32
    v_sub_f32 v32, v27, v30
    v_fmac_f32 v33, v32, v32
    v_sub_f32 v32, v28, v30
    v_fmac_f32 v33, v32, v32
    v_sub_f32 v32, v29, v30
    v_fmac_f32 v33, v32, v32
    s_nop 1
    v_add_f32_dpp v33, v33, v33 row_ror:8 row_mask:0xf bank_mask:0xf
    s_nop 1
    v_add_f32_dpp v33, v33, v33 row_ror:4 row_mask:0xf bank_mask:0xf
    s_nop 1
    v_add_f32_dpp v33, v33, v33 row_ror:2 row_mask:0xf bank_mask:0xf
    s_nop 1
    v_add_f32_dpp v33, v33, v33 row_ror:1 row_mask:0xf bank_mask:0xf
    v_mov_b32 v31, v33
    s_nop 1
    v_permlane16_swap_b32 v33, v31
    v_add_f32 v33, v33, v31
    v_mov_b32 v31, v33
    s_nop 1
    v_permlane32_swap_b32 v33, v31
    v_add_f32 v33, v33, v31
    v_mul_f32 v33, 0x3acccccd, v33
    v_cvt_pk_bf16_f32 v30, v30, v30
    v_lshlrev_b32 v30, 16, v30
    v_cvt_pk_bf16_f32 v33, v33, v33
    v_lshlrev_b32 v33, 16, v33
    v_add_f32 v33, 0x3727c5ac, v33
    v_cvt_pk_bf16_f32 v33, v33, v33
    v_lshlrev_b32 v33, 16, v33
    v_sqrt_f32 v33, v33
    s_nop 0
    v_cvt_pk_bf16_f32 v33, v33, v33
    v_lshlrev_b32 v33, 16, v33
    v_rcp_f32 v34, v33
    v_sub_f32 v20, v20, v30
    v_sub_f32 v21, v21, v30
    v_sub_f32 v22, v22, v30
    v_sub_f32 v23, v23, v30
    v_sub_f32 v24, v24, v30
    v_sub_f32 v25, v25, v30
    v_sub_f32 v26, v26, v30
    v_sub_f32 v27, v27, v30
    v_sub_f32 v28, v28, v30
    v_sub_f32 v29, v29, v30
    v_cvt_pk_bf16_f32 v50, v20, v21
    v_lshlrev_b32 v20, 16, v50
    v_and_b32 v21, 0xffff0000, v50
    v_cvt_pk_bf16_f32 v51, v22, v23
    v_lshlrev_b32 v22, 16, v51
    v_and_b32 v23, 0xffff0000, v51
    v_cvt_pk_bf16_f32 v52, v24, v25
    v_lshlrev_b32 v24, 16, v52
    v_and_b32 v25, 0xffff0000, v52
    v_cvt_pk_bf16_f32 v53, v26, v27
    v_lshlrev_b32 v26, 16, v53
    v_and_b32 v27, 0xffff0000, v53
    v_cvt_pk_bf16_f32 v54, v28, v29
    v_lshlrev_b32 v28, 16, v54
    v_and_b32 v29, 0xffff0000, v54
    v_mul_f32 v35, v20, v34
    v_fma_f32 v36, -v35, v33, v20
    v_fma_f32 v20, v36, v34, v35
    v_mul_f32 v35, v21, v34
    v_fma_f32 v36, -v35, v33, v21
    v_fma_f32 v21, v36, v34, v35
    v_mul_f32 v35, v22, v34
    v_fma_f32 v36, -v35, v33, v22
    v_fma_f32 v22, v36, v34, v35
    v_mul_f32 v35, v23, v34
    v_fma_f32 v36, -v35, v33, v23
    v_fma_f32 v23, v36, v34, v35
    v_mul_f32 v35, v24, v34
    v_fma_f32 v36, -v35, v33, v24
    v_fma_f32 v24, v36, v34, v35
    v_mul_f32 v35, v25, v34
    v_fma_f32 v36, -v35, v33, v25
    v_fma_f32 v25, v36, v34, v35
    v_mul_f32 v35, v26, v34
    v_fma_f32 v36, -v35, v33, v26
    v_fma_f32 v26, v36, v34, v35
    v_mul_f32 v35, v27, v34
    v_fma_f32 v36, -v35, v33, v27
    v_fma_f32 v27, v36, v34, v35
    v_mul_f32 v35, v28, v34
    v_fma_f32 v36, -v35, v33, v28
    v_fma_f32 v28, v36, v34, v35
    v_mul_f32 v35, v29, v34
    v_fma_f32 v36, -v35, v33, v29
    v_fma_f32 v29, v36, v34, v35
    v_cvt_pk_bf16_f32 v50, v20, v21
    v_cvt_pk_bf16_f32 v51, v22, v23
    v_cvt_pk_bf16_f32 v52, v24, v25
    v_cvt_pk_bf16_f32 v53, v26, v27
    v_cvt_pk_bf16_f32 v54, v28, v29
    buffer_store_dword v50, v6, s[4:7], s28 offen offset:0 sc1
    buffer_store_dword v51, v6, s[4:7], s28 offen offset:256 sc1
    buffer_store_dword v52, v6, s[4:7], s28 offen offset:512 sc1
    buffer_store_dword v53, v6, s[4:7], s28 offen offset:768 sc1
    buffer_store_dword v54, v6, s[4:7], s28 offen offset:1024 sc1
    s_add_u32 s28, s28, 1280
    s_waitcnt vmcnt(35)
    v_lshlrev_b32 v20, 16, v55
    v_and_b32 v21, 0xffff0000, v55
    v_lshlrev_b32 v22, 16, v56
    v_and_b32 v23, 0xffff0000, v56
    v_lshlrev_b32 v24, 16, v57
    v_and_b32 v25, 0xffff0000, v57
    v_lshlrev_b32 v26, 16, v58
    v_and_b32 v27, 0xffff0000, v58
    v_lshlrev_b32 v28, 16, v59
    v_and_b32 v29, 0xffff0000, v59
    v_add_f32 v30, v20, v21
    v_add_f32 v30, v30, v22
    v_add_f32 v30, v30, v23
    v_add_f32 v30, v30, v24
    v_add_f32 v30, v30, v25
    v_add_f32 v30, v30, v26
    v_add_f32 v30, v30, v27
    v_add_f32 v30, v30, v28
    v_add_f32 v30, v30, v29
    s_nop 1
    v_add_f32_dpp v30, v30, v30 row_ror:8 row_mask:0xf bank_mask:0xf
    s_nop 1
    v_add_f32_dpp v30, v30, v30 row_ror:4 row_mask:0xf bank_mask:0xf
    s_nop 1
    v_add_f32_dpp v30, v30, v30 row_ror:2 row_mask:0xf bank_mask:0xf
    s_nop 1
    v_add_f32_dpp v30, v30, v30 row_ror:1 row_mask:0xf bank_mask:0xf
    v_mov_b32 v31, v30
    s_nop 1
    v_permlane16_swap_b32 v30, v31
    v_add_f32 v30, v30, v31
    v_mov_b32 v31, v30
    s_nop 1
    v_permlane32_swap_b32 v30, v31
    v_add_f32 v30, v30, v31
    v_mul_f32 v30, 0x3acccccd, v30
    v_sub_f32 v32, v20, v30
    v_mul_f32 v33, v32, v32
    v_sub_f32 v32, v21, v30
    v_fmac_f32 v33, v32, v32
    v_sub_f32 v32, v22, v30
    v_fmac_f32 v33, v32, v32
    v_sub_f32 v32, v23, v30
    v_fmac_f32 v33, v32, v32
    v_sub_f32 v32, v24, v30
    v_fmac_f32 v33, v32, v32
    v_sub_f32 v32, v25, v30
    v_fmac_f32 v33, v32, v32
    v_sub_f32 v32, v26, v30
    v_fmac_f32 v33, v32, v32
    v_sub_f32 v32, v27, v30
    v_fmac_f32 v33, v32, v32
    v_sub_f32 v32, v28, v30
    v_fmac_f32 v33, v32, v32
    v_sub_f32 v32, v29, v30
    v_fmac_f32 v33, v32, v32
    s_nop 1
    v_add_f32_dpp v33, v33, v33 row_ror:8 row_mask:0xf bank_mask:0xf
    s_nop 1
    v_add_f32_dpp v33, v33, v33 row_ror:4 row_mask:0xf bank_mask:0xf
    s_nop 1
    v_add_f32_dpp v33, v33, v33 row_ror:2 row_mask:0xf bank_mask:0xf
    s_nop 1
    v_add_f32_dpp v33, v33, v33 row_ror:1 row_mask:0xf bank_mask:0xf
    v_mov_b32 v31, v33
    s_nop 1
    v_permlane16_swap_b32 v33, v31
    v_add_f32 v33, v33, v31
    v_mov_b32 v31, v33
    s_nop 1
    v_permlane32_swap_b32 v33, v31
    v_add_f32 v33, v33, v31
    v_mul_f32 v33, 0x3acccccd, v33
    v_cvt_pk_bf16_f32 v30, v30, v30
    v_lshlrev_b32 v30, 16, v30
    v_cvt_pk_bf16_f32 v33, v33, v33
    v_lshlrev_b32 v33, 16, v33
    v_add_f32 v33, 0x3727c5ac, v33
    v_cvt_pk_bf16_f32 v33, v33, v33
    v_lshlrev_b32 v33, 16, v33
    v_sqrt_f32 v33, v33
    s_nop 0
    v_cvt_pk_bf16_f32 v33, v33, v33
    v_lshlrev_b32 v33, 16, v33
    v_rcp_f32 v34, v33
    v_sub_f32 v20, v20, v30
    v_sub_f32 v21, v21, v30
    v_sub_f32 v22, v22, v30
    v_sub_f32 v23, v23, v30
    v_sub_f32 v24, v24, v30
    v_sub_f32 v25, v25, v30
    v_sub_f32 v26, v26, v30
    v_sub_f32 v27, v27, v30
    v_sub_f32 v28, v28, v30
    v_sub_f32 v29, v29, v30
    v_cvt_pk_bf16_f32 v55, v20, v21
    v_lshlrev_b32 v20, 16, v55
    v_and_b32 v21, 0xffff0000, v55
    v_cvt_pk_bf16_f32 v56, v22, v23
    v_lshlrev_b32 v22, 16, v56
    v_and_b32 v23, 0xffff0000, v56
    v_cvt_pk_bf16_f32 v57, v24, v25
    v_lshlrev_b32 v24, 16, v57
    v_and_b32 v25, 0xffff0000, v57
    v_cvt_pk_bf16_f32 v58, v26, v27
    v_lshlrev_b32 v26, 16, v58
    v_and_b32 v27, 0xffff0000, v58
    v_cvt_pk_bf16_f32 v59, v28, v29
    v_lshlrev_b32 v28, 16, v59
    v_and_b32 v29, 0xffff0000, v59
    v_mul_f32 v35, v20, v34
    v_fma_f32 v36, -v35, v33, v20
    v_fma_f32 v20, v36, v34, v35
    v_mul_f32 v35, v21, v34
    v_fma_f32 v36, -v35, v33, v21
    v_fma_f32 v21, v36, v34, v35
    v_mul_f32 v35, v22, v34
    v_fma_f32 v36, -v35, v33, v22
    v_fma_f32 v22, v36, v34, v35
    v_mul_f32 v35, v23, v34
    v_fma_f32 v36, -v35, v33, v23
    v_fma_f32 v23, v36, v34, v35
    v_mul_f32 v35, v24, v34
    v_fma_f32 v36, -v35, v33, v24
    v_fma_f32 v24, v36, v34, v35
    v_mul_f32 v35, v25, v34
    v_fma_f32 v36, -v35, v33, v25
    v_fma_f32 v25, v36, v34, v35
    v_mul_f32 v35, v26, v34
    v_fma_f32 v36, -v35, v33, v26
    v_fma_f32 v26, v36, v34, v35
    v_mul_f32 v35, v27, v34
    v_fma_f32 v36, -v35, v33, v27
    v_fma_f32 v27, v36, v34, v35
    v_mul_f32 v35, v28, v34
    v_fma_f32 v36, -v35, v33, v28
    v_fma_f32 v28, v36, v34, v35
    v_mul_f32 v35, v29, v34
    v_fma_f32 v36, -v35, v33, v29
    v_fma_f32 v29, v36, v34, v35
    v_cvt_pk_bf16_f32 v55, v20, v21
    v_cvt_pk_bf16_f32 v56, v22, v23
    v_cvt_pk_bf16_f32 v57, v24, v25
    v_cvt_pk_bf16_f32 v58, v26, v27
    v_cvt_pk_bf16_f32 v59, v28, v29
    buffer_store_dword v55, v6, s[4:7], s28 offen offset:0 sc1
    buffer_store_dword v56, v6, s[4:7], s28 offen offset:256 sc1
    buffer_store_dword v57, v6, s[4:7], s28 offen offset:512 sc1
    buffer_store_dword v58, v6, s[4:7], s28 offen offset:768 sc1
    buffer_store_dword v59, v6, s[4:7], s28 offen offset:1024 sc1
    s_add_u32 s28, s28, 1280
    s_waitcnt vmcnt(35)
    v_lshlrev_b32 v20, 16, v60
    v_and_b32 v21, 0xffff0000, v60
    v_lshlrev_b32 v22, 16, v61
    v_and_b32 v23, 0xffff0000, v61
    v_lshlrev_b32 v24, 16, v62
    v_and_b32 v25, 0xffff0000, v62
    v_lshlrev_b32 v26, 16, v63
    v_and_b32 v27, 0xffff0000, v63
    v_lshlrev_b32 v28, 16, v64
    v_and_b32 v29, 0xffff0000, v64
    v_add_f32 v30, v20, v21
    v_add_f32 v30, v30, v22
    v_add_f32 v30, v30, v23
    v_add_f32 v30, v30, v24
    v_add_f32 v30, v30, v25
    v_add_f32 v30, v30, v26
    v_add_f32 v30, v30, v27
    v_add_f32 v30, v30, v28
    v_add_f32 v30, v30, v29
    s_nop 1
    v_add_f32_dpp v30, v30, v30 row_ror:8 row_mask:0xf bank_mask:0xf
    s_nop 1
    v_add_f32_dpp v30, v30, v30 row_ror:4 row_mask:0xf bank_mask:0xf
    s_nop 1
    v_add_f32_dpp v30, v30, v30 row_ror:2 row_mask:0xf bank_mask:0xf
    s_nop 1
    v_add_f32_dpp v30, v30, v30 row_ror:1 row_mask:0xf bank_mask:0xf
    v_mov_b32 v31, v30
    s_nop 1
    v_permlane16_swap_b32 v30, v31
    v_add_f32 v30, v30, v31
    v_mov_b32 v31, v30
    s_nop 1
    v_permlane32_swap_b32 v30, v31
    v_add_f32 v30, v30, v31
    v_mul_f32 v30, 0x3acccccd, v30
    v_sub_f32 v32, v20, v30
    v_mul_f32 v33, v32, v32
    v_sub_f32 v32, v21, v30
    v_fmac_f32 v33, v32, v32
    v_sub_f32 v32, v22, v30
    v_fmac_f32 v33, v32, v32
    v_sub_f32 v32, v23, v30
    v_fmac_f32 v33, v32, v32
    v_sub_f32 v32, v24, v30
    v_fmac_f32 v33, v32, v32
    v_sub_f32 v32, v25, v30
    v_fmac_f32 v33, v32, v32
    v_sub_f32 v32, v26, v30
    v_fmac_f32 v33, v32, v32
    v_sub_f32 v32, v27, v30
    v_fmac_f32 v33, v32, v32
    v_sub_f32 v32, v28, v30
    v_fmac_f32 v33, v32, v32
    v_sub_f32 v32, v29, v30
    v_fmac_f32 v33, v32, v32
    s_nop 1
    v_add_f32_dpp v33, v33, v33 row_ror:8 row_mask:0xf bank_mask:0xf
    s_nop 1
    v_add_f32_dpp v33, v33, v33 row_ror:4 row_mask:0xf bank_mask:0xf
    s_nop 1
    v_add_f32_dpp v33, v33, v33 row_ror:2 row_mask:0xf bank_mask:0xf
    s_nop 1
    v_add_f32_dpp v33, v33, v33 row_ror:1 row_mask:0xf bank_mask:0xf
    v_mov_b32 v31, v33
    s_nop 1
    v_permlane16_swap_b32 v33, v31
    v_add_f32 v33, v33, v31
    v_mov_b32 v31, v33
    s_nop 1
    v_permlane32_swap_b32 v33, v31
    v_add_f32 v33, v33, v31
    v_mul_f32 v33, 0x3acccccd, v33
    v_cvt_pk_bf16_f32 v30, v30, v30
    v_lshlrev_b32 v30, 16, v30
    v_cvt_pk_bf16_f32 v33, v33, v33
    v_lshlrev_b32 v33, 16, v33
    v_add_f32 v33, 0x3727c5ac, v33
    v_cvt_pk_bf16_f32 v33, v33, v33
    v_lshlrev_b32 v33, 16, v33
    v_sqrt_f32 v33, v33
    s_nop 0
    v_cvt_pk_bf16_f32 v33, v33, v33
    v_lshlrev_b32 v33, 16, v33
    v_rcp_f32 v34, v33
    v_sub_f32 v20, v20, v30
    v_sub_f32 v21, v21, v30
    v_sub_f32 v22, v22, v30
    v_sub_f32 v23, v23, v30
    v_sub_f32 v24, v24, v30
    v_sub_f32 v25, v25, v30
    v_sub_f32 v26, v26, v30
    v_sub_f32 v27, v27, v30
    v_sub_f32 v28, v28, v30
    v_sub_f32 v29, v29, v30
    v_cvt_pk_bf16_f32 v60, v20, v21
    v_lshlrev_b32 v20, 16, v60
    v_and_b32 v21, 0xffff0000, v60
    v_cvt_pk_bf16_f32 v61, v22, v23
    v_lshlrev_b32 v22, 16, v61
    v_and_b32 v23, 0xffff0000, v61
    v_cvt_pk_bf16_f32 v62, v24, v25
    v_lshlrev_b32 v24, 16, v62
    v_and_b32 v25, 0xffff0000, v62
    v_cvt_pk_bf16_f32 v63, v26, v27
    v_lshlrev_b32 v26, 16, v63
    v_and_b32 v27, 0xffff0000, v63
    v_cvt_pk_bf16_f32 v64, v28, v29
    v_lshlrev_b32 v28, 16, v64
    v_and_b32 v29, 0xffff0000, v64
    v_mul_f32 v35, v20, v34
    v_fma_f32 v36, -v35, v33, v20
    v_fma_f32 v20, v36, v34, v35
    v_mul_f32 v35, v21, v34
    v_fma_f32 v36, -v35, v33, v21
    v_fma_f32 v21, v36, v34, v35
    v_mul_f32 v35, v22, v34
    v_fma_f32 v36, -v35, v33, v22
    v_fma_f32 v22, v36, v34, v35
    v_mul_f32 v35, v23, v34
    v_fma_f32 v36, -v35, v33, v23
    v_fma_f32 v23, v36, v34, v35
    v_mul_f32 v35, v24, v34
    v_fma_f32 v36, -v35, v33, v24
    v_fma_f32 v24, v36, v34, v35
    v_mul_f32 v35, v25, v34
    v_fma_f32 v36, -v35, v33, v25
    v_fma_f32 v25, v36, v34, v35
    v_mul_f32 v35, v26, v34
    v_fma_f32 v36, -v35, v33, v26
    v_fma_f32 v26, v36, v34, v35
    v_mul_f32 v35, v27, v34
    v_fma_f32 v36, -v35, v33, v27
    v_fma_f32 v27, v36, v34, v35
    v_mul_f32 v35, v28, v34
    v_fma_f32 v36, -v35, v33, v28
    v_fma_f32 v28, v36, v34, v35
    v_mul_f32 v35, v29, v34
    v_fma_f32 v36, -v35, v33, v29
    v_fma_f32 v29, v36, v34, v35
    v_cvt_pk_bf16_f32 v60, v20, v21
    v_cvt_pk_bf16_f32 v61, v22, v23
    v_cvt_pk_bf16_f32 v62, v24, v25
    v_cvt_pk_bf16_f32 v63, v26, v27
    v_cvt_pk_bf16_f32 v64, v28, v29
    buffer_store_dword v60, v6, s[4:7], s28 offen offset:0 sc1
    buffer_store_dword v61, v6, s[4:7], s28 offen offset:256 sc1
    buffer_store_dword v62, v6, s[4:7], s28 offen offset:512 sc1
    buffer_store_dword v63, v6, s[4:7], s28 offen offset:768 sc1
    buffer_store_dword v64, v6, s[4:7], s28 offen offset:1024 sc1
    s_add_u32 s28, s28, 1280
    s_waitcnt vmcnt(35)
    v_lshlrev_b32 v20, 16, v65
    v_and_b32 v21, 0xffff0000, v65
    v_lshlrev_b32 v22, 16, v66
    v_and_b32 v23, 0xffff0000, v66
    v_lshlrev_b32 v24, 16, v67
    v_and_b32 v25, 0xffff0000, v67
    v_lshlrev_b32 v26, 16, v68
    v_and_b32 v27, 0xffff0000, v68
    v_lshlrev_b32 v28, 16, v69
    v_and_b32 v29, 0xffff0000, v69
    v_add_f32 v30, v20, v21
    v_add_f32 v30, v30, v22
    v_add_f32 v30, v30, v23
    v_add_f32 v30, v30, v24
    v_add_f32 v30, v30, v25
    v_add_f32 v30, v30, v26
    v_add_f32 v30, v30, v27
    v_add_f32 v30, v30, v28
    v_add_f32 v30, v30, v29
    s_nop 1
    v_add_f32_dpp v30, v30, v30 row_ror:8 row_mask:0xf bank_mask:0xf
    s_nop 1
    v_add_f32_dpp v30, v30, v30 row_ror:4 row_mask:0xf bank_mask:0xf
    s_nop 1
    v_add_f32_dpp v30, v30, v30 row_ror:2 row_mask:0xf bank_mask:0xf
    s_nop 1
    v_add_f32_dpp v30, v30, v30 row_ror:1 row_mask:0xf bank_mask:0xf
    v_mov_b32 v31, v30
    s_nop 1
    v_permlane16_swap_b32 v30, v31
    v_add_f32 v30, v30, v31
    v_mov_b32 v31, v30
    s_nop 1
    v_permlane32_swap_b32 v30, v31
    v_add_f32 v30, v30, v31
    v_mul_f32 v30, 0x3acccccd, v30
    v_sub_f32 v32, v20, v30
    v_mul_f32 v33, v32, v32
    v_sub_f32 v32, v21, v30
    v_fmac_f32 v33, v32, v32
    v_sub_f32 v32, v22, v30
    v_fmac_f32 v33, v32, v32
    v_sub_f32 v32, v23, v30
    v_fmac_f32 v33, v32, v32
    v_sub_f32 v32, v24, v30
    v_fmac_f32 v33, v32, v32
    v_sub_f32 v32, v25, v30
    v_fmac_f32 v33, v32, v32
    v_sub_f32 v32, v26, v30
    v_fmac_f32 v33, v32, v32
    v_sub_f32 v32, v27, v30
    v_fmac_f32 v33, v32, v32
    v_sub_f32 v32, v28, v30
    v_fmac_f32 v33, v32, v32
    v_sub_f32 v32, v29, v30
    v_fmac_f32 v33, v32, v32
    s_nop 1
    v_add_f32_dpp v33, v33, v33 row_ror:8 row_mask:0xf bank_mask:0xf
    s_nop 1
    v_add_f32_dpp v33, v33, v33 row_ror:4 row_mask:0xf bank_mask:0xf
    s_nop 1
    v_add_f32_dpp v33, v33, v33 row_ror:2 row_mask:0xf bank_mask:0xf
    s_nop 1
    v_add_f32_dpp v33, v33, v33 row_ror:1 row_mask:0xf bank_mask:0xf
    v_mov_b32 v31, v33
    s_nop 1
    v_permlane16_swap_b32 v33, v31
    v_add_f32 v33, v33, v31
    v_mov_b32 v31, v33
    s_nop 1
    v_permlane32_swap_b32 v33, v31
    v_add_f32 v33, v33, v31
    v_mul_f32 v33, 0x3acccccd, v33
    v_cvt_pk_bf16_f32 v30, v30, v30
    v_lshlrev_b32 v30, 16, v30
    v_cvt_pk_bf16_f32 v33, v33, v33
    v_lshlrev_b32 v33, 16, v33
    v_add_f32 v33, 0x3727c5ac, v33
    v_cvt_pk_bf16_f32 v33, v33, v33
    v_lshlrev_b32 v33, 16, v33
    v_sqrt_f32 v33, v33
    s_nop 0
    v_cvt_pk_bf16_f32 v33, v33, v33
    v_lshlrev_b32 v33, 16, v33
    v_rcp_f32 v34, v33
    v_sub_f32 v20, v20, v30
    v_sub_f32 v21, v21, v30
    v_sub_f32 v22, v22, v30
    v_sub_f32 v23, v23, v30
    v_sub_f32 v24, v24, v30
    v_sub_f32 v25, v25, v30
    v_sub_f32 v26, v26, v30
    v_sub_f32 v27, v27, v30
    v_sub_f32 v28, v28, v30
    v_sub_f32 v29, v29, v30
    v_cvt_pk_bf16_f32 v65, v20, v21
    v_lshlrev_b32 v20, 16, v65
    v_and_b32 v21, 0xffff0000, v65
    v_cvt_pk_bf16_f32 v66, v22, v23
    v_lshlrev_b32 v22, 16, v66
    v_and_b32 v23, 0xffff0000, v66
    v_cvt_pk_bf16_f32 v67, v24, v25
    v_lshlrev_b32 v24, 16, v67
    v_and_b32 v25, 0xffff0000, v67
    v_cvt_pk_bf16_f32 v68, v26, v27
    v_lshlrev_b32 v26, 16, v68
    v_and_b32 v27, 0xffff0000, v68
    v_cvt_pk_bf16_f32 v69, v28, v29
    v_lshlrev_b32 v28, 16, v69
    v_and_b32 v29, 0xffff0000, v69
    v_mul_f32 v35, v20, v34
    v_fma_f32 v36, -v35, v33, v20
    v_fma_f32 v20, v36, v34, v35
    v_mul_f32 v35, v21, v34
    v_fma_f32 v36, -v35, v33, v21
    v_fma_f32 v21, v36, v34, v35
    v_mul_f32 v35, v22, v34
    v_fma_f32 v36, -v35, v33, v22
    v_fma_f32 v22, v36, v34, v35
    v_mul_f32 v35, v23, v34
    v_fma_f32 v36, -v35, v33, v23
    v_fma_f32 v23, v36, v34, v35
    v_mul_f32 v35, v24, v34
    v_fma_f32 v36, -v35, v33, v24
    v_fma_f32 v24, v36, v34, v35
    v_mul_f32 v35, v25, v34
    v_fma_f32 v36, -v35, v33, v25
    v_fma_f32 v25, v36, v34, v35
    v_mul_f32 v35, v26, v34
    v_fma_f32 v36, -v35, v33, v26
    v_fma_f32 v26, v36, v34, v35
    v_mul_f32 v35, v27, v34
    v_fma_f32 v36, -v35, v33, v27
    v_fma_f32 v27, v36, v34, v35
    v_mul_f32 v35, v28, v34
    v_fma_f32 v36, -v35, v33, v28
    v_fma_f32 v28, v36, v34, v35
    v_mul_f32 v35, v29, v34
    v_fma_f32 v36, -v35, v33, v29
    v_fma_f32 v29, v36, v34, v35
    v_cvt_pk_bf16_f32 v65, v20, v21
    v_cvt_pk_bf16_f32 v66, v22, v23
    v_cvt_pk_bf16_f32 v67, v24, v25
    v_cvt_pk_bf16_f32 v68, v26, v27
    v_cvt_pk_bf16_f32 v69, v28, v29
    buffer_store_dword v65, v6, s[4:7], s28 offen offset:0 sc1
    buffer_store_dword v66, v6, s[4:7], s28 offen offset:256 sc1
    buffer_store_dword v67, v6, s[4:7], s28 offen offset:512 sc1
    buffer_store_dword v68, v6, s[4:7], s28 offen offset:768 sc1
    buffer_store_dword v69, v6, s[4:7], s28 offen offset:1024 sc1
    s_add_u32 s28, s28, 1280
    s_waitcnt vmcnt(35)
    v_lshlrev_b32 v20, 16, v70
    v_and_b32 v21, 0xffff0000, v70
    v_lshlrev_b32 v22, 16, v71
    v_and_b32 v23, 0xffff0000, v71
    v_lshlrev_b32 v24, 16, v72
    v_and_b32 v25, 0xffff0000, v72
    v_lshlrev_b32 v26, 16, v73
    v_and_b32 v27, 0xffff0000, v73
    v_lshlrev_b32 v28, 16, v74
    v_and_b32 v29, 0xffff0000, v74
    v_add_f32 v30, v20, v21
    v_add_f32 v30, v30, v22
    v_add_f32 v30, v30, v23
    v_add_f32 v30, v30, v24
    v_add_f32 v30, v30, v25
    v_add_f32 v30, v30, v26
    v_add_f32 v30, v30, v27
    v_add_f32 v30, v30, v28
    v_add_f32 v30, v30, v29
    s_nop 1
    v_add_f32_dpp v30, v30, v30 row_ror:8 row_mask:0xf bank_mask:0xf
    s_nop 1
    v_add_f32_dpp v30, v30, v30 row_ror:4 row_mask:0xf bank_mask:0xf
    s_nop 1
    v_add_f32_dpp v30, v30, v30 row_ror:2 row_mask:0xf bank_mask:0xf
    s_nop 1
    v_add_f32_dpp v30, v30, v30 row_ror:1 row_mask:0xf bank_mask:0xf
    v_mov_b32 v31, v30
    s_nop 1
    v_permlane16_swap_b32 v30, v31
    v_add_f32 v30, v30, v31
    v_mov_b32 v31, v30
    s_nop 1
    v_permlane32_swap_b32 v30, v31
    v_add_f32 v30, v30, v31
    v_mul_f32 v30, 0x3acccccd, v30
    v_sub_f32 v32, v20, v30
    v_mul_f32 v33, v32, v32
    v_sub_f32 v32, v21, v30
    v_fmac_f32 v33, v32, v32
    v_sub_f32 v32, v22, v30
    v_fmac_f32 v33, v32, v32
    v_sub_f32 v32, v23, v30
    v_fmac_f32 v33, v32, v32
    v_sub_f32 v32, v24, v30
    v_fmac_f32 v33, v32, v32
    v_sub_f32 v32, v25, v30
    v_fmac_f32 v33, v32, v32
    v_sub_f32 v32, v26, v30
    v_fmac_f32 v33, v32, v32
    v_sub_f32 v32, v27, v30
    v_fmac_f32 v33, v32, v32
    v_sub_f32 v32, v28, v30
    v_fmac_f32 v33, v32, v32
    v_sub_f32 v32, v29, v30
    v_fmac_f32 v33, v32, v32
    s_nop 1
    v_add_f32_dpp v33, v33, v33 row_ror:8 row_mask:0xf bank_mask:0xf
    s_nop 1
    v_add_f32_dpp v33, v33, v33 row_ror:4 row_mask:0xf bank_mask:0xf
    s_nop 1
    v_add_f32_dpp v33, v33, v33 row_ror:2 row_mask:0xf bank_mask:0xf
    s_nop 1
    v_add_f32_dpp v33, v33, v33 row_ror:1 row_mask:0xf bank_mask:0xf
    v_mov_b32 v31, v33
    s_nop 1
    v_permlane16_swap_b32 v33, v31
    v_add_f32 v33, v33, v31
    v_mov_b32 v31, v33
    s_nop 1
    v_permlane32_swap_b32 v33, v31
    v_add_f32 v33, v33, v31
    v_mul_f32 v33, 0x3acccccd, v33
    v_cvt_pk_bf16_f32 v30, v30, v30
    v_lshlrev_b32 v30, 16, v30
    v_cvt_pk_bf16_f32 v33, v33, v33
    v_lshlrev_b32 v33, 16, v33
    v_add_f32 v33, 0x3727c5ac, v33
    v_cvt_pk_bf16_f32 v33, v33, v33
    v_lshlrev_b32 v33, 16, v33
    v_sqrt_f32 v33, v33
    s_nop 0
    v_cvt_pk_bf16_f32 v33, v33, v33
    v_lshlrev_b32 v33, 16, v33
    v_rcp_f32 v34, v33
    v_sub_f32 v20, v20, v30
    v_sub_f32 v21, v21, v30
    v_sub_f32 v22, v22, v30
    v_sub_f32 v23, v23, v30
    v_sub_f32 v24, v24, v30
    v_sub_f32 v25, v25, v30
    v_sub_f32 v26, v26, v30
    v_sub_f32 v27, v27, v30
    v_sub_f32 v28, v28, v30
    v_sub_f32 v29, v29, v30
    v_cvt_pk_bf16_f32 v70, v20, v21
    v_lshlrev_b32 v20, 16, v70
    v_and_b32 v21, 0xffff0000, v70
    v_cvt_pk_bf16_f32 v71, v22, v23
    v_lshlrev_b32 v22, 16, v71
    v_and_b32 v23, 0xffff0000, v71
    v_cvt_pk_bf16_f32 v72, v24, v25
    v_lshlrev_b32 v24, 16, v72
    v_and_b32 v25, 0xffff0000, v72
    v_cvt_pk_bf16_f32 v73, v26, v27
    v_lshlrev_b32 v26, 16, v73
    v_and_b32 v27, 0xffff0000, v73
    v_cvt_pk_bf16_f32 v74, v28, v29
    v_lshlrev_b32 v28, 16, v74
    v_and_b32 v29, 0xffff0000, v74
    v_mul_f32 v35, v20, v34
    v_fma_f32 v36, -v35, v33, v20
    v_fma_f32 v20, v36, v34, v35
    v_mul_f32 v35, v21, v34
    v_fma_f32 v36, -v35, v33, v21
    v_fma_f32 v21, v36, v34, v35
    v_mul_f32 v35, v22, v34
    v_fma_f32 v36, -v35, v33, v22
    v_fma_f32 v22, v36, v34, v35
    v_mul_f32 v35, v23, v34
    v_fma_f32 v36, -v35, v33, v23
    v_fma_f32 v23, v36, v34, v35
    v_mul_f32 v35, v24, v34
    v_fma_f32 v36, -v35, v33, v24
    v_fma_f32 v24, v36, v34, v35
    v_mul_f32 v35, v25, v34
    v_fma_f32 v36, -v35, v33, v25
    v_fma_f32 v25, v36, v34, v35
    v_mul_f32 v35, v26, v34
    v_fma_f32 v36, -v35, v33, v26
    v_fma_f32 v26, v36, v34, v35
    v_mul_f32 v35, v27, v34
    v_fma_f32 v36, -v35, v33, v27
    v_fma_f32 v27, v36, v34, v35
    v_mul_f32 v35, v28, v34
    v_fma_f32 v36, -v35, v33, v28
    v_fma_f32 v28, v36, v34, v35
    v_mul_f32 v35, v29, v34
    v_fma_f32 v36, -v35, v33, v29
    v_fma_f32 v29, v36, v34, v35
    v_cvt_pk_bf16_f32 v70, v20, v21
    v_cvt_pk_bf16_f32 v71, v22, v23
    v_cvt_pk_bf16_f32 v72, v24, v25
    v_cvt_pk_bf16_f32 v73, v26, v27
    v_cvt_pk_bf16_f32 v74, v28, v29
    buffer_store_dword v70, v6, s[4:7], s28 offen offset:0 sc1
    buffer_store_dword v71, v6, s[4:7], s28 offen offset:256 sc1
    buffer_store_dword v72, v6, s[4:7], s28 offen offset:512 sc1
    buffer_store_dword v73, v6, s[4:7], s28 offen offset:768 sc1
    buffer_store_dword v74, v6, s[4:7], s28 offen offset:1024 sc1
    s_add_u32 s28, s28, 1280
    s_waitcnt vmcnt(35)
    v_lshlrev_b32 v20, 16, v75
    v_and_b32 v21, 0xffff0000, v75
    v_lshlrev_b32 v22, 16, v76
    v_and_b32 v23, 0xffff0000, v76
    v_lshlrev_b32 v24, 16, v77
    v_and_b32 v25, 0xffff0000, v77
    v_lshlrev_b32 v26, 16, v78
    v_and_b32 v27, 0xffff0000, v78
    v_lshlrev_b32 v28, 16, v79
    v_and_b32 v29, 0xffff0000, v79
    v_add_f32 v30, v20, v21
    v_add_f32 v30, v30, v22
    v_add_f32 v30, v30, v23
    v_add_f32 v30, v30, v24
    v_add_f32 v30, v30, v25
    v_add_f32 v30, v30, v26
    v_add_f32 v30, v30, v27
    v_add_f32 v30, v30, v28
    v_add_f32 v30, v30, v29
    s_nop 1
    v_add_f32_dpp v30, v30, v30 row_ror:8 row_mask:0xf bank_mask:0xf
    s_nop 1
    v_add_f32_dpp v30, v30, v30 row_ror:4 row_mask:0xf bank_mask:0xf
    s_nop 1
    v_add_f32_dpp v30, v30, v30 row_ror:2 row_mask:0xf bank_mask:0xf
    s_nop 1
    v_add_f32_dpp v30, v30, v30 row_ror:1 row_mask:0xf bank_mask:0xf
    v_mov_b32 v31, v30
    s_nop 1
    v_permlane16_swap_b32 v30, v31
    v_add_f32 v30, v30, v31
    v_mov_b32 v31, v30
    s_nop 1
    v_permlane32_swap_b32 v30, v31
    v_add_f32 v30, v30, v31
    v_mul_f32 v30, 0x3acccccd, v30
    v_sub_f32 v32, v20, v30
    v_mul_f32 v33, v32, v32
    v_sub_f32 v32, v21, v30
    v_fmac_f32 v33, v32, v32
    v_sub_f32 v32, v22, v30
    v_fmac_f32 v33, v32, v32
    v_sub_f32 v32, v23, v30
    v_fmac_f32 v33, v32, v32
    v_sub_f32 v32, v24, v30
    v_fmac_f32 v33, v32, v32
    v_sub_f32 v32, v25, v30
    v_fmac_f32 v33, v32, v32
    v_sub_f32 v32, v26, v30
    v_fmac_f32 v33, v32, v32
    v_sub_f32 v32, v27, v30
    v_fmac_f32 v33, v32, v32
    v_sub_f32 v32, v28, v30
    v_fmac_f32 v33, v32, v32
    v_sub_f32 v32, v29, v30
    v_fmac_f32 v33, v32, v32
    s_nop 1
    v_add_f32_dpp v33, v33, v33 row_ror:8 row_mask:0xf bank_mask:0xf
    s_nop 1
    v_add_f32_dpp v33, v33, v33 row_ror:4 row_mask:0xf bank_mask:0xf
    s_nop 1
    v_add_f32_dpp v33, v33, v33 row_ror:2 row_mask:0xf bank_mask:0xf
    s_nop 1
    v_add_f32_dpp v33, v33, v33 row_ror:1 row_mask:0xf bank_mask:0xf
    v_mov_b32 v31, v33
    s_nop 1
    v_permlane16_swap_b32 v33, v31
    v_add_f32 v33, v33, v31
    v_mov_b32 v31, v33
    s_nop 1
    v_permlane32_swap_b32 v33, v31
    v_add_f32 v33, v33, v31
    v_mul_f32 v33, 0x3acccccd, v33
    v_cvt_pk_bf16_f32 v30, v30, v30
    v_lshlrev_b32 v30, 16, v30
    v_cvt_pk_bf16_f32 v33, v33, v33
    v_lshlrev_b32 v33, 16, v33
    v_add_f32 v33, 0x3727c5ac, v33
    v_cvt_pk_bf16_f32 v33, v33, v33
    v_lshlrev_b32 v33, 16, v33
    v_sqrt_f32 v33, v33
    s_nop 0
    v_cvt_pk_bf16_f32 v33, v33, v33
    v_lshlrev_b32 v33, 16, v33
    v_rcp_f32 v34, v33
    v_sub_f32 v20, v20, v30
    v_sub_f32 v21, v21, v30
    v_sub_f32 v22, v22, v30
    v_sub_f32 v23, v23, v30
    v_sub_f32 v24, v24, v30
    v_sub_f32 v25, v25, v30
    v_sub_f32 v26, v26, v30
    v_sub_f32 v27, v27, v30
    v_sub_f32 v28, v28, v30
    v_sub_f32 v29, v29, v30
    v_cvt_pk_bf16_f32 v75, v20, v21
    v_lshlrev_b32 v20, 16, v75
    v_and_b32 v21, 0xffff0000, v75
    v_cvt_pk_bf16_f32 v76, v22, v23
    v_lshlrev_b32 v22, 16, v76
    v_and_b32 v23, 0xffff0000, v76
    v_cvt_pk_bf16_f32 v77, v24, v25
    v_lshlrev_b32 v24, 16, v77
    v_and_b32 v25, 0xffff0000, v77
    v_cvt_pk_bf16_f32 v78, v26, v27
    v_lshlrev_b32 v26, 16, v78
    v_and_b32 v27, 0xffff0000, v78
    v_cvt_pk_bf16_f32 v79, v28, v29
    v_lshlrev_b32 v28, 16, v79
    v_and_b32 v29, 0xffff0000, v79
    v_mul_f32 v35, v20, v34
    v_fma_f32 v36, -v35, v33, v20
    v_fma_f32 v20, v36, v34, v35
    v_mul_f32 v35, v21, v34
    v_fma_f32 v36, -v35, v33, v21
    v_fma_f32 v21, v36, v34, v35
    v_mul_f32 v35, v22, v34
    v_fma_f32 v36, -v35, v33, v22
    v_fma_f32 v22, v36, v34, v35
    v_mul_f32 v35, v23, v34
    v_fma_f32 v36, -v35, v33, v23
    v_fma_f32 v23, v36, v34, v35
    v_mul_f32 v35, v24, v34
    v_fma_f32 v36, -v35, v33, v24
    v_fma_f32 v24, v36, v34, v35
    v_mul_f32 v35, v25, v34
    v_fma_f32 v36, -v35, v33, v25
    v_fma_f32 v25, v36, v34, v35
    v_mul_f32 v35, v26, v34
    v_fma_f32 v36, -v35, v33, v26
    v_fma_f32 v26, v36, v34, v35
    v_mul_f32 v35, v27, v34
    v_fma_f32 v36, -v35, v33, v27
    v_fma_f32 v27, v36, v34, v35
    v_mul_f32 v35, v28, v34
    v_fma_f32 v36, -v35, v33, v28
    v_fma_f32 v28, v36, v34, v35
    v_mul_f32 v35, v29, v34
    v_fma_f32 v36, -v35, v33, v29
    v_fma_f32 v29, v36, v34, v35
    v_cvt_pk_bf16_f32 v75, v20, v21
    v_cvt_pk_bf16_f32 v76, v22, v23
    v_cvt_pk_bf16_f32 v77, v24, v25
    v_cvt_pk_bf16_f32 v78, v26, v27
    v_cvt_pk_bf16_f32 v79, v28, v29
    buffer_store_dword v75, v6, s[4:7], s28 offen offset:0 sc1
    buffer_store_dword v76, v6, s[4:7], s28 offen offset:256 sc1
    buffer_store_dword v77, v6, s[4:7], s28 offen offset:512 sc1
    buffer_store_dword v78, v6, s[4:7], s28 offen offset:768 sc1
    buffer_store_dword v79, v6, s[4:7], s28 offen offset:1024 sc1
    s_add_u32 s28, s28, 1280
    s_waitcnt vmcnt(0)
    s_barrier
    s_cmp_lg_u32 s16, 0
    s_cbranch_scc1 L_lnd_175
    v_mov_b32 v20, 1
    v_mov_b32 v21, 80
    s_mov_b64 exec, 1
    buffer_atomic_add v20, v21, s[12:15], 0 offen sc1
    s_mov_b64 exec, -1
L_lnd_175:
L_nln_174:
    s_cmp_lt_u32 s17, 72
    s_cbranch_scc1 L_nd_176
    s_sleep 127
    s_sleep 127
L_nd_176:
    s_mov_b32 s18, 0
    s_mov_b32 s19, 64
    v_and_b32 v1, 63, v0
    s_cmp_lt_u32 s17, 24
    s_cbranch_scc1 L_pk_177
    s_cmp_lt_u32 s17, 48
    s_cbranch_scc1 L_pk_178
    s_cmp_lt_u32 s17, 72
    s_cbranch_scc1 L_pk_179
    s_branch L_pk_180
L_pk_177:
    s_mov_b32 s20, 0
    s_sub_u32 s21, s17, 0
    s_lshl_b32 s21, s21, 8
    s_lshl_b32 s24, s16, 6
    s_add_u32 s21, s21, s24
    s_add_u32 s22, s21, 32
    s_mov_b32 s23, 12288
    s_load_dwordx2 s[24:25], s[0:1], 24
    s_waitcnt lgkmcnt(0)
    s_mov_b32 s8, s24
    s_and_b32 s9, s25, 0xffff
    s_mov_b32 s10, 7864320
    s_mov_b32 s11, 0x20000
    s_mov_b32 s44, s24
    s_and_b32 s45, s25, 0xffff
    s_mov_b32 s46, 7864320
    s_mov_b32 s47, 0x20000
    s_branch L_pk_181
L_pk_178:
    s_mov_b32 s20, 1
    s_sub_u32 s21, s17, 24
    s_lshl_b32 s21, s21, 8
    s_lshl_b32 s24, s16, 6
    s_add_u32 s21, s21, s24
    s_add_u32 s22, s21, 32
    s_mov_b32 s23, 12288
    s_load_dwordx2 s[24:25], s[0:1], 32
    s_waitcnt lgkmcnt(0)
    s_mov_b32 s8, s24
    s_and_b32 s9, s25, 0xffff
    s_mov_b32 s10, 7864320
    s_mov_b32 s11, 0x20000
    s_mov_b32 s44, s24
    s_and_b32 s45, s25, 0xffff
    s_mov_b32 s46, 7864320
    s_mov_b32 s47, 0x20000
    s_branch L_pk_181
L_pk_179:
    s_mov_b32 s20, 2
    s_sub_u32 s21, s17, 48
    s_lshl_b32 s21, s21, 8
    s_lshl_b32 s24, s16, 6
    s_add_u32 s21, s21, s24
    s_add_u32 s22, s21, 32
    s_mov_b32 s23, 12288
    s_load_dwordx2 s[24:25], s[0:1], 16
    s_waitcnt lgkmcnt(0)
    s_mov_b32 s8, s24
    s_and_b32 s9, s25, 0xffff
    s_mov_b32 s10, 7864320
    s_mov_b32 s11, 0x20000
    s_mov_b32 s44, s24
    s_and_b32 s45, s25, 0xffff
    s_mov_b32 s46, 7864320
    s_mov_b32 s47, 0x20000
    s_branch L_pk_181
L_pk_180:
    s_mov_b32 s20, 3
    s_sub_u32 s21, s17, 72
    s_lshl_b32 s21, s21, 7
    s_lshl_b32 s24, s16, 5
    s_add_u32 s21, s21, s24
    s_mov_b32 s22, s21
    s_mov_b32 s23, 3072
    s_load_dwordx2 s[24:25], s[0:1], 64
    s_load_dwordx2 s[26:27], s[0:1], 72
    s_waitcnt lgkmcnt(0)
    s_mov_b32 s8, s24
    s_and_b32 s9, s25, 0xffff
    s_mov_b32 s10, 1966080
    s_mov_b32 s11, 0x20000
    s_mov_b32 s44, s26
    s_and_b32 s45, s27, 0xffff
    s_mov_b32 s46, 1966080
    s_mov_b32 s47, 0x20000
L_pk_181:
    s_mul_i32 s28, s16, 640
    s_add_u32 s28, s28, 0
    v_add_u32 v2, s28, v1
    v_mul_u32_u24 v3, 52429, v2
    v_lshrrev_b32 v3, 22, v3
    v_mul_u32_u24 v7, 80, v3
    v_sub_u32 v2, v2, v7
    v_and_b32 v7, 15, v3
    v_xor_b32 v2, v2, v7
    v_lshlrev_b32 v2, 4, v2
    v_mul_u32_u24 v3, 1280, v3
    v_add_u32 v10, v2, v3
    v_add_u32 v10, 117440512, v10
    s_mul_i32 s28, s16, 640
    s_add_u32 s28, s28, 64
    v_add_u32 v2, s28, v1
    v_mul_u32_u24 v3, 52429, v2
    v_lshrrev_b32 v3, 22, v3
    v_mul_u32_u24 v7, 80, v3
    v_sub_u32 v2, v2, v7
    v_and_b32 v7, 15, v3
    v_xor_b32 v2, v2, v7
    v_lshlrev_b32 v2, 4, v2
    v_mul_u32_u24 v3, 1280, v3
    v_add_u32 v11, v2, v3
    v_add_u32 v11, 117440512, v11
    s_mul_i32 s28, s16, 640
    s_add_u32 s28, s28, 128
    v_add_u32 v2, s28, v1
    v_mul_u32_u24 v3, 52429, v2
    v_lshrrev_b32 v3, 22, v3
    v_mul_u32_u24 v7, 80, v3
    v_sub_u32 v2, v2, v7
    v_and_b32 v7, 15, v3
    v_xor_b32 v2, v2, v7
    v_lshlrev_b32 v2, 4, v2
    v_mul_u32_u24 v3, 1280, v3
    v_add_u32 v12, v2, v3
    v_add_u32 v12, 117440512, v12
    s_mul_i32 s28, s16, 640
    s_add_u32 s28, s28, 192
    v_add_u32 v2, s28, v1
    v_mul_u32_u24 v3, 52429, v2
    v_lshrrev_b32 v3, 22, v3
    v_mul_u32_u24 v7, 80, v3
    v_sub_u32 v2, v2, v7
    v_and_b32 v7, 15, v3
    v_xor_b32 v2, v2, v7
    v_lshlrev_b32 v2, 4, v2
    v_mul_u32_u24 v3, 1280, v3
    v_add_u32 v13, v2, v3
    v_add_u32 v13, 117440512, v13
    s_mul_i32 s28, s16, 640
    s_add_u32 s28, s28, 256
    v_add_u32 v2, s28, v1
    v_mul_u32_u24 v3, 52429, v2
    v_lshrrev_b32 v3, 22, v3
    v_mul_u32_u24 v7, 80, v3
    v_sub_u32 v2, v2, v7
    v_and_b32 v7, 15, v3
    v_xor_b32 v2, v2, v7
    v_lshlrev_b32 v2, 4, v2
    v_mul_u32_u24 v3, 1280, v3
    v_add_u32 v14, v2, v3
    v_add_u32 v14, 117440512, v14
    s_mul_i32 s28, s16, 640
    s_add_u32 s28, s28, 320
    v_add_u32 v2, s28, v1
    v_mul_u32_u24 v3, 52429, v2
    v_lshrrev_b32 v3, 22, v3
    v_mul_u32_u24 v7, 80, v3
    v_sub_u32 v2, v2, v7
    v_and_b32 v7, 15, v3
    v_xor_b32 v2, v2, v7
    v_lshlrev_b32 v2, 4, v2
    v_mul_u32_u24 v3, 1280, v3
    v_add_u32 v15, v2, v3
    v_add_u32 v15, 117440512, v15
    s_mul_i32 s28, s16, 640
    s_add_u32 s28, s28, 384
    v_add_u32 v2, s28, v1
    v_mul_u32_u24 v3, 52429, v2
    v_lshrrev_b32 v3, 22, v3
    v_mul_u32_u24 v7, 80, v3
    v_sub_u32 v2, v2, v7
    v_and_b32 v7, 15, v3
    v_xor_b32 v2, v2, v7
    v_lshlrev_b32 v2, 4, v2
    v_mul_u32_u24 v3, 1280, v3
    v_add_u32 v16, v2, v3
    v_add_u32 v16, 117440512, v16
    s_mul_i32 s28, s16, 640
    s_add_u32 s28, s28, 448
    v_add_u32 v2, s28, v1
    v_mul_u32_u24 v3, 52429, v2
    v_lshrrev_b32 v3, 22, v3
    v_mul_u32_u24 v7, 80, v3
    v_sub_u32 v2, v2, v7
    v_and_b32 v7, 15, v3
    v_xor_b32 v2, v2, v7
    v_lshlrev_b32 v2, 4, v2
    v_mul_u32_u24 v3, 1280, v3
    v_add_u32 v17, v2, v3
    v_add_u32 v17, 117440512, v17
    s_mul_i32 s28, s16, 640
    s_add_u32 s28, s28, 512
    v_add_u32 v2, s28, v1
    v_mul_u32_u24 v3, 52429, v2
    v_lshrrev_b32 v3, 22, v3
    v_mul_u32_u24 v7, 80, v3
    v_sub_u32 v2, v2, v7
    v_and_b32 v7, 15, v3
    v_xor_b32 v2, v2, v7
    v_lshlrev_b32 v2, 4, v2
    v_mul_u32_u24 v3, 1280, v3
    v_add_u32 v18, v2, v3
    v_add_u32 v18, 117440512, v18
    s_mul_i32 s28, s16, 640
    s_add_u32 s28, s28, 576
    v_add_u32 v2, s28, v1
    v_mul_u32_u24 v3, 52429, v2
    v_lshrrev_b32 v3, 22, v3
    v_mul_u32_u24 v7, 80, v3
    v_sub_u32 v2, v2, v7
    v_and_b32 v7, 15, v3
    v_xor_b32 v2, v2, v7
    v_lshlrev_b32 v2, 4, v2
    v_mul_u32_u24 v3, 1280, v3
    v_add_u32 v19, v2, v3
    v_add_u32 v19, 117440512, v19
    s_mov_b32 s33, s18
    s_mul_i32 s32, s18, 40960
    s_mov_b32 s34, 0
    s_mov_b32 s35, 40960
    s_mov_b32 s36, 81920
    s_mul_i32 s37, s16, 10240
    s_mul_i32 s26, s16, 20480
    s_add_u32 s26, s26, 40960
    s_cmp_eq_u32 s20, 3
    s_cbranch_scc1 L_wgu_182
    v_lshrrev_b32 v2, 3, v1
    v_and_b32 v3, 7, v1
    v_lshrrev_b32 v7, 1, v2
    v_and_b32 v7, 1, v7
    v_lshlrev_b32 v7, 2, v7
    v_xor_b32 v3, v3, v7
    v_lshlrev_b32 v3, 4, v3
    v_mul_u32_u24 v4, 12288, v2
    v_add_u32 v4, v4, v3
    s_lshl_b32 s24, s21, 1
    v_add_u32 v4, s24, v4
    v_lshrrev_b32 v6, 5, v1
    v_lshlrev_b32 v6, 3, v6
    v_and_b32 v7, 15, v1
    v_lshrrev_b32 v7, 2, v7
    v_add_u32 v6, v6, v7
    v_lshlrev_b32 v6, 7, v6
    v_lshrrev_b32 v7, 1, v7
    v_lshlrev_b32 v7, 6, v7
    v_add_u32 v6, v6, v7
    v_lshrrev_b32 v7, 4, v1
    v_and_b32 v7, 1, v7
    v_lshlrev_b32 v7, 5, v7
    v_add_u32 v6, v6, v7
    v_and_b32 v7, 3, v1
    v_lshlrev_b32 v7, 3, v7
    v_add_u32 v6, v6, v7
    v_add_u32 v6, s26, v6
    v_xor_b32 v7, 64, v6
    s_mov_b32 s28, 0
    s_add_u32 m0, s26, 0
    s_nop 0
    buffer_load_dwordx4 v4, s[8:11], s28 offen lds
    s_add_u32 s28, s28, 98304
    s_add_u32 m0, s26, 1024
    s_nop 0
    buffer_load_dwordx4 v4, s[8:11], s28 offen lds
    s_add_u32 s28, s28, 98304
    s_add_u32 m0, s26, 2048
    s_nop 0
    buffer_load_dwordx4 v4, s[8:11], s28 offen lds
    s_add_u32 s28, s28, 98304
    s_add_u32 m0, s26, 3072
    s_nop 0
    buffer_load_dwordx4 v4, s[8:11], s28 offen lds
    s_mov_b32 s28, 393216
    s_add_u32 m0, s26, 4096
    s_nop 0
    buffer_load_dwordx4 v4, s[8:11], s28 offen lds
    s_add_u32 s28, s28, 98304
    s_add_u32 m0, s26, 5120
    s_nop 0
    buffer_load_dwordx4 v4, s[8:11], s28 offen lds
    s_add_u32 s28, s28, 98304
    s_add_u32 m0, s26, 6144
    s_nop 0
    buffer_load_dwordx4 v4, s[8:11], s28 offen lds
    s_add_u32 s28, s28, 98304
    s_add_u32 m0, s26, 7168
    s_nop 0
    buffer_load_dwordx4 v4, s[8:11], s28 offen lds
    s_mov_b32 s28, 786432
    s_add_u32 m0, s26, 8192
    s_nop 0
    buffer_load_dwordx4 v4, s[8:11], s28 offen lds
    s_add_u32 s28, s28, 98304
    s_add_u32 m0, s26, 9216
    s_nop 0
    buffer_load_dwordx4 v4, s[8:11], s28 offen lds
    s_add_u32 s28, s28, 98304
    s_add_u32 m0, s26, 10240
    s_nop 0
    buffer_load_dwordx4 v4, s[8:11], s28 offen lds
    s_add_u32 s28, s28, 98304
    s_add_u32 m0, s26, 11264
    s_nop 0
    buffer_load_dwordx4 v4, s[8:11], s28 offen lds
    s_mov_b32 s28, 1179648
    s_add_u32 m0, s26, 12288
    s_nop 0
    buffer_load_dwordx4 v4, s[8:11], s28 offen lds
    s_add_u32 s28, s28, 98304
    s_add_u32 m0, s26, 13312
    s_nop 0
    buffer_load_dwordx4 v4, s[8:11], s28 offen lds
    s_add_u32 s28, s28, 98304
    s_add_u32 m0, s26, 14336
    s_nop 0
    buffer_load_dwordx4 v4, s[8:11], s28 offen lds
    s_add_u32 s28, s28, 98304
    s_add_u32 m0, s26, 15360
    s_nop 0
    buffer_load_dwordx4 v4, s[8:11], s28 offen lds
    s_mov_b32 s28, 1572864
    s_add_u32 m0, s26, 16384
    s_nop 0
    buffer_load_dwordx4 v4, s[8:11], s28 offen lds
    s_add_u32 s28, s28, 98304
    s_add_u32 m0, s26, 17408
    s_nop 0
    buffer_load_dwordx4 v4, s[8:11], s28 offen lds
    s_add_u32 s28, s28, 98304
    s_add_u32 m0, s26, 18432
    s_nop 0
    buffer_load_dwordx4 v4, s[8:11], s28 offen lds
    s_add_u32 s28, s28, 98304
    s_add_u32 m0, s26, 19456
    s_nop 0
    buffer_load_dwordx4 v4, s[8:11], s28 offen lds
    s_waitcnt vmcnt(16)
    ds_read_b64_tr_b16 a[0:1], v6 offset:0
    ds_read_b64_tr_b16 a[2:3], v6 offset:512
    ds_read_b64_tr_b16 a[160:161], v7 offset:0
    ds_read_b64_tr_b16 a[162:163], v7 offset:512
    ds_read_b64_tr_b16 a[4:5], v6 offset:2048
    ds_read_b64_tr_b16 a[6:7], v6 offset:2560
    ds_read_b64_tr_b16 a[164:165], v7 offset:2048
    ds_read_b64_tr_b16 a[166:167], v7 offset:2560
    s_waitcnt lgkmcnt(0)
    s_mov_b32 s28, 1966080
    s_add_u32 m0, s26, 0
    s_nop 0
    buffer_load_dwordx4 v4, s[8:11], s28 offen lds
    s_add_u32 s28, s28, 98304
    s_add_u32 m0, s26, 1024
    s_nop 0
    buffer_load_dwordx4 v4, s[8:11], s28 offen lds
    s_add_u32 s28, s28, 98304
    s_add_u32 m0, s26, 2048
    s_nop 0
    buffer_load_dwordx4 v4, s[8:11], s28 offen lds
    s_add_u32 s28, s28, 98304
    s_add_u32 m0, s26, 3072
    s_nop 0
    buffer_load_dwordx4 v4, s[8:11], s28 offen lds
    s_waitcnt vmcnt(16)
    ds_read_b64_tr_b16 a[8:9], v6 offset:4096
    ds_read_b64_tr_b16 a[10:11], v6 offset:4608
    ds_read_b64_tr_b16 a[168:169], v7 offset:4096
    ds_read_b64_tr_b16 a[170:171], v7 offset:4608
    ds_read_b64_tr_b16 a[12:13], v6 offset:6144
    ds_read_b64_tr_b16 a[14:15], v6 offset:6656
    ds_read_b64_tr_b16 a[172:173], v7 offset:6144
    ds_read_b64_tr_b16 a[174:175], v7 offset:6656
    s_waitcnt lgkmcnt(0)
    s_mov_b32 s28, 2359296
    s_add_u32 m0, s26, 4096
    s_nop 0
    buffer_load_dwordx4 v4, s[8:11], s28 offen lds
    s_add_u32 s28, s28, 98304
    s_add_u32 m0, s26, 5120
    s_nop 0
    buffer_load_dwordx4 v4, s[8:11], s28 offen lds
    s_add_u32 s28, s28, 98304
    s_add_u32 m0, s26, 6144
    s_nop 0
    buffer_load_dwordx4 v4, s[8:11], s28 offen lds
    s_add_u32 s28, s28, 98304
    s_add_u32 m0, s26, 7168
    s_nop 0
    buffer_load_dwordx4 v4, s[8:11], s28 offen lds
    s_waitcnt vmcnt(16)
    ds_read_b64_tr_b16 a[16:17], v6 offset:8192
    ds_read_b64_tr_b16 a[18:19], v6 offset:8704
    ds_read_b64_tr_b16 a[176:177], v7 offset:8192
    ds_read_b64_tr_b16 a[178:179], v7 offset:8704
    ds_read_b64_tr_b16 a[20:21], v6 offset:10240
    ds_read_b64_tr_b16 a[22:23], v6 offset:10752
    ds_read_b64_tr_b16 a[180:181], v7 offset:10240
    ds_read_b64_tr_b16 a[182:183], v7 offset:10752
    s_waitcnt lgkmcnt(0)
    s_mov_b32 s28, 2752512
    s_add_u32 m0, s26, 8192
    s_nop 0
    buffer_load_dwordx4 v4, s[8:11], s28 offen lds
    s_add_u32 s28, s28, 98304
    s_add_u32 m0, s26, 9216
    s_nop 0
    buffer_load_dwordx4 v4, s[8:11], s28 offen lds
    s_add_u32 s28, s28, 98304
    s_add_u32 m0, s26, 10240
    s_nop 0
    buffer_load_dwordx4 v4, s[8:11], s28 offen lds
    s_add_u32 s28, s28, 98304
    s_add_u32 m0, s26, 11264
    s_nop 0
    buffer_load_dwordx4 v4, s[8:11], s28 offen lds
    s_waitcnt vmcnt(16)
    ds_read_b64_tr_b16 a[24:25], v6 offset:12288
    ds_read_b64_tr_b16 a[26:27], v6 offset:12800
    ds_read_b64_tr_b16 a[184:185], v7 offset:12288
    ds_read_b64_tr_b16 a[186:187], v7 offset:12800
    ds_read_b64_tr_b16 a[28:29], v6 offset:14336
    ds_read_b64_tr_b16 a[30:31], v6 offset:14848
    ds_read_b64_tr_b16 a[188:189], v7 offset:14336
    ds_read_b64_tr_b16 a[190:191], v7 offset:14848
    s_waitcnt lgkmcnt(0)
    s_mov_b32 s28, 3145728
    s_add_u32 m0, s26, 12288
    s_nop 0
    buffer_load_dwordx4 v4, s[8:11], s28 offen lds
    s_add_u32 s28, s28, 98304
    s_add_u32 m0, s26, 13312
    s_nop 0
    buffer_load_dwordx4 v4, s[8:11], s28 offen lds
    s_add_u32 s28, s28, 98304
    s_add_u32 m0, s26, 14336
    s_nop 0
    buffer_load_dwordx4 v4, s[8:11], s28 offen lds
    s_add_u32 s28, s28, 98304
    s_add_u32 m0, s26, 15360
    s_nop 0
    buffer_load_dwordx4 v4, s[8:11], s28 offen lds
    s_waitcnt vmcnt(16)
    ds_read_b64_tr_b16 a[32:33], v6 offset:16384
    ds_read_b64_tr_b16 a[34:35], v6 offset:16896
    ds_read_b64_tr_b16 a[192:193], v7 offset:16384
    ds_read_b64_tr_b16 a[194:195], v7 offset:16896
    ds_read_b64_tr_b16 a[36:37], v6 offset:18432
    ds_read_b64_tr_b16 a[38:39], v6 offset:18944
    ds_read_b64_tr_b16 a[196:197], v7 offset:18432
    ds_read_b64_tr_b16 a[198:199], v7 offset:18944
    s_waitcnt lgkmcnt(0)
    s_mov_b32 s28, 3538944
    s_add_u32 m0, s26, 16384
    s_nop 0
    buffer_load_dwordx4 v4, s[8:11], s28 offen lds
    s_add_u32 s28, s28, 98304
    s_add_u32 m0, s26, 17408
    s_nop 0
    buffer_load_dwordx4 v4, s[8:11], s28 offen lds
    s_add_u32 s28, s28, 98304
    s_add_u32 m0, s26, 18432
    s_nop 0
    buffer_load_dwordx4 v4, s[8:11], s28 offen lds
    s_add_u32 s28, s28, 98304
    s_add_u32 m0, s26, 19456
    s_nop 0
    buffer_load_dwordx4 v4, s[8:11], s28 offen lds
    s_waitcnt vmcnt(16)
    ds_read_b64_tr_b16 a[40:41], v6 offset:0
    ds_read_b64_tr_b16 a[42:43], v6 offset:512
    ds_read_b64_tr_b16 a[200:201], v7 offset:0
    ds_read_b64_tr_b16 a[202:203], v7 offset:512
    ds_read_b64_tr_b16 a[44:45], v6 offset:2048
    ds_read_b64_tr_b16 a[46:47], v6 offset:2560
    ds_read_b64_tr_b16 a[204:205], v7 offset:2048
    ds_read_b64_tr_b16 a[206:207], v7 offset:2560
    s_waitcnt lgkmcnt(0)
    s_mov_b32 s28, 3932160
    s_add_u32 m0, s26, 0
    s_nop 0
    buffer_load_dwordx4 v4, s[8:11], s28 offen lds
    s_add_u32 s28, s28, 98304
    s_add_u32 m0, s26, 1024
    s_nop 0
    buffer_load_dwordx4 v4, s[8:11], s28 offen lds
    s_add_u32 s28, s28, 98304
    s_add_u32 m0, s26, 2048
    s_nop 0
    buffer_load_dwordx4 v4, s[8:11], s28 offen lds
    s_add_u32 s28, s28, 98304
    s_add_u32 m0, s26, 3072
    s_nop 0
    buffer_load_dwordx4 v4, s[8:11], s28 offen lds
    s_waitcnt vmcnt(16)
    ds_read_b64_tr_b16 a[48:49], v6 offset:4096
    ds_read_b64_tr_b16 a[50:51], v6 offset:4608
    ds_read_b64_tr_b16 a[208:209], v7 offset:4096
    ds_read_b64_tr_b16 a[210:211], v7 offset:4608
    ds_read_b64_tr_b16 a[52:53], v6 offset:6144
    ds_read_b64_tr_b16 a[54:55], v6 offset:6656
    ds_read_b64_tr_b16 a[212:213], v7 offset:6144
    ds_read_b64_tr_b16 a[214:215], v7 offset:6656
    s_waitcnt lgkmcnt(0)
    s_mov_b32 s28, 4325376
    s_add_u32 m0, s26, 4096
    s_nop 0
    buffer_load_dwordx4 v4, s[8:11], s28 offen lds
    s_add_u32 s28, s28, 98304
    s_add_u32 m0, s26, 5120
    s_nop 0
    buffer_load_dwordx4 v4, s[8:11], s28 offen lds
    s_add_u32 s28, s28, 98304
    s_add_u32 m0, s26, 6144
    s_nop 0
    buffer_load_dwordx4 v4, s[8:11], s28 offen lds
    s_add_u32 s28, s28, 98304
    s_add_u32 m0, s26, 7168
    s_nop 0
    buffer_load_dwordx4 v4, s[8:11], s28 offen lds
    s_waitcnt vmcnt(16)
    ds_read_b64_tr_b16 a[56:57], v6 offset:8192
    ds_read_b64_tr_b16 a[58:59], v6 offset:8704
    ds_read_b64_tr_b16 a[216:217], v7 offset:8192
    ds_read_b64_tr_b16 a[218:219], v7 offset:8704
    ds_read_b64_tr_b16 a[60:61], v6 offset:10240
    ds_read_b64_tr_b16 a[62:63], v6 offset:10752
    ds_read_b64_tr_b16 a[220:221], v7 offset:10240
    ds_read_b64_tr_b16 a[222:223], v7 offset:10752
    s_waitcnt lgkmcnt(0)
    s_mov_b32 s28, 4718592
    s_add_u32 m0, s26, 8192
    s_nop 0
    buffer_load_dwordx4 v4, s[8:11], s28 offen lds
    s_add_u32 s28, s28, 98304
    s_add_u32 m0, s26, 9216
    s_nop 0
    buffer_load_dwordx4 v4, s[8:11], s28 offen lds
    s_add_u32 s28, s28, 98304
    s_add_u32 m0, s26, 10240
    s_nop 0
    buffer_load_dwordx4 v4, s[8:11], s28 offen lds
    s_add_u32 s28, s28, 98304
    s_add_u32 m0, s26, 11264
    s_nop 0
    buffer_load_dwordx4 v4, s[8:11], s28 offen lds
    s_waitcnt vmcnt(16)
    ds_read_b64_tr_b16 a[64:65], v6 offset:12288
    ds_read_b64_tr_b16 a[66:67], v6 offset:12800
    ds_read_b64_tr_b16 a[224:225], v7 offset:12288
    ds_read_b64_tr_b16 a[226:227], v7 offset:12800
    ds_read_b64_tr_b16 a[68:69], v6 offset:14336
    ds_read_b64_tr_b16 a[70:71], v6 offset:14848
    ds_read_b64_tr_b16 a[228:229], v7 offset:14336
    ds_read_b64_tr_b16 a[230:231], v7 offset:14848
    s_waitcnt lgkmcnt(0)
    s_mov_b32 s28, 5111808
    s_add_u32 m0, s26, 12288
    s_nop 0
    buffer_load_dwordx4 v4, s[8:11], s28 offen lds
    s_add_u32 s28, s28, 98304
    s_add_u32 m0, s26, 13312
    s_nop 0
    buffer_load_dwordx4 v4, s[8:11], s28 offen lds
    s_add_u32 s28, s28, 98304
    s_add_u32 m0, s26, 14336
    s_nop 0
    buffer_load_dwordx4 v4, s[8:11], s28 offen lds
    s_add_u32 s28, s28, 98304
    s_add_u32 m0, s26, 15360
    s_nop 0
    buffer_load_dwordx4 v4, s[8:11], s28 offen lds
    s_waitcnt vmcnt(16)
    ds_read_b64_tr_b16 a[72:73], v6 offset:16384
    ds_read_b64_tr_b16 a[74:75], v6 offset:16896
    ds_read_b64_tr_b16 a[232:233], v7 offset:16384
    ds_read_b64_tr_b16 a[234:235], v7 offset:16896
    ds_read_b64_tr_b16 a[76:77], v6 offset:18432
    ds_read_b64_tr_b16 a[78:79], v6 offset:18944
    ds_read_b64_tr_b16 a[236:237], v7 offset:18432
    ds_read_b64_tr_b16 a[238:239], v7 offset:18944
    s_waitcnt lgkmcnt(0)
    s_mov_b32 s28, 5505024
    s_add_u32 m0, s26, 16384
    s_nop 0
    buffer_load_dwordx4 v4, s[8:11], s28 offen lds
    s_add_u32 s28, s28, 98304
    s_add_u32 m0, s26, 17408
    s_nop 0
    buffer_load_dwordx4 v4, s[8:11], s28 offen lds
    s_add_u32 s28, s28, 98304
    s_add_u32 m0, s26, 18432
    s_nop 0
    buffer_load_dwordx4 v4, s[8:11], s28 offen lds
    s_add_u32 s28, s28, 98304
    s_add_u32 m0, s26, 19456
    s_nop 0
    buffer_load_dwordx4 v4, s[8:11], s28 offen lds
    s_waitcnt vmcnt(16)
    ds_read_b64_tr_b16 a[80:81], v6 offset:0
    ds_read_b64_tr_b16 a[82:83], v6 offset:512
    ds_read_b64_tr_b16 a[240:241], v7 offset:0
    ds_read_b64_tr_b16 a[242:243], v7 offset:512
    ds_read_b64_tr_b16 a[84:85], v6 offset:2048
    ds_read_b64_tr_b16 a[86:87], v6 offset:2560
    ds_read_b64_tr_b16 a[244:245], v7 offset:2048
    ds_read_b64_tr_b16 a[246:247], v7 offset:2560
    s_waitcnt lgkmcnt(0)
    s_mov_b32 s28, 5898240
    s_add_u32 m0, s26, 0
    s_nop 0
    buffer_load_dwordx4 v4, s[8:11], s28 offen lds
    s_add_u32 s28, s28, 98304
    s_add_u32 m0, s26, 1024
    s_nop 0
    buffer_load_dwordx4 v4, s[8:11], s28 offen lds
    s_add_u32 s28, s28, 98304
    s_add_u32 m0, s26, 2048
    s_nop 0
    buffer_load_dwordx4 v4, s[8:11], s28 offen lds
    s_add_u32 s28, s28, 98304
    s_add_u32 m0, s26, 3072
    s_nop 0
    buffer_load_dwordx4 v4, s[8:11], s28 offen lds
    s_waitcnt vmcnt(16)
    ds_read_b64_tr_b16 a[88:89], v6 offset:4096
    ds_read_b64_tr_b16 a[90:91], v6 offset:4608
    ds_read_b64_tr_b16 a[248:249], v7 offset:4096
    ds_read_b64_tr_b16 a[250:251], v7 offset:4608
    ds_read_b64_tr_b16 a[92:93], v6 offset:6144
    ds_read_b64_tr_b16 a[94:95], v6 offset:6656
    ds_read_b64_tr_b16 a[252:253], v7 offset:6144
    ds_read_b64_tr_b16 a[254:255], v7 offset:6656
    s_waitcnt lgkmcnt(0)
    s_mov_b32 s28, 6291456
    s_add_u32 m0, s26, 4096
    s_nop 0
    buffer_load_dwordx4 v4, s[8:11], s28 offen lds
    s_add_u32 s28, s28, 98304
    s_add_u32 m0, s26, 5120
    s_nop 0
    buffer_load_dwordx4 v4, s[8:11], s28 offen lds
    s_add_u32 s28, s28, 98304
    s_add_u32 m0, s26, 6144
    s_nop 0
    buffer_load_dwordx4 v4, s[8:11], s28 offen lds
    s_add_u32 s28, s28, 98304
    s_add_u32 m0, s26, 7168
    s_nop 0
    buffer_load_dwordx4 v4, s[8:11], s28 offen lds
    s_waitcnt vmcnt(16)
    ds_read_b64_tr_b16 a[96:97], v6 offset:8192
    ds_read_b64_tr_b16 a[98:99], v6 offset:8704
    ds_read_b64_tr_b16 v[192:193], v7 offset:8192
    ds_read_b64_tr_b16 v[194:195], v7 offset:8704
    ds_read_b64_tr_b16 a[100:101], v6 offset:10240
    ds_read_b64_tr_b16 a[102:103], v6 offset:10752
    ds_read_b64_tr_b16 v[196:197], v7 offset:10240
    ds_read_b64_tr_b16 v[198:199], v7 offset:10752
    s_waitcnt lgkmcnt(0)
    s_mov_b32 s28, 6684672
    s_add_u32 m0, s26, 8192
    s_nop 0
    buffer_load_dwordx4 v4, s[8:11], s28 offen lds
    s_add_u32 s28, s28, 98304
    s_add_u32 m0, s26, 9216
    s_nop 0
    buffer_load_dwordx4 v4, s[8:11], s28 offen lds
    s_add_u32 s28, s28, 98304
    s_add_u32 m0, s26, 10240
    s_nop 0
    buffer_load_dwordx4 v4, s[8:11], s28 offen lds
    s_add_u32 s28, s28, 98304
    s_add_u32 m0, s26, 11264
    s_nop 0
    buffer_load_dwordx4 v4, s[8:11], s28 offen lds
    s_waitcnt vmcnt(16)
    ds_read_b64_tr_b16 a[104:105], v6 offset:12288
    ds_read_b64_tr_b16 a[106:107], v6 offset:12800
    ds_read_b64_tr_b16 v[200:201], v7 offset:12288
    ds_read_b64_tr_b16 v[202:203], v7 offset:12800
    ds_read_b64_tr_b16 a[108:109], v6 offset:14336
    ds_read_b64_tr_b16 a[110:111], v6 offset:14848
    ds_read_b64_tr_b16 v[204:205], v7 offset:14336
    ds_read_b64_tr_b16 v[206:207], v7 offset:14848
    s_waitcnt lgkmcnt(0)
    s_mov_b32 s28, 7077888
    s_add_u32 m0, s26, 12288
    s_nop 0
    buffer_load_dwordx4 v4, s[8:11], s28 offen lds
    s_add_u32 s28, s28, 98304
    s_add_u32 m0, s26, 13312
    s_nop 0
    buffer_load_dwordx4 v4, s[8:11], s28 offen lds
    s_add_u32 s28, s28, 98304
    s_add_u32 m0, s26, 14336
    s_nop 0
    buffer_load_dwordx4 v4, s[8:11], s28 offen lds
    s_add_u32 s28, s28, 98304
    s_add_u32 m0, s26, 15360
    s_nop 0
    buffer_load_dwordx4 v4, s[8:11], s28 offen lds
    s_waitcnt vmcnt(16)
    ds_read_b64_tr_b16 a[112:113], v6 offset:16384
    ds_read_b64_tr_b16 a[114:115], v6 offset:16896
    ds_read_b64_tr_b16 v[208:209], v7 offset:16384
    ds_read_b64_tr_b16 v[210:211], v7 offset:16896
    ds_read_b64_tr_b16 a[116:117], v6 offset:18432
    ds_read_b64_tr_b16 a[118:119], v6 offset:18944
    ds_read_b64_tr_b16 v[212:213], v7 offset:18432
    ds_read_b64_tr_b16 v[214:215], v7 offset:18944
    s_waitcnt lgkmcnt(0)
    s_mov_b32 s28, 7471104
    s_add_u32 m0, s26, 16384
    s_nop 0
    buffer_load_dwordx4 v4, s[8:11], s28 offen lds
    s_add_u32 s28, s28, 98304
    s_add_u32 m0, s26, 17408
    s_nop 0
    buffer_load_dwordx4 v4, s[8:11], s28 offen lds
    s_add_u32 s28, s28, 98304
    s_add_u32 m0, s26, 18432
    s_nop 0
    buffer_load_dwordx4 v4, s[8:11], s28 offen lds
    s_add_u32 s28, s28, 98304
    s_add_u32 m0, s26, 19456
    s_nop 0
    buffer_load_dwordx4 v4, s[8:11], s28 offen lds
    s_waitcnt vmcnt(16)
    ds_read_b64_tr_b16 a[120:121], v6 offset:0
    ds_read_b64_tr_b16 a[122:123], v6 offset:512
    ds_read_b64_tr_b16 v[216:217], v7 offset:0
    ds_read_b64_tr_b16 v[218:219], v7 offset:512
    ds_read_b64_tr_b16 a[124:125], v6 offset:2048
    ds_read_b64_tr_b16 a[126:127], v6 offset:2560
    ds_read_b64_tr_b16 v[220:221], v7 offset:2048
    ds_read_b64_tr_b16 v[222:223], v7 offset:2560
    s_waitcnt lgkmcnt(0)
    s_waitcnt vmcnt(12)
    ds_read_b64_tr_b16 a[128:129], v6 offset:4096
    ds_read_b64_tr_b16 a[130:131], v6 offset:4608
    ds_read_b64_tr_b16 v[224:225], v7 offset:4096
    ds_read_b64_tr_b16 v[226:227], v7 offset:4608
    ds_read_b64_tr_b16 a[132:133], v6 offset:6144
    ds_read_b64_tr_b16 a[134:135], v6 offset:6656
    ds_read_b64_tr_b16 v[228:229], v7 offset:6144
    ds_read_b64_tr_b16 v[230:231], v7 offset:6656
    s_waitcnt lgkmcnt(0)
    s_waitcnt vmcnt(8)
    ds_read_b64_tr_b16 a[136:137], v6 offset:8192
    ds_read_b64_tr_b16 a[138:139], v6 offset:8704
    ds_read_b64_tr_b16 v[232:233], v7 offset:8192
    ds_read_b64_tr_b16 v[234:235], v7 offset:8704
    ds_read_b64_tr_b16 a[140:141], v6 offset:10240
    ds_read_b64_tr_b16 a[142:143], v6 offset:10752
    ds_read_b64_tr_b16 v[236:237], v7 offset:10240
    ds_read_b64_tr_b16 v[238:239], v7 offset:10752
    s_waitcnt lgkmcnt(0)
    s_waitcnt vmcnt(4)
    ds_read_b64_tr_b16 a[144:145], v6 offset:12288
    ds_read_b64_tr_b16 a[146:147], v6 offset:12800
    ds_read_b64_tr_b16 v[240:241], v7 offset:12288
    ds_read_b64_tr_b16 v[242:243], v7 offset:12800
    ds_read_b64_tr_b16 a[148:149], v6 offset:14336
    ds_read_b64_tr_b16 a[150:151], v6 offset:14848
    ds_read_b64_tr_b16 v[244:245], v7 offset:14336
    ds_read_b64_tr_b16 v[246:247], v7 offset:14848
    s_waitcnt lgkmcnt(0)
    s_waitcnt vmcnt(0)
    ds_read_b64_tr_b16 a[152:153], v6 offset:16384
    ds_read_b64_tr_b16 a[154:155], v6 offset:16896
    ds_read_b64_tr_b16 v[248:249], v7 offset:16384
    ds_read_b64_tr_b16 v[250:251], v7 offset:16896
    ds_read_b64_tr_b16 a[156:157], v6 offset:18432
    ds_read_b64_tr_b16 a[158:159], v6 offset:18944
    ds_read_b64_tr_b16 v[252:253], v7 offset:18432
    ds_read_b64_tr_b16 v[254:255], v7 offset:18944
    s_waitcnt lgkmcnt(0)
    s_branch L_wdone_183
L_wgu_182:
    v_lshrrev_b32 v2, 2, v1
    v_mul_lo_u32 v2, v2, s23
    v_and_b32 v3, 3, v1
    v_lshlrev_b32 v3, 4, v3
    v_add_u32 v2, v2, v3
    s_lshl_b32 s24, s21, 1
    v_add_u32 v4, s24, v2
    v_mov_b32 v5, v4
    v_lshrrev_b32 v6, 5, v1
    v_lshlrev_b32 v6, 3, v6
    v_and_b32 v7, 15, v1
    v_lshrrev_b32 v7, 2, v7
    v_add_u32 v6, v6, v7
    v_lshlrev_b32 v6, 6, v6
    v_lshrrev_b32 v7, 4, v1
    v_and_b32 v7, 1, v7
    v_lshlrev_b32 v7, 5, v7
    v_add_u32 v6, v6, v7
    v_and_b32 v7, 3, v1
    v_lshlrev_b32 v7, 3, v7
    v_add_u32 v6, v6, v7
    v_add_u32 v6, s26, v6
    s_mov_b32 s28, 0
    s_add_u32 m0, s26, 0
    s_nop 0
    buffer_load_dwordx4 v4, s[8:11], s28 offen lds
    s_add_u32 s28, s28, 49152
    s_add_u32 m0, s26, 1024
    s_nop 0
    buffer_load_dwordx4 v4, s[8:11], s28 offen lds
    s_add_u32 s28, s28, 49152
    s_add_u32 m0, s26, 2048
    s_nop 0
    buffer_load_dwordx4 v4, s[8:11], s28 offen lds
    s_add_u32 s28, s28, 49152
    s_add_u32 m0, s26, 3072
    s_nop 0
    buffer_load_dwordx4 v4, s[8:11], s28 offen lds
    s_mov_b32 s28, 196608
    s_add_u32 m0, s26, 4096
    s_nop 0
    buffer_load_dwordx4 v4, s[8:11], s28 offen lds
    s_add_u32 s28, s28, 49152
    s_add_u32 m0, s26, 5120
    s_nop 0
    buffer_load_dwordx4 v4, s[8:11], s28 offen lds
    s_add_u32 s28, s28, 49152
    s_add_u32 m0, s26, 6144
    s_nop 0
    buffer_load_dwordx4 v4, s[8:11], s28 offen lds
    s_add_u32 s28, s28, 49152
    s_add_u32 m0, s26, 7168
    s_nop 0
    buffer_load_dwordx4 v4, s[8:11], s28 offen lds
    s_mov_b32 s28, 393216
    s_add_u32 m0, s26, 8192
    s_nop 0
    buffer_load_dwordx4 v4, s[8:11], s28 offen lds
    s_add_u32 s28, s28, 49152
    s_add_u32 m0, s26, 9216
    s_nop 0
    buffer_load_dwordx4 v4, s[8:11], s28 offen lds
    s_add_u32 s28, s28, 49152
    s_add_u32 m0, s26, 10240
    s_nop 0
    buffer_load_dwordx4 v4, s[8:11], s28 offen lds
    s_add_u32 s28, s28, 49152
    s_add_u32 m0, s26, 11264
    s_nop 0
    buffer_load_dwordx4 v4, s[8:11], s28 offen lds
    s_mov_b32 s28, 589824
    s_add_u32 m0, s26, 12288
    s_nop 0
    buffer_load_dwordx4 v4, s[8:11], s28 offen lds
    s_add_u32 s28, s28, 49152
    s_add_u32 m0, s26, 13312
    s_nop 0
    buffer_load_dwordx4 v4, s[8:11], s28 offen lds
    s_add_u32 s28, s28, 49152
    s_add_u32 m0, s26, 14336
    s_nop 0
    buffer_load_dwordx4 v4, s[8:11], s28 offen lds
    s_add_u32 s28, s28, 49152
    s_add_u32 m0, s26, 15360
    s_nop 0
    buffer_load_dwordx4 v4, s[8:11], s28 offen lds
    s_mov_b32 s28, 786432
    s_add_u32 m0, s26, 16384
    s_nop 0
    buffer_load_dwordx4 v4, s[8:11], s28 offen lds
    s_add_u32 s28, s28, 49152
    s_add_u32 m0, s26, 17408
    s_nop 0
    buffer_load_dwordx4 v4, s[8:11], s28 offen lds
    s_add_u32 s28, s28, 49152
    s_add_u32 m0, s26, 18432
    s_nop 0
    buffer_load_dwordx4 v4, s[8:11], s28 offen lds
    s_add_u32 s28, s28, 49152
    s_add_u32 m0, s26, 19456
    s_nop 0
    buffer_load_dwordx4 v4, s[8:11], s28 offen lds
    s_waitcnt vmcnt(16)
    ds_read_b64_tr_b16 a[0:1], v6 offset:0
    ds_read_b64_tr_b16 a[2:3], v6 offset:256
    ds_read_b64_tr_b16 a[4:5], v6 offset:1024
    ds_read_b64_tr_b16 a[6:7], v6 offset:1280
    ds_read_b64_tr_b16 a[8:9], v6 offset:2048
    ds_read_b64_tr_b16 a[10:11], v6 offset:2304
    ds_read_b64_tr_b16 a[12:13], v6 offset:3072
    ds_read_b64_tr_b16 a[14:15], v6 offset:3328
    s_waitcnt lgkmcnt(0)
    s_mov_b32 s28, 983040
    s_add_u32 m0, s26, 0
    s_nop 0
    buffer_load_dwordx4 v4, s[8:11], s28 offen lds
    s_add_u32 s28, s28, 49152
    s_add_u32 m0, s26, 1024
    s_nop 0
    buffer_load_dwordx4 v4, s[8:11], s28 offen lds
    s_add_u32 s28, s28, 49152
    s_add_u32 m0, s26, 2048
    s_nop 0
    buffer_load_dwordx4 v4, s[8:11], s28 offen lds
    s_add_u32 s28, s28, 49152
    s_add_u32 m0, s26, 3072
    s_nop 0
    buffer_load_dwordx4 v4, s[8:11], s28 offen lds
    s_waitcnt vmcnt(16)
    ds_read_b64_tr_b16 a[16:17], v6 offset:4096
    ds_read_b64_tr_b16 a[18:19], v6 offset:4352
    ds_read_b64_tr_b16 a[20:21], v6 offset:5120
    ds_read_b64_tr_b16 a[22:23], v6 offset:5376
    ds_read_b64_tr_b16 a[24:25], v6 offset:6144
    ds_read_b64_tr_b16 a[26:27], v6 offset:6400
    ds_read_b64_tr_b16 a[28:29], v6 offset:7168
    ds_read_b64_tr_b16 a[30:31], v6 offset:7424
    s_waitcnt lgkmcnt(0)
    s_mov_b32 s28, 1179648
    s_add_u32 m0, s26, 4096
    s_nop 0
    buffer_load_dwordx4 v4, s[8:11], s28 offen lds
    s_add_u32 s28, s28, 49152
    s_add_u32 m0, s26, 5120
    s_nop 0
    buffer_load_dwordx4 v4, s[8:11], s28 offen lds
    s_add_u32 s28, s28, 49152
    s_add_u32 m0, s26, 6144
    s_nop 0
    buffer_load_dwordx4 v4, s[8:11], s28 offen lds
    s_add_u32 s28, s28, 49152
    s_add_u32 m0, s26, 7168
    s_nop 0
    buffer_load_dwordx4 v4, s[8:11], s28 offen lds
    s_waitcnt vmcnt(16)
    ds_read_b64_tr_b16 a[32:33], v6 offset:8192
    ds_read_b64_tr_b16 a[34:35], v6 offset:8448
    ds_read_b64_tr_b16 a[36:37], v6 offset:9216
    ds_read_b64_tr_b16 a[38:39], v6 offset:9472
    ds_read_b64_tr_b16 a[40:41], v6 offset:10240
    ds_read_b64_tr_b16 a[42:43], v6 offset:10496
    ds_read_b64_tr_b16 a[44:45], v6 offset:11264
    ds_read_b64_tr_b16 a[46:47], v6 offset:11520
    s_waitcnt lgkmcnt(0)
    s_mov_b32 s28, 1376256
    s_add_u32 m0, s26, 8192
    s_nop 0
    buffer_load_dwordx4 v4, s[8:11], s28 offen lds
    s_add_u32 s28, s28, 49152
    s_add_u32 m0, s26, 9216
    s_nop 0
    buffer_load_dwordx4 v4, s[8:11], s28 offen lds
    s_add_u32 s28, s28, 49152
    s_add_u32 m0, s26, 10240
    s_nop 0
    buffer_load_dwordx4 v4, s[8:11], s28 offen lds
    s_add_u32 s28, s28, 49152
    s_add_u32 m0, s26, 11264
    s_nop 0
    buffer_load_dwordx4 v4, s[8:11], s28 offen lds
    s_waitcnt vmcnt(16)
    ds_read_b64_tr_b16 a[48:49], v6 offset:12288
    ds_read_b64_tr_b16 a[50:51], v6 offset:12544
    ds_read_b64_tr_b16 a[52:53], v6 offset:13312
    ds_read_b64_tr_b16 a[54:55], v6 offset:13568
    ds_read_b64_tr_b16 a[56:57], v6 offset:14336
    ds_read_b64_tr_b16 a[58:59], v6 offset:14592
    ds_read_b64_tr_b16 a[60:61], v6 offset:15360
    ds_read_b64_tr_b16 a[62:63], v6 offset:15616
    s_waitcnt lgkmcnt(0)
    s_mov_b32 s28, 1572864
    s_add_u32 m0, s26, 12288
    s_nop 0
    buffer_load_dwordx4 v4, s[8:11], s28 offen lds
    s_add_u32 s28, s28, 49152
    s_add_u32 m0, s26, 13312
    s_nop 0
    buffer_load_dwordx4 v4, s[8:11], s28 offen lds
    s_add_u32 s28, s28, 49152
    s_add_u32 m0, s26, 14336
    s_nop 0
    buffer_load_dwordx4 v4, s[8:11], s28 offen lds
    s_add_u32 s28, s28, 49152
    s_add_u32 m0, s26, 15360
    s_nop 0
    buffer_load_dwordx4 v4, s[8:11], s28 offen lds
    s_waitcnt vmcnt(16)
    ds_read_b64_tr_b16 a[64:65], v6 offset:16384
    ds_read_b64_tr_b16 a[66:67], v6 offset:16640
    ds_read_b64_tr_b16 a[68:69], v6 offset:17408
    ds_read_b64_tr_b16 a[70:71], v6 offset:17664
    ds_read_b64_tr_b16 a[72:73], v6 offset:18432
    ds_read_b64_tr_b16 a[74:75], v6 offset:18688
    ds_read_b64_tr_b16 a[76:77], v6 offset:19456
    ds_read_b64_tr_b16 a[78:79], v6 offset:19712
    s_waitcnt lgkmcnt(0)
    s_mov_b32 s28, 1769472
    s_add_u32 m0, s26, 16384
    s_nop 0
    buffer_load_dwordx4 v4, s[8:11], s28 offen lds
    s_add_u32 s28, s28, 49152
    s_add_u32 m0, s26, 17408
    s_nop 0
    buffer_load_dwordx4 v4, s[8:11], s28 offen lds
    s_add_u32 s28, s28, 49152
    s_add_u32 m0, s26, 18432
    s_nop 0
    buffer_load_dwordx4 v4, s[8:11], s28 offen lds
    s_add_u32 s28, s28, 49152
    s_add_u32 m0, s26, 19456
    s_nop 0
    buffer_load_dwordx4 v4, s[8:11], s28 offen lds
    s_waitcnt vmcnt(16)
    ds_read_b64_tr_b16 a[80:81], v6 offset:0
    ds_read_b64_tr_b16 a[82:83], v6 offset:256
    ds_read_b64_tr_b16 a[84:85], v6 offset:1024
    ds_read_b64_tr_b16 a[86:87], v6 offset:1280
    ds_read_b64_tr_b16 a[88:89], v6 offset:2048
    ds_read_b64_tr_b16 a[90:91], v6 offset:2304
    ds_read_b64_tr_b16 a[92:93], v6 offset:3072
    ds_read_b64_tr_b16 a[94:95], v6 offset:3328
    s_waitcnt lgkmcnt(0)
    s_mov_b32 s28, 0
    s_add_u32 m0, s26, 0
    s_nop 0
    buffer_load_dwordx4 v4, s[44:47], s28 offen lds
    s_add_u32 s28, s28, 49152
    s_add_u32 m0, s26, 1024
    s_nop 0
    buffer_load_dwordx4 v4, s[44:47], s28 offen lds
    s_add_u32 s28, s28, 49152
    s_add_u32 m0, s26, 2048
    s_nop 0
    buffer_load_dwordx4 v4, s[44:47], s28 offen lds
    s_add_u32 s28, s28, 49152
    s_add_u32 m0, s26, 3072
    s_nop 0
    buffer_load_dwordx4 v4, s[44:47], s28 offen lds
    s_waitcnt vmcnt(16)
    ds_read_b64_tr_b16 a[96:97], v6 offset:4096
    ds_read_b64_tr_b16 a[98:99], v6 offset:4352
    ds_read_b64_tr_b16 a[100:101], v6 offset:5120
    ds_read_b64_tr_b16 a[102:103], v6 offset:5376
    ds_read_b64_tr_b16 a[104:105], v6 offset:6144
    ds_read_b64_tr_b16 a[106:107], v6 offset:6400
    ds_read_b64_tr_b16 a[108:109], v6 offset:7168
    ds_read_b64_tr_b16 a[110:111], v6 offset:7424
    s_waitcnt lgkmcnt(0)
    s_mov_b32 s28, 196608
    s_add_u32 m0, s26, 4096
    s_nop 0
    buffer_load_dwordx4 v4, s[44:47], s28 offen lds
    s_add_u32 s28, s28, 49152
    s_add_u32 m0, s26, 5120
    s_nop 0
    buffer_load_dwordx4 v4, s[44:47], s28 offen lds
    s_add_u32 s28, s28, 49152
    s_add_u32 m0, s26, 6144
    s_nop 0
    buffer_load_dwordx4 v4, s[44:47], s28 offen lds
    s_add_u32 s28, s28, 49152
    s_add_u32 m0, s26, 7168
    s_nop 0
    buffer_load_dwordx4 v4, s[44:47], s28 offen lds
    s_waitcnt vmcnt(16)
    ds_read_b64_tr_b16 a[112:113], v6 offset:8192
    ds_read_b64_tr_b16 a[114:115], v6 offset:8448
    ds_read_b64_tr_b16 a[116:117], v6 offset:9216
    ds_read_b64_tr_b16 a[118:119], v6 offset:9472
    ds_read_b64_tr_b16 a[120:121], v6 offset:10240
    ds_read_b64_tr_b16 a[122:123], v6 offset:10496
    ds_read_b64_tr_b16 a[124:125], v6 offset:11264
    ds_read_b64_tr_b16 a[126:127], v6 offset:11520
    s_waitcnt lgkmcnt(0)
    s_mov_b32 s28, 393216
    s_add_u32 m0, s26, 8192
    s_nop 0
    buffer_load_dwordx4 v4, s[44:47], s28 offen lds
    s_add_u32 s28, s28, 49152
    s_add_u32 m0, s26, 9216
    s_nop 0
    buffer_load_dwordx4 v4, s[44:47], s28 offen lds
    s_add_u32 s28, s28, 49152
    s_add_u32 m0, s26, 10240
    s_nop 0
    buffer_load_dwordx4 v4, s[44:47], s28 offen lds
    s_add_u32 s28, s28, 49152
    s_add_u32 m0, s26, 11264
    s_nop 0
    buffer_load_dwordx4 v4, s[44:47], s28 offen lds
    s_waitcnt vmcnt(16)
    ds_read_b64_tr_b16 a[128:129], v6 offset:12288
    ds_read_b64_tr_b16 a[130:131], v6 offset:12544
    ds_read_b64_tr_b16 a[132:133], v6 offset:13312
    ds_read_b64_tr_b16 a[134:135], v6 offset:13568
    ds_read_b64_tr_b16 a[136:137], v6 offset:14336
    ds_read_b64_tr_b16 a[138:139], v6 offset:14592
    ds_read_b64_tr_b16 a[140:141], v6 offset:15360
    ds_read_b64_tr_b16 a[142:143], v6 offset:15616
    s_waitcnt lgkmcnt(0)
    s_mov_b32 s28, 589824
    s_add_u32 m0, s26, 12288
    s_nop 0
    buffer_load_dwordx4 v4, s[44:47], s28 offen lds
    s_add_u32 s28, s28, 49152
    s_add_u32 m0, s26, 13312
    s_nop 0
    buffer_load_dwordx4 v4, s[44:47], s28 offen lds
    s_add_u32 s28, s28, 49152
    s_add_u32 m0, s26, 14336
    s_nop 0
    buffer_load_dwordx4 v4, s[44:47], s28 offen lds
    s_add_u32 s28, s28, 49152
    s_add_u32 m0, s26, 15360
    s_nop 0
    buffer_load_dwordx4 v4, s[44:47], s28 offen lds
    s_waitcnt vmcnt(16)
    ds_read_b64_tr_b16 a[144:145], v6 offset:16384
    ds_read_b64_tr_b16 a[146:147], v6 offset:16640
    ds_read_b64_tr_b16 a[148:149], v6 offset:17408
    ds_read_b64_tr_b16 a[150:151], v6 offset:17664
    ds_read_b64_tr_b16 a[152:153], v6 offset:18432
    ds_read_b64_tr_b16 a[154:155], v6 offset:18688
    ds_read_b64_tr_b16 a[156:157], v6 offset:19456
    ds_read_b64_tr_b16 a[158:159], v6 offset:19712
    s_waitcnt lgkmcnt(0)
    s_mov_b32 s28, 786432
    s_add_u32 m0, s26, 16384
    s_nop 0
    buffer_load_dwordx4 v4, s[44:47], s28 offen lds
    s_add_u32 s28, s28, 49152
    s_add_u32 m0, s26, 17408
    s_nop 0
    buffer_load_dwordx4 v4, s[44:47], s28 offen lds
    s_add_u32 s28, s28, 49152
    s_add_u32 m0, s26, 18432
    s_nop 0
    buffer_load_dwordx4 v4, s[44:47], s28 offen lds
    s_add_u32 s28, s28, 49152
    s_add_u32 m0, s26, 19456
    s_nop 0
    buffer_load_dwordx4 v4, s[44:47], s28 offen lds
    s_waitcnt vmcnt(16)
    ds_read_b64_tr_b16 a[160:161], v6 offset:0
    ds_read_b64_tr_b16 a[162:163], v6 offset:256
    ds_read_b64_tr_b16 a[164:165], v6 offset:1024
    ds_read_b64_tr_b16 a[166:167], v6 offset:1280
    ds_read_b64_tr_b16 a[168:169], v6 offset:2048
    ds_read_b64_tr_b16 a[170:171], v6 offset:2304
    ds_read_b64_tr_b16 a[172:173], v6 offset:3072
    ds_read_b64_tr_b16 a[174:175], v6 offset:3328
    s_waitcnt lgkmcnt(0)
    s_mov_b32 s28, 983040
    s_add_u32 m0, s26, 0
    s_nop 0
    buffer_load_dwordx4 v4, s[44:47], s28 offen lds
    s_add_u32 s28, s28, 49152
    s_add_u32 m0, s26, 1024
    s_nop 0
    buffer_load_dwordx4 v4, s[44:47], s28 offen lds
    s_add_u32 s28, s28, 49152
    s_add_u32 m0, s26, 2048
    s_nop 0
    buffer_load_dwordx4 v4, s[44:47], s28 offen lds
    s_add_u32 s28, s28, 49152
    s_add_u32 m0, s26, 3072
    s_nop 0
    buffer_load_dwordx4 v4, s[44:47], s28 offen lds
    s_waitcnt vmcnt(16)
    ds_read_b64_tr_b16 a[176:177], v6 offset:4096
    ds_read_b64_tr_b16 a[178:179], v6 offset:4352
    ds_read_b64_tr_b16 a[180:181], v6 offset:5120
    ds_read_b64_tr_b16 a[182:183], v6 offset:5376
    ds_read_b64_tr_b16 a[184:185], v6 offset:6144
    ds_read_b64_tr_b16 a[186:187], v6 offset:6400
    ds_read_b64_tr_b16 a[188:189], v6 offset:7168
    ds_read_b64_tr_b16 a[190:191], v6 offset:7424
    s_waitcnt lgkmcnt(0)
    s_mov_b32 s28, 1179648
    s_add_u32 m0, s26, 4096
    s_nop 0
    buffer_load_dwordx4 v4, s[44:47], s28 offen lds
    s_add_u32 s28, s28, 49152
    s_add_u32 m0, s26, 5120
    s_nop 0
    buffer_load_dwordx4 v4, s[44:47], s28 offen lds
    s_add_u32 s28, s28, 49152
    s_add_u32 m0, s26, 6144
    s_nop 0
    buffer_load_dwordx4 v4, s[44:47], s28 offen lds
    s_add_u32 s28, s28, 49152
    s_add_u32 m0, s26, 7168
    s_nop 0
    buffer_load_dwordx4 v4, s[44:47], s28 offen lds
    s_waitcnt vmcnt(16)
    ds_read_b64_tr_b16 a[192:193], v6 offset:8192
    ds_read_b64_tr_b16 a[194:195], v6 offset:8448
    ds_read_b64_tr_b16 a[196:197], v6 offset:9216
    ds_read_b64_tr_b16 a[198:199], v6 offset:9472
    ds_read_b64_tr_b16 a[200:201], v6 offset:10240
    ds_read_b64_tr_b16 a[202:203], v6 offset:10496
    ds_read_b64_tr_b16 a[204:205], v6 offset:11264
    ds_read_b64_tr_b16 a[206:207], v6 offset:11520
    s_waitcnt lgkmcnt(0)
    s_mov_b32 s28, 1376256
    s_add_u32 m0, s26, 8192
    s_nop 0
    buffer_load_dwordx4 v4, s[44:47], s28 offen lds
    s_add_u32 s28, s28, 49152
    s_add_u32 m0, s26, 9216
    s_nop 0
    buffer_load_dwordx4 v4, s[44:47], s28 offen lds
    s_add_u32 s28, s28, 49152
    s_add_u32 m0, s26, 10240
    s_nop 0
    buffer_load_dwordx4 v4, s[44:47], s28 offen lds
    s_add_u32 s28, s28, 49152
    s_add_u32 m0, s26, 11264
    s_nop 0
    buffer_load_dwordx4 v4, s[44:47], s28 offen lds
    s_waitcnt vmcnt(16)
    ds_read_b64_tr_b16 a[208:209], v6 offset:12288
    ds_read_b64_tr_b16 a[210:211], v6 offset:12544
    ds_read_b64_tr_b16 a[212:213], v6 offset:13312
    ds_read_b64_tr_b16 a[214:215], v6 offset:13568
    ds_read_b64_tr_b16 a[216:217], v6 offset:14336
    ds_read_b64_tr_b16 a[218:219], v6 offset:14592
    ds_read_b64_tr_b16 a[220:221], v6 offset:15360
    ds_read_b64_tr_b16 a[222:223], v6 offset:15616
    s_waitcnt lgkmcnt(0)
    s_mov_b32 s28, 1572864
    s_add_u32 m0, s26, 12288
    s_nop 0
    buffer_load_dwordx4 v4, s[44:47], s28 offen lds
    s_add_u32 s28, s28, 49152
    s_add_u32 m0, s26, 13312
    s_nop 0
    buffer_load_dwordx4 v4, s[44:47], s28 offen lds
    s_add_u32 s28, s28, 49152
    s_add_u32 m0, s26, 14336
    s_nop 0
    buffer_load_dwordx4 v4, s[44:47], s28 offen lds
    s_add_u32 s28, s28, 49152
    s_add_u32 m0, s26, 15360
    s_nop 0
    buffer_load_dwordx4 v4, s[44:47], s28 offen lds
    s_waitcnt vmcnt(16)
    ds_read_b64_tr_b16 a[224:225], v6 offset:16384
    ds_read_b64_tr_b16 a[226:227], v6 offset:16640
    ds_read_b64_tr_b16 a[228:229], v6 offset:17408
    ds_read_b64_tr_b16 a[230:231], v6 offset:17664
    ds_read_b64_tr_b16 a[232:233], v6 offset:18432
    ds_read_b64_tr_b16 a[234:235], v6 offset:18688
    ds_read_b64_tr_b16 a[236:237], v6 offset:19456
    ds_read_b64_tr_b16 a[238:239], v6 offset:19712
    s_waitcnt lgkmcnt(0)
    s_mov_b32 s28, 1769472
    s_add_u32 m0, s26, 16384
    s_nop 0
    buffer_load_dwordx4 v4, s[44:47], s28 offen lds
    s_add_u32 s28, s28, 49152
    s_add_u32 m0, s26, 17408
    s_nop 0
    buffer_load_dwordx4 v4, s[44:47], s28 offen lds
    s_add_u32 s28, s28, 49152
    s_add_u32 m0, s26, 18432
    s_nop 0
    buffer_load_dwordx4 v4, s[44:47], s28 offen lds
    s_add_u32 s28, s28, 49152
    s_add_u32 m0, s26, 19456
    s_nop 0
    buffer_load_dwordx4 v4, s[44:47], s28 offen lds
    s_waitcnt vmcnt(16)
    ds_read_b64_tr_b16 a[240:241], v6 offset:0
    ds_read_b64_tr_b16 a[242:243], v6 offset:256
    ds_read_b64_tr_b16 a[244:245], v6 offset:1024
    ds_read_b64_tr_b16 a[246:247], v6 offset:1280
    ds_read_b64_tr_b16 a[248:249], v6 offset:2048
    ds_read_b64_tr_b16 a[250:251], v6 offset:2304
    ds_read_b64_tr_b16 a[252:253], v6 offset:3072
    ds_read_b64_tr_b16 a[254:255], v6 offset:3328
    s_waitcnt lgkmcnt(0)
    s_waitcnt vmcnt(12)
    ds_read_b64_tr_b16 v[192:193], v6 offset:4096
    ds_read_b64_tr_b16 v[194:195], v6 offset:4352
    ds_read_b64_tr_b16 v[196:197], v6 offset:5120
    ds_read_b64_tr_b16 v[198:199], v6 offset:5376
    ds_read_b64_tr_b16 v[200:201], v6 offset:6144
    ds_read_b64_tr_b16 v[202:203], v6 offset:6400
    ds_read_b64_tr_b16 v[204:205], v6 offset:7168
    ds_read_b64_tr_b16 v[206:207], v6 offset:7424
    s_waitcnt lgkmcnt(0)
    s_waitcnt vmcnt(8)
    ds_read_b64_tr_b16 v[208:209], v6 offset:8192
    ds_read_b64_tr_b16 v[210:211], v6 offset:8448
    ds_read_b64_tr_b16 v[212:213], v6 offset:9216
    ds_read_b64_tr_b16 v[214:215], v6 offset:9472
    ds_read_b64_tr_b16 v[216:217], v6 offset:10240
    ds_read_b64_tr_b16 v[218:219], v6 offset:10496
    ds_read_b64_tr_b16 v[220:221], v6 offset:11264
    ds_read_b64_tr_b16 v[222:223], v6 offset:11520
    s_waitcnt lgkmcnt(0)
    s_waitcnt vmcnt(4)
    ds_read_b64_tr_b16 v[224:225], v6 offset:12288
    ds_read_b64_tr_b16 v[226:227], v6 offset:12544
    ds_read_b64_tr_b16 v[228:229], v6 offset:13312
    ds_read_b64_tr_b16 v[230:231], v6 offset:13568
    ds_read_b64_tr_b16 v[232:233], v6 offset:14336
    ds_read_b64_tr_b16 v[234:235], v6 offset:14592
    ds_read_b64_tr_b16 v[236:237], v6 offset:15360
    ds_read_b64_tr_b16 v[238:239], v6 offset:15616
    s_waitcnt lgkmcnt(0)
    s_waitcnt vmcnt(0)
    ds_read_b64_tr_b16 v[240:241], v6 offset:16384
    ds_read_b64_tr_b16 v[242:243], v6 offset:16640
    ds_read_b64_tr_b16 v[244:245], v6 offset:17408
    ds_read_b64_tr_b16 v[246:247], v6 offset:17664
    ds_read_b64_tr_b16 v[248:249], v6 offset:18432
    ds_read_b64_tr_b16 v[250:251], v6 offset:18688
    ds_read_b64_tr_b16 v[252:253], v6 offset:19456
    ds_read_b64_tr_b16 v[254:255], v6 offset:19712
    s_waitcnt lgkmcnt(0)
L_wdone_183:
    s_barrier
    v_mov_b32 v2, 76
    s_mov_b32 s38, 0
L_dw_184:
    buffer_load_dword v3, v2, s[12:15], 0 offen sc1
    s_waitcnt vmcnt(0)
    v_cmp_gt_u32 vcc, 1, v3
    s_cbranch_vccz L_dwk_185
    s_sleep 2
    s_add_u32 s38, s38, 1
    s_cmp_lt_u32 s38, 4194304
    s_cbranch_scc1 L_dw_184
    s_branch L_end_1
L_dwk_185:
    v_mov_b32 v2, 68
    s_mov_b32 s38, 0
L_dw_186:
    buffer_load_dword v3, v2, s[12:15], 0 offen sc1
    s_waitcnt vmcnt(0)
    v_cmp_gt_u32 vcc, 40, v3
    s_cbranch_vccz L_dwk_187
    s_sleep 2
    s_add_u32 s38, s38, 1
    s_cmp_lt_u32 s38, 4194304
    s_cbranch_scc1 L_dw_186
    s_branch L_end_1
L_dwk_187:
    s_add_u32 s38, s37, s34
    s_add_u32 m0, s38, 0
    s_nop 0
    buffer_load_dwordx4 v10, s[4:7], s32 offen lds
    s_add_u32 m0, s38, 1024
    s_nop 0
    buffer_load_dwordx4 v11, s[4:7], s32 offen lds
    s_add_u32 m0, s38, 2048
    s_nop 0
    buffer_load_dwordx4 v12, s[4:7], s32 offen lds
    s_add_u32 m0, s38, 3072
    s_nop 0
    buffer_load_dwordx4 v13, s[4:7], s32 offen lds
    s_add_u32 m0, s38, 4096
    s_nop 0
    buffer_load_dwordx4 v14, s[4:7], s32 offen lds
    s_add_u32 m0, s38, 5120
    s_nop 0
    buffer_load_dwordx4 v15, s[4:7], s32 offen lds
    s_add_u32 m0, s38, 6144
    s_nop 0
    buffer_load_dwordx4 v16, s[4:7], s32 offen lds
    s_add_u32 m0, s38, 7168
    s_nop 0
    buffer_load_dwordx4 v17, s[4:7], s32 offen lds
    s_add_u32 m0, s38, 8192
    s_nop 0
    buffer_load_dwordx4 v18, s[4:7], s32 offen lds
    s_add_u32 m0, s38, 9216
    s_nop 0
    buffer_load_dwordx4 v19, s[4:7], s32 offen lds
    s_add_u32 s32, s32, 40960
    s_add_u32 s38, s37, s35
    s_add_u32 m0, s38, 0
    s_nop 0
    buffer_load_dwordx4 v10, s[4:7], s32 offen lds
    s_add_u32 m0, s38, 1024
    s_nop 0
    buffer_load_dwordx4 v11, s[4:7], s32 offen lds
    s_add_u32 m0, s38, 2048
    s_nop 0
    buffer_load_dwordx4 v12, s[4:7], s32 offen lds
    s_add_u32 m0, s38, 3072
    s_nop 0
    buffer_load_dwordx4 v13, s[4:7], s32 offen lds
    s_add_u32 m0, s38, 4096
    s_nop 0
    buffer_load_dwordx4 v14, s[4:7], s32 offen lds
    s_add_u32 m0, s38, 5120
    s_nop 0
    buffer_load_dwordx4 v15, s[4:7], s32 offen lds
    s_add_u32 m0, s38, 6144
    s_nop 0
    buffer_load_dwordx4 v16, s[4:7], s32 offen lds
    s_add_u32 m0, s38, 7168
    s_nop 0
    buffer_load_dwordx4 v17, s[4:7], s32 offen lds
    s_add_u32 m0, s38, 8192
    s_nop 0
    buffer_load_dwordx4 v18, s[4:7], s32 offen lds
    s_add_u32 m0, s38, 9216
    s_nop 0
    buffer_load_dwordx4 v19, s[4:7], s32 offen lds
    s_add_u32 s32, s32, 40960
    v_and_b32 v2, 31, v1
    v_lshrrev_b32 v3, 5, v1
    v_and_b32 v7, 15, v2
    v_mul_u32_u24 v2, 80, v2
    v_add_u32 v8, 0, v3
    v_xor_b32 v8, v8, v7
    v_add_u32 v8, v8, v2
    v_lshlrev_b32 v20, 4, v8
    v_add_u32 v8, 2, v3
    v_xor_b32 v8, v8, v7
    v_add_u32 v8, v8, v2
    v_lshlrev_b32 v21, 4, v8
    v_add_u32 v8, 4, v3
    v_xor_b32 v8, v8, v7
    v_add_u32 v8, v8, v2
    v_lshlrev_b32 v22, 4, v8
    v_add_u32 v8, 6, v3
    v_xor_b32 v8, v8, v7
    v_add_u32 v8, v8, v2
    v_lshlrev_b32 v23, 4, v8
    v_add_u32 v8, 8, v3
    v_xor_b32 v8, v8, v7
    v_add_u32 v8, v8, v2
    v_lshlrev_b32 v24, 4, v8
    v_add_u32 v8, 10, v3
    v_xor_b32 v8, v8, v7
    v_add_u32 v8, v8, v2
    v_lshlrev_b32 v25, 4, v8
    v_add_u32 v8, 12, v3
    v_xor_b32 v8, v8, v7
    v_add_u32 v8, v8, v2
    v_lshlrev_b32 v26, 4, v8
    v_add_u32 v8, 14, v3
    v_xor_b32 v8, v8, v7
    v_add_u32 v8, v8, v2
    v_lshlrev_b32 v27, 4, v8
    s_lshl_b32 s29, s16, 12
    s_add_u32 s29, s29, 122880
    v_lshlrev_b32 v29, 4, v1
    v_add_u32 v29, s29, v29
    s_cmp_eq_u32 s20, 1
    s_cbranch_scc1 L_ov_188
    s_cmp_eq_u32 s20, 3
    s_cbranch_scc1 L_og_190
    s_mov_b32 s28, 54525952
    s_cmp_eq_u32 s20, 0
    s_cselect_b32 s28, 4194304, s28
    s_lshl_b32 s24, s21, 1
    s_add_u32 s28, s28, s24
    s_mov_b32 s30, 393216
    v_and_b32 v2, 31, v1
    v_lshrrev_b32 v3, 5, v1
    v_and_b32 v7, 7, v2
    v_xor_b32 v3, v3, v7
    v_lshlrev_b32 v3, 4, v3
    v_lshlrev_b32 v28, 7, v2
    v_add_u32 v28, v28, v3
    v_add_u32 v28, s29, v28
    v_lshrrev_b32 v2, 3, v1
    v_and_b32 v3, 7, v1
    v_xor_b32 v3, v3, v2
    v_lshlrev_b32 v3, 4, v3
    v_mul_u32_u24 v30, 12288, v2
    v_add_u32 v30, v30, v3
    v_add_u32 v30, s28, v30
    s_branch L_oo_189
L_ov_188:
    s_lshl_b32 s24, s21, 6
    s_add_u32 s28, s24, 29360128
    s_mov_b32 s30, 393216
    v_and_b32 v2, 31, v1
    v_lshrrev_b32 v3, 5, v1
    v_lshrrev_b32 v7, 1, v2
    v_and_b32 v7, 3, v7
    v_xor_b32 v3, v3, v7
    v_lshlrev_b32 v3, 4, v3
    v_lshlrev_b32 v28, 6, v2
    v_add_u32 v28, v28, v3
    v_add_u32 v28, s29, v28
    v_lshrrev_b32 v2, 2, v1
    v_and_b32 v3, 3, v1
    v_lshrrev_b32 v7, 3, v1
    v_and_b32 v7, 3, v7
    v_xor_b32 v3, v3, v7
    v_lshlrev_b32 v3, 4, v3
    v_mul_u32_u24 v30, 64, v2
    v_add_u32 v30, v30, v3
    v_add_u32 v30, s28, v30
    s_branch L_oo_189
L_og_190:
    s_lshl_b32 s24, s21, 1
    s_add_u32 s28, s24, 121634816
    s_mov_b32 s30, 98304
    v_and_b32 v2, 31, v1
    v_lshrrev_b32 v3, 5, v1
    v_lshrrev_b32 v7, 1, v2
    v_and_b32 v7, 3, v7
    v_xor_b32 v3, v3, v7
    v_lshlrev_b32 v3, 4, v3
    v_lshlrev_b32 v28, 6, v2
    v_add_u32 v28, v28, v3
    v_add_u32 v28, s29, v28
    v_lshrrev_b32 v2, 2, v1
    v_and_b32 v3, 3, v1
    v_lshrrev_b32 v7, 3, v1
    v_and_b32 v7, 3, v7
    v_xor_b32 v3, v3, v7
    v_lshlrev_b32 v3, 4, v3
    v_mul_u32_u24 v30, 3072, v2
    v_add_u32 v30, v30, v3
    v_add_u32 v30, s28, v30
L_oo_189:
    s_mul_i32 s31, s18, s30
    s_lshl_b32 s28, s17, 7
    s_add_u32 s28, s28, 2097152
    v_mov_b32 v31, s28
    s_cmp_eq_u32 s20, 1
    s_cbranch_scc1 L_kind1_193
    s_cmp_eq_u32 s20, 3
    s_cbranch_scc1 L_kind3_194
    s_branch L_kind0_192
L_kind0_192:
    s_waitcnt vmcnt(10)
    s_barrier
    v_add_u32 v40, s34, v20
    v_add_u32 v41, s34, v21
    v_add_u32 v42, s34, v22
    v_add_u32 v43, s34, v23
    v_add_u32 v44, s34, v24
    v_add_u32 v45, s34, v25
    v_add_u32 v46, s34, v26
    v_add_u32 v47, s34, v27
    ds_read_b128 v[48:51], v40 offset:0
    ds_read_b128 v[52:55], v41 offset:0
    ds_read_b128 v[56:59], v42 offset:0
    ds_read_b128 v[60:63], v43 offset:0
    s_waitcnt lgkmcnt(3)
    v_mfma_f32_32x32x16_bf16 v[64:79], a[0:3], v[48:51], 0
    v_mfma_f32_32x32x16_bf16 v[80:95], a[160:163], v[48:51], 0
    ds_read_b128 v[48:51], v44 offset:0
    s_waitcnt lgkmcnt(3)
    v_mfma_f32_32x32x16_bf16 v[64:79], a[4:7], v[52:55], v[64:79]
    s_add_u32 s38, s37, s36
    s_add_u32 m0, s38, 0
    s_nop 0
    buffer_load_dwordx4 v10, s[4:7], s32 offen lds
    v_mfma_f32_32x32x16_bf16 v[80:95], a[164:167], v[52:55], v[80:95]
    ds_read_b128 v[52:55], v45 offset:0
    s_waitcnt lgkmcnt(3)
    v_mfma_f32_32x32x16_bf16 v[64:79], a[8:11], v[56:59], v[64:79]
    v_mfma_f32_32x32x16_bf16 v[80:95], a[168:171], v[56:59], v[80:95]
    ds_read_b128 v[56:59], v46 offset:0
    s_waitcnt lgkmcnt(3)
    v_mfma_f32_32x32x16_bf16 v[64:79], a[12:15], v[60:63], v[64:79]
    v_mfma_f32_32x32x16_bf16 v[80:95], a[172:175], v[60:63], v[80:95]
    ds_read_b128 v[60:63], v47 offset:0
    s_waitcnt lgkmcnt(3)
    v_mfma_f32_32x32x16_bf16 v[64:79], a[16:19], v[48:51], v[64:79]
    v_mfma_f32_32x32x16_bf16 v[80:95], a[176:179], v[48:51], v[80:95]
    ds_read_b128 v[48:51], v40 offset:256
    s_waitcnt lgkmcnt(3)
    v_mfma_f32_32x32x16_bf16 v[64:79], a[20:23], v[52:55], v[64:79]
    s_add_u32 m0, s38, 1024
    s_nop 0
    buffer_load_dwordx4 v11, s[4:7], s32 offen lds
    v_mfma_f32_32x32x16_bf16 v[80:95], a[180:183], v[52:55], v[80:95]
    ds_read_b128 v[52:55], v41 offset:256
    s_waitcnt lgkmcnt(3)
    v_mfma_f32_32x32x16_bf16 v[64:79], a[24:27], v[56:59], v[64:79]
    v_mfma_f32_32x32x16_bf16 v[80:95], a[184:187], v[56:59], v[80:95]
    ds_read_b128 v[56:59], v42 offset:256
    s_waitcnt lgkmcnt(3)
    v_mfma_f32_32x32x16_bf16 v[64:79], a[28:31], v[60:63], v[64:79]
    v_mfma_f32_32x32x16_bf16 v[80:95], a[188:191], v[60:63], v[80:95]
    ds_read_b128 v[60:63], v43 offset:256
    s_waitcnt lgkmcnt(3)
    v_mfma_f32_32x32x16_bf16 v[64:79], a[32:35], v[48:51], v[64:79]
    v_mfma_f32_32x32x16_bf16 v[80:95], a[192:195], v[48:51], v[80:95]
    ds_read_b128 v[48:51], v44 offset:256
    s_waitcnt lgkmcnt(3)
    v_mfma_f32_32x32x16_bf16 v[64:79], a[36:39], v[52:55], v[64:79]
    s_add_u32 m0, s38, 2048
    s_nop 0
    buffer_load_dwordx4 v12, s[4:7], s32 offen lds
    v_mfma_f32_32x32x16_bf16 v[80:95], a[196:199], v[52:55], v[80:95]
    ds_read_b128 v[52:55], v45 offset:256
    s_waitcnt lgkmcnt(3)
    v_mfma_f32_32x32x16_bf16 v[64:79], a[40:43], v[56:59], v[64:79]
    v_mfma_f32_32x32x16_bf16 v[80:95], a[200:203], v[56:59], v[80:95]
    ds_read_b128 v[56:59], v46 offset:256
    s_waitcnt lgkmcnt(3)
    v_mfma_f32_32x32x16_bf16 v[64:79], a[44:47], v[60:63], v[64:79]
    v_mfma_f32_32x32x16_bf16 v[80:95], a[204:207], v[60:63], v[80:95]
    ds_read_b128 v[60:63], v47 offset:256
    s_waitcnt lgkmcnt(3)
    v_mfma_f32_32x32x16_bf16 v[64:79], a[48:51], v[48:51], v[64:79]
    v_mfma_f32_32x32x16_bf16 v[80:95], a[208:211], v[48:51], v[80:95]
    ds_read_b128 v[48:51], v40 offset:512
    s_waitcnt lgkmcnt(3)
    v_mfma_f32_32x32x16_bf16 v[64:79], a[52:55], v[52:55], v[64:79]
    s_add_u32 m0, s38, 3072
    s_nop 0
    buffer_load_dwordx4 v13, s[4:7], s32 offen lds
    v_mfma_f32_32x32x16_bf16 v[80:95], a[212:215], v[52:55], v[80:95]
    ds_read_b128 v[52:55], v41 offset:512
    s_waitcnt lgkmcnt(3)
    v_mfma_f32_32x32x16_bf16 v[64:79], a[56:59], v[56:59], v[64:79]
    v_mfma_f32_32x32x16_bf16 v[80:95], a[216:219], v[56:59], v[80:95]
    ds_read_b128 v[56:59], v42 offset:512
    s_waitcnt lgkmcnt(3)
    v_mfma_f32_32x32x16_bf16 v[64:79], a[60:63], v[60:63], v[64:79]
    v_mfma_f32_32x32x16_bf16 v[80:95], a[220:223], v[60:63], v[80:95]
    ds_read_b128 v[60:63], v43 offset:512
    s_waitcnt lgkmcnt(3)
    v_mfma_f32_32x32x16_bf16 v[64:79], a[64:67], v[48:51], v[64:79]
    v_mfma_f32_32x32x16_bf16 v[80:95], a[224:227], v[48:51], v[80:95]
    ds_read_b128 v[48:51], v44 offset:512
    s_waitcnt lgkmcnt(3)
    v_mfma_f32_32x32x16_bf16 v[64:79], a[68:71], v[52:55], v[64:79]
    s_add_u32 m0, s38, 4096
    s_nop 0
    buffer_load_dwordx4 v14, s[4:7], s32 offen lds
    v_mfma_f32_32x32x16_bf16 v[80:95], a[228:231], v[52:55], v[80:95]
    ds_read_b128 v[52:55], v45 offset:512
    s_waitcnt lgkmcnt(3)
    v_mfma_f32_32x32x16_bf16 v[64:79], a[72:75], v[56:59], v[64:79]
    v_mfma_f32_32x32x16_bf16 v[80:95], a[232:235], v[56:59], v[80:95]
    ds_read_b128 v[56:59], v46 offset:512
    s_waitcnt lgkmcnt(3)
    v_mfma_f32_32x32x16_bf16 v[64:79], a[76:79], v[60:63], v[64:79]
    v_mfma_f32_32x32x16_bf16 v[80:95], a[236:239], v[60:63], v[80:95]
    ds_read_b128 v[60:63], v47 offset:512
    s_waitcnt lgkmcnt(3)
    v_mfma_f32_32x32x16_bf16 v[64:79], a[80:83], v[48:51], v[64:79]
    v_mfma_f32_32x32x16_bf16 v[80:95], a[240:243], v[48:51], v[80:95]
    ds_read_b128 v[48:51], v40 offset:768
    s_waitcnt lgkmcnt(3)
    v_mfma_f32_32x32x16_bf16 v[64:79], a[84:87], v[52:55], v[64:79]
    s_add_u32 m0, s38, 5120
    s_nop 0
    buffer_load_dwordx4 v15, s[4:7], s32 offen lds
    v_mfma_f32_32x32x16_bf16 v[80:95], a[244:247], v[52:55], v[80:95]
    ds_read_b128 v[52:55], v41 offset:768
    s_waitcnt lgkmcnt(3)
    v_mfma_f32_32x32x16_bf16 v[64:79], a[88:91], v[56:59], v[64:79]
    v_mfma_f32_32x32x16_bf16 v[80:95], a[248:251], v[56:59], v[80:95]
    ds_read_b128 v[56:59], v42 offset:768
    s_waitcnt lgkmcnt(3)
    v_mfma_f32_32x32x16_bf16 v[64:79], a[92:95], v[60:63], v[64:79]
    v_mfma_f32_32x32x16_bf16 v[80:95], a[252:255], v[60:63], v[80:95]
    ds_read_b128 v[60:63], v43 offset:768
    s_waitcnt lgkmcnt(3)
    v_mfma_f32_32x32x16_bf16 v[64:79], a[96:99], v[48:51], v[64:79]
    v_mfma_f32_32x32x16_bf16 v[80:95], v[192:195], v[48:51], v[80:95]
    ds_read_b128 v[48:51], v44 offset:768
    s_waitcnt lgkmcnt(3)
    v_mfma_f32_32x32x16_bf16 v[64:79], a[100:103], v[52:55], v[64:79]
    s_add_u32 m0, s38, 6144
    s_nop 0
    buffer_load_dwordx4 v16, s[4:7], s32 offen lds
    v_mfma_f32_32x32x16_bf16 v[80:95], v[196:199], v[52:55], v[80:95]
    ds_read_b128 v[52:55], v45 offset:768
    s_waitcnt lgkmcnt(3)
    v_mfma_f32_32x32x16_bf16 v[64:79], a[104:107], v[56:59], v[64:79]
    v_mfma_f32_32x32x16_bf16 v[80:95], v[200:203], v[56:59], v[80:95]
    ds_read_b128 v[56:59], v46 offset:768
    s_waitcnt lgkmcnt(3)
    v_mfma_f32_32x32x16_bf16 v[64:79], a[108:111], v[60:63], v[64:79]
    v_mfma_f32_32x32x16_bf16 v[80:95], v[204:207], v[60:63], v[80:95]
    ds_read_b128 v[60:63], v47 offset:768
    s_waitcnt lgkmcnt(3)
    v_mfma_f32_32x32x16_bf16 v[64:79], a[112:115], v[48:51], v[64:79]
    v_mfma_f32_32x32x16_bf16 v[80:95], v[208:211], v[48:51], v[80:95]
    ds_read_b128 v[48:51], v40 offset:1024
    s_waitcnt lgkmcnt(3)
    v_mfma_f32_32x32x16_bf16 v[64:79], a[116:119], v[52:55], v[64:79]
    s_add_u32 m0, s38, 7168
    s_nop 0
    buffer_load_dwordx4 v17, s[4:7], s32 offen lds
    v_mfma_f32_32x32x16_bf16 v[80:95], v[212:215], v[52:55], v[80:95]
    ds_read_b128 v[52:55], v41 offset:1024
    s_waitcnt lgkmcnt(3)
    v_mfma_f32_32x32x16_bf16 v[64:79], a[120:123], v[56:59], v[64:79]
    v_mfma_f32_32x32x16_bf16 v[80:95], v[216:219], v[56:59], v[80:95]
    ds_read_b128 v[56:59], v42 offset:1024
    s_waitcnt lgkmcnt(3)
    v_mfma_f32_32x32x16_bf16 v[64:79], a[124:127], v[60:63], v[64:79]
    v_mfma_f32_32x32x16_bf16 v[80:95], v[220:223], v[60:63], v[80:95]
    ds_read_b128 v[60:63], v43 offset:1024
    s_waitcnt lgkmcnt(3)
    v_mfma_f32_32x32x16_bf16 v[64:79], a[128:131], v[48:51], v[64:79]
    v_mfma_f32_32x32x16_bf16 v[80:95], v[224:227], v[48:51], v[80:95]
    ds_read_b128 v[48:51], v44 offset:1024
    s_waitcnt lgkmcnt(3)
    v_mfma_f32_32x32x16_bf16 v[64:79], a[132:135], v[52:55], v[64:79]
    s_add_u32 m0, s38, 8192
    s_nop 0
    buffer_load_dwordx4 v18, s[4:7], s32 offen lds
    v_mfma_f32_32x32x16_bf16 v[80:95], v[228:231], v[52:55], v[80:95]
    ds_read_b128 v[52:55], v45 offset:1024
    s_waitcnt lgkmcnt(3)
    v_mfma_f32_32x32x16_bf16 v[64:79], a[136:139], v[56:59], v[64:79]
    v_mfma_f32_32x32x16_bf16 v[80:95], v[232:235], v[56:59], v[80:95]
    ds_read_b128 v[56:59], v46 offset:1024
    s_waitcnt lgkmcnt(3)
    v_mfma_f32_32x32x16_bf16 v[64:79], a[140:143], v[60:63], v[64:79]
    v_mfma_f32_32x32x16_bf16 v[80:95], v[236:239], v[60:63], v[80:95]
    ds_read_b128 v[60:63], v47 offset:1024
    s_waitcnt lgkmcnt(3)
    v_mfma_f32_32x32x16_bf16 v[64:79], a[144:147], v[48:51], v[64:79]
    v_mfma_f32_32x32x16_bf16 v[80:95], v[240:243], v[48:51], v[80:95]
    s_waitcnt lgkmcnt(2)
    v_mfma_f32_32x32x16_bf16 v[64:79], a[148:151], v[52:55], v[64:79]
    s_add_u32 m0, s38, 9216
    s_nop 0
    buffer_load_dwordx4 v19, s[4:7], s32 offen lds
    v_mfma_f32_32x32x16_bf16 v[80:95], v[244:247], v[52:55], v[80:95]
    s_waitcnt lgkmcnt(1)
    v_mfma_f32_32x32x16_bf16 v[64:79], a[152:155], v[56:59], v[64:79]
    v_mfma_f32_32x32x16_bf16 v[80:95], v[248:251], v[56:59], v[80:95]
    s_waitcnt lgkmcnt(0)
    v_mfma_f32_32x32x16_bf16 v[64:79], a[156:159], v[60:63], v[64:79]
    v_mfma_f32_32x32x16_bf16 v[80:95], v[252:255], v[60:63], v[80:95]
    s_add_u32 s32, s32, 40960
    s_nop 7
    s_nop 3
    v_cvt_pk_bf16_f32 v136, v64, v65
    v_cvt_pk_bf16_f32 v137, v66, v67
    v_cvt_pk_bf16_f32 v138, v68, v69
    v_cvt_pk_bf16_f32 v139, v70, v71
    v_xor_b32 v134, 0, v28
    v_permlane32_swap_b32 v136, v138
    v_permlane32_swap_b32 v137, v139
    ds_write_b128 v134, v[136:139]
    v_cvt_pk_bf16_f32 v140, v72, v73
    v_cvt_pk_bf16_f32 v141, v74, v75
    v_cvt_pk_bf16_f32 v142, v76, v77
    v_cvt_pk_bf16_f32 v143, v78, v79
    v_xor_b32 v134, 32, v28
    v_permlane32_swap_b32 v140, v142
    v_permlane32_swap_b32 v141, v143
    ds_write_b128 v134, v[140:143]
    v_cvt_pk_bf16_f32 v136, v80, v81
    v_cvt_pk_bf16_f32 v137, v82, v83
    v_cvt_pk_bf16_f32 v138, v84, v85
    v_cvt_pk_bf16_f32 v139, v86, v87
    v_xor_b32 v134, 64, v28
    v_permlane32_swap_b32 v136, v138
    v_permlane32_swap_b32 v137, v139
    ds_write_b128 v134, v[136:139]
    v_cvt_pk_bf16_f32 v140, v88, v89
    v_cvt_pk_bf16_f32 v141, v90, v91
    v_cvt_pk_bf16_f32 v142, v92, v93
    v_cvt_pk_bf16_f32 v143, v94, v95
    v_xor_b32 v134, 96, v28
    v_permlane32_swap_b32 v140, v142
    v_permlane32_swap_b32 v141, v143
    ds_write_b128 v134, v[140:143]
    s_waitcnt lgkmcnt(0)
    ds_read_b128 v[144:147], v29 offset:0
    ds_read_b128 v[148:151], v29 offset:1024
    ds_read_b128 v[152:155], v29 offset:2048
    ds_read_b128 v[156:159], v29 offset:3072
    s_waitcnt lgkmcnt(3)
    buffer_store_dwordx4 v[144:147], v30, s[4:7], s31 offen offset:0 sc1
    s_waitcnt lgkmcnt(2)
    s_add_u32 s39, s31, 98304
    buffer_store_dwordx4 v[148:151], v30, s[4:7], s39 offen sc1
    s_waitcnt lgkmcnt(1)
    s_add_u32 s39, s31, 196608
    buffer_store_dwordx4 v[152:155], v30, s[4:7], s39 offen sc1
    s_waitcnt lgkmcnt(0)
    s_add_u32 s39, s31, 294912
    buffer_store_dwordx4 v[156:159], v30, s[4:7], s39 offen sc1
    s_add_u32 s33, s33, 1
    s_mov_b32 s38, s34
    s_mov_b32 s34, s35
    s_mov_b32 s35, s36
    s_mov_b32 s36, s38
    s_waitcnt vmcnt(0)
    s_barrier
    s_cmp_lg_u32 s16, 0
    s_cbranch_scc1 L_pp_195
    v_mov_b32 v9, s33
    s_mov_b64 exec, 1
    buffer_store_dword v9, v31, s[4:7], 0 offen sc1
    s_mov_b64 exec, -1
L_pp_195:
    s_add_u32 s31, s31, s30
    s_cmp_ge_u32 s33, s19
    s_cbranch_scc1 L_pend_191
    v_add_u32 v40, s34, v20
    v_add_u32 v41, s34, v21
    v_add_u32 v42, s34, v22
    v_add_u32 v43, s34, v23
    v_add_u32 v44, s34, v24
    v_add_u32 v45, s34, v25
    v_add_u32 v46, s34, v26
    v_add_u32 v47, s34, v27
    ds_read_b128 v[48:51], v40 offset:0
    ds_read_b128 v[52:55], v41 offset:0
    ds_read_b128 v[56:59], v42 offset:0
    ds_read_b128 v[60:63], v43 offset:0
    s_waitcnt lgkmcnt(3)
    v_mfma_f32_32x32x16_bf16 v[96:111], a[0:3], v[48:51], 0
    v_mfma_f32_32x32x16_bf16 v[112:127], a[160:163], v[48:51], 0
    ds_read_b128 v[48:51], v44 offset:0
    s_waitcnt lgkmcnt(3)
    v_mfma_f32_32x32x16_bf16 v[96:111], a[4:7], v[52:55], v[96:111]
    s_add_u32 s38, s37, s36
    s_add_u32 m0, s38, 0
    s_nop 0
    buffer_load_dwordx4 v10, s[4:7], s32 offen lds
    v_mfma_f32_32x32x16_bf16 v[112:127], a[164:167], v[52:55], v[112:127]
    ds_read_b128 v[52:55], v45 offset:0
    s_waitcnt lgkmcnt(3)
    v_mfma_f32_32x32x16_bf16 v[96:111], a[8:11], v[56:59], v[96:111]
    v_mfma_f32_32x32x16_bf16 v[112:127], a[168:171], v[56:59], v[112:127]
    ds_read_b128 v[56:59], v46 offset:0
    s_waitcnt lgkmcnt(3)
    v_mfma_f32_32x32x16_bf16 v[96:111], a[12:15], v[60:63], v[96:111]
    v_mfma_f32_32x32x16_bf16 v[112:127], a[172:175], v[60:63], v[112:127]
    ds_read_b128 v[60:63], v47 offset:0
    s_waitcnt lgkmcnt(3)
    v_mfma_f32_32x32x16_bf16 v[96:111], a[16:19], v[48:51], v[96:111]
    v_mfma_f32_32x32x16_bf16 v[112:127], a[176:179], v[48:51], v[112:127]
    ds_read_b128 v[48:51], v40 offset:256
    s_waitcnt lgkmcnt(3)
    v_mfma_f32_32x32x16_bf16 v[96:111], a[20:23], v[52:55], v[96:111]
    s_add_u32 m0, s38, 1024
    s_nop 0
    buffer_load_dwordx4 v11, s[4:7], s32 offen lds
    v_mfma_f32_32x32x16_bf16 v[112:127], a[180:183], v[52:55], v[112:127]
    ds_read_b128 v[52:55], v41 offset:256
    s_waitcnt lgkmcnt(3)
    v_mfma_f32_32x32x16_bf16 v[96:111], a[24:27], v[56:59], v[96:111]
    v_mfma_f32_32x32x16_bf16 v[112:127], a[184:187], v[56:59], v[112:127]
    ds_read_b128 v[56:59], v42 offset:256
    s_waitcnt lgkmcnt(3)
    v_mfma_f32_32x32x16_bf16 v[96:111], a[28:31], v[60:63], v[96:111]
    v_mfma_f32_32x32x16_bf16 v[112:127], a[188:191], v[60:63], v[112:127]
    ds_read_b128 v[60:63], v43 offset:256
    s_waitcnt lgkmcnt(3)
    v_mfma_f32_32x32x16_bf16 v[96:111], a[32:35], v[48:51], v[96:111]
    v_mfma_f32_32x32x16_bf16 v[112:127], a[192:195], v[48:51], v[112:127]
    ds_read_b128 v[48:51], v44 offset:256
    s_waitcnt lgkmcnt(3)
    v_mfma_f32_32x32x16_bf16 v[96:111], a[36:39], v[52:55], v[96:111]
    s_add_u32 m0, s38, 2048
    s_nop 0
    buffer_load_dwordx4 v12, s[4:7], s32 offen lds
    v_mfma_f32_32x32x16_bf16 v[112:127], a[196:199], v[52:55], v[112:127]
    ds_read_b128 v[52:55], v45 offset:256
    s_waitcnt lgkmcnt(3)
    v_mfma_f32_32x32x16_bf16 v[96:111], a[40:43], v[56:59], v[96:111]
    v_mfma_f32_32x32x16_bf16 v[112:127], a[200:203], v[56:59], v[112:127]
    ds_read_b128 v[56:59], v46 offset:256
    s_waitcnt lgkmcnt(3)
    v_mfma_f32_32x32x16_bf16 v[96:111], a[44:47], v[60:63], v[96:111]
    v_mfma_f32_32x32x16_bf16 v[112:127], a[204:207], v[60:63], v[112:127]
    ds_read_b128 v[60:63], v47 offset:256
    s_waitcnt lgkmcnt(3)
    v_mfma_f32_32x32x16_bf16 v[96:111], a[48:51], v[48:51], v[96:111]
    v_mfma_f32_32x32x16_bf16 v[112:127], a[208:211], v[48:51], v[112:127]
    ds_read_b128 v[48:51], v40 offset:512
    s_waitcnt lgkmcnt(3)
    v_mfma_f32_32x32x16_bf16 v[96:111], a[52:55], v[52:55], v[96:111]
    s_add_u32 m0, s38, 3072
    s_nop 0
    buffer_load_dwordx4 v13, s[4:7], s32 offen lds
    v_mfma_f32_32x32x16_bf16 v[112:127], a[212:215], v[52:55], v[112:127]
    ds_read_b128 v[52:55], v41 offset:512
    s_waitcnt lgkmcnt(3)
    v_mfma_f32_32x32x16_bf16 v[96:111], a[56:59], v[56:59], v[96:111]
    v_mfma_f32_32x32x16_bf16 v[112:127], a[216:219], v[56:59], v[112:127]
    ds_read_b128 v[56:59], v42 offset:512
    s_waitcnt lgkmcnt(3)
    v_mfma_f32_32x32x16_bf16 v[96:111], a[60:63], v[60:63], v[96:111]
    v_mfma_f32_32x32x16_bf16 v[112:127], a[220:223], v[60:63], v[112:127]
    ds_read_b128 v[60:63], v43 offset:512
    s_waitcnt lgkmcnt(3)
    v_mfma_f32_32x32x16_bf16 v[96:111], a[64:67], v[48:51], v[96:111]
    v_mfma_f32_32x32x16_bf16 v[112:127], a[224:227], v[48:51], v[112:127]
    ds_read_b128 v[48:51], v44 offset:512
    s_waitcnt lgkmcnt(3)
    v_mfma_f32_32x32x16_bf16 v[96:111], a[68:71], v[52:55], v[96:111]
    s_add_u32 m0, s38, 4096
    s_nop 0
    buffer_load_dwordx4 v14, s[4:7], s32 offen lds
    v_mfma_f32_32x32x16_bf16 v[112:127], a[228:231], v[52:55], v[112:127]
    ds_read_b128 v[52:55], v45 offset:512
    s_waitcnt lgkmcnt(3)
    v_mfma_f32_32x32x16_bf16 v[96:111], a[72:75], v[56:59], v[96:111]
    v_mfma_f32_32x32x16_bf16 v[112:127], a[232:235], v[56:59], v[112:127]
    ds_read_b128 v[56:59], v46 offset:512
    s_waitcnt lgkmcnt(3)
    v_mfma_f32_32x32x16_bf16 v[96:111], a[76:79], v[60:63], v[96:111]
    v_mfma_f32_32x32x16_bf16 v[112:127], a[236:239], v[60:63], v[112:127]
    ds_read_b128 v[60:63], v47 offset:512
    s_waitcnt lgkmcnt(3)
    v_mfma_f32_32x32x16_bf16 v[96:111], a[80:83], v[48:51], v[96:111]
    v_mfma_f32_32x32x16_bf16 v[112:127], a[240:243], v[48:51], v[112:127]
    ds_read_b128 v[48:51], v40 offset:768
    s_waitcnt lgkmcnt(3)
    v_mfma_f32_32x32x16_bf16 v[96:111], a[84:87], v[52:55], v[96:111]
    s_add_u32 m0, s38, 5120
    s_nop 0
    buffer_load_dwordx4 v15, s[4:7], s32 offen lds
    v_mfma_f32_32x32x16_bf16 v[112:127], a[244:247], v[52:55], v[112:127]
    ds_read_b128 v[52:55], v41 offset:768
    s_waitcnt lgkmcnt(3)
    v_mfma_f32_32x32x16_bf16 v[96:111], a[88:91], v[56:59], v[96:111]
    v_mfma_f32_32x32x16_bf16 v[112:127], a[248:251], v[56:59], v[112:127]
    ds_read_b128 v[56:59], v42 offset:768
    s_waitcnt lgkmcnt(3)
    v_mfma_f32_32x32x16_bf16 v[96:111], a[92:95], v[60:63], v[96:111]
    v_mfma_f32_32x32x16_bf16 v[112:127], a[252:255], v[60:63], v[112:127]
    ds_read_b128 v[60:63], v43 offset:768
    s_waitcnt lgkmcnt(3)
    v_mfma_f32_32x32x16_bf16 v[96:111], a[96:99], v[48:51], v[96:111]
    v_mfma_f32_32x32x16_bf16 v[112:127], v[192:195], v[48:51], v[112:127]
    ds_read_b128 v[48:51], v44 offset:768
    s_waitcnt lgkmcnt(3)
    v_mfma_f32_32x32x16_bf16 v[96:111], a[100:103], v[52:55], v[96:111]
    s_add_u32 m0, s38, 6144
    s_nop 0
    buffer_load_dwordx4 v16, s[4:7], s32 offen lds
    v_mfma_f32_32x32x16_bf16 v[112:127], v[196:199], v[52:55], v[112:127]
    ds_read_b128 v[52:55], v45 offset:768
    s_waitcnt lgkmcnt(3)
    v_mfma_f32_32x32x16_bf16 v[96:111], a[104:107], v[56:59], v[96:111]
    v_mfma_f32_32x32x16_bf16 v[112:127], v[200:203], v[56:59], v[112:127]
    ds_read_b128 v[56:59], v46 offset:768
    s_waitcnt lgkmcnt(3)
    v_mfma_f32_32x32x16_bf16 v[96:111], a[108:111], v[60:63], v[96:111]
    v_mfma_f32_32x32x16_bf16 v[112:127], v[204:207], v[60:63], v[112:127]
    ds_read_b128 v[60:63], v47 offset:768
    s_waitcnt lgkmcnt(3)
    v_mfma_f32_32x32x16_bf16 v[96:111], a[112:115], v[48:51], v[96:111]
    v_mfma_f32_32x32x16_bf16 v[112:127], v[208:211], v[48:51], v[112:127]
    ds_read_b128 v[48:51], v40 offset:1024
    s_waitcnt lgkmcnt(3)
    v_mfma_f32_32x32x16_bf16 v[96:111], a[116:119], v[52:55], v[96:111]
    s_add_u32 m0, s38, 7168
    s_nop 0
    buffer_load_dwordx4 v17, s[4:7], s32 offen lds
    v_mfma_f32_32x32x16_bf16 v[112:127], v[212:215], v[52:55], v[112:127]
    ds_read_b128 v[52:55], v41 offset:1024
    s_waitcnt lgkmcnt(3)
    v_mfma_f32_32x32x16_bf16 v[96:111], a[120:123], v[56:59], v[96:111]
    v_mfma_f32_32x32x16_bf16 v[112:127], v[216:219], v[56:59], v[112:127]
    ds_read_b128 v[56:59], v42 offset:1024
    s_waitcnt lgkmcnt(3)
    v_mfma_f32_32x32x16_bf16 v[96:111], a[124:127], v[60:63], v[96:111]
    v_mfma_f32_32x32x16_bf16 v[112:127], v[220:223], v[60:63], v[112:127]
    ds_read_b128 v[60:63], v43 offset:1024
    s_waitcnt lgkmcnt(3)
    v_mfma_f32_32x32x16_bf16 v[96:111], a[128:131], v[48:51], v[96:111]
    v_mfma_f32_32x32x16_bf16 v[112:127], v[224:227], v[48:51], v[112:127]
    ds_read_b128 v[48:51], v44 offset:1024
    s_waitcnt lgkmcnt(3)
    v_mfma_f32_32x32x16_bf16 v[96:111], a[132:135], v[52:55], v[96:111]
    s_add_u32 m0, s38, 8192
    s_nop 0
    buffer_load_dwordx4 v18, s[4:7], s32 offen lds
    v_mfma_f32_32x32x16_bf16 v[112:127], v[228:231], v[52:55], v[112:127]
    ds_read_b128 v[52:55], v45 offset:1024
    s_waitcnt lgkmcnt(3)
    v_mfma_f32_32x32x16_bf16 v[96:111], a[136:139], v[56:59], v[96:111]
    v_mfma_f32_32x32x16_bf16 v[112:127], v[232:235], v[56:59], v[112:127]
    ds_read_b128 v[56:59], v46 offset:1024
    s_waitcnt lgkmcnt(3)
    v_mfma_f32_32x32x16_bf16 v[96:111], a[140:143], v[60:63], v[96:111]
    v_mfma_f32_32x32x16_bf16 v[112:127], v[236:239], v[60:63], v[112:127]
    ds_read_b128 v[60:63], v47 offset:1024
    s_waitcnt lgkmcnt(3)
    v_mfma_f32_32x32x16_bf16 v[96:111], a[144:147], v[48:51], v[96:111]
    v_mfma_f32_32x32x16_bf16 v[112:127], v[240:243], v[48:51], v[112:127]
    s_waitcnt lgkmcnt(2)
    v_mfma_f32_32x32x16_bf16 v[96:111], a[148:151], v[52:55], v[96:111]
    s_add_u32 m0, s38, 9216
    s_nop 0
    buffer_load_dwordx4 v19, s[4:7], s32 offen lds
    v_mfma_f32_32x32x16_bf16 v[112:127], v[244:247], v[52:55], v[112:127]
    s_waitcnt lgkmcnt(1)
    v_mfma_f32_32x32x16_bf16 v[96:111], a[152:155], v[56:59], v[96:111]
    v_mfma_f32_32x32x16_bf16 v[112:127], v[248:251], v[56:59], v[112:127]
    s_waitcnt lgkmcnt(0)
    v_mfma_f32_32x32x16_bf16 v[96:111], a[156:159], v[60:63], v[96:111]
    v_mfma_f32_32x32x16_bf16 v[112:127], v[252:255], v[60:63], v[112:127]
    s_add_u32 s32, s32, 40960
    s_nop 7
    s_nop 3
    v_cvt_pk_bf16_f32 v136, v96, v97
    v_cvt_pk_bf16_f32 v137, v98, v99
    v_cvt_pk_bf16_f32 v138, v100, v101
    v_cvt_pk_bf16_f32 v139, v102, v103
    v_xor_b32 v134, 0, v28
    v_permlane32_swap_b32 v136, v138
    v_permlane32_swap_b32 v137, v139
    ds_write_b128 v134, v[136:139]
    v_cvt_pk_bf16_f32 v140, v104, v105
    v_cvt_pk_bf16_f32 v141, v106, v107
    v_cvt_pk_bf16_f32 v142, v108, v109
    v_cvt_pk_bf16_f32 v143, v110, v111
    v_xor_b32 v134, 32, v28
    v_permlane32_swap_b32 v140, v142
    v_permlane32_swap_b32 v141, v143
    ds_write_b128 v134, v[140:143]
    v_cvt_pk_bf16_f32 v136, v112, v113
    v_cvt_pk_bf16_f32 v137, v114, v115
    v_cvt_pk_bf16_f32 v138, v116, v117
    v_cvt_pk_bf16_f32 v139, v118, v119
    v_xor_b32 v134, 64, v28
    v_permlane32_swap_b32 v136, v138
    v_permlane32_swap_b32 v137, v139
    ds_write_b128 v134, v[136:139]
    v_cvt_pk_bf16_f32 v140, v120, v121
    v_cvt_pk_bf16_f32 v141, v122, v123
    v_cvt_pk_bf16_f32 v142, v124, v125
    v_cvt_pk_bf16_f32 v143, v126, v127
    v_xor_b32 v134, 96, v28
    v_permlane32_swap_b32 v140, v142
    v_permlane32_swap_b32 v141, v143
    ds_write_b128 v134, v[140:143]
    s_waitcnt lgkmcnt(0)
    ds_read_b128 v[144:147], v29 offset:0
    ds_read_b128 v[148:151], v29 offset:1024
    ds_read_b128 v[152:155], v29 offset:2048
    ds_read_b128 v[156:159], v29 offset:3072
    s_waitcnt lgkmcnt(3)
    buffer_store_dwordx4 v[144:147], v30, s[4:7], s31 offen offset:0 sc1
    s_waitcnt lgkmcnt(2)
    s_add_u32 s39, s31, 98304
    buffer_store_dwordx4 v[148:151], v30, s[4:7], s39 offen sc1
    s_waitcnt lgkmcnt(1)
    s_add_u32 s39, s31, 196608
    buffer_store_dwordx4 v[152:155], v30, s[4:7], s39 offen sc1
    s_waitcnt lgkmcnt(0)
    s_add_u32 s39, s31, 294912
    buffer_store_dwordx4 v[156:159], v30, s[4:7], s39 offen sc1
    s_add_u32 s33, s33, 1
    s_mov_b32 s38, s34
    s_mov_b32 s34, s35
    s_mov_b32 s35, s36
    s_mov_b32 s36, s38
    s_waitcnt vmcnt(0)
    s_barrier
    s_cmp_lg_u32 s16, 0
    s_cbranch_scc1 L_pp_197
    v_mov_b32 v9, s33
    s_mov_b64 exec, 1
    buffer_store_dword v9, v31, s[4:7], 0 offen sc1
    s_mov_b64 exec, -1
L_pp_197:
    v_mov_b32 v2, 80
    s_mov_b32 s38, 0
L_dw_198:
    buffer_load_dword v3, v2, s[12:15], 0 offen sc1
    s_waitcnt vmcnt(0)
    v_cmp_gt_u32 vcc, 24, v3
    s_cbranch_vccz L_dwk_199
    s_sleep 2
    s_add_u32 s38, s38, 1
    s_cmp_lt_u32 s38, 4194304
    s_cbranch_scc1 L_dw_198
    s_branch L_end_1
L_dwk_199:
    s_add_u32 s31, s31, s30
    s_cmp_ge_u32 s33, s19
    s_cbranch_scc1 L_pend_191
    v_add_u32 v40, s34, v20
    v_add_u32 v41, s34, v21
    v_add_u32 v42, s34, v22
    v_add_u32 v43, s34, v23
    v_add_u32 v44, s34, v24
    v_add_u32 v45, s34, v25
    v_add_u32 v46, s34, v26
    v_add_u32 v47, s34, v27
    ds_read_b128 v[48:51], v40 offset:0
    ds_read_b128 v[52:55], v41 offset:0
    ds_read_b128 v[56:59], v42 offset:0
    ds_read_b128 v[60:63], v43 offset:0
    s_waitcnt lgkmcnt(3)
    v_mfma_f32_32x32x16_bf16 v[64:79], a[0:3], v[48:51], 0
    v_mfma_f32_32x32x16_bf16 v[80:95], a[160:163], v[48:51], 0
    ds_read_b128 v[48:51], v44 offset:0
    s_waitcnt lgkmcnt(3)
    v_mfma_f32_32x32x16_bf16 v[64:79], a[4:7], v[52:55], v[64:79]
    s_add_u32 s38, s37, s36
    s_add_u32 m0, s38, 0
    s_nop 0
    buffer_load_dwordx4 v10, s[4:7], s32 offen lds
    v_mfma_f32_32x32x16_bf16 v[80:95], a[164:167], v[52:55], v[80:95]
    ds_read_b128 v[52:55], v45 offset:0
    s_waitcnt lgkmcnt(3)
    v_mfma_f32_32x32x16_bf16 v[64:79], a[8:11], v[56:59], v[64:79]
    v_mfma_f32_32x32x16_bf16 v[80:95], a[168:171], v[56:59], v[80:95]
    ds_read_b128 v[56:59], v46 offset:0
    s_waitcnt lgkmcnt(3)
    v_mfma_f32_32x32x16_bf16 v[64:79], a[12:15], v[60:63], v[64:79]
    v_mfma_f32_32x32x16_bf16 v[80:95], a[172:175], v[60:63], v[80:95]
    ds_read_b128 v[60:63], v47 offset:0
    s_waitcnt lgkmcnt(3)
    v_mfma_f32_32x32x16_bf16 v[64:79], a[16:19], v[48:51], v[64:79]
    v_mfma_f32_32x32x16_bf16 v[80:95], a[176:179], v[48:51], v[80:95]
    ds_read_b128 v[48:51], v40 offset:256
    s_waitcnt lgkmcnt(3)
    v_mfma_f32_32x32x16_bf16 v[64:79], a[20:23], v[52:55], v[64:79]
    s_add_u32 m0, s38, 1024
    s_nop 0
    buffer_load_dwordx4 v11, s[4:7], s32 offen lds
    v_mfma_f32_32x32x16_bf16 v[80:95], a[180:183], v[52:55], v[80:95]
    ds_read_b128 v[52:55], v41 offset:256
    s_waitcnt lgkmcnt(3)
    v_mfma_f32_32x32x16_bf16 v[64:79], a[24:27], v[56:59], v[64:79]
    v_mfma_f32_32x32x16_bf16 v[80:95], a[184:187], v[56:59], v[80:95]
    ds_read_b128 v[56:59], v42 offset:256
    s_waitcnt lgkmcnt(3)
    v_mfma_f32_32x32x16_bf16 v[64:79], a[28:31], v[60:63], v[64:79]
    v_mfma_f32_32x32x16_bf16 v[80:95], a[188:191], v[60:63], v[80:95]
    ds_read_b128 v[60:63], v43 offset:256
    s_waitcnt lgkmcnt(3)
    v_mfma_f32_32x32x16_bf16 v[64:79], a[32:35], v[48:51], v[64:79]
    v_mfma_f32_32x32x16_bf16 v[80:95], a[192:195], v[48:51], v[80:95]
    ds_read_b128 v[48:51], v44 offset:256
    s_waitcnt lgkmcnt(3)
    v_mfma_f32_32x32x16_bf16 v[64:79], a[36:39], v[52:55], v[64:79]
    s_add_u32 m0, s38, 2048
    s_nop 0
    buffer_load_dwordx4 v12, s[4:7], s32 offen lds
    v_mfma_f32_32x32x16_bf16 v[80:95], a[196:199], v[52:55], v[80:95]
    ds_read_b128 v[52:55], v45 offset:256
    s_waitcnt lgkmcnt(3)
    v_mfma_f32_32x32x16_bf16 v[64:79], a[40:43], v[56:59], v[64:79]
    v_mfma_f32_32x32x16_bf16 v[80:95], a[200:203], v[56:59], v[80:95]
    ds_read_b128 v[56:59], v46 offset:256
    s_waitcnt lgkmcnt(3)
    v_mfma_f32_32x32x16_bf16 v[64:79], a[44:47], v[60:63], v[64:79]
    v_mfma_f32_32x32x16_bf16 v[80:95], a[204:207], v[60:63], v[80:95]
    ds_read_b128 v[60:63], v47 offset:256
    s_waitcnt lgkmcnt(3)
    v_mfma_f32_32x32x16_bf16 v[64:79], a[48:51], v[48:51], v[64:79]
    v_mfma_f32_32x32x16_bf16 v[80:95], a[208:211], v[48:51], v[80:95]
    ds_read_b128 v[48:51], v40 offset:512
    s_waitcnt lgkmcnt(3)
    v_mfma_f32_32x32x16_bf16 v[64:79], a[52:55], v[52:55], v[64:79]
    s_add_u32 m0, s38, 3072
    s_nop 0
    buffer_load_dwordx4 v13, s[4:7], s32 offen lds
    v_mfma_f32_32x32x16_bf16 v[80:95], a[212:215], v[52:55], v[80:95]
    ds_read_b128 v[52:55], v41 offset:512
    s_waitcnt lgkmcnt(3)
    v_mfma_f32_32x32x16_bf16 v[64:79], a[56:59], v[56:59], v[64:79]
    v_mfma_f32_32x32x16_bf16 v[80:95], a[216:219], v[56:59], v[80:95]
    ds_read_b128 v[56:59], v42 offset:512
    s_waitcnt lgkmcnt(3)
    v_mfma_f32_32x32x16_bf16 v[64:79], a[60:63], v[60:63], v[64:79]
    v_mfma_f32_32x32x16_bf16 v[80:95], a[220:223], v[60:63], v[80:95]
    ds_read_b128 v[60:63], v43 offset:512
    s_waitcnt lgkmcnt(3)
    v_mfma_f32_32x32x16_bf16 v[64:79], a[64:67], v[48:51], v[64:79]
    v_mfma_f32_32x32x16_bf16 v[80:95], a[224:227], v[48:51], v[80:95]
    ds_read_b128 v[48:51], v44 offset:512
    s_waitcnt lgkmcnt(3)
    v_mfma_f32_32x32x16_bf16 v[64:79], a[68:71], v[52:55], v[64:79]
    s_add_u32 m0, s38, 4096
    s_nop 0
    buffer_load_dwordx4 v14, s[4:7], s32 offen lds
    v_mfma_f32_32x32x16_bf16 v[80:95], a[228:231], v[52:55], v[80:95]
    ds_read_b128 v[52:55], v45 offset:512
    s_waitcnt lgkmcnt(3)
    v_mfma_f32_32x32x16_bf16 v[64:79], a[72:75], v[56:59], v[64:79]
    v_mfma_f32_32x32x16_bf16 v[80:95], a[232:235], v[56:59], v[80:95]
    ds_read_b128 v[56:59], v46 offset:512
    s_waitcnt lgkmcnt(3)
    v_mfma_f32_32x32x16_bf16 v[64:79], a[76:79], v[60:63], v[64:79]
    v_mfma_f32_32x32x16_bf16 v[80:95], a[236:239], v[60:63], v[80:95]
    ds_read_b128 v[60:63], v47 offset:512
    s_waitcnt lgkmcnt(3)
    v_mfma_f32_32x32x16_bf16 v[64:79], a[80:83], v[48:51], v[64:79]
    v_mfma_f32_32x32x16_bf16 v[80:95], a[240:243], v[48:51], v[80:95]
    ds_read_b128 v[48:51], v40 offset:768
    s_waitcnt lgkmcnt(3)
    v_mfma_f32_32x32x16_bf16 v[64:79], a[84:87], v[52:55], v[64:79]
    s_add_u32 m0, s38, 5120
    s_nop 0
    buffer_load_dwordx4 v15, s[4:7], s32 offen lds
    v_mfma_f32_32x32x16_bf16 v[80:95], a[244:247], v[52:55], v[80:95]
    ds_read_b128 v[52:55], v41 offset:768
    s_waitcnt lgkmcnt(3)
    v_mfma_f32_32x32x16_bf16 v[64:79], a[88:91], v[56:59], v[64:79]
    v_mfma_f32_32x32x16_bf16 v[80:95], a[248:251], v[56:59], v[80:95]
    ds_read_b128 v[56:59], v42 offset:768
    s_waitcnt lgkmcnt(3)
    v_mfma_f32_32x32x16_bf16 v[64:79], a[92:95], v[60:63], v[64:79]
    v_mfma_f32_32x32x16_bf16 v[80:95], a[252:255], v[60:63], v[80:95]
    ds_read_b128 v[60:63], v43 offset:768
    s_waitcnt lgkmcnt(3)
    v_mfma_f32_32x32x16_bf16 v[64:79], a[96:99], v[48:51], v[64:79]
    v_mfma_f32_32x32x16_bf16 v[80:95], v[192:195], v[48:51], v[80:95]
    ds_read_b128 v[48:51], v44 offset:768
    s_waitcnt lgkmcnt(3)
    v_mfma_f32_32x32x16_bf16 v[64:79], a[100:103], v[52:55], v[64:79]
    s_add_u32 m0, s38, 6144
    s_nop 0
    buffer_load_dwordx4 v16, s[4:7], s32 offen lds
    v_mfma_f32_32x32x16_bf16 v[80:95], v[196:199], v[52:55], v[80:95]
    ds_read_b128 v[52:55], v45 offset:768
    s_waitcnt lgkmcnt(3)
    v_mfma_f32_32x32x16_bf16 v[64:79], a[104:107], v[56:59], v[64:79]
    v_mfma_f32_32x32x16_bf16 v[80:95], v[200:203], v[56:59], v[80:95]
    ds_read_b128 v[56:59], v46 offset:768
    s_waitcnt lgkmcnt(3)
    v_mfma_f32_32x32x16_bf16 v[64:79], a[108:111], v[60:63], v[64:79]
    v_mfma_f32_32x32x16_bf16 v[80:95], v[204:207], v[60:63], v[80:95]
    ds_read_b128 v[60:63], v47 offset:768
    s_waitcnt lgkmcnt(3)
    v_mfma_f32_32x32x16_bf16 v[64:79], a[112:115], v[48:51], v[64:79]
    v_mfma_f32_32x32x16_bf16 v[80:95], v[208:211], v[48:51], v[80:95]
    ds_read_b128 v[48:51], v40 offset:1024
    s_waitcnt lgkmcnt(3)
    v_mfma_f32_32x32x16_bf16 v[64:79], a[116:119], v[52:55], v[64:79]
    s_add_u32 m0, s38, 7168
    s_nop 0
    buffer_load_dwordx4 v17, s[4:7], s32 offen lds
    v_mfma_f32_32x32x16_bf16 v[80:95], v[212:215], v[52:55], v[80:95]
    ds_read_b128 v[52:55], v41 offset:1024
    s_waitcnt lgkmcnt(3)
    v_mfma_f32_32x32x16_bf16 v[64:79], a[120:123], v[56:59], v[64:79]
    v_mfma_f32_32x32x16_bf16 v[80:95], v[216:219], v[56:59], v[80:95]
    ds_read_b128 v[56:59], v42 offset:1024
    s_waitcnt lgkmcnt(3)
    v_mfma_f32_32x32x16_bf16 v[64:79], a[124:127], v[60:63], v[64:79]
    v_mfma_f32_32x32x16_bf16 v[80:95], v[220:223], v[60:63], v[80:95]
    ds_read_b128 v[60:63], v43 offset:1024
    s_waitcnt lgkmcnt(3)
    v_mfma_f32_32x32x16_bf16 v[64:79], a[128:131], v[48:51], v[64:79]
    v_mfma_f32_32x32x16_bf16 v[80:95], v[224:227], v[48:51], v[80:95]
    ds_read_b128 v[48:51], v44 offset:1024
    s_waitcnt lgkmcnt(3)
    v_mfma_f32_32x32x16_bf16 v[64:79], a[132:135], v[52:55], v[64:79]
    s_add_u32 m0, s38, 8192
    s_nop 0
    buffer_load_dwordx4 v18, s[4:7], s32 offen lds
    v_mfma_f32_32x32x16_bf16 v[80:95], v[228:231], v[52:55], v[80:95]
    ds_read_b128 v[52:55], v45 offset:1024
    s_waitcnt lgkmcnt(3)
    v_mfma_f32_32x32x16_bf16 v[64:79], a[136:139], v[56:59], v[64:79]
    v_mfma_f32_32x32x16_bf16 v[80:95], v[232:235], v[56:59], v[80:95]
    ds_read_b128 v[56:59], v46 offset:1024
    s_waitcnt lgkmcnt(3)
    v_mfma_f32_32x32x16_bf16 v[64:79], a[140:143], v[60:63], v[64:79]
    v_mfma_f32_32x32x16_bf16 v[80:95], v[236:239], v[60:63], v[80:95]
    ds_read_b128 v[60:63], v47 offset:1024
    s_waitcnt lgkmcnt(3)
    v_mfma_f32_32x32x16_bf16 v[64:79], a[144:147], v[48:51], v[64:79]
    v_mfma_f32_32x32x16_bf16 v[80:95], v[240:243], v[48:51], v[80:95]
    s_waitcnt lgkmcnt(2)
    v_mfma_f32_32x32x16_bf16 v[64:79], a[148:151], v[52:55], v[64:79]
    s_add_u32 m0, s38, 9216
    s_nop 0
    buffer_load_dwordx4 v19, s[4:7], s32 offen lds
    v_mfma_f32_32x32x16_bf16 v[80:95], v[244:247], v[52:55], v[80:95]
    s_waitcnt lgkmcnt(1)
    v_mfma_f32_32x32x16_bf16 v[64:79], a[152:155], v[56:59], v[64:79]
    v_mfma_f32_32x32x16_bf16 v[80:95], v[248:251], v[56:59], v[80:95]
    s_waitcnt lgkmcnt(0)
    v_mfma_f32_32x32x16_bf16 v[64:79], a[156:159], v[60:63], v[64:79]
    v_mfma_f32_32x32x16_bf16 v[80:95], v[252:255], v[60:63], v[80:95]
    s_add_u32 s32, s32, 40960
    s_add_u32 s33, s33, 1
    s_mov_b32 s38, s34
    s_mov_b32 s34, s35
    s_mov_b32 s35, s36
    s_mov_b32 s36, s38
    s_cmp_ge_u32 s33, s19
    s_cbranch_scc1 L_pfa_201
    s_waitcnt vmcnt(10)
    s_barrier
L_ploop_200:
    v_add_u32 v40, s34, v20
    v_add_u32 v41, s34, v21
    v_add_u32 v42, s34, v22
    v_add_u32 v43, s34, v23
    v_add_u32 v44, s34, v24
    v_add_u32 v45, s34, v25
    v_add_u32 v46, s34, v26
    v_add_u32 v47, s34, v27
    ds_read_b128 v[48:51], v40 offset:0
    ds_read_b128 v[52:55], v41 offset:0
    ds_read_b128 v[56:59], v42 offset:0
    ds_read_b128 v[60:63], v43 offset:0
    s_waitcnt lgkmcnt(3)
    v_mfma_f32_32x32x16_bf16 v[96:111], a[0:3], v[48:51], 0
    v_mfma_f32_32x32x16_bf16 v[112:127], a[160:163], v[48:51], 0
    ds_read_b128 v[48:51], v44 offset:0
    s_waitcnt lgkmcnt(3)
    v_mfma_f32_32x32x16_bf16 v[96:111], a[4:7], v[52:55], v[96:111]
    s_add_u32 s38, s37, s36
    s_add_u32 m0, s38, 0
    s_nop 0
    buffer_load_dwordx4 v10, s[4:7], s32 offen lds
    v_mfma_f32_32x32x16_bf16 v[112:127], a[164:167], v[52:55], v[112:127]
    ds_read_b128 v[52:55], v45 offset:0
    s_waitcnt lgkmcnt(3)
    v_mfma_f32_32x32x16_bf16 v[96:111], a[8:11], v[56:59], v[96:111]
    v_mfma_f32_32x32x16_bf16 v[112:127], a[168:171], v[56:59], v[112:127]
    ds_read_b128 v[56:59], v46 offset:0
    s_waitcnt lgkmcnt(3)
    v_mfma_f32_32x32x16_bf16 v[96:111], a[12:15], v[60:63], v[96:111]
    v_cvt_pk_bf16_f32 v136, v64, v65
    v_mfma_f32_32x32x16_bf16 v[112:127], a[172:175], v[60:63], v[112:127]
    v_cvt_pk_bf16_f32 v137, v66, v67
    ds_read_b128 v[60:63], v47 offset:0
    s_waitcnt lgkmcnt(3)
    v_mfma_f32_32x32x16_bf16 v[96:111], a[16:19], v[48:51], v[96:111]
    v_cvt_pk_bf16_f32 v138, v68, v69
    v_mfma_f32_32x32x16_bf16 v[112:127], a[176:179], v[48:51], v[112:127]
    v_cvt_pk_bf16_f32 v139, v70, v71
    ds_read_b128 v[48:51], v40 offset:256
    s_waitcnt lgkmcnt(3)
    v_mfma_f32_32x32x16_bf16 v[96:111], a[20:23], v[52:55], v[96:111]
    v_xor_b32 v134, 0, v28
    v_permlane32_swap_b32 v136, v138
    v_permlane32_swap_b32 v137, v139
    ds_write_b128 v134, v[136:139]
    v_mfma_f32_32x32x16_bf16 v[112:127], a[180:183], v[52:55], v[112:127]
    s_add_u32 m0, s38, 1024
    s_nop 0
    buffer_load_dwordx4 v11, s[4:7], s32 offen lds
    ds_read_b128 v[52:55], v41 offset:256
    s_waitcnt lgkmcnt(4)
    v_mfma_f32_32x32x16_bf16 v[96:111], a[24:27], v[56:59], v[96:111]
    v_cvt_pk_bf16_f32 v140, v72, v73
    v_mfma_f32_32x32x16_bf16 v[112:127], a[184:187], v[56:59], v[112:127]
    v_cvt_pk_bf16_f32 v141, v74, v75
    ds_read_b128 v[56:59], v42 offset:256
    s_waitcnt lgkmcnt(4)
    v_mfma_f32_32x32x16_bf16 v[96:111], a[28:31], v[60:63], v[96:111]
    v_cvt_pk_bf16_f32 v142, v76, v77
    v_mfma_f32_32x32x16_bf16 v[112:127], a[188:191], v[60:63], v[112:127]
    v_cvt_pk_bf16_f32 v143, v78, v79
    ds_read_b128 v[60:63], v43 offset:256
    s_waitcnt lgkmcnt(4)
    v_mfma_f32_32x32x16_bf16 v[96:111], a[32:35], v[48:51], v[96:111]
    v_xor_b32 v134, 32, v28
    v_permlane32_swap_b32 v140, v142
    v_permlane32_swap_b32 v141, v143
    v_mfma_f32_32x32x16_bf16 v[112:127], a[192:195], v[48:51], v[112:127]
    ds_write_b128 v134, v[140:143]
    ds_read_b128 v[48:51], v44 offset:256
    s_waitcnt lgkmcnt(4)
    v_mfma_f32_32x32x16_bf16 v[96:111], a[36:39], v[52:55], v[96:111]
    v_cvt_pk_bf16_f32 v136, v80, v81
    v_cvt_pk_bf16_f32 v137, v82, v83
    v_mfma_f32_32x32x16_bf16 v[112:127], a[196:199], v[52:55], v[112:127]
    s_add_u32 m0, s38, 2048
    s_nop 0
    buffer_load_dwordx4 v12, s[4:7], s32 offen lds
    ds_read_b128 v[52:55], v45 offset:256
    s_waitcnt lgkmcnt(4)
    v_mfma_f32_32x32x16_bf16 v[96:111], a[40:43], v[56:59], v[96:111]
    v_cvt_pk_bf16_f32 v138, v84, v85
    v_mfma_f32_32x32x16_bf16 v[112:127], a[200:203], v[56:59], v[112:127]
    v_cvt_pk_bf16_f32 v139, v86, v87
    ds_read_b128 v[56:59], v46 offset:256
    s_waitcnt lgkmcnt(4)
    v_mfma_f32_32x32x16_bf16 v[96:111], a[44:47], v[60:63], v[96:111]
    v_xor_b32 v134, 64, v28
    v_permlane32_swap_b32 v136, v138
    v_permlane32_swap_b32 v137, v139
    v_mfma_f32_32x32x16_bf16 v[112:127], a[204:207], v[60:63], v[112:127]
    ds_write_b128 v134, v[136:139]
    ds_read_b128 v[60:63], v47 offset:256
    s_waitcnt lgkmcnt(4)
    v_mfma_f32_32x32x16_bf16 v[96:111], a[48:51], v[48:51], v[96:111]
    v_cvt_pk_bf16_f32 v140, v88, v89
    v_mfma_f32_32x32x16_bf16 v[112:127], a[208:211], v[48:51], v[112:127]
    v_cvt_pk_bf16_f32 v141, v90, v91
    ds_read_b128 v[48:51], v40 offset:512
    s_waitcnt lgkmcnt(4)
    v_mfma_f32_32x32x16_bf16 v[96:111], a[52:55], v[52:55], v[96:111]
    v_cvt_pk_bf16_f32 v142, v92, v93
    v_cvt_pk_bf16_f32 v143, v94, v95
    v_mfma_f32_32x32x16_bf16 v[112:127], a[212:215], v[52:55], v[112:127]
    s_add_u32 m0, s38, 3072
    s_nop 0
    buffer_load_dwordx4 v13, s[4:7], s32 offen lds
    ds_read_b128 v[52:55], v41 offset:512
    s_waitcnt lgkmcnt(4)
    v_mfma_f32_32x32x16_bf16 v[96:111], a[56:59], v[56:59], v[96:111]
    v_xor_b32 v134, 96, v28
    v_permlane32_swap_b32 v140, v142
    v_permlane32_swap_b32 v141, v143
    v_mfma_f32_32x32x16_bf16 v[112:127], a[216:219], v[56:59], v[112:127]
    ds_write_b128 v134, v[140:143]
    ds_read_b128 v[56:59], v42 offset:512
    s_waitcnt lgkmcnt(4)
    v_mfma_f32_32x32x16_bf16 v[96:111], a[60:63], v[60:63], v[96:111]
    v_mfma_f32_32x32x16_bf16 v[112:127], a[220:223], v[60:63], v[112:127]
    ds_read_b128 v[60:63], v43 offset:512
    s_waitcnt lgkmcnt(4)
    v_mfma_f32_32x32x16_bf16 v[96:111], a[64:67], v[48:51], v[96:111]
    v_mfma_f32_32x32x16_bf16 v[112:127], a[224:227], v[48:51], v[112:127]
    ds_read_b128 v[48:51], v44 offset:512
    s_waitcnt lgkmcnt(4)
    v_mfma_f32_32x32x16_bf16 v[96:111], a[68:71], v[52:55], v[96:111]
    s_waitcnt lgkmcnt(3)
    ds_read_b128 v[144:147], v29 offset:0
    v_mfma_f32_32x32x16_bf16 v[112:127], a[228:231], v[52:55], v[112:127]
    s_add_u32 m0, s38, 4096
    s_nop 0
    buffer_load_dwordx4 v14, s[4:7], s32 offen lds
    ds_read_b128 v[52:55], v45 offset:512
    s_waitcnt lgkmcnt(4)
    v_mfma_f32_32x32x16_bf16 v[96:111], a[72:75], v[56:59], v[96:111]
    v_mfma_f32_32x32x16_bf16 v[112:127], a[232:235], v[56:59], v[112:127]
    ds_read_b128 v[56:59], v46 offset:512
    s_waitcnt lgkmcnt(4)
    v_mfma_f32_32x32x16_bf16 v[96:111], a[76:79], v[60:63], v[96:111]
    v_mfma_f32_32x32x16_bf16 v[112:127], a[236:239], v[60:63], v[112:127]
    ds_read_b128 v[60:63], v47 offset:512
    s_waitcnt lgkmcnt(4)
    v_mfma_f32_32x32x16_bf16 v[96:111], a[80:83], v[48:51], v[96:111]
    s_waitcnt lgkmcnt(3)
    buffer_store_dwordx4 v[144:147], v30, s[4:7], s31 offen offset:0 sc1
    v_mfma_f32_32x32x16_bf16 v[112:127], a[240:243], v[48:51], v[112:127]
    ds_read_b128 v[48:51], v40 offset:768
    s_waitcnt lgkmcnt(3)
    v_mfma_f32_32x32x16_bf16 v[96:111], a[84:87], v[52:55], v[96:111]
    ds_read_b128 v[148:151], v29 offset:1024
    v_mfma_f32_32x32x16_bf16 v[112:127], a[244:247], v[52:55], v[112:127]
    s_add_u32 m0, s38, 5120
    s_nop 0
    buffer_load_dwordx4 v15, s[4:7], s32 offen lds
    ds_read_b128 v[52:55], v41 offset:768
    s_waitcnt lgkmcnt(4)
    v_mfma_f32_32x32x16_bf16 v[96:111], a[88:91], v[56:59], v[96:111]
    v_mfma_f32_32x32x16_bf16 v[112:127], a[248:251], v[56:59], v[112:127]
    ds_read_b128 v[56:59], v42 offset:768
    s_waitcnt lgkmcnt(4)
    v_mfma_f32_32x32x16_bf16 v[96:111], a[92:95], v[60:63], v[96:111]
    v_mfma_f32_32x32x16_bf16 v[112:127], a[252:255], v[60:63], v[112:127]
    ds_read_b128 v[60:63], v43 offset:768
    s_waitcnt lgkmcnt(4)
    v_mfma_f32_32x32x16_bf16 v[96:111], a[96:99], v[48:51], v[96:111]
    s_waitcnt lgkmcnt(3)
    s_add_u32 s39, s31, 98304
    buffer_store_dwordx4 v[148:151], v30, s[4:7], s39 offen sc1
    v_mfma_f32_32x32x16_bf16 v[112:127], v[192:195], v[48:51], v[112:127]
    ds_read_b128 v[48:51], v44 offset:768
    s_waitcnt lgkmcnt(3)
    v_mfma_f32_32x32x16_bf16 v[96:111], a[100:103], v[52:55], v[96:111]
    ds_read_b128 v[152:155], v29 offset:2048
    v_mfma_f32_32x32x16_bf16 v[112:127], v[196:199], v[52:55], v[112:127]
    s_add_u32 m0, s38, 6144
    s_nop 0
    buffer_load_dwordx4 v16, s[4:7], s32 offen lds
    ds_read_b128 v[52:55], v45 offset:768
    s_waitcnt lgkmcnt(4)
    v_mfma_f32_32x32x16_bf16 v[96:111], a[104:107], v[56:59], v[96:111]
    v_mfma_f32_32x32x16_bf16 v[112:127], v[200:203], v[56:59], v[112:127]
    ds_read_b128 v[56:59], v46 offset:768
    s_waitcnt lgkmcnt(4)
    v_mfma_f32_32x32x16_bf16 v[96:111], a[108:111], v[60:63], v[96:111]
    v_mfma_f32_32x32x16_bf16 v[112:127], v[204:207], v[60:63], v[112:127]
    ds_read_b128 v[60:63], v47 offset:768
    s_waitcnt lgkmcnt(4)
    v_mfma_f32_32x32x16_bf16 v[96:111], a[112:115], v[48:51], v[96:111]
    s_waitcnt lgkmcnt(3)
    s_add_u32 s39, s31, 196608
    buffer_store_dwordx4 v[152:155], v30, s[4:7], s39 offen sc1
    v_mfma_f32_32x32x16_bf16 v[112:127], v[208:211], v[48:51], v[112:127]
    ds_read_b128 v[48:51], v40 offset:1024
    s_waitcnt lgkmcnt(3)
    v_mfma_f32_32x32x16_bf16 v[96:111], a[116:119], v[52:55], v[96:111]
    ds_read_b128 v[156:159], v29 offset:3072
    v_mfma_f32_32x32x16_bf16 v[112:127], v[212:215], v[52:55], v[112:127]
    s_add_u32 m0, s38, 7168
    s_nop 0
    buffer_load_dwordx4 v17, s[4:7], s32 offen lds
    ds_read_b128 v[52:55], v41 offset:1024
    s_waitcnt lgkmcnt(4)
    v_mfma_f32_32x32x16_bf16 v[96:111], a[120:123], v[56:59], v[96:111]
    v_mfma_f32_32x32x16_bf16 v[112:127], v[216:219], v[56:59], v[112:127]
    ds_read_b128 v[56:59], v42 offset:1024
    s_waitcnt lgkmcnt(4)
    v_mfma_f32_32x32x16_bf16 v[96:111], a[124:127], v[60:63], v[96:111]
    v_mfma_f32_32x32x16_bf16 v[112:127], v[220:223], v[60:63], v[112:127]
    ds_read_b128 v[60:63], v43 offset:1024
    s_waitcnt lgkmcnt(4)
    v_mfma_f32_32x32x16_bf16 v[96:111], a[128:131], v[48:51], v[96:111]
    s_waitcnt lgkmcnt(3)
    s_add_u32 s39, s31, 294912
    buffer_store_dwordx4 v[156:159], v30, s[4:7], s39 offen sc1
    v_mfma_f32_32x32x16_bf16 v[112:127], v[224:227], v[48:51], v[112:127]
    ds_read_b128 v[48:51], v44 offset:1024
    s_waitcnt lgkmcnt(3)
    v_mfma_f32_32x32x16_bf16 v[96:111], a[132:135], v[52:55], v[96:111]
    s_add_u32 m0, s38, 8192
    s_nop 0
    buffer_load_dwordx4 v18, s[4:7], s32 offen lds
    v_mfma_f32_32x32x16_bf16 v[112:127], v[228:231], v[52:55], v[112:127]
    ds_read_b128 v[52:55], v45 offset:1024
    s_waitcnt lgkmcnt(3)
    v_mfma_f32_32x32x16_bf16 v[96:111], a[136:139], v[56:59], v[96:111]
    v_mfma_f32_32x32x16_bf16 v[112:127], v[232:235], v[56:59], v[112:127]
    ds_read_b128 v[56:59], v46 offset:1024
    s_waitcnt lgkmcnt(3)
    v_mfma_f32_32x32x16_bf16 v[96:111], a[140:143], v[60:63], v[96:111]
    v_mfma_f32_32x32x16_bf16 v[112:127], v[236:239], v[60:63], v[112:127]
    ds_read_b128 v[60:63], v47 offset:1024
    s_waitcnt lgkmcnt(3)
    v_mfma_f32_32x32x16_bf16 v[96:111], a[144:147], v[48:51], v[96:111]
    v_mfma_f32_32x32x16_bf16 v[112:127], v[240:243], v[48:51], v[112:127]
    s_waitcnt lgkmcnt(2)
    v_mfma_f32_32x32x16_bf16 v[96:111], a[148:151], v[52:55], v[96:111]
    s_add_u32 m0, s38, 9216
    s_nop 0
    buffer_load_dwordx4 v19, s[4:7], s32 offen lds
    v_mfma_f32_32x32x16_bf16 v[112:127], v[244:247], v[52:55], v[112:127]
    s_waitcnt lgkmcnt(1)
    v_mfma_f32_32x32x16_bf16 v[96:111], a[152:155], v[56:59], v[96:111]
    v_mfma_f32_32x32x16_bf16 v[112:127], v[248:251], v[56:59], v[112:127]
    s_waitcnt lgkmcnt(0)
    v_mfma_f32_32x32x16_bf16 v[96:111], a[156:159], v[60:63], v[96:111]
    v_mfma_f32_32x32x16_bf16 v[112:127], v[252:255], v[60:63], v[112:127]
    s_add_u32 s32, s32, 40960
    s_add_u32 s31, s31, s30
    s_add_u32 s33, s33, 1
    s_mov_b32 s38, s34
    s_mov_b32 s34, s35
    s_mov_b32 s35, s36
    s_mov_b32 s36, s38
    s_cmp_ge_u32 s33, s19
    s_cbranch_scc1 L_pfb_202
    s_waitcnt vmcnt(14)
    s_barrier
    s_sub_u32 s39, s33, 2
    s_cmp_lg_u32 s16, 0
    s_cbranch_scc1 L_pp_203
    v_mov_b32 v9, s39
    s_mov_b64 exec, 1
    buffer_store_dword v9, v31, s[4:7], 0 offen sc1
    s_mov_b64 exec, -1
L_pp_203:
    v_add_u32 v40, s34, v20
    v_add_u32 v41, s34, v21
    v_add_u32 v42, s34, v22
    v_add_u32 v43, s34, v23
    v_add_u32 v44, s34, v24
    v_add_u32 v45, s34, v25
    v_add_u32 v46, s34, v26
    v_add_u32 v47, s34, v27
    ds_read_b128 v[48:51], v40 offset:0
    ds_read_b128 v[52:55], v41 offset:0
    ds_read_b128 v[56:59], v42 offset:0
    ds_read_b128 v[60:63], v43 offset:0
    s_waitcnt lgkmcnt(3)
    v_mfma_f32_32x32x16_bf16 v[64:79], a[0:3], v[48:51], 0
    v_mfma_f32_32x32x16_bf16 v[80:95], a[160:163], v[48:51], 0
    ds_read_b128 v[48:51], v44 offset:0
    s_waitcnt lgkmcnt(3)
    v_mfma_f32_32x32x16_bf16 v[64:79], a[4:7], v[52:55], v[64:79]
    s_add_u32 s38, s37, s36
    s_add_u32 m0, s38, 0
    s_nop 0
    buffer_load_dwordx4 v10, s[4:7], s32 offen lds
    v_mfma_f32_32x32x16_bf16 v[80:95], a[164:167], v[52:55], v[80:95]
    ds_read_b128 v[52:55], v45 offset:0
    s_waitcnt lgkmcnt(3)
    v_mfma_f32_32x32x16_bf16 v[64:79], a[8:11], v[56:59], v[64:79]
    v_mfma_f32_32x32x16_bf16 v[80:95], a[168:171], v[56:59], v[80:95]
    ds_read_b128 v[56:59], v46 offset:0
    s_waitcnt lgkmcnt(3)
    v_mfma_f32_32x32x16_bf16 v[64:79], a[12:15], v[60:63], v[64:79]
    v_cvt_pk_bf16_f32 v136, v96, v97
    v_mfma_f32_32x32x16_bf16 v[80:95], a[172:175], v[60:63], v[80:95]
    v_cvt_pk_bf16_f32 v137, v98, v99
    ds_read_b128 v[60:63], v47 offset:0
    s_waitcnt lgkmcnt(3)
    v_mfma_f32_32x32x16_bf16 v[64:79], a[16:19], v[48:51], v[64:79]
    v_cvt_pk_bf16_f32 v138, v100, v101
    v_mfma_f32_32x32x16_bf16 v[80:95], a[176:179], v[48:51], v[80:95]
    v_cvt_pk_bf16_f32 v139, v102, v103
    ds_read_b128 v[48:51], v40 offset:256
    s_waitcnt lgkmcnt(3)
    v_mfma_f32_32x32x16_bf16 v[64:79], a[20:23], v[52:55], v[64:79]
    v_xor_b32 v134, 0, v28
    v_permlane32_swap_b32 v136, v138
    v_permlane32_swap_b32 v137, v139
    ds_write_b128 v134, v[136:139]
    v_mfma_f32_32x32x16_bf16 v[80:95], a[180:183], v[52:55], v[80:95]
    s_add_u32 m0, s38, 1024
    s_nop 0
    buffer_load_dwordx4 v11, s[4:7], s32 offen lds
    ds_read_b128 v[52:55], v41 offset:256
    s_waitcnt lgkmcnt(4)
    v_mfma_f32_32x32x16_bf16 v[64:79], a[24:27], v[56:59], v[64:79]
    v_cvt_pk_bf16_f32 v140, v104, v105
    v_mfma_f32_32x32x16_bf16 v[80:95], a[184:187], v[56:59], v[80:95]
    v_cvt_pk_bf16_f32 v141, v106, v107
    ds_read_b128 v[56:59], v42 offset:256
    s_waitcnt lgkmcnt(4)
    v_mfma_f32_32x32x16_bf16 v[64:79], a[28:31], v[60:63], v[64:79]
    v_cvt_pk_bf16_f32 v142, v108, v109
    v_mfma_f32_32x32x16_bf16 v[80:95], a[188:191], v[60:63], v[80:95]
    v_cvt_pk_bf16_f32 v143, v110, v111
    ds_read_b128 v[60:63], v43 offset:256
    s_waitcnt lgkmcnt(4)
    v_mfma_f32_32x32x16_bf16 v[64:79], a[32:35], v[48:51], v[64:79]
    v_xor_b32 v134, 32, v28
    v_permlane32_swap_b32 v140, v142
    v_permlane32_swap_b32 v141, v143
    v_mfma_f32_32x32x16_bf16 v[80:95], a[192:195], v[48:51], v[80:95]
    ds_write_b128 v134, v[140:143]
    ds_read_b128 v[48:51], v44 offset:256
    s_waitcnt lgkmcnt(4)
    v_mfma_f32_32x32x16_bf16 v[64:79], a[36:39], v[52:55], v[64:79]
    v_cvt_pk_bf16_f32 v136, v112, v113
    v_cvt_pk_bf16_f32 v137, v114, v115
    v_mfma_f32_32x32x16_bf16 v[80:95], a[196:199], v[52:55], v[80:95]
    s_add_u32 m0, s38, 2048
    s_nop 0
    buffer_load_dwordx4 v12, s[4:7], s32 offen lds
    ds_read_b128 v[52:55], v45 offset:256
    s_waitcnt lgkmcnt(4)
    v_mfma_f32_32x32x16_bf16 v[64:79], a[40:43], v[56:59], v[64:79]
    v_cvt_pk_bf16_f32 v138, v116, v117
    v_mfma_f32_32x32x16_bf16 v[80:95], a[200:203], v[56:59], v[80:95]
    v_cvt_pk_bf16_f32 v139, v118, v119
    ds_read_b128 v[56:59], v46 offset:256
    s_waitcnt lgkmcnt(4)
    v_mfma_f32_32x32x16_bf16 v[64:79], a[44:47], v[60:63], v[64:79]
    v_xor_b32 v134, 64, v28
    v_permlane32_swap_b32 v136, v138
    v_permlane32_swap_b32 v137, v139
    v_mfma_f32_32x32x16_bf16 v[80:95], a[204:207], v[60:63], v[80:95]
    ds_write_b128 v134, v[136:139]
    ds_read_b128 v[60:63], v47 offset:256
    s_waitcnt lgkmcnt(4)
    v_mfma_f32_32x32x16_bf16 v[64:79], a[48:51], v[48:51], v[64:79]
    v_cvt_pk_bf16_f32 v140, v120, v121
    v_mfma_f32_32x32x16_bf16 v[80:95], a[208:211], v[48:51], v[80:95]
    v_cvt_pk_bf16_f32 v141, v122, v123
    ds_read_b128 v[48:51], v40 offset:512
    s_waitcnt lgkmcnt(4)
    v_mfma_f32_32x32x16_bf16 v[64:79], a[52:55], v[52:55], v[64:79]
    v_cvt_pk_bf16_f32 v142, v124, v125
    v_cvt_pk_bf16_f32 v143, v126, v127
    v_mfma_f32_32x32x16_bf16 v[80:95], a[212:215], v[52:55], v[80:95]
    s_add_u32 m0, s38, 3072
    s_nop 0
    buffer_load_dwordx4 v13, s[4:7], s32 offen lds
    ds_read_b128 v[52:55], v41 offset:512
    s_waitcnt lgkmcnt(4)
    v_mfma_f32_32x32x16_bf16 v[64:79], a[56:59], v[56:59], v[64:79]
    v_xor_b32 v134, 96, v28
    v_permlane32_swap_b32 v140, v142
    v_permlane32_swap_b32 v141, v143
    v_mfma_f32_32x32x16_bf16 v[80:95], a[216:219], v[56:59], v[80:95]
    ds_write_b128 v134, v[140:143]
    ds_read_b128 v[56:59], v42 offset:512
    s_waitcnt lgkmcnt(4)
    v_mfma_f32_32x32x16_bf16 v[64:79], a[60:63], v[60:63], v[64:79]
    v_mfma_f32_32x32x16_bf16 v[80:95], a[220:223], v[60:63], v[80:95]
    ds_read_b128 v[60:63], v43 offset:512
    s_waitcnt lgkmcnt(4)
    v_mfma_f32_32x32x16_bf16 v[64:79], a[64:67], v[48:51], v[64:79]
    v_mfma_f32_32x32x16_bf16 v[80:95], a[224:227], v[48:51], v[80:95]
    ds_read_b128 v[48:51], v44 offset:512
    s_waitcnt lgkmcnt(4)
    v_mfma_f32_32x32x16_bf16 v[64:79], a[68:71], v[52:55], v[64:79]
    s_waitcnt lgkmcnt(3)
    ds_read_b128 v[144:147], v29 offset:0
    v_mfma_f32_32x32x16_bf16 v[80:95], a[228:231], v[52:55], v[80:95]
    s_add_u32 m0, s38, 4096
    s_nop 0
    buffer_load_dwordx4 v14, s[4:7], s32 offen lds
    ds_read_b128 v[52:55], v45 offset:512
    s_waitcnt lgkmcnt(4)
    v_mfma_f32_32x32x16_bf16 v[64:79], a[72:75], v[56:59], v[64:79]
    v_mfma_f32_32x32x16_bf16 v[80:95], a[232:235], v[56:59], v[80:95]
    ds_read_b128 v[56:59], v46 offset:512
    s_waitcnt lgkmcnt(4)
    v_mfma_f32_32x32x16_bf16 v[64:79], a[76:79], v[60:63], v[64:79]
    v_mfma_f32_32x32x16_bf16 v[80:95], a[236:239], v[60:63], v[80:95]
    ds_read_b128 v[60:63], v47 offset:512
    s_waitcnt lgkmcnt(4)
    v_mfma_f32_32x32x16_bf16 v[64:79], a[80:83], v[48:51], v[64:79]
    s_waitcnt lgkmcnt(3)
    buffer_store_dwordx4 v[144:147], v30, s[4:7], s31 offen offset:0 sc1
    v_mfma_f32_32x32x16_bf16 v[80:95], a[240:243], v[48:51], v[80:95]
    ds_read_b128 v[48:51], v40 offset:768
    s_waitcnt lgkmcnt(3)
    v_mfma_f32_32x32x16_bf16 v[64:79], a[84:87], v[52:55], v[64:79]
    ds_read_b128 v[148:151], v29 offset:1024
    v_mfma_f32_32x32x16_bf16 v[80:95], a[244:247], v[52:55], v[80:95]
    s_add_u32 m0, s38, 5120
    s_nop 0
    buffer_load_dwordx4 v15, s[4:7], s32 offen lds
    ds_read_b128 v[52:55], v41 offset:768
    s_waitcnt lgkmcnt(4)
    v_mfma_f32_32x32x16_bf16 v[64:79], a[88:91], v[56:59], v[64:79]
    v_mfma_f32_32x32x16_bf16 v[80:95], a[248:251], v[56:59], v[80:95]
    ds_read_b128 v[56:59], v42 offset:768
    s_waitcnt lgkmcnt(4)
    v_mfma_f32_32x32x16_bf16 v[64:79], a[92:95], v[60:63], v[64:79]
    v_mfma_f32_32x32x16_bf16 v[80:95], a[252:255], v[60:63], v[80:95]
    ds_read_b128 v[60:63], v43 offset:768
    s_waitcnt lgkmcnt(4)
    v_mfma_f32_32x32x16_bf16 v[64:79], a[96:99], v[48:51], v[64:79]
    s_waitcnt lgkmcnt(3)
    s_add_u32 s39, s31, 98304
    buffer_store_dwordx4 v[148:151], v30, s[4:7], s39 offen sc1
    v_mfma_f32_32x32x16_bf16 v[80:95], v[192:195], v[48:51], v[80:95]
    ds_read_b128 v[48:51], v44 offset:768
    s_waitcnt lgkmcnt(3)
    v_mfma_f32_32x32x16_bf16 v[64:79], a[100:103], v[52:55], v[64:79]
    ds_read_b128 v[152:155], v29 offset:2048
    v_mfma_f32_32x32x16_bf16 v[80:95], v[196:199], v[52:55], v[80:95]
    s_add_u32 m0, s38, 6144
    s_nop 0
    buffer_load_dwordx4 v16, s[4:7], s32 offen lds
    ds_read_b128 v[52:55], v45 offset:768
    s_waitcnt lgkmcnt(4)
    v_mfma_f32_32x32x16_bf16 v[64:79], a[104:107], v[56:59], v[64:79]
    v_mfma_f32_32x32x16_bf16 v[80:95], v[200:203], v[56:59], v[80:95]
    ds_read_b128 v[56:59], v46 offset:768
    s_waitcnt lgkmcnt(4)
    v_mfma_f32_32x32x16_bf16 v[64:79], a[108:111], v[60:63], v[64:79]
    v_mfma_f32_32x32x16_bf16 v[80:95], v[204:207], v[60:63], v[80:95]
    ds_read_b128 v[60:63], v47 offset:768
    s_waitcnt lgkmcnt(4)
    v_mfma_f32_32x32x16_bf16 v[64:79], a[112:115], v[48:51], v[64:79]
    s_waitcnt lgkmcnt(3)
    s_add_u32 s39, s31, 196608
    buffer_store_dwordx4 v[152:155], v30, s[4:7], s39 offen sc1
    v_mfma_f32_32x32x16_bf16 v[80:95], v[208:211], v[48:51], v[80:95]
    ds_read_b128 v[48:51], v40 offset:1024
    s_waitcnt lgkmcnt(3)
    v_mfma_f32_32x32x16_bf16 v[64:79], a[116:119], v[52:55], v[64:79]
    ds_read_b128 v[156:159], v29 offset:3072
    v_mfma_f32_32x32x16_bf16 v[80:95], v[212:215], v[52:55], v[80:95]
    s_add_u32 m0, s38, 7168
    s_nop 0
    buffer_load_dwordx4 v17, s[4:7], s32 offen lds
    ds_read_b128 v[52:55], v41 offset:1024
    s_waitcnt lgkmcnt(4)
    v_mfma_f32_32x32x16_bf16 v[64:79], a[120:123], v[56:59], v[64:79]
    v_mfma_f32_32x32x16_bf16 v[80:95], v[216:219], v[56:59], v[80:95]
    ds_read_b128 v[56:59], v42 offset:1024
    s_waitcnt lgkmcnt(4)
    v_mfma_f32_32x32x16_bf16 v[64:79], a[124:127], v[60:63], v[64:79]
    v_mfma_f32_32x32x16_bf16 v[80:95], v[220:223], v[60:63], v[80:95]
    ds_read_b128 v[60:63], v43 offset:1024
    s_waitcnt lgkmcnt(4)
    v_mfma_f32_32x32x16_bf16 v[64:79], a[128:131], v[48:51], v[64:79]
    s_waitcnt lgkmcnt(3)
    s_add_u32 s39, s31, 294912
    buffer_store_dwordx4 v[156:159], v30, s[4:7], s39 offen sc1
    v_mfma_f32_32x32x16_bf16 v[80:95], v[224:227], v[48:51], v[80:95]
    ds_read_b128 v[48:51], v44 offset:1024
    s_waitcnt lgkmcnt(3)
    v_mfma_f32_32x32x16_bf16 v[64:79], a[132:135], v[52:55], v[64:79]
    s_add_u32 m0, s38, 8192
    s_nop 0
    buffer_load_dwordx4 v18, s[4:7], s32 offen lds
    v_mfma_f32_32x32x16_bf16 v[80:95], v[228:231], v[52:55], v[80:95]
    ds_read_b128 v[52:55], v45 offset:1024
    s_waitcnt lgkmcnt(3)
    v_mfma_f32_32x32x16_bf16 v[64:79], a[136:139], v[56:59], v[64:79]
    v_mfma_f32_32x32x16_bf16 v[80:95], v[232:235], v[56:59], v[80:95]
    ds_read_b128 v[56:59], v46 offset:1024
    s_waitcnt lgkmcnt(3)
    v_mfma_f32_32x32x16_bf16 v[64:79], a[140:143], v[60:63], v[64:79]
    v_mfma_f32_32x32x16_bf16 v[80:95], v[236:239], v[60:63], v[80:95]
    ds_read_b128 v[60:63], v47 offset:1024
    s_waitcnt lgkmcnt(3)
    v_mfma_f32_32x32x16_bf16 v[64:79], a[144:147], v[48:51], v[64:79]
    v_mfma_f32_32x32x16_bf16 v[80:95], v[240:243], v[48:51], v[80:95]
    s_waitcnt lgkmcnt(2)
    v_mfma_f32_32x32x16_bf16 v[64:79], a[148:151], v[52:55], v[64:79]
    s_add_u32 m0, s38, 9216
    s_nop 0
    buffer_load_dwordx4 v19, s[4:7], s32 offen lds
    v_mfma_f32_32x32x16_bf16 v[80:95], v[244:247], v[52:55], v[80:95]
    s_waitcnt lgkmcnt(1)
    v_mfma_f32_32x32x16_bf16 v[64:79], a[152:155], v[56:59], v[64:79]
    v_mfma_f32_32x32x16_bf16 v[80:95], v[248:251], v[56:59], v[80:95]
    s_waitcnt lgkmcnt(0)
    v_mfma_f32_32x32x16_bf16 v[64:79], a[156:159], v[60:63], v[64:79]
    v_mfma_f32_32x32x16_bf16 v[80:95], v[252:255], v[60:63], v[80:95]
    s_add_u32 s32, s32, 40960
    s_add_u32 s31, s31, s30
    s_add_u32 s33, s33, 1
    s_mov_b32 s38, s34
    s_mov_b32 s34, s35
    s_mov_b32 s35, s36
    s_mov_b32 s36, s38
    s_cmp_ge_u32 s33, s19
    s_cbranch_scc1 L_pfa_201
    s_waitcnt vmcnt(14)
    s_barrier
    s_sub_u32 s39, s33, 2
    s_cmp_lg_u32 s16, 0
    s_cbranch_scc1 L_pp_204
    v_mov_b32 v9, s39
    s_mov_b64 exec, 1
    buffer_store_dword v9, v31, s[4:7], 0 offen sc1
    s_mov_b64 exec, -1
L_pp_204:
    s_branch L_ploop_200
L_pfa_201:
    s_nop 7
    s_nop 3
    v_cvt_pk_bf16_f32 v136, v64, v65
    v_cvt_pk_bf16_f32 v137, v66, v67
    v_cvt_pk_bf16_f32 v138, v68, v69
    v_cvt_pk_bf16_f32 v139, v70, v71
    v_xor_b32 v134, 0, v28
    v_permlane32_swap_b32 v136, v138
    v_permlane32_swap_b32 v137, v139
    ds_write_b128 v134, v[136:139]
    v_cvt_pk_bf16_f32 v140, v72, v73
    v_cvt_pk_bf16_f32 v141, v74, v75
    v_cvt_pk_bf16_f32 v142, v76, v77
    v_cvt_pk_bf16_f32 v143, v78, v79
    v_xor_b32 v134, 32, v28
    v_permlane32_swap_b32 v140, v142
    v_permlane32_swap_b32 v141, v143
    ds_write_b128 v134, v[140:143]
    v_cvt_pk_bf16_f32 v136, v80, v81
    v_cvt_pk_bf16_f32 v137, v82, v83
    v_cvt_pk_bf16_f32 v138, v84, v85
    v_cvt_pk_bf16_f32 v139, v86, v87
    v_xor_b32 v134, 64, v28
    v_permlane32_swap_b32 v136, v138
    v_permlane32_swap_b32 v137, v139
    ds_write_b128 v134, v[136:139]
    v_cvt_pk_bf16_f32 v140, v88, v89
    v_cvt_pk_bf16_f32 v141, v90, v91
    v_cvt_pk_bf16_f32 v142, v92, v93
    v_cvt_pk_bf16_f32 v143, v94, v95
    v_xor_b32 v134, 96, v28
    v_permlane32_swap_b32 v140, v142
    v_permlane32_swap_b32 v141, v143
    ds_write_b128 v134, v[140:143]
    s_waitcnt lgkmcnt(0)
    ds_read_b128 v[144:147], v29 offset:0
    ds_read_b128 v[148:151], v29 offset:1024
    ds_read_b128 v[152:155], v29 offset:2048
    ds_read_b128 v[156:159], v29 offset:3072
    s_waitcnt lgkmcnt(3)
    buffer_store_dwordx4 v[144:147], v30, s[4:7], s31 offen offset:0 sc1
    s_waitcnt lgkmcnt(2)
    s_add_u32 s39, s31, 98304
    buffer_store_dwordx4 v[148:151], v30, s[4:7], s39 offen sc1
    s_waitcnt lgkmcnt(1)
    s_add_u32 s39, s31, 196608
    buffer_store_dwordx4 v[152:155], v30, s[4:7], s39 offen sc1
    s_waitcnt lgkmcnt(0)
    s_add_u32 s39, s31, 294912
    buffer_store_dwordx4 v[156:159], v30, s[4:7], s39 offen sc1
    s_waitcnt vmcnt(0)
    s_barrier
    s_cmp_lg_u32 s16, 0
    s_cbranch_scc1 L_pp_205
    v_mov_b32 v9, s33
    s_mov_b64 exec, 1
    buffer_store_dword v9, v31, s[4:7], 0 offen sc1
    s_mov_b64 exec, -1
L_pp_205:
    s_branch L_pend_191
L_pfb_202:
    s_nop 7
    s_nop 3
    v_cvt_pk_bf16_f32 v136, v96, v97
    v_cvt_pk_bf16_f32 v137, v98, v99
    v_cvt_pk_bf16_f32 v138, v100, v101
    v_cvt_pk_bf16_f32 v139, v102, v103
    v_xor_b32 v134, 0, v28
    v_permlane32_swap_b32 v136, v138
    v_permlane32_swap_b32 v137, v139
    ds_write_b128 v134, v[136:139]
    v_cvt_pk_bf16_f32 v140, v104, v105
    v_cvt_pk_bf16_f32 v141, v106, v107
    v_cvt_pk_bf16_f32 v142, v108, v109
    v_cvt_pk_bf16_f32 v143, v110, v111
    v_xor_b32 v134, 32, v28
    v_permlane32_swap_b32 v140, v142
    v_permlane32_swap_b32 v141, v143
    ds_write_b128 v134, v[140:143]
    v_cvt_pk_bf16_f32 v136, v112, v113
    v_cvt_pk_bf16_f32 v137, v114, v115
    v_cvt_pk_bf16_f32 v138, v116, v117
    v_cvt_pk_bf16_f32 v139, v118, v119
    v_xor_b32 v134, 64, v28
    v_permlane32_swap_b32 v136, v138
    v_permlane32_swap_b32 v137, v139
    ds_write_b128 v134, v[136:139]
    v_cvt_pk_bf16_f32 v140, v120, v121
    v_cvt_pk_bf16_f32 v141, v122, v123
    v_cvt_pk_bf16_f32 v142, v124, v125
    v_cvt_pk_bf16_f32 v143, v126, v127
    v_xor_b32 v134, 96, v28
    v_permlane32_swap_b32 v140, v142
    v_permlane32_swap_b32 v141, v143
    ds_write_b128 v134, v[140:143]
    s_waitcnt lgkmcnt(0)
    ds_read_b128 v[144:147], v29 offset:0
    ds_read_b128 v[148:151], v29 offset:1024
    ds_read_b128 v[152:155], v29 offset:2048
    ds_read_b128 v[156:159], v29 offset:3072
    s_waitcnt lgkmcnt(3)
    buffer_store_dwordx4 v[144:147], v30, s[4:7], s31 offen offset:0 sc1
    s_waitcnt lgkmcnt(2)
    s_add_u32 s39, s31, 98304
    buffer_store_dwordx4 v[148:151], v30, s[4:7], s39 offen sc1
    s_waitcnt lgkmcnt(1)
    s_add_u32 s39, s31, 196608
    buffer_store_dwordx4 v[152:155], v30, s[4:7], s39 offen sc1
    s_waitcnt lgkmcnt(0)
    s_add_u32 s39, s31, 294912
    buffer_store_dwordx4 v[156:159], v30, s[4:7], s39 offen sc1
    s_waitcnt vmcnt(0)
    s_barrier
    s_cmp_lg_u32 s16, 0
    s_cbranch_scc1 L_pp_206
    v_mov_b32 v9, s33
    s_mov_b64 exec, 1
    buffer_store_dword v9, v31, s[4:7], 0 offen sc1
    s_mov_b64 exec, -1
L_pp_206:
    s_branch L_pend_191
L_kind1_193:
    s_waitcnt vmcnt(10)
    s_barrier
    v_add_u32 v40, s34, v20
    v_add_u32 v41, s34, v21
    v_add_u32 v42, s34, v22
    v_add_u32 v43, s34, v23
    v_add_u32 v44, s34, v24
    v_add_u32 v45, s34, v25
    v_add_u32 v46, s34, v26
    v_add_u32 v47, s34, v27
    ds_read_b128 v[48:51], v40 offset:0
    ds_read_b128 v[52:55], v41 offset:0
    ds_read_b128 v[56:59], v42 offset:0
    ds_read_b128 v[60:63], v43 offset:0
    s_waitcnt lgkmcnt(3)
    v_mfma_f32_32x32x16_bf16 v[64:79], v[48:51], a[0:3], 0
    v_mfma_f32_32x32x16_bf16 v[80:95], v[48:51], a[160:163], 0
    ds_read_b128 v[48:51], v44 offset:0
    s_waitcnt lgkmcnt(3)
    v_mfma_f32_32x32x16_bf16 v[64:79], v[52:55], a[4:7], v[64:79]
    s_add_u32 s38, s37, s36
    s_add_u32 m0, s38, 0
    s_nop 0
    buffer_load_dwordx4 v10, s[4:7], s32 offen lds
    v_mfma_f32_32x32x16_bf16 v[80:95], v[52:55], a[164:167], v[80:95]
    ds_read_b128 v[52:55], v45 offset:0
    s_waitcnt lgkmcnt(3)
    v_mfma_f32_32x32x16_bf16 v[64:79], v[56:59], a[8:11], v[64:79]
    v_mfma_f32_32x32x16_bf16 v[80:95], v[56:59], a[168:171], v[80:95]
    ds_read_b128 v[56:59], v46 offset:0
    s_waitcnt lgkmcnt(3)
    v_mfma_f32_32x32x16_bf16 v[64:79], v[60:63], a[12:15], v[64:79]
    v_mfma_f32_32x32x16_bf16 v[80:95], v[60:63], a[172:175], v[80:95]
    ds_read_b128 v[60:63], v47 offset:0
    s_waitcnt lgkmcnt(3)
    v_mfma_f32_32x32x16_bf16 v[64:79], v[48:51], a[16:19], v[64:79]
    v_mfma_f32_32x32x16_bf16 v[80:95], v[48:51], a[176:179], v[80:95]
    ds_read_b128 v[48:51], v40 offset:256
    s_waitcnt lgkmcnt(3)
    v_mfma_f32_32x32x16_bf16 v[64:79], v[52:55], a[20:23], v[64:79]
    s_add_u32 m0, s38, 1024
    s_nop 0
    buffer_load_dwordx4 v11, s[4:7], s32 offen lds
    v_mfma_f32_32x32x16_bf16 v[80:95], v[52:55], a[180:183], v[80:95]
    ds_read_b128 v[52:55], v41 offset:256
    s_waitcnt lgkmcnt(3)
    v_mfma_f32_32x32x16_bf16 v[64:79], v[56:59], a[24:27], v[64:79]
    v_mfma_f32_32x32x16_bf16 v[80:95], v[56:59], a[184:187], v[80:95]
    ds_read_b128 v[56:59], v42 offset:256
    s_waitcnt lgkmcnt(3)
    v_mfma_f32_32x32x16_bf16 v[64:79], v[60:63], a[28:31], v[64:79]
    v_mfma_f32_32x32x16_bf16 v[80:95], v[60:63], a[188:191], v[80:95]
    ds_read_b128 v[60:63], v43 offset:256
    s_waitcnt lgkmcnt(3)
    v_mfma_f32_32x32x16_bf16 v[64:79], v[48:51], a[32:35], v[64:79]
    v_mfma_f32_32x32x16_bf16 v[80:95], v[48:51], a[192:195], v[80:95]
    ds_read_b128 v[48:51], v44 offset:256
    s_waitcnt lgkmcnt(3)
    v_mfma_f32_32x32x16_bf16 v[64:79], v[52:55], a[36:39], v[64:79]
    s_add_u32 m0, s38, 2048
    s_nop 0
    buffer_load_dwordx4 v12, s[4:7], s32 offen lds
    v_mfma_f32_32x32x16_bf16 v[80:95], v[52:55], a[196:199], v[80:95]
    ds_read_b128 v[52:55], v45 offset:256
    s_waitcnt lgkmcnt(3)
    v_mfma_f32_32x32x16_bf16 v[64:79], v[56:59], a[40:43], v[64:79]
    v_mfma_f32_32x32x16_bf16 v[80:95], v[56:59], a[200:203], v[80:95]
    ds_read_b128 v[56:59], v46 offset:256
    s_waitcnt lgkmcnt(3)
    v_mfma_f32_32x32x16_bf16 v[64:79], v[60:63], a[44:47], v[64:79]
    v_mfma_f32_32x32x16_bf16 v[80:95], v[60:63], a[204:207], v[80:95]
    ds_read_b128 v[60:63], v47 offset:256
    s_waitcnt lgkmcnt(3)
    v_mfma_f32_32x32x16_bf16 v[64:79], v[48:51], a[48:51], v[64:79]
    v_mfma_f32_32x32x16_bf16 v[80:95], v[48:51], a[208:211], v[80:95]
    ds_read_b128 v[48:51], v40 offset:512
    s_waitcnt lgkmcnt(3)
    v_mfma_f32_32x32x16_bf16 v[64:79], v[52:55], a[52:55], v[64:79]
    s_add_u32 m0, s38, 3072
    s_nop 0
    buffer_load_dwordx4 v13, s[4:7], s32 offen lds
    v_mfma_f32_32x32x16_bf16 v[80:95], v[52:55], a[212:215], v[80:95]
    ds_read_b128 v[52:55], v41 offset:512
    s_waitcnt lgkmcnt(3)
    v_mfma_f32_32x32x16_bf16 v[64:79], v[56:59], a[56:59], v[64:79]
    v_mfma_f32_32x32x16_bf16 v[80:95], v[56:59], a[216:219], v[80:95]
    ds_read_b128 v[56:59], v42 offset:512
    s_waitcnt lgkmcnt(3)
    v_mfma_f32_32x32x16_bf16 v[64:79], v[60:63], a[60:63], v[64:79]
    v_mfma_f32_32x32x16_bf16 v[80:95], v[60:63], a[220:223], v[80:95]
    ds_read_b128 v[60:63], v43 offset:512
    s_waitcnt lgkmcnt(3)
    v_mfma_f32_32x32x16_bf16 v[64:79], v[48:51], a[64:67], v[64:79]
    v_mfma_f32_32x32x16_bf16 v[80:95], v[48:51], a[224:227], v[80:95]
    ds_read_b128 v[48:51], v44 offset:512
    s_waitcnt lgkmcnt(3)
    v_mfma_f32_32x32x16_bf16 v[64:79], v[52:55], a[68:71], v[64:79]
    s_add_u32 m0, s38, 4096
    s_nop 0
    buffer_load_dwordx4 v14, s[4:7], s32 offen lds
    v_mfma_f32_32x32x16_bf16 v[80:95], v[52:55], a[228:231], v[80:95]
    ds_read_b128 v[52:55], v45 offset:512
    s_waitcnt lgkmcnt(3)
    v_mfma_f32_32x32x16_bf16 v[64:79], v[56:59], a[72:75], v[64:79]
    v_mfma_f32_32x32x16_bf16 v[80:95], v[56:59], a[232:235], v[80:95]
    ds_read_b128 v[56:59], v46 offset:512
    s_waitcnt lgkmcnt(3)
    v_mfma_f32_32x32x16_bf16 v[64:79], v[60:63], a[76:79], v[64:79]
    v_mfma_f32_32x32x16_bf16 v[80:95], v[60:63], a[236:239], v[80:95]
    ds_read_b128 v[60:63], v47 offset:512
    s_waitcnt lgkmcnt(3)
    v_mfma_f32_32x32x16_bf16 v[64:79], v[48:51], a[80:83], v[64:79]
    v_mfma_f32_32x32x16_bf16 v[80:95], v[48:51], a[240:243], v[80:95]
    ds_read_b128 v[48:51], v40 offset:768
    s_waitcnt lgkmcnt(3)
    v_mfma_f32_32x32x16_bf16 v[64:79], v[52:55], a[84:87], v[64:79]
    s_add_u32 m0, s38, 5120
    s_nop 0
    buffer_load_dwordx4 v15, s[4:7], s32 offen lds
    v_mfma_f32_32x32x16_bf16 v[80:95], v[52:55], a[244:247], v[80:95]
    ds_read_b128 v[52:55], v41 offset:768
    s_waitcnt lgkmcnt(3)
    v_mfma_f32_32x32x16_bf16 v[64:79], v[56:59], a[88:91], v[64:79]
    v_mfma_f32_32x32x16_bf16 v[80:95], v[56:59], a[248:251], v[80:95]
    ds_read_b128 v[56:59], v42 offset:768
    s_waitcnt lgkmcnt(3)
    v_mfma_f32_32x32x16_bf16 v[64:79], v[60:63], a[92:95], v[64:79]
    v_mfma_f32_32x32x16_bf16 v[80:95], v[60:63], a[252:255], v[80:95]
    ds_read_b128 v[60:63], v43 offset:768
    s_waitcnt lgkmcnt(3)
    v_mfma_f32_32x32x16_bf16 v[64:79], v[48:51], a[96:99], v[64:79]
    v_mfma_f32_32x32x16_bf16 v[80:95], v[48:51], v[192:195], v[80:95]
    ds_read_b128 v[48:51], v44 offset:768
    s_waitcnt lgkmcnt(3)
    v_mfma_f32_32x32x16_bf16 v[64:79], v[52:55], a[100:103], v[64:79]
    s_add_u32 m0, s38, 6144
    s_nop 0
    buffer_load_dwordx4 v16, s[4:7], s32 offen lds
    v_mfma_f32_32x32x16_bf16 v[80:95], v[52:55], v[196:199], v[80:95]
    ds_read_b128 v[52:55], v45 offset:768
    s_waitcnt lgkmcnt(3)
    v_mfma_f32_32x32x16_bf16 v[64:79], v[56:59], a[104:107], v[64:79]
    v_mfma_f32_32x32x16_bf16 v[80:95], v[56:59], v[200:203], v[80:95]
    ds_read_b128 v[56:59], v46 offset:768
    s_waitcnt lgkmcnt(3)
    v_mfma_f32_32x32x16_bf16 v[64:79], v[60:63], a[108:111], v[64:79]
    v_mfma_f32_32x32x16_bf16 v[80:95], v[60:63], v[204:207], v[80:95]
    ds_read_b128 v[60:63], v47 offset:768
    s_waitcnt lgkmcnt(3)
    v_mfma_f32_32x32x16_bf16 v[64:79], v[48:51], a[112:115], v[64:79]
    v_mfma_f32_32x32x16_bf16 v[80:95], v[48:51], v[208:211], v[80:95]
    ds_read_b128 v[48:51], v40 offset:1024
    s_waitcnt lgkmcnt(3)
    v_mfma_f32_32x32x16_bf16 v[64:79], v[52:55], a[116:119], v[64:79]
    s_add_u32 m0, s38, 7168
    s_nop 0
    buffer_load_dwordx4 v17, s[4:7], s32 offen lds
    v_mfma_f32_32x32x16_bf16 v[80:95], v[52:55], v[212:215], v[80:95]
    ds_read_b128 v[52:55], v41 offset:1024
    s_waitcnt lgkmcnt(3)
    v_mfma_f32_32x32x16_bf16 v[64:79], v[56:59], a[120:123], v[64:79]
    v_mfma_f32_32x32x16_bf16 v[80:95], v[56:59], v[216:219], v[80:95]
    ds_read_b128 v[56:59], v42 offset:1024
    s_waitcnt lgkmcnt(3)
    v_mfma_f32_32x32x16_bf16 v[64:79], v[60:63], a[124:127], v[64:79]
    v_mfma_f32_32x32x16_bf16 v[80:95], v[60:63], v[220:223], v[80:95]
    ds_read_b128 v[60:63], v43 offset:1024
    s_waitcnt lgkmcnt(3)
    v_mfma_f32_32x32x16_bf16 v[64:79], v[48:51], a[128:131], v[64:79]
    v_mfma_f32_32x32x16_bf16 v[80:95], v[48:51], v[224:227], v[80:95]
    ds_read_b128 v[48:51], v44 offset:1024
    s_waitcnt lgkmcnt(3)
    v_mfma_f32_32x32x16_bf16 v[64:79], v[52:55], a[132:135], v[64:79]
    s_add_u32 m0, s38, 8192
    s_nop 0
    buffer_load_dwordx4 v18, s[4:7], s32 offen lds
    v_mfma_f32_32x32x16_bf16 v[80:95], v[52:55], v[228:231], v[80:95]
    ds_read_b128 v[52:55], v45 offset:1024
    s_waitcnt lgkmcnt(3)
    v_mfma_f32_32x32x16_bf16 v[64:79], v[56:59], a[136:139], v[64:79]
    v_mfma_f32_32x32x16_bf16 v[80:95], v[56:59], v[232:235], v[80:95]
    ds_read_b128 v[56:59], v46 offset:1024
    s_waitcnt lgkmcnt(3)
    v_mfma_f32_32x32x16_bf16 v[64:79], v[60:63], a[140:143], v[64:79]
    v_mfma_f32_32x32x16_bf16 v[80:95], v[60:63], v[236:239], v[80:95]
    ds_read_b128 v[60:63], v47 offset:1024
    s_waitcnt lgkmcnt(3)
    v_mfma_f32_32x32x16_bf16 v[64:79], v[48:51], a[144:147], v[64:79]
    v_mfma_f32_32x32x16_bf16 v[80:95], v[48:51], v[240:243], v[80:95]
    s_waitcnt lgkmcnt(2)
    v_mfma_f32_32x32x16_bf16 v[64:79], v[52:55], a[148:151], v[64:79]
    s_add_u32 m0, s38, 9216
    s_nop 0
    buffer_load_dwordx4 v19, s[4:7], s32 offen lds
    v_mfma_f32_32x32x16_bf16 v[80:95], v[52:55], v[244:247], v[80:95]
    s_waitcnt lgkmcnt(1)
    v_mfma_f32_32x32x16_bf16 v[64:79], v[56:59], a[152:155], v[64:79]
    v_mfma_f32_32x32x16_bf16 v[80:95], v[56:59], v[248:251], v[80:95]
    s_waitcnt lgkmcnt(0)
    v_mfma_f32_32x32x16_bf16 v[64:79], v[60:63], a[156:159], v[64:79]
    v_mfma_f32_32x32x16_bf16 v[80:95], v[60:63], v[252:255], v[80:95]
    s_add_u32 s32, s32, 40960
    s_nop 7
    s_nop 3
    v_cvt_pk_bf16_f32 v136, v64, v65
    v_cvt_pk_bf16_f32 v137, v66, v67
    v_cvt_pk_bf16_f32 v138, v68, v69
    v_cvt_pk_bf16_f32 v139, v70, v71
    v_xor_b32 v134, 0, v28
    v_permlane32_swap_b32 v136, v138
    v_permlane32_swap_b32 v137, v139
    ds_write_b128 v134, v[136:139] offset:0
    v_cvt_pk_bf16_f32 v140, v72, v73
    v_cvt_pk_bf16_f32 v141, v74, v75
    v_cvt_pk_bf16_f32 v142, v76, v77
    v_cvt_pk_bf16_f32 v143, v78, v79
    v_xor_b32 v134, 32, v28
    v_permlane32_swap_b32 v140, v142
    v_permlane32_swap_b32 v141, v143
    ds_write_b128 v134, v[140:143] offset:0
    v_cvt_pk_bf16_f32 v136, v80, v81
    v_cvt_pk_bf16_f32 v137, v82, v83
    v_cvt_pk_bf16_f32 v138, v84, v85
    v_cvt_pk_bf16_f32 v139, v86, v87
    v_xor_b32 v134, 0, v28
    v_permlane32_swap_b32 v136, v138
    v_permlane32_swap_b32 v137, v139
    ds_write_b128 v134, v[136:139] offset:2048
    v_cvt_pk_bf16_f32 v140, v88, v89
    v_cvt_pk_bf16_f32 v141, v90, v91
    v_cvt_pk_bf16_f32 v142, v92, v93
    v_cvt_pk_bf16_f32 v143, v94, v95
    v_xor_b32 v134, 32, v28
    v_permlane32_swap_b32 v140, v142
    v_permlane32_swap_b32 v141, v143
    ds_write_b128 v134, v[140:143] offset:2048
    s_waitcnt lgkmcnt(0)
    ds_read_b128 v[144:147], v29 offset:0
    ds_read_b128 v[148:151], v29 offset:1024
    ds_read_b128 v[152:155], v29 offset:2048
    ds_read_b128 v[156:159], v29 offset:3072
    s_waitcnt lgkmcnt(3)
    buffer_store_dwordx4 v[144:147], v30, s[4:7], s31 offen offset:0 sc1
    s_waitcnt lgkmcnt(2)
    buffer_store_dwordx4 v[148:151], v30, s[4:7], s31 offen offset:1024 sc1
    s_waitcnt lgkmcnt(1)
    buffer_store_dwordx4 v[152:155], v30, s[4:7], s31 offen offset:2048 sc1
    s_waitcnt lgkmcnt(0)
    buffer_store_dwordx4 v[156:159], v30, s[4:7], s31 offen offset:3072 sc1
    s_add_u32 s33, s33, 1
    s_mov_b32 s38, s34
    s_mov_b32 s34, s35
    s_mov_b32 s35, s36
    s_mov_b32 s36, s38
    s_waitcnt vmcnt(0)
    s_barrier
    s_cmp_lg_u32 s16, 0
    s_cbranch_scc1 L_pp_207
    v_mov_b32 v9, s33
    s_mov_b64 exec, 1
    buffer_store_dword v9, v31, s[4:7], 0 offen sc1
    s_mov_b64 exec, -1
L_pp_207:
    s_add_u32 s31, s31, s30
    s_cmp_ge_u32 s33, s19
    s_cbranch_scc1 L_pend_191
    v_add_u32 v40, s34, v20
    v_add_u32 v41, s34, v21
    v_add_u32 v42, s34, v22
    v_add_u32 v43, s34, v23
    v_add_u32 v44, s34, v24
    v_add_u32 v45, s34, v25
    v_add_u32 v46, s34, v26
    v_add_u32 v47, s34, v27
    ds_read_b128 v[48:51], v40 offset:0
    ds_read_b128 v[52:55], v41 offset:0
    ds_read_b128 v[56:59], v42 offset:0
    ds_read_b128 v[60:63], v43 offset:0
    s_waitcnt lgkmcnt(3)
    v_mfma_f32_32x32x16_bf16 v[96:111], v[48:51], a[0:3], 0
    v_mfma_f32_32x32x16_bf16 v[112:127], v[48:51], a[160:163], 0
    ds_read_b128 v[48:51], v44 offset:0
    s_waitcnt lgkmcnt(3)
    v_mfma_f32_32x32x16_bf16 v[96:111], v[52:55], a[4:7], v[96:111]
    s_add_u32 s38, s37, s36
    s_add_u32 m0, s38, 0
    s_nop 0
    buffer_load_dwordx4 v10, s[4:7], s32 offen lds
    v_mfma_f32_32x32x16_bf16 v[112:127], v[52:55], a[164:167], v[112:127]
    ds_read_b128 v[52:55], v45 offset:0
    s_waitcnt lgkmcnt(3)
    v_mfma_f32_32x32x16_bf16 v[96:111], v[56:59], a[8:11], v[96:111]
    v_mfma_f32_32x32x16_bf16 v[112:127], v[56:59], a[168:171], v[112:127]
    ds_read_b128 v[56:59], v46 offset:0
    s_waitcnt lgkmcnt(3)
    v_mfma_f32_32x32x16_bf16 v[96:111], v[60:63], a[12:15], v[96:111]
    v_mfma_f32_32x32x16_bf16 v[112:127], v[60:63], a[172:175], v[112:127]
    ds_read_b128 v[60:63], v47 offset:0
    s_waitcnt lgkmcnt(3)
    v_mfma_f32_32x32x16_bf16 v[96:111], v[48:51], a[16:19], v[96:111]
    v_mfma_f32_32x32x16_bf16 v[112:127], v[48:51], a[176:179], v[112:127]
    ds_read_b128 v[48:51], v40 offset:256
    s_waitcnt lgkmcnt(3)
    v_mfma_f32_32x32x16_bf16 v[96:111], v[52:55], a[20:23], v[96:111]
    s_add_u32 m0, s38, 1024
    s_nop 0
    buffer_load_dwordx4 v11, s[4:7], s32 offen lds
    v_mfma_f32_32x32x16_bf16 v[112:127], v[52:55], a[180:183], v[112:127]
    ds_read_b128 v[52:55], v41 offset:256
    s_waitcnt lgkmcnt(3)
    v_mfma_f32_32x32x16_bf16 v[96:111], v[56:59], a[24:27], v[96:111]
    v_mfma_f32_32x32x16_bf16 v[112:127], v[56:59], a[184:187], v[112:127]
    ds_read_b128 v[56:59], v42 offset:256
    s_waitcnt lgkmcnt(3)
    v_mfma_f32_32x32x16_bf16 v[96:111], v[60:63], a[28:31], v[96:111]
    v_mfma_f32_32x32x16_bf16 v[112:127], v[60:63], a[188:191], v[112:127]
    ds_read_b128 v[60:63], v43 offset:256
    s_waitcnt lgkmcnt(3)
    v_mfma_f32_32x32x16_bf16 v[96:111], v[48:51], a[32:35], v[96:111]
    v_mfma_f32_32x32x16_bf16 v[112:127], v[48:51], a[192:195], v[112:127]
    ds_read_b128 v[48:51], v44 offset:256
    s_waitcnt lgkmcnt(3)
    v_mfma_f32_32x32x16_bf16 v[96:111], v[52:55], a[36:39], v[96:111]
    s_add_u32 m0, s38, 2048
    s_nop 0
    buffer_load_dwordx4 v12, s[4:7], s32 offen lds
    v_mfma_f32_32x32x16_bf16 v[112:127], v[52:55], a[196:199], v[112:127]
    ds_read_b128 v[52:55], v45 offset:256
    s_waitcnt lgkmcnt(3)
    v_mfma_f32_32x32x16_bf16 v[96:111], v[56:59], a[40:43], v[96:111]
    v_mfma_f32_32x32x16_bf16 v[112:127], v[56:59], a[200:203], v[112:127]
    ds_read_b128 v[56:59], v46 offset:256
    s_waitcnt lgkmcnt(3)
    v_mfma_f32_32x32x16_bf16 v[96:111], v[60:63], a[44:47], v[96:111]
    v_mfma_f32_32x32x16_bf16 v[112:127], v[60:63], a[204:207], v[112:127]
    ds_read_b128 v[60:63], v47 offset:256
    s_waitcnt lgkmcnt(3)
    v_mfma_f32_32x32x16_bf16 v[96:111], v[48:51], a[48:51], v[96:111]
    v_mfma_f32_32x32x16_bf16 v[112:127], v[48:51], a[208:211], v[112:127]
    ds_read_b128 v[48:51], v40 offset:512
    s_waitcnt lgkmcnt(3)
    v_mfma_f32_32x32x16_bf16 v[96:111], v[52:55], a[52:55], v[96:111]
    s_add_u32 m0, s38, 3072
    s_nop 0
    buffer_load_dwordx4 v13, s[4:7], s32 offen lds
    v_mfma_f32_32x32x16_bf16 v[112:127], v[52:55], a[212:215], v[112:127]
    ds_read_b128 v[52:55], v41 offset:512
    s_waitcnt lgkmcnt(3)
    v_mfma_f32_32x32x16_bf16 v[96:111], v[56:59], a[56:59], v[96:111]
    v_mfma_f32_32x32x16_bf16 v[112:127], v[56:59], a[216:219], v[112:127]
    ds_read_b128 v[56:59], v42 offset:512
    s_waitcnt lgkmcnt(3)
    v_mfma_f32_32x32x16_bf16 v[96:111], v[60:63], a[60:63], v[96:111]
    v_mfma_f32_32x32x16_bf16 v[112:127], v[60:63], a[220:223], v[112:127]
    ds_read_b128 v[60:63], v43 offset:512
    s_waitcnt lgkmcnt(3)
    v_mfma_f32_32x32x16_bf16 v[96:111], v[48:51], a[64:67], v[96:111]
    v_mfma_f32_32x32x16_bf16 v[112:127], v[48:51], a[224:227], v[112:127]
    ds_read_b128 v[48:51], v44 offset:512
    s_waitcnt lgkmcnt(3)
    v_mfma_f32_32x32x16_bf16 v[96:111], v[52:55], a[68:71], v[96:111]
    s_add_u32 m0, s38, 4096
    s_nop 0
    buffer_load_dwordx4 v14, s[4:7], s32 offen lds
    v_mfma_f32_32x32x16_bf16 v[112:127], v[52:55], a[228:231], v[112:127]
    ds_read_b128 v[52:55], v45 offset:512
    s_waitcnt lgkmcnt(3)
    v_mfma_f32_32x32x16_bf16 v[96:111], v[56:59], a[72:75], v[96:111]
    v_mfma_f32_32x32x16_bf16 v[112:127], v[56:59], a[232:235], v[112:127]
    ds_read_b128 v[56:59], v46 offset:512
    s_waitcnt lgkmcnt(3)
    v_mfma_f32_32x32x16_bf16 v[96:111], v[60:63], a[76:79], v[96:111]
    v_mfma_f32_32x32x16_bf16 v[112:127], v[60:63], a[236:239], v[112:127]
    ds_read_b128 v[60:63], v47 offset:512
    s_waitcnt lgkmcnt(3)
    v_mfma_f32_32x32x16_bf16 v[96:111], v[48:51], a[80:83], v[96:111]
    v_mfma_f32_32x32x16_bf16 v[112:127], v[48:51], a[240:243], v[112:127]
    ds_read_b128 v[48:51], v40 offset:768
    s_waitcnt lgkmcnt(3)
    v_mfma_f32_32x32x16_bf16 v[96:111], v[52:55], a[84:87], v[96:111]
    s_add_u32 m0, s38, 5120
    s_nop 0
    buffer_load_dwordx4 v15, s[4:7], s32 offen lds
    v_mfma_f32_32x32x16_bf16 v[112:127], v[52:55], a[244:247], v[112:127]
    ds_read_b128 v[52:55], v41 offset:768
    s_waitcnt lgkmcnt(3)
    v_mfma_f32_32x32x16_bf16 v[96:111], v[56:59], a[88:91], v[96:111]
    v_mfma_f32_32x32x16_bf16 v[112:127], v[56:59], a[248:251], v[112:127]
    ds_read_b128 v[56:59], v42 offset:768
    s_waitcnt lgkmcnt(3)
    v_mfma_f32_32x32x16_bf16 v[96:111], v[60:63], a[92:95], v[96:111]
    v_mfma_f32_32x32x16_bf16 v[112:127], v[60:63], a[252:255], v[112:127]
    ds_read_b128 v[60:63], v43 offset:768
    s_waitcnt lgkmcnt(3)
    v_mfma_f32_32x32x16_bf16 v[96:111], v[48:51], a[96:99], v[96:111]
    v_mfma_f32_32x32x16_bf16 v[112:127], v[48:51], v[192:195], v[112:127]
    ds_read_b128 v[48:51], v44 offset:768
    s_waitcnt lgkmcnt(3)
    v_mfma_f32_32x32x16_bf16 v[96:111], v[52:55], a[100:103], v[96:111]
    s_add_u32 m0, s38, 6144
    s_nop 0
    buffer_load_dwordx4 v16, s[4:7], s32 offen lds
    v_mfma_f32_32x32x16_bf16 v[112:127], v[52:55], v[196:199], v[112:127]
    ds_read_b128 v[52:55], v45 offset:768
    s_waitcnt lgkmcnt(3)
    v_mfma_f32_32x32x16_bf16 v[96:111], v[56:59], a[104:107], v[96:111]
    v_mfma_f32_32x32x16_bf16 v[112:127], v[56:59], v[200:203], v[112:127]
    ds_read_b128 v[56:59], v46 offset:768
    s_waitcnt lgkmcnt(3)
    v_mfma_f32_32x32x16_bf16 v[96:111], v[60:63], a[108:111], v[96:111]
    v_mfma_f32_32x32x16_bf16 v[112:127], v[60:63], v[204:207], v[112:127]
    ds_read_b128 v[60:63], v47 offset:768
    s_waitcnt lgkmcnt(3)
    v_mfma_f32_32x32x16_bf16 v[96:111], v[48:51], a[112:115], v[96:111]
    v_mfma_f32_32x32x16_bf16 v[112:127], v[48:51], v[208:211], v[112:127]
    ds_read_b128 v[48:51], v40 offset:1024
    s_waitcnt lgkmcnt(3)
    v_mfma_f32_32x32x16_bf16 v[96:111], v[52:55], a[116:119], v[96:111]
    s_add_u32 m0, s38, 7168
    s_nop 0
    buffer_load_dwordx4 v17, s[4:7], s32 offen lds
    v_mfma_f32_32x32x16_bf16 v[112:127], v[52:55], v[212:215], v[112:127]
    ds_read_b128 v[52:55], v41 offset:1024
    s_waitcnt lgkmcnt(3)
    v_mfma_f32_32x32x16_bf16 v[96:111], v[56:59], a[120:123], v[96:111]
    v_mfma_f32_32x32x16_bf16 v[112:127], v[56:59], v[216:219], v[112:127]
    ds_read_b128 v[56:59], v42 offset:1024
    s_waitcnt lgkmcnt(3)
    v_mfma_f32_32x32x16_bf16 v[96:111], v[60:63], a[124:127], v[96:111]
    v_mfma_f32_32x32x16_bf16 v[112:127], v[60:63], v[220:223], v[112:127]
    ds_read_b128 v[60:63], v43 offset:1024
    s_waitcnt lgkmcnt(3)
    v_mfma_f32_32x32x16_bf16 v[96:111], v[48:51], a[128:131], v[96:111]
    v_mfma_f32_32x32x16_bf16 v[112:127], v[48:51], v[224:227], v[112:127]
    ds_read_b128 v[48:51], v44 offset:1024
    s_waitcnt lgkmcnt(3)
    v_mfma_f32_32x32x16_bf16 v[96:111], v[52:55], a[132:135], v[96:111]
    s_add_u32 m0, s38, 8192
    s_nop 0
    buffer_load_dwordx4 v18, s[4:7], s32 offen lds
    v_mfma_f32_32x32x16_bf16 v[112:127], v[52:55], v[228:231], v[112:127]
    ds_read_b128 v[52:55], v45 offset:1024
    s_waitcnt lgkmcnt(3)
    v_mfma_f32_32x32x16_bf16 v[96:111], v[56:59], a[136:139], v[96:111]
    v_mfma_f32_32x32x16_bf16 v[112:127], v[56:59], v[232:235], v[112:127]
    ds_read_b128 v[56:59], v46 offset:1024
    s_waitcnt lgkmcnt(3)
    v_mfma_f32_32x32x16_bf16 v[96:111], v[60:63], a[140:143], v[96:111]
    v_mfma_f32_32x32x16_bf16 v[112:127], v[60:63], v[236:239], v[112:127]
    ds_read_b128 v[60:63], v47 offset:1024
    s_waitcnt lgkmcnt(3)
    v_mfma_f32_32x32x16_bf16 v[96:111], v[48:51], a[144:147], v[96:111]
    v_mfma_f32_32x32x16_bf16 v[112:127], v[48:51], v[240:243], v[112:127]
    s_waitcnt lgkmcnt(2)
    v_mfma_f32_32x32x16_bf16 v[96:111], v[52:55], a[148:151], v[96:111]
    s_add_u32 m0, s38, 9216
    s_nop 0
    buffer_load_dwordx4 v19, s[4:7], s32 offen lds
    v_mfma_f32_32x32x16_bf16 v[112:127], v[52:55], v[244:247], v[112:127]
    s_waitcnt lgkmcnt(1)
    v_mfma_f32_32x32x16_bf16 v[96:111], v[56:59], a[152:155], v[96:111]
    v_mfma_f32_32x32x16_bf16 v[112:127], v[56:59], v[248:251], v[112:127]
    s_waitcnt lgkmcnt(0)
    v_mfma_f32_32x32x16_bf16 v[96:111], v[60:63], a[156:159], v[96:111]
    v_mfma_f32_32x32x16_bf16 v[112:127], v[60:63], v[252:255], v[112:127]
    s_add_u32 s32, s32, 40960
    s_nop 7
    s_nop 3
    v_cvt_pk_bf16_f32 v136, v96, v97
    v_cvt_pk_bf16_f32 v137, v98, v99
    v_cvt_pk_bf16_f32 v138, v100, v101
    v_cvt_pk_bf16_f32 v139, v102, v103
    v_xor_b32 v134, 0, v28
    v_permlane32_swap_b32 v136, v138
    v_permlane32_swap_b32 v137, v139
    ds_write_b128 v134, v[136:139] offset:0
    v_cvt_pk_bf16_f32 v140, v104, v105
    v_cvt_pk_bf16_f32 v141, v106, v107
    v_cvt_pk_bf16_f32 v142, v108, v109
    v_cvt_pk_bf16_f32 v143, v110, v111
    v_xor_b32 v134, 32, v28
    v_permlane32_swap_b32 v140, v142
    v_permlane32_swap_b32 v141, v143
    ds_write_b128 v134, v[140:143] offset:0
    v_cvt_pk_bf16_f32 v136, v112, v113
    v_cvt_pk_bf16_f32 v137, v114, v115
    v_cvt_pk_bf16_f32 v138, v116, v117
    v_cvt_pk_bf16_f32 v139, v118, v119
    v_xor_b32 v134, 0, v28
    v_permlane32_swap_b32 v136, v138
    v_permlane32_swap_b32 v137, v139
    ds_write_b128 v134, v[136:139] offset:2048
    v_cvt_pk_bf16_f32 v140, v120, v121
    v_cvt_pk_bf16_f32 v141, v122, v123
    v_cvt_pk_bf16_f32 v142, v124, v125
    v_cvt_pk_bf16_f32 v143, v126, v127
    v_xor_b32 v134, 32, v28
    v_permlane32_swap_b32 v140, v142
    v_permlane32_swap_b32 v141, v143
    ds_write_b128 v134, v[140:143] offset:2048
    s_waitcnt lgkmcnt(0)
    ds_read_b128 v[144:147], v29 offset:0
    ds_read_b128 v[148:151], v29 offset:1024
    ds_read_b128 v[152:155], v29 offset:2048
    ds_read_b128 v[156:159], v29 offset:3072
    s_waitcnt lgkmcnt(3)
    buffer_store_dwordx4 v[144:147], v30, s[4:7], s31 offen offset:0 sc1
    s_waitcnt lgkmcnt(2)
    buffer_store_dwordx4 v[148:151], v30, s[4:7], s31 offen offset:1024 sc1
    s_waitcnt lgkmcnt(1)
    buffer_store_dwordx4 v[152:155], v30, s[4:7], s31 offen offset:2048 sc1
    s_waitcnt lgkmcnt(0)
    buffer_store_dwordx4 v[156:159], v30, s[4:7], s31 offen offset:3072 sc1
    s_add_u32 s33, s33, 1
    s_mov_b32 s38, s34
    s_mov_b32 s34, s35
    s_mov_b32 s35, s36
    s_mov_b32 s36, s38
    s_waitcnt vmcnt(0)
    s_barrier
    s_cmp_lg_u32 s16, 0
    s_cbranch_scc1 L_pp_209
    v_mov_b32 v9, s33
    s_mov_b64 exec, 1
    buffer_store_dword v9, v31, s[4:7], 0 offen sc1
    s_mov_b64 exec, -1
L_pp_209:
    v_mov_b32 v2, 80
    s_mov_b32 s38, 0
L_dw_210:
    buffer_load_dword v3, v2, s[12:15], 0 offen sc1
    s_waitcnt vmcnt(0)
    v_cmp_gt_u32 vcc, 24, v3
    s_cbranch_vccz L_dwk_211
    s_sleep 2
    s_add_u32 s38, s38, 1
    s_cmp_lt_u32 s38, 4194304
    s_cbranch_scc1 L_dw_210
    s_branch L_end_1
L_dwk_211:
    s_add_u32 s31, s31, s30
    s_cmp_ge_u32 s33, s19
    s_cbranch_scc1 L_pend_191
    v_add_u32 v40, s34, v20
    v_add_u32 v41, s34, v21
    v_add_u32 v42, s34, v22
    v_add_u32 v43, s34, v23
    v_add_u32 v44, s34, v24
    v_add_u32 v45, s34, v25
    v_add_u32 v46, s34, v26
    v_add_u32 v47, s34, v27
    ds_read_b128 v[48:51], v40 offset:0
    ds_read_b128 v[52:55], v41 offset:0
    ds_read_b128 v[56:59], v42 offset:0
    ds_read_b128 v[60:63], v43 offset:0
    s_waitcnt lgkmcnt(3)
    v_mfma_f32_32x32x16_bf16 v[64:79], v[48:51], a[0:3], 0
    v_mfma_f32_32x32x16_bf16 v[80:95], v[48:51], a[160:163], 0
    ds_read_b128 v[48:51], v44 offset:0
    s_waitcnt lgkmcnt(3)
    v_mfma_f32_32x32x16_bf16 v[64:79], v[52:55], a[4:7], v[64:79]
    s_add_u32 s38, s37, s36
    s_add_u32 m0, s38, 0
    s_nop 0
    buffer_load_dwordx4 v10, s[4:7], s32 offen lds
    v_mfma_f32_32x32x16_bf16 v[80:95], v[52:55], a[164:167], v[80:95]
    ds_read_b128 v[52:55], v45 offset:0
    s_waitcnt lgkmcnt(3)
    v_mfma_f32_32x32x16_bf16 v[64:79], v[56:59], a[8:11], v[64:79]
    v_mfma_f32_32x32x16_bf16 v[80:95], v[56:59], a[168:171], v[80:95]
    ds_read_b128 v[56:59], v46 offset:0
    s_waitcnt lgkmcnt(3)
    v_mfma_f32_32x32x16_bf16 v[64:79], v[60:63], a[12:15], v[64:79]
    v_mfma_f32_32x32x16_bf16 v[80:95], v[60:63], a[172:175], v[80:95]
    ds_read_b128 v[60:63], v47 offset:0
    s_waitcnt lgkmcnt(3)
    v_mfma_f32_32x32x16_bf16 v[64:79], v[48:51], a[16:19], v[64:79]
    v_mfma_f32_32x32x16_bf16 v[80:95], v[48:51], a[176:179], v[80:95]
    ds_read_b128 v[48:51], v40 offset:256
    s_waitcnt lgkmcnt(3)
    v_mfma_f32_32x32x16_bf16 v[64:79], v[52:55], a[20:23], v[64:79]
    s_add_u32 m0, s38, 1024
    s_nop 0
    buffer_load_dwordx4 v11, s[4:7], s32 offen lds
    v_mfma_f32_32x32x16_bf16 v[80:95], v[52:55], a[180:183], v[80:95]
    ds_read_b128 v[52:55], v41 offset:256
    s_waitcnt lgkmcnt(3)
    v_mfma_f32_32x32x16_bf16 v[64:79], v[56:59], a[24:27], v[64:79]
    v_mfma_f32_32x32x16_bf16 v[80:95], v[56:59], a[184:187], v[80:95]
    ds_read_b128 v[56:59], v42 offset:256
    s_waitcnt lgkmcnt(3)
    v_mfma_f32_32x32x16_bf16 v[64:79], v[60:63], a[28:31], v[64:79]
    v_mfma_f32_32x32x16_bf16 v[80:95], v[60:63], a[188:191], v[80:95]
    ds_read_b128 v[60:63], v43 offset:256
    s_waitcnt lgkmcnt(3)
    v_mfma_f32_32x32x16_bf16 v[64:79], v[48:51], a[32:35], v[64:79]
    v_mfma_f32_32x32x16_bf16 v[80:95], v[48:51], a[192:195], v[80:95]
    ds_read_b128 v[48:51], v44 offset:256
    s_waitcnt lgkmcnt(3)
    v_mfma_f32_32x32x16_bf16 v[64:79], v[52:55], a[36:39], v[64:79]
    s_add_u32 m0, s38, 2048
    s_nop 0
    buffer_load_dwordx4 v12, s[4:7], s32 offen lds
    v_mfma_f32_32x32x16_bf16 v[80:95], v[52:55], a[196:199], v[80:95]
    ds_read_b128 v[52:55], v45 offset:256
    s_waitcnt lgkmcnt(3)
    v_mfma_f32_32x32x16_bf16 v[64:79], v[56:59], a[40:43], v[64:79]
    v_mfma_f32_32x32x16_bf16 v[80:95], v[56:59], a[200:203], v[80:95]
    ds_read_b128 v[56:59], v46 offset:256
    s_waitcnt lgkmcnt(3)
    v_mfma_f32_32x32x16_bf16 v[64:79], v[60:63], a[44:47], v[64:79]
    v_mfma_f32_32x32x16_bf16 v[80:95], v[60:63], a[204:207], v[80:95]
    ds_read_b128 v[60:63], v47 offset:256
    s_waitcnt lgkmcnt(3)
    v_mfma_f32_32x32x16_bf16 v[64:79], v[48:51], a[48:51], v[64:79]
    v_mfma_f32_32x32x16_bf16 v[80:95], v[48:51], a[208:211], v[80:95]
    ds_read_b128 v[48:51], v40 offset:512
    s_waitcnt lgkmcnt(3)
    v_mfma_f32_32x32x16_bf16 v[64:79], v[52:55], a[52:55], v[64:79]
    s_add_u32 m0, s38, 3072
    s_nop 0
    buffer_load_dwordx4 v13, s[4:7], s32 offen lds
    v_mfma_f32_32x32x16_bf16 v[80:95], v[52:55], a[212:215], v[80:95]
    ds_read_b128 v[52:55], v41 offset:512
    s_waitcnt lgkmcnt(3)
    v_mfma_f32_32x32x16_bf16 v[64:79], v[56:59], a[56:59], v[64:79]
    v_mfma_f32_32x32x16_bf16 v[80:95], v[56:59], a[216:219], v[80:95]
    ds_read_b128 v[56:59], v42 offset:512
    s_waitcnt lgkmcnt(3)
    v_mfma_f32_32x32x16_bf16 v[64:79], v[60:63], a[60:63], v[64:79]
    v_mfma_f32_32x32x16_bf16 v[80:95], v[60:63], a[220:223], v[80:95]
    ds_read_b128 v[60:63], v43 offset:512
    s_waitcnt lgkmcnt(3)
    v_mfma_f32_32x32x16_bf16 v[64:79], v[48:51], a[64:67], v[64:79]
    v_mfma_f32_32x32x16_bf16 v[80:95], v[48:51], a[224:227], v[80:95]
    ds_read_b128 v[48:51], v44 offset:512
    s_waitcnt lgkmcnt(3)
    v_mfma_f32_32x32x16_bf16 v[64:79], v[52:55], a[68:71], v[64:79]
    s_add_u32 m0, s38, 4096
    s_nop 0
    buffer_load_dwordx4 v14, s[4:7], s32 offen lds
    v_mfma_f32_32x32x16_bf16 v[80:95], v[52:55], a[228:231], v[80:95]
    ds_read_b128 v[52:55], v45 offset:512
    s_waitcnt lgkmcnt(3)
    v_mfma_f32_32x32x16_bf16 v[64:79], v[56:59], a[72:75], v[64:79]
    v_mfma_f32_32x32x16_bf16 v[80:95], v[56:59], a[232:235], v[80:95]
    ds_read_b128 v[56:59], v46 offset:512
    s_waitcnt lgkmcnt(3)
    v_mfma_f32_32x32x16_bf16 v[64:79], v[60:63], a[76:79], v[64:79]
    v_mfma_f32_32x32x16_bf16 v[80:95], v[60:63], a[236:239], v[80:95]
    ds_read_b128 v[60:63], v47 offset:512
    s_waitcnt lgkmcnt(3)
    v_mfma_f32_32x32x16_bf16 v[64:79], v[48:51], a[80:83], v[64:79]
    v_mfma_f32_32x32x16_bf16 v[80:95], v[48:51], a[240:243], v[80:95]
    ds_read_b128 v[48:51], v40 offset:768
    s_waitcnt lgkmcnt(3)
    v_mfma_f32_32x32x16_bf16 v[64:79], v[52:55], a[84:87], v[64:79]
    s_add_u32 m0, s38, 5120
    s_nop 0
    buffer_load_dwordx4 v15, s[4:7], s32 offen lds
    v_mfma_f32_32x32x16_bf16 v[80:95], v[52:55], a[244:247], v[80:95]
    ds_read_b128 v[52:55], v41 offset:768
    s_waitcnt lgkmcnt(3)
    v_mfma_f32_32x32x16_bf16 v[64:79], v[56:59], a[88:91], v[64:79]
    v_mfma_f32_32x32x16_bf16 v[80:95], v[56:59], a[248:251], v[80:95]
    ds_read_b128 v[56:59], v42 offset:768
    s_waitcnt lgkmcnt(3)
    v_mfma_f32_32x32x16_bf16 v[64:79], v[60:63], a[92:95], v[64:79]
    v_mfma_f32_32x32x16_bf16 v[80:95], v[60:63], a[252:255], v[80:95]
    ds_read_b128 v[60:63], v43 offset:768
    s_waitcnt lgkmcnt(3)
    v_mfma_f32_32x32x16_bf16 v[64:79], v[48:51], a[96:99], v[64:79]
    v_mfma_f32_32x32x16_bf16 v[80:95], v[48:51], v[192:195], v[80:95]
    ds_read_b128 v[48:51], v44 offset:768
    s_waitcnt lgkmcnt(3)
    v_mfma_f32_32x32x16_bf16 v[64:79], v[52:55], a[100:103], v[64:79]
    s_add_u32 m0, s38, 6144
    s_nop 0
    buffer_load_dwordx4 v16, s[4:7], s32 offen lds
    v_mfma_f32_32x32x16_bf16 v[80:95], v[52:55], v[196:199], v[80:95]
    ds_read_b128 v[52:55], v45 offset:768
    s_waitcnt lgkmcnt(3)
    v_mfma_f32_32x32x16_bf16 v[64:79], v[56:59], a[104:107], v[64:79]
    v_mfma_f32_32x32x16_bf16 v[80:95], v[56:59], v[200:203], v[80:95]
    ds_read_b128 v[56:59], v46 offset:768
    s_waitcnt lgkmcnt(3)
    v_mfma_f32_32x32x16_bf16 v[64:79], v[60:63], a[108:111], v[64:79]
    v_mfma_f32_32x32x16_bf16 v[80:95], v[60:63], v[204:207], v[80:95]
    ds_read_b128 v[60:63], v47 offset:768
    s_waitcnt lgkmcnt(3)
    v_mfma_f32_32x32x16_bf16 v[64:79], v[48:51], a[112:115], v[64:79]
    v_mfma_f32_32x32x16_bf16 v[80:95], v[48:51], v[208:211], v[80:95]
    ds_read_b128 v[48:51], v40 offset:1024
    s_waitcnt lgkmcnt(3)
    v_mfma_f32_32x32x16_bf16 v[64:79], v[52:55], a[116:119], v[64:79]
    s_add_u32 m0, s38, 7168
    s_nop 0
    buffer_load_dwordx4 v17, s[4:7], s32 offen lds
    v_mfma_f32_32x32x16_bf16 v[80:95], v[52:55], v[212:215], v[80:95]
    ds_read_b128 v[52:55], v41 offset:1024
    s_waitcnt lgkmcnt(3)
    v_mfma_f32_32x32x16_bf16 v[64:79], v[56:59], a[120:123], v[64:79]
    v_mfma_f32_32x32x16_bf16 v[80:95], v[56:59], v[216:219], v[80:95]
    ds_read_b128 v[56:59], v42 offset:1024
    s_waitcnt lgkmcnt(3)
    v_mfma_f32_32x32x16_bf16 v[64:79], v[60:63], a[124:127], v[64:79]
    v_mfma_f32_32x32x16_bf16 v[80:95], v[60:63], v[220:223], v[80:95]
    ds_read_b128 v[60:63], v43 offset:1024
    s_waitcnt lgkmcnt(3)
    v_mfma_f32_32x32x16_bf16 v[64:79], v[48:51], a[128:131], v[64:79]
    v_mfma_f32_32x32x16_bf16 v[80:95], v[48:51], v[224:227], v[80:95]
    ds_read_b128 v[48:51], v44 offset:1024
    s_waitcnt lgkmcnt(3)
    v_mfma_f32_32x32x16_bf16 v[64:79], v[52:55], a[132:135], v[64:79]
    s_add_u32 m0, s38, 8192
    s_nop 0
    buffer_load_dwordx4 v18, s[4:7], s32 offen lds
    v_mfma_f32_32x32x16_bf16 v[80:95], v[52:55], v[228:231], v[80:95]
    ds_read_b128 v[52:55], v45 offset:1024
    s_waitcnt lgkmcnt(3)
    v_mfma_f32_32x32x16_bf16 v[64:79], v[56:59], a[136:139], v[64:79]
    v_mfma_f32_32x32x16_bf16 v[80:95], v[56:59], v[232:235], v[80:95]
    ds_read_b128 v[56:59], v46 offset:1024
    s_waitcnt lgkmcnt(3)
    v_mfma_f32_32x32x16_bf16 v[64:79], v[60:63], a[140:143], v[64:79]
    v_mfma_f32_32x32x16_bf16 v[80:95], v[60:63], v[236:239], v[80:95]
    ds_read_b128 v[60:63], v47 offset:1024
    s_waitcnt lgkmcnt(3)
    v_mfma_f32_32x32x16_bf16 v[64:79], v[48:51], a[144:147], v[64:79]
    v_mfma_f32_32x32x16_bf16 v[80:95], v[48:51], v[240:243], v[80:95]
    s_waitcnt lgkmcnt(2)
    v_mfma_f32_32x32x16_bf16 v[64:79], v[52:55], a[148:151], v[64:79]
    s_add_u32 m0, s38, 9216
    s_nop 0
    buffer_load_dwordx4 v19, s[4:7], s32 offen lds
    v_mfma_f32_32x32x16_bf16 v[80:95], v[52:55], v[244:247], v[80:95]
    s_waitcnt lgkmcnt(1)
    v_mfma_f32_32x32x16_bf16 v[64:79], v[56:59], a[152:155], v[64:79]
    v_mfma_f32_32x32x16_bf16 v[80:95], v[56:59], v[248:251], v[80:95]
    s_waitcnt lgkmcnt(0)
    v_mfma_f32_32x32x16_bf16 v[64:79], v[60:63], a[156:159], v[64:79]
    v_mfma_f32_32x32x16_bf16 v[80:95], v[60:63], v[252:255], v[80:95]
    s_add_u32 s32, s32, 40960
    s_add_u32 s33, s33, 1
    s_mov_b32 s38, s34
    s_mov_b32 s34, s35
    s_mov_b32 s35, s36
    s_mov_b32 s36, s38
    s_cmp_ge_u32 s33, s19
    s_cbranch_scc1 L_pfa_213
    s_waitcnt vmcnt(10)
    s_barrier
L_ploop_212:
    v_add_u32 v40, s34, v20
    v_add_u32 v41, s34, v21
    v_add_u32 v42, s34, v22
    v_add_u32 v43, s34, v23
    v_add_u32 v44, s34, v24
    v_add_u32 v45, s34, v25
    v_add_u32 v46, s34, v26
    v_add_u32 v47, s34, v27
    ds_read_b128 v[48:51], v40 offset:0
    ds_read_b128 v[52:55], v41 offset:0
    ds_read_b128 v[56:59], v42 offset:0
    ds_read_b128 v[60:63], v43 offset:0
    s_waitcnt lgkmcnt(3)
    v_mfma_f32_32x32x16_bf16 v[96:111], v[48:51], a[0:3], 0
    v_mfma_f32_32x32x16_bf16 v[112:127], v[48:51], a[160:163], 0
    ds_read_b128 v[48:51], v44 offset:0
    s_waitcnt lgkmcnt(3)
    v_mfma_f32_32x32x16_bf16 v[96:111], v[52:55], a[4:7], v[96:111]
    s_add_u32 s38, s37, s36
    s_add_u32 m0, s38, 0
    s_nop 0
    buffer_load_dwordx4 v10, s[4:7], s32 offen lds
    v_mfma_f32_32x32x16_bf16 v[112:127], v[52:55], a[164:167], v[112:127]
    ds_read_b128 v[52:55], v45 offset:0
    s_waitcnt lgkmcnt(3)
    v_mfma_f32_32x32x16_bf16 v[96:111], v[56:59], a[8:11], v[96:111]
    v_mfma_f32_32x32x16_bf16 v[112:127], v[56:59], a[168:171], v[112:127]
    ds_read_b128 v[56:59], v46 offset:0
    s_waitcnt lgkmcnt(3)
    v_mfma_f32_32x32x16_bf16 v[96:111], v[60:63], a[12:15], v[96:111]
    v_cvt_pk_bf16_f32 v136, v64, v65
    v_mfma_f32_32x32x16_bf16 v[112:127], v[60:63], a[172:175], v[112:127]
    v_cvt_pk_bf16_f32 v137, v66, v67
    ds_read_b128 v[60:63], v47 offset:0
    s_waitcnt lgkmcnt(3)
    v_mfma_f32_32x32x16_bf16 v[96:111], v[48:51], a[16:19], v[96:111]
    v_cvt_pk_bf16_f32 v138, v68, v69
    v_mfma_f32_32x32x16_bf16 v[112:127], v[48:51], a[176:179], v[112:127]
    v_cvt_pk_bf16_f32 v139, v70, v71
    ds_read_b128 v[48:51], v40 offset:256
    s_waitcnt lgkmcnt(3)
    v_mfma_f32_32x32x16_bf16 v[96:111], v[52:55], a[20:23], v[96:111]
    v_xor_b32 v134, 0, v28
    v_permlane32_swap_b32 v136, v138
    v_permlane32_swap_b32 v137, v139
    ds_write_b128 v134, v[136:139] offset:0
    v_mfma_f32_32x32x16_bf16 v[112:127], v[52:55], a[180:183], v[112:127]
    s_add_u32 m0, s38, 1024
    s_nop 0
    buffer_load_dwordx4 v11, s[4:7], s32 offen lds
    ds_read_b128 v[52:55], v41 offset:256
    s_waitcnt lgkmcnt(4)
    v_mfma_f32_32x32x16_bf16 v[96:111], v[56:59], a[24:27], v[96:111]
    v_cvt_pk_bf16_f32 v140, v72, v73
    v_mfma_f32_32x32x16_bf16 v[112:127], v[56:59], a[184:187], v[112:127]
    v_cvt_pk_bf16_f32 v141, v74, v75
    ds_read_b128 v[56:59], v42 offset:256
    s_waitcnt lgkmcnt(4)
    v_mfma_f32_32x32x16_bf16 v[96:111], v[60:63], a[28:31], v[96:111]
    v_cvt_pk_bf16_f32 v142, v76, v77
    v_mfma_f32_32x32x16_bf16 v[112:127], v[60:63], a[188:191], v[112:127]
    v_cvt_pk_bf16_f32 v143, v78, v79
    ds_read_b128 v[60:63], v43 offset:256
    s_waitcnt lgkmcnt(4)
    v_mfma_f32_32x32x16_bf16 v[96:111], v[48:51], a[32:35], v[96:111]
    v_xor_b32 v134, 32, v28
    v_permlane32_swap_b32 v140, v142
    v_permlane32_swap_b32 v141, v143
    v_mfma_f32_32x32x16_bf16 v[112:127], v[48:51], a[192:195], v[112:127]
    ds_write_b128 v134, v[140:143] offset:0
    ds_read_b128 v[48:51], v44 offset:256
    s_waitcnt lgkmcnt(4)
    v_mfma_f32_32x32x16_bf16 v[96:111], v[52:55], a[36:39], v[96:111]
    v_cvt_pk_bf16_f32 v136, v80, v81
    v_cvt_pk_bf16_f32 v137, v82, v83
    v_mfma_f32_32x32x16_bf16 v[112:127], v[52:55], a[196:199], v[112:127]
    s_add_u32 m0, s38, 2048
    s_nop 0
    buffer_load_dwordx4 v12, s[4:7], s32 offen lds
    ds_read_b128 v[52:55], v45 offset:256
    s_waitcnt lgkmcnt(4)
    v_mfma_f32_32x32x16_bf16 v[96:111], v[56:59], a[40:43], v[96:111]
    v_cvt_pk_bf16_f32 v138, v84, v85
    v_mfma_f32_32x32x16_bf16 v[112:127], v[56:59], a[200:203], v[112:127]
    v_cvt_pk_bf16_f32 v139, v86, v87
    ds_read_b128 v[56:59], v46 offset:256
    s_waitcnt lgkmcnt(4)
    v_mfma_f32_32x32x16_bf16 v[96:111], v[60:63], a[44:47], v[96:111]
    v_xor_b32 v134, 0, v28
    v_permlane32_swap_b32 v136, v138
    v_permlane32_swap_b32 v137, v139
    v_mfma_f32_32x32x16_bf16 v[112:127], v[60:63], a[204:207], v[112:127]
    ds_write_b128 v134, v[136:139] offset:2048
    ds_read_b128 v[60:63], v47 offset:256
    s_waitcnt lgkmcnt(4)
    v_mfma_f32_32x32x16_bf16 v[96:111], v[48:51], a[48:51], v[96:111]
    v_cvt_pk_bf16_f32 v140, v88, v89
    v_mfma_f32_32x32x16_bf16 v[112:127], v[48:51], a[208:211], v[112:127]
    v_cvt_pk_bf16_f32 v141, v90, v91
    ds_read_b128 v[48:51], v40 offset:512
    s_waitcnt lgkmcnt(4)
    v_mfma_f32_32x32x16_bf16 v[96:111], v[52:55], a[52:55], v[96:111]
    v_cvt_pk_bf16_f32 v142, v92, v93
    v_cvt_pk_bf16_f32 v143, v94, v95
    v_mfma_f32_32x32x16_bf16 v[112:127], v[52:55], a[212:215], v[112:127]
    s_add_u32 m0, s38, 3072
    s_nop 0
    buffer_load_dwordx4 v13, s[4:7], s32 offen lds
    ds_read_b128 v[52:55], v41 offset:512
    s_waitcnt lgkmcnt(4)
    v_mfma_f32_32x32x16_bf16 v[96:111], v[56:59], a[56:59], v[96:111]
    v_xor_b32 v134, 32, v28
    v_permlane32_swap_b32 v140, v142
    v_permlane32_swap_b32 v141, v143
    v_mfma_f32_32x32x16_bf16 v[112:127], v[56:59], a[216:219], v[112:127]
    ds_write_b128 v134, v[140:143] offset:2048
    ds_read_b128 v[56:59], v42 offset:512
    s_waitcnt lgkmcnt(4)
    v_mfma_f32_32x32x16_bf16 v[96:111], v[60:63], a[60:63], v[96:111]
    v_mfma_f32_32x32x16_bf16 v[112:127], v[60:63], a[220:223], v[112:127]
    ds_read_b128 v[60:63], v43 offset:512
    s_waitcnt lgkmcnt(4)
    v_mfma_f32_32x32x16_bf16 v[96:111], v[48:51], a[64:67], v[96:111]
    v_mfma_f32_32x32x16_bf16 v[112:127], v[48:51], a[224:227], v[112:127]
    ds_read_b128 v[48:51], v44 offset:512
    s_waitcnt lgkmcnt(4)
    v_mfma_f32_32x32x16_bf16 v[96:111], v[52:55], a[68:71], v[96:111]
    s_waitcnt lgkmcnt(3)
    ds_read_b128 v[144:147], v29 offset:0
    v_mfma_f32_32x32x16_bf16 v[112:127], v[52:55], a[228:231], v[112:127]
    s_add_u32 m0, s38, 4096
    s_nop 0
    buffer_load_dwordx4 v14, s[4:7], s32 offen lds
    ds_read_b128 v[52:55], v45 offset:512
    s_waitcnt lgkmcnt(4)
    v_mfma_f32_32x32x16_bf16 v[96:111], v[56:59], a[72:75], v[96:111]
    v_mfma_f32_32x32x16_bf16 v[112:127], v[56:59], a[232:235], v[112:127]
    ds_read_b128 v[56:59], v46 offset:512
    s_waitcnt lgkmcnt(4)
    v_mfma_f32_32x32x16_bf16 v[96:111], v[60:63], a[76:79], v[96:111]
    v_mfma_f32_32x32x16_bf16 v[112:127], v[60:63], a[236:239], v[112:127]
    ds_read_b128 v[60:63], v47 offset:512
    s_waitcnt lgkmcnt(4)
    v_mfma_f32_32x32x16_bf16 v[96:111], v[48:51], a[80:83], v[96:111]
    s_waitcnt lgkmcnt(3)
    buffer_store_dwordx4 v[144:147], v30, s[4:7], s31 offen offset:0 sc1
    v_mfma_f32_32x32x16_bf16 v[112:127], v[48:51], a[240:243], v[112:127]
    ds_read_b128 v[48:51], v40 offset:768
    s_waitcnt lgkmcnt(3)
    v_mfma_f32_32x32x16_bf16 v[96:111], v[52:55], a[84:87], v[96:111]
    ds_read_b128 v[148:151], v29 offset:1024
    v_mfma_f32_32x32x16_bf16 v[112:127], v[52:55], a[244:247], v[112:127]
    s_add_u32 m0, s38, 5120
    s_nop 0
    buffer_load_dwordx4 v15, s[4:7], s32 offen lds
    ds_read_b128 v[52:55], v41 offset:768
    s_waitcnt lgkmcnt(4)
    v_mfma_f32_32x32x16_bf16 v[96:111], v[56:59], a[88:91], v[96:111]
    v_mfma_f32_32x32x16_bf16 v[112:127], v[56:59], a[248:251], v[112:127]
    ds_read_b128 v[56:59], v42 offset:768
    s_waitcnt lgkmcnt(4)
    v_mfma_f32_32x32x16_bf16 v[96:111], v[60:63], a[92:95], v[96:111]
    v_mfma_f32_32x32x16_bf16 v[112:127], v[60:63], a[252:255], v[112:127]
    ds_read_b128 v[60:63], v43 offset:768
    s_waitcnt lgkmcnt(4)
    v_mfma_f32_32x32x16_bf16 v[96:111], v[48:51], a[96:99], v[96:111]
    s_waitcnt lgkmcnt(3)
    buffer_store_dwordx4 v[148:151], v30, s[4:7], s31 offen offset:1024 sc1
    v_mfma_f32_32x32x16_bf16 v[112:127], v[48:51], v[192:195], v[112:127]
    ds_read_b128 v[48:51], v44 offset:768
    s_waitcnt lgkmcnt(3)
    v_mfma_f32_32x32x16_bf16 v[96:111], v[52:55], a[100:103], v[96:111]
    ds_read_b128 v[152:155], v29 offset:2048
    v_mfma_f32_32x32x16_bf16 v[112:127], v[52:55], v[196:199], v[112:127]
    s_add_u32 m0, s38, 6144
    s_nop 0
    buffer_load_dwordx4 v16, s[4:7], s32 offen lds
    ds_read_b128 v[52:55], v45 offset:768
    s_waitcnt lgkmcnt(4)
    v_mfma_f32_32x32x16_bf16 v[96:111], v[56:59], a[104:107], v[96:111]
    v_mfma_f32_32x32x16_bf16 v[112:127], v[56:59], v[200:203], v[112:127]
    ds_read_b128 v[56:59], v46 offset:768
    s_waitcnt lgkmcnt(4)
    v_mfma_f32_32x32x16_bf16 v[96:111], v[60:63], a[108:111], v[96:111]
    v_mfma_f32_32x32x16_bf16 v[112:127], v[60:63], v[204:207], v[112:127]
    ds_read_b128 v[60:63], v47 offset:768
    s_waitcnt lgkmcnt(4)
    v_mfma_f32_32x32x16_bf16 v[96:111], v[48:51], a[112:115], v[96:111]
    s_waitcnt lgkmcnt(3)
    buffer_store_dwordx4 v[152:155], v30, s[4:7], s31 offen offset:2048 sc1
    v_mfma_f32_32x32x16_bf16 v[112:127], v[48:51], v[208:211], v[112:127]
    ds_read_b128 v[48:51], v40 offset:1024
    s_waitcnt lgkmcnt(3)
    v_mfma_f32_32x32x16_bf16 v[96:111], v[52:55], a[116:119], v[96:111]
    ds_read_b128 v[156:159], v29 offset:3072
    v_mfma_f32_32x32x16_bf16 v[112:127], v[52:55], v[212:215], v[112:127]
    s_add_u32 m0, s38, 7168
    s_nop 0
    buffer_load_dwordx4 v17, s[4:7], s32 offen lds
    ds_read_b128 v[52:55], v41 offset:1024
    s_waitcnt lgkmcnt(4)
    v_mfma_f32_32x32x16_bf16 v[96:111], v[56:59], a[120:123], v[96:111]
    v_mfma_f32_32x32x16_bf16 v[112:127], v[56:59], v[216:219], v[112:127]
    ds_read_b128 v[56:59], v42 offset:1024
    s_waitcnt lgkmcnt(4)
    v_mfma_f32_32x32x16_bf16 v[96:111], v[60:63], a[124:127], v[96:111]
    v_mfma_f32_32x32x16_bf16 v[112:127], v[60:63], v[220:223], v[112:127]
    ds_read_b128 v[60:63], v43 offset:1024
    s_waitcnt lgkmcnt(4)
    v_mfma_f32_32x32x16_bf16 v[96:111], v[48:51], a[128:131], v[96:111]
    s_waitcnt lgkmcnt(3)
    buffer_store_dwordx4 v[156:159], v30, s[4:7], s31 offen offset:3072 sc1
    v_mfma_f32_32x32x16_bf16 v[112:127], v[48:51], v[224:227], v[112:127]
    ds_read_b128 v[48:51], v44 offset:1024
    s_waitcnt lgkmcnt(3)
    v_mfma_f32_32x32x16_bf16 v[96:111], v[52:55], a[132:135], v[96:111]
    s_add_u32 m0, s38, 8192
    s_nop 0
    buffer_load_dwordx4 v18, s[4:7], s32 offen lds
    v_mfma_f32_32x32x16_bf16 v[112:127], v[52:55], v[228:231], v[112:127]
    ds_read_b128 v[52:55], v45 offset:1024
    s_waitcnt lgkmcnt(3)
    v_mfma_f32_32x32x16_bf16 v[96:111], v[56:59], a[136:139], v[96:111]
    v_mfma_f32_32x32x16_bf16 v[112:127], v[56:59], v[232:235], v[112:127]
    ds_read_b128 v[56:59], v46 offset:1024
    s_waitcnt lgkmcnt(3)
    v_mfma_f32_32x32x16_bf16 v[96:111], v[60:63], a[140:143], v[96:111]
    v_mfma_f32_32x32x16_bf16 v[112:127], v[60:63], v[236:239], v[112:127]
    ds_read_b128 v[60:63], v47 offset:1024
    s_waitcnt lgkmcnt(3)
    v_mfma_f32_32x32x16_bf16 v[96:111], v[48:51], a[144:147], v[96:111]
    v_mfma_f32_32x32x16_bf16 v[112:127], v[48:51], v[240:243], v[112:127]
    s_waitcnt lgkmcnt(2)
    v_mfma_f32_32x32x16_bf16 v[96:111], v[52:55], a[148:151], v[96:111]
    s_add_u32 m0, s38, 9216
    s_nop 0
    buffer_load_dwordx4 v19, s[4:7], s32 offen lds
    v_mfma_f32_32x32x16_bf16 v[112:127], v[52:55], v[244:247], v[112:127]
    s_waitcnt lgkmcnt(1)
    v_mfma_f32_32x32x16_bf16 v[96:111], v[56:59], a[152:155], v[96:111]
    v_mfma_f32_32x32x16_bf16 v[112:127], v[56:59], v[248:251], v[112:127]
    s_waitcnt lgkmcnt(0)
    v_mfma_f32_32x32x16_bf16 v[96:111], v[60:63], a[156:159], v[96:111]
    v_mfma_f32_32x32x16_bf16 v[112:127], v[60:63], v[252:255], v[112:127]
    s_add_u32 s32, s32, 40960
    s_add_u32 s31, s31, s30
    s_add_u32 s33, s33, 1
    s_mov_b32 s38, s34
    s_mov_b32 s34, s35
    s_mov_b32 s35, s36
    s_mov_b32 s36, s38
    s_cmp_ge_u32 s33, s19
    s_cbranch_scc1 L_pfb_214
    s_waitcnt vmcnt(14)
    s_barrier
    s_sub_u32 s39, s33, 2
    s_cmp_lg_u32 s16, 0
    s_cbranch_scc1 L_pp_215
    v_mov_b32 v9, s39
    s_mov_b64 exec, 1
    buffer_store_dword v9, v31, s[4:7], 0 offen sc1
    s_mov_b64 exec, -1
L_pp_215:
    v_add_u32 v40, s34, v20
    v_add_u32 v41, s34, v21
    v_add_u32 v42, s34, v22
    v_add_u32 v43, s34, v23
    v_add_u32 v44, s34, v24
    v_add_u32 v45, s34, v25
    v_add_u32 v46, s34, v26
    v_add_u32 v47, s34, v27
    ds_read_b128 v[48:51], v40 offset:0
    ds_read_b128 v[52:55], v41 offset:0
    ds_read_b128 v[56:59], v42 offset:0
    ds_read_b128 v[60:63], v43 offset:0
    s_waitcnt lgkmcnt(3)
    v_mfma_f32_32x32x16_bf16 v[64:79], v[48:51], a[0:3], 0
    v_mfma_f32_32x32x16_bf16 v[80:95], v[48:51], a[160:163], 0
    ds_read_b128 v[48:51], v44 offset:0
    s_waitcnt lgkmcnt(3)
    v_mfma_f32_32x32x16_bf16 v[64:79], v[52:55], a[4:7], v[64:79]
    s_add_u32 s38, s37, s36
    s_add_u32 m0, s38, 0
    s_nop 0
    buffer_load_dwordx4 v10, s[4:7], s32 offen lds
    v_mfma_f32_32x32x16_bf16 v[80:95], v[52:55], a[164:167], v[80:95]
    ds_read_b128 v[52:55], v45 offset:0
    s_waitcnt lgkmcnt(3)
    v_mfma_f32_32x32x16_bf16 v[64:79], v[56:59], a[8:11], v[64:79]
    v_mfma_f32_32x32x16_bf16 v[80:95], v[56:59], a[168:171], v[80:95]
    ds_read_b128 v[56:59], v46 offset:0
    s_waitcnt lgkmcnt(3)
    v_mfma_f32_32x32x16_bf16 v[64:79], v[60:63], a[12:15], v[64:79]
    v_cvt_pk_bf16_f32 v136, v96, v97
    v_mfma_f32_32x32x16_bf16 v[80:95], v[60:63], a[172:175], v[80:95]
    v_cvt_pk_bf16_f32 v137, v98, v99
    ds_read_b128 v[60:63], v47 offset:0
    s_waitcnt lgkmcnt(3)
    v_mfma_f32_32x32x16_bf16 v[64:79], v[48:51], a[16:19], v[64:79]
    v_cvt_pk_bf16_f32 v138, v100, v101
    v_mfma_f32_32x32x16_bf16 v[80:95], v[48:51], a[176:179], v[80:95]
    v_cvt_pk_bf16_f32 v139, v102, v103
    ds_read_b128 v[48:51], v40 offset:256
    s_waitcnt lgkmcnt(3)
    v_mfma_f32_32x32x16_bf16 v[64:79], v[52:55], a[20:23], v[64:79]
    v_xor_b32 v134, 0, v28
    v_permlane32_swap_b32 v136, v138
    v_permlane32_swap_b32 v137, v139
    ds_write_b128 v134, v[136:139] offset:0
    v_mfma_f32_32x32x16_bf16 v[80:95], v[52:55], a[180:183], v[80:95]
    s_add_u32 m0, s38, 1024
    s_nop 0
    buffer_load_dwordx4 v11, s[4:7], s32 offen lds
    ds_read_b128 v[52:55], v41 offset:256
    s_waitcnt lgkmcnt(4)
    v_mfma_f32_32x32x16_bf16 v[64:79], v[56:59], a[24:27], v[64:79]
    v_cvt_pk_bf16_f32 v140, v104, v105
    v_mfma_f32_32x32x16_bf16 v[80:95], v[56:59], a[184:187], v[80:95]
    v_cvt_pk_bf16_f32 v141, v106, v107
    ds_read_b128 v[56:59], v42 offset:256
    s_waitcnt lgkmcnt(4)
    v_mfma_f32_32x32x16_bf16 v[64:79], v[60:63], a[28:31], v[64:79]
    v_cvt_pk_bf16_f32 v142, v108, v109
    v_mfma_f32_32x32x16_bf16 v[80:95], v[60:63], a[188:191], v[80:95]
    v_cvt_pk_bf16_f32 v143, v110, v111
    ds_read_b128 v[60:63], v43 offset:256
    s_waitcnt lgkmcnt(4)
    v_mfma_f32_32x32x16_bf16 v[64:79], v[48:51], a[32:35], v[64:79]
    v_xor_b32 v134, 32, v28
    v_permlane32_swap_b32 v140, v142
    v_permlane32_swap_b32 v141, v143
    v_mfma_f32_32x32x16_bf16 v[80:95], v[48:51], a[192:195], v[80:95]
    ds_write_b128 v134, v[140:143] offset:0
    ds_read_b128 v[48:51], v44 offset:256
    s_waitcnt lgkmcnt(4)
    v_mfma_f32_32x32x16_bf16 v[64:79], v[52:55], a[36:39], v[64:79]
    v_cvt_pk_bf16_f32 v136, v112, v113
    v_cvt_pk_bf16_f32 v137, v114, v115
    v_mfma_f32_32x32x16_bf16 v[80:95], v[52:55], a[196:199], v[80:95]
    s_add_u32 m0, s38, 2048
    s_nop 0
    buffer_load_dwordx4 v12, s[4:7], s32 offen lds
    ds_read_b128 v[52:55], v45 offset:256
    s_waitcnt lgkmcnt(4)
    v_mfma_f32_32x32x16_bf16 v[64:79], v[56:59], a[40:43], v[64:79]
    v_cvt_pk_bf16_f32 v138, v116, v117
    v_mfma_f32_32x32x16_bf16 v[80:95], v[56:59], a[200:203], v[80:95]
    v_cvt_pk_bf16_f32 v139, v118, v119
    ds_read_b128 v[56:59], v46 offset:256
    s_waitcnt lgkmcnt(4)
    v_mfma_f32_32x32x16_bf16 v[64:79], v[60:63], a[44:47], v[64:79]
    v_xor_b32 v134, 0, v28
    v_permlane32_swap_b32 v136, v138
    v_permlane32_swap_b32 v137, v139
    v_mfma_f32_32x32x16_bf16 v[80:95], v[60:63], a[204:207], v[80:95]
    ds_write_b128 v134, v[136:139] offset:2048
    ds_read_b128 v[60:63], v47 offset:256
    s_waitcnt lgkmcnt(4)
    v_mfma_f32_32x32x16_bf16 v[64:79], v[48:51], a[48:51], v[64:79]
    v_cvt_pk_bf16_f32 v140, v120, v121
    v_mfma_f32_32x32x16_bf16 v[80:95], v[48:51], a[208:211], v[80:95]
    v_cvt_pk_bf16_f32 v141, v122, v123
    ds_read_b128 v[48:51], v40 offset:512
    s_waitcnt lgkmcnt(4)
    v_mfma_f32_32x32x16_bf16 v[64:79], v[52:55], a[52:55], v[64:79]
    v_cvt_pk_bf16_f32 v142, v124, v125
    v_cvt_pk_bf16_f32 v143, v126, v127
    v_mfma_f32_32x32x16_bf16 v[80:95], v[52:55], a[212:215], v[80:95]
    s_add_u32 m0, s38, 3072
    s_nop 0
    buffer_load_dwordx4 v13, s[4:7], s32 offen lds
    ds_read_b128 v[52:55], v41 offset:512
    s_waitcnt lgkmcnt(4)
    v_mfma_f32_32x32x16_bf16 v[64:79], v[56:59], a[56:59], v[64:79]
    v_xor_b32 v134, 32, v28
    v_permlane32_swap_b32 v140, v142
    v_permlane32_swap_b32 v141, v143
    v_mfma_f32_32x32x16_bf16 v[80:95], v[56:59], a[216:219], v[80:95]
    ds_write_b128 v134, v[140:143] offset:2048
    ds_read_b128 v[56:59], v42 offset:512
    s_waitcnt lgkmcnt(4)
    v_mfma_f32_32x32x16_bf16 v[64:79], v[60:63], a[60:63], v[64:79]
    v_mfma_f32_32x32x16_bf16 v[80:95], v[60:63], a[220:223], v[80:95]
    ds_read_b128 v[60:63], v43 offset:512
    s_waitcnt lgkmcnt(4)
    v_mfma_f32_32x32x16_bf16 v[64:79], v[48:51], a[64:67], v[64:79]
    v_mfma_f32_32x32x16_bf16 v[80:95], v[48:51], a[224:227], v[80:95]
    ds_read_b128 v[48:51], v44 offset:512
    s_waitcnt lgkmcnt(4)
    v_mfma_f32_32x32x16_bf16 v[64:79], v[52:55], a[68:71], v[64:79]
    s_waitcnt lgkmcnt(3)
    ds_read_b128 v[144:147], v29 offset:0
    v_mfma_f32_32x32x16_bf16 v[80:95], v[52:55], a[228:231], v[80:95]
    s_add_u32 m0, s38, 4096
    s_nop 0
    buffer_load_dwordx4 v14, s[4:7], s32 offen lds
    ds_read_b128 v[52:55], v45 offset:512
    s_waitcnt lgkmcnt(4)
    v_mfma_f32_32x32x16_bf16 v[64:79], v[56:59], a[72:75], v[64:79]
    v_mfma_f32_32x32x16_bf16 v[80:95], v[56:59], a[232:235], v[80:95]
    ds_read_b128 v[56:59], v46 offset:512
    s_waitcnt lgkmcnt(4)
    v_mfma_f32_32x32x16_bf16 v[64:79], v[60:63], a[76:79], v[64:79]
    v_mfma_f32_32x32x16_bf16 v[80:95], v[60:63], a[236:239], v[80:95]
    ds_read_b128 v[60:63], v47 offset:512
    s_waitcnt lgkmcnt(4)
    v_mfma_f32_32x32x16_bf16 v[64:79], v[48:51], a[80:83], v[64:79]
    s_waitcnt lgkmcnt(3)
    buffer_store_dwordx4 v[144:147], v30, s[4:7], s31 offen offset:0 sc1
    v_mfma_f32_32x32x16_bf16 v[80:95], v[48:51], a[240:243], v[80:95]
    ds_read_b128 v[48:51], v40 offset:768
    s_waitcnt lgkmcnt(3)
    v_mfma_f32_32x32x16_bf16 v[64:79], v[52:55], a[84:87], v[64:79]
    ds_read_b128 v[148:151], v29 offset:1024
    v_mfma_f32_32x32x16_bf16 v[80:95], v[52:55], a[244:247], v[80:95]
    s_add_u32 m0, s38, 5120
    s_nop 0
    buffer_load_dwordx4 v15, s[4:7], s32 offen lds
    ds_read_b128 v[52:55], v41 offset:768
    s_waitcnt lgkmcnt(4)
    v_mfma_f32_32x32x16_bf16 v[64:79], v[56:59], a[88:91], v[64:79]
    v_mfma_f32_32x32x16_bf16 v[80:95], v[56:59], a[248:251], v[80:95]
    ds_read_b128 v[56:59], v42 offset:768
    s_waitcnt lgkmcnt(4)
    v_mfma_f32_32x32x16_bf16 v[64:79], v[60:63], a[92:95], v[64:79]
    v_mfma_f32_32x32x16_bf16 v[80:95], v[60:63], a[252:255], v[80:95]
    ds_read_b128 v[60:63], v43 offset:768
    s_waitcnt lgkmcnt(4)
    v_mfma_f32_32x32x16_bf16 v[64:79], v[48:51], a[96:99], v[64:79]
    s_waitcnt lgkmcnt(3)
    buffer_store_dwordx4 v[148:151], v30, s[4:7], s31 offen offset:1024 sc1
    v_mfma_f32_32x32x16_bf16 v[80:95], v[48:51], v[192:195], v[80:95]
    ds_read_b128 v[48:51], v44 offset:768
    s_waitcnt lgkmcnt(3)
    v_mfma_f32_32x32x16_bf16 v[64:79], v[52:55], a[100:103], v[64:79]
    ds_read_b128 v[152:155], v29 offset:2048
    v_mfma_f32_32x32x16_bf16 v[80:95], v[52:55], v[196:199], v[80:95]
    s_add_u32 m0, s38, 6144
    s_nop 0
    buffer_load_dwordx4 v16, s[4:7], s32 offen lds
    ds_read_b128 v[52:55], v45 offset:768
    s_waitcnt lgkmcnt(4)
    v_mfma_f32_32x32x16_bf16 v[64:79], v[56:59], a[104:107], v[64:79]
    v_mfma_f32_32x32x16_bf16 v[80:95], v[56:59], v[200:203], v[80:95]
    ds_read_b128 v[56:59], v46 offset:768
    s_waitcnt lgkmcnt(4)
    v_mfma_f32_32x32x16_bf16 v[64:79], v[60:63], a[108:111], v[64:79]
    v_mfma_f32_32x32x16_bf16 v[80:95], v[60:63], v[204:207], v[80:95]
    ds_read_b128 v[60:63], v47 offset:768
    s_waitcnt lgkmcnt(4)
    v_mfma_f32_32x32x16_bf16 v[64:79], v[48:51], a[112:115], v[64:79]
    s_waitcnt lgkmcnt(3)
    buffer_store_dwordx4 v[152:155], v30, s[4:7], s31 offen offset:2048 sc1
    v_mfma_f32_32x32x16_bf16 v[80:95], v[48:51], v[208:211], v[80:95]
    ds_read_b128 v[48:51], v40 offset:1024
    s_waitcnt lgkmcnt(3)
    v_mfma_f32_32x32x16_bf16 v[64:79], v[52:55], a[116:119], v[64:79]
    ds_read_b128 v[156:159], v29 offset:3072
    v_mfma_f32_32x32x16_bf16 v[80:95], v[52:55], v[212:215], v[80:95]
    s_add_u32 m0, s38, 7168
    s_nop 0
    buffer_load_dwordx4 v17, s[4:7], s32 offen lds
    ds_read_b128 v[52:55], v41 offset:1024
    s_waitcnt lgkmcnt(4)
    v_mfma_f32_32x32x16_bf16 v[64:79], v[56:59], a[120:123], v[64:79]
    v_mfma_f32_32x32x16_bf16 v[80:95], v[56:59], v[216:219], v[80:95]
    ds_read_b128 v[56:59], v42 offset:1024
    s_waitcnt lgkmcnt(4)
    v_mfma_f32_32x32x16_bf16 v[64:79], v[60:63], a[124:127], v[64:79]
    v_mfma_f32_32x32x16_bf16 v[80:95], v[60:63], v[220:223], v[80:95]
    ds_read_b128 v[60:63], v43 offset:1024
    s_waitcnt lgkmcnt(4)
    v_mfma_f32_32x32x16_bf16 v[64:79], v[48:51], a[128:131], v[64:79]
    s_waitcnt lgkmcnt(3)
    buffer_store_dwordx4 v[156:159], v30, s[4:7], s31 offen offset:3072 sc1
    v_mfma_f32_32x32x16_bf16 v[80:95], v[48:51], v[224:227], v[80:95]
    ds_read_b128 v[48:51], v44 offset:1024
    s_waitcnt lgkmcnt(3)
    v_mfma_f32_32x32x16_bf16 v[64:79], v[52:55], a[132:135], v[64:79]
    s_add_u32 m0, s38, 8192
    s_nop 0
    buffer_load_dwordx4 v18, s[4:7], s32 offen lds
    v_mfma_f32_32x32x16_bf16 v[80:95], v[52:55], v[228:231], v[80:95]
    ds_read_b128 v[52:55], v45 offset:1024
    s_waitcnt lgkmcnt(3)
    v_mfma_f32_32x32x16_bf16 v[64:79], v[56:59], a[136:139], v[64:79]
    v_mfma_f32_32x32x16_bf16 v[80:95], v[56:59], v[232:235], v[80:95]
    ds_read_b128 v[56:59], v46 offset:1024
    s_waitcnt lgkmcnt(3)
    v_mfma_f32_32x32x16_bf16 v[64:79], v[60:63], a[140:143], v[64:79]
    v_mfma_f32_32x32x16_bf16 v[80:95], v[60:63], v[236:239], v[80:95]
    ds_read_b128 v[60:63], v47 offset:1024
    s_waitcnt lgkmcnt(3)
    v_mfma_f32_32x32x16_bf16 v[64:79], v[48:51], a[144:147], v[64:79]
    v_mfma_f32_32x32x16_bf16 v[80:95], v[48:51], v[240:243], v[80:95]
    s_waitcnt lgkmcnt(2)
    v_mfma_f32_32x32x16_bf16 v[64:79], v[52:55], a[148:151], v[64:79]
    s_add_u32 m0, s38, 9216
    s_nop 0
    buffer_load_dwordx4 v19, s[4:7], s32 offen lds
    v_mfma_f32_32x32x16_bf16 v[80:95], v[52:55], v[244:247], v[80:95]
    s_waitcnt lgkmcnt(1)
    v_mfma_f32_32x32x16_bf16 v[64:79], v[56:59], a[152:155], v[64:79]
    v_mfma_f32_32x32x16_bf16 v[80:95], v[56:59], v[248:251], v[80:95]
    s_waitcnt lgkmcnt(0)
    v_mfma_f32_32x32x16_bf16 v[64:79], v[60:63], a[156:159], v[64:79]
    v_mfma_f32_32x32x16_bf16 v[80:95], v[60:63], v[252:255], v[80:95]
    s_add_u32 s32, s32, 40960
    s_add_u32 s31, s31, s30
    s_add_u32 s33, s33, 1
    s_mov_b32 s38, s34
    s_mov_b32 s34, s35
    s_mov_b32 s35, s36
    s_mov_b32 s36, s38
    s_cmp_ge_u32 s33, s19
    s_cbranch_scc1 L_pfa_213
    s_waitcnt vmcnt(14)
    s_barrier
    s_sub_u32 s39, s33, 2
    s_cmp_lg_u32 s16, 0
    s_cbranch_scc1 L_pp_216
    v_mov_b32 v9, s39
    s_mov_b64 exec, 1
    buffer_store_dword v9, v31, s[4:7], 0 offen sc1
    s_mov_b64 exec, -1
L_pp_216:
    s_branch L_ploop_212
L_pfa_213:
    s_nop 7
    s_nop 3
    v_cvt_pk_bf16_f32 v136, v64, v65
    v_cvt_pk_bf16_f32 v137, v66, v67
    v_cvt_pk_bf16_f32 v138, v68, v69
    v_cvt_pk_bf16_f32 v139, v70, v71
    v_xor_b32 v134, 0, v28
    v_permlane32_swap_b32 v136, v138
    v_permlane32_swap_b32 v137, v139
    ds_write_b128 v134, v[136:139] offset:0
    v_cvt_pk_bf16_f32 v140, v72, v73
    v_cvt_pk_bf16_f32 v141, v74, v75
    v_cvt_pk_bf16_f32 v142, v76, v77
    v_cvt_pk_bf16_f32 v143, v78, v79
    v_xor_b32 v134, 32, v28
    v_permlane32_swap_b32 v140, v142
    v_permlane32_swap_b32 v141, v143
    ds_write_b128 v134, v[140:143] offset:0
    v_cvt_pk_bf16_f32 v136, v80, v81
    v_cvt_pk_bf16_f32 v137, v82, v83
    v_cvt_pk_bf16_f32 v138, v84, v85
    v_cvt_pk_bf16_f32 v139, v86, v87
    v_xor_b32 v134, 0, v28
    v_permlane32_swap_b32 v136, v138
    v_permlane32_swap_b32 v137, v139
    ds_write_b128 v134, v[136:139] offset:2048
    v_cvt_pk_bf16_f32 v140, v88, v89
    v_cvt_pk_bf16_f32 v141, v90, v91
    v_cvt_pk_bf16_f32 v142, v92, v93
    v_cvt_pk_bf16_f32 v143, v94, v95
    v_xor_b32 v134, 32, v28
    v_permlane32_swap_b32 v140, v142
    v_permlane32_swap_b32 v141, v143
    ds_write_b128 v134, v[140:143] offset:2048
    s_waitcnt lgkmcnt(0)
    ds_read_b128 v[144:147], v29 offset:0
    ds_read_b128 v[148:151], v29 offset:1024
    ds_read_b128 v[152:155], v29 offset:2048
    ds_read_b128 v[156:159], v29 offset:3072
    s_waitcnt lgkmcnt(3)
    buffer_store_dwordx4 v[144:147], v30, s[4:7], s31 offen offset:0 sc1
    s_waitcnt lgkmcnt(2)
    buffer_store_dwordx4 v[148:151], v30, s[4:7], s31 offen offset:1024 sc1
    s_waitcnt lgkmcnt(1)
    buffer_store_dwordx4 v[152:155], v30, s[4:7], s31 offen offset:2048 sc1
    s_waitcnt lgkmcnt(0)
    buffer_store_dwordx4 v[156:159], v30, s[4:7], s31 offen offset:3072 sc1
    s_waitcnt vmcnt(0)
    s_barrier
    s_cmp_lg_u32 s16, 0
    s_cbranch_scc1 L_pp_217
    v_mov_b32 v9, s33
    s_mov_b64 exec, 1
    buffer_store_dword v9, v31, s[4:7], 0 offen sc1
    s_mov_b64 exec, -1
L_pp_217:
    s_branch L_pend_191
L_pfb_214:
    s_nop 7
    s_nop 3
    v_cvt_pk_bf16_f32 v136, v96, v97
    v_cvt_pk_bf16_f32 v137, v98, v99
    v_cvt_pk_bf16_f32 v138, v100, v101
    v_cvt_pk_bf16_f32 v139, v102, v103
    v_xor_b32 v134, 0, v28
    v_permlane32_swap_b32 v136, v138
    v_permlane32_swap_b32 v137, v139
    ds_write_b128 v134, v[136:139] offset:0
    v_cvt_pk_bf16_f32 v140, v104, v105
    v_cvt_pk_bf16_f32 v141, v106, v107
    v_cvt_pk_bf16_f32 v142, v108, v109
    v_cvt_pk_bf16_f32 v143, v110, v111
    v_xor_b32 v134, 32, v28
    v_permlane32_swap_b32 v140, v142
    v_permlane32_swap_b32 v141, v143
    ds_write_b128 v134, v[140:143] offset:0
    v_cvt_pk_bf16_f32 v136, v112, v113
    v_cvt_pk_bf16_f32 v137, v114, v115
    v_cvt_pk_bf16_f32 v138, v116, v117
    v_cvt_pk_bf16_f32 v139, v118, v119
    v_xor_b32 v134, 0, v28
    v_permlane32_swap_b32 v136, v138
    v_permlane32_swap_b32 v137, v139
    ds_write_b128 v134, v[136:139] offset:2048
    v_cvt_pk_bf16_f32 v140, v120, v121
    v_cvt_pk_bf16_f32 v141, v122, v123
    v_cvt_pk_bf16_f32 v142, v124, v125
    v_cvt_pk_bf16_f32 v143, v126, v127
    v_xor_b32 v134, 32, v28
    v_permlane32_swap_b32 v140, v142
    v_permlane32_swap_b32 v141, v143
    ds_write_b128 v134, v[140:143] offset:2048
    s_waitcnt lgkmcnt(0)
    ds_read_b128 v[144:147], v29 offset:0
    ds_read_b128 v[148:151], v29 offset:1024
    ds_read_b128 v[152:155], v29 offset:2048
    ds_read_b128 v[156:159], v29 offset:3072
    s_waitcnt lgkmcnt(3)
    buffer_store_dwordx4 v[144:147], v30, s[4:7], s31 offen offset:0 sc1
    s_waitcnt lgkmcnt(2)
    buffer_store_dwordx4 v[148:151], v30, s[4:7], s31 offen offset:1024 sc1
    s_waitcnt lgkmcnt(1)
    buffer_store_dwordx4 v[152:155], v30, s[4:7], s31 offen offset:2048 sc1
    s_waitcnt lgkmcnt(0)
    buffer_store_dwordx4 v[156:159], v30, s[4:7], s31 offen offset:3072 sc1
    s_waitcnt vmcnt(0)
    s_barrier
    s_cmp_lg_u32 s16, 0
    s_cbranch_scc1 L_pp_218
    v_mov_b32 v9, s33
    s_mov_b64 exec, 1
    buffer_store_dword v9, v31, s[4:7], 0 offen sc1
    s_mov_b64 exec, -1
L_pp_218:
    s_branch L_pend_191
L_kind3_194:
    s_waitcnt vmcnt(10)
    s_barrier
    v_add_u32 v40, s34, v20
    v_add_u32 v41, s34, v21
    v_add_u32 v42, s34, v22
    v_add_u32 v43, s34, v23
    v_add_u32 v44, s34, v24
    v_add_u32 v45, s34, v25
    v_add_u32 v46, s34, v26
    v_add_u32 v47, s34, v27
    ds_read_b128 v[48:51], v40 offset:0
    ds_read_b128 v[52:55], v41 offset:0
    ds_read_b128 v[56:59], v42 offset:0
    ds_read_b128 v[60:63], v43 offset:0
    s_waitcnt lgkmcnt(3)
    v_mfma_f32_32x32x16_bf16 v[64:79], a[0:3], v[48:51], 0
    v_mfma_f32_32x32x16_bf16 v[80:95], a[160:163], v[48:51], 0
    ds_read_b128 v[48:51], v44 offset:0
    s_waitcnt lgkmcnt(3)
    v_mfma_f32_32x32x16_bf16 v[64:79], a[4:7], v[52:55], v[64:79]
    s_add_u32 s38, s37, s36
    s_add_u32 m0, s38, 0
    s_nop 0
    buffer_load_dwordx4 v10, s[4:7], s32 offen lds
    v_mfma_f32_32x32x16_bf16 v[80:95], a[164:167], v[52:55], v[80:95]
    ds_read_b128 v[52:55], v45 offset:0
    s_waitcnt lgkmcnt(3)
    v_mfma_f32_32x32x16_bf16 v[64:79], a[8:11], v[56:59], v[64:79]
    v_mfma_f32_32x32x16_bf16 v[80:95], a[168:171], v[56:59], v[80:95]
    ds_read_b128 v[56:59], v46 offset:0
    s_waitcnt lgkmcnt(3)
    v_mfma_f32_32x32x16_bf16 v[64:79], a[12:15], v[60:63], v[64:79]
    v_mfma_f32_32x32x16_bf16 v[80:95], a[172:175], v[60:63], v[80:95]
    ds_read_b128 v[60:63], v47 offset:0
    s_waitcnt lgkmcnt(3)
    v_mfma_f32_32x32x16_bf16 v[64:79], a[16:19], v[48:51], v[64:79]
    v_mfma_f32_32x32x16_bf16 v[80:95], a[176:179], v[48:51], v[80:95]
    ds_read_b128 v[48:51], v40 offset:256
    s_waitcnt lgkmcnt(3)
    v_mfma_f32_32x32x16_bf16 v[64:79], a[20:23], v[52:55], v[64:79]
    s_add_u32 m0, s38, 1024
    s_nop 0
    buffer_load_dwordx4 v11, s[4:7], s32 offen lds
    v_mfma_f32_32x32x16_bf16 v[80:95], a[180:183], v[52:55], v[80:95]
    ds_read_b128 v[52:55], v41 offset:256
    s_waitcnt lgkmcnt(3)
    v_mfma_f32_32x32x16_bf16 v[64:79], a[24:27], v[56:59], v[64:79]
    v_mfma_f32_32x32x16_bf16 v[80:95], a[184:187], v[56:59], v[80:95]
    ds_read_b128 v[56:59], v42 offset:256
    s_waitcnt lgkmcnt(3)
    v_mfma_f32_32x32x16_bf16 v[64:79], a[28:31], v[60:63], v[64:79]
    v_mfma_f32_32x32x16_bf16 v[80:95], a[188:191], v[60:63], v[80:95]
    ds_read_b128 v[60:63], v43 offset:256
    s_waitcnt lgkmcnt(3)
    v_mfma_f32_32x32x16_bf16 v[64:79], a[32:35], v[48:51], v[64:79]
    v_mfma_f32_32x32x16_bf16 v[80:95], a[192:195], v[48:51], v[80:95]
    ds_read_b128 v[48:51], v44 offset:256
    s_waitcnt lgkmcnt(3)
    v_mfma_f32_32x32x16_bf16 v[64:79], a[36:39], v[52:55], v[64:79]
    s_add_u32 m0, s38, 2048
    s_nop 0
    buffer_load_dwordx4 v12, s[4:7], s32 offen lds
    v_mfma_f32_32x32x16_bf16 v[80:95], a[196:199], v[52:55], v[80:95]
    ds_read_b128 v[52:55], v45 offset:256
    s_waitcnt lgkmcnt(3)
    v_mfma_f32_32x32x16_bf16 v[64:79], a[40:43], v[56:59], v[64:79]
    v_mfma_f32_32x32x16_bf16 v[80:95], a[200:203], v[56:59], v[80:95]
    ds_read_b128 v[56:59], v46 offset:256
    s_waitcnt lgkmcnt(3)
    v_mfma_f32_32x32x16_bf16 v[64:79], a[44:47], v[60:63], v[64:79]
    v_mfma_f32_32x32x16_bf16 v[80:95], a[204:207], v[60:63], v[80:95]
    ds_read_b128 v[60:63], v47 offset:256
    s_waitcnt lgkmcnt(3)
    v_mfma_f32_32x32x16_bf16 v[64:79], a[48:51], v[48:51], v[64:79]
    v_mfma_f32_32x32x16_bf16 v[80:95], a[208:211], v[48:51], v[80:95]
    ds_read_b128 v[48:51], v40 offset:512
    s_waitcnt lgkmcnt(3)
    v_mfma_f32_32x32x16_bf16 v[64:79], a[52:55], v[52:55], v[64:79]
    s_add_u32 m0, s38, 3072
    s_nop 0
    buffer_load_dwordx4 v13, s[4:7], s32 offen lds
    v_mfma_f32_32x32x16_bf16 v[80:95], a[212:215], v[52:55], v[80:95]
    ds_read_b128 v[52:55], v41 offset:512
    s_waitcnt lgkmcnt(3)
    v_mfma_f32_32x32x16_bf16 v[64:79], a[56:59], v[56:59], v[64:79]
    v_mfma_f32_32x32x16_bf16 v[80:95], a[216:219], v[56:59], v[80:95]
    ds_read_b128 v[56:59], v42 offset:512
    s_waitcnt lgkmcnt(3)
    v_mfma_f32_32x32x16_bf16 v[64:79], a[60:63], v[60:63], v[64:79]
    v_mfma_f32_32x32x16_bf16 v[80:95], a[220:223], v[60:63], v[80:95]
    ds_read_b128 v[60:63], v43 offset:512
    s_waitcnt lgkmcnt(3)
    v_mfma_f32_32x32x16_bf16 v[64:79], a[64:67], v[48:51], v[64:79]
    v_mfma_f32_32x32x16_bf16 v[80:95], a[224:227], v[48:51], v[80:95]
    ds_read_b128 v[48:51], v44 offset:512
    s_waitcnt lgkmcnt(3)
    v_mfma_f32_32x32x16_bf16 v[64:79], a[68:71], v[52:55], v[64:79]
    s_add_u32 m0, s38, 4096
    s_nop 0
    buffer_load_dwordx4 v14, s[4:7], s32 offen lds
    v_mfma_f32_32x32x16_bf16 v[80:95], a[228:231], v[52:55], v[80:95]
    ds_read_b128 v[52:55], v45 offset:512
    s_waitcnt lgkmcnt(3)
    v_mfma_f32_32x32x16_bf16 v[64:79], a[72:75], v[56:59], v[64:79]
    v_mfma_f32_32x32x16_bf16 v[80:95], a[232:235], v[56:59], v[80:95]
    ds_read_b128 v[56:59], v46 offset:512
    s_waitcnt lgkmcnt(3)
    v_mfma_f32_32x32x16_bf16 v[64:79], a[76:79], v[60:63], v[64:79]
    v_mfma_f32_32x32x16_bf16 v[80:95], a[236:239], v[60:63], v[80:95]
    ds_read_b128 v[60:63], v47 offset:512
    s_waitcnt lgkmcnt(3)
    v_mfma_f32_32x32x16_bf16 v[64:79], a[80:83], v[48:51], v[64:79]
    v_mfma_f32_32x32x16_bf16 v[80:95], a[240:243], v[48:51], v[80:95]
    ds_read_b128 v[48:51], v40 offset:768
    s_waitcnt lgkmcnt(3)
    v_mfma_f32_32x32x16_bf16 v[64:79], a[84:87], v[52:55], v[64:79]
    s_add_u32 m0, s38, 5120
    s_nop 0
    buffer_load_dwordx4 v15, s[4:7], s32 offen lds
    v_mfma_f32_32x32x16_bf16 v[80:95], a[244:247], v[52:55], v[80:95]
    ds_read_b128 v[52:55], v41 offset:768
    s_waitcnt lgkmcnt(3)
    v_mfma_f32_32x32x16_bf16 v[64:79], a[88:91], v[56:59], v[64:79]
    v_mfma_f32_32x32x16_bf16 v[80:95], a[248:251], v[56:59], v[80:95]
    ds_read_b128 v[56:59], v42 offset:768
    s_waitcnt lgkmcnt(3)
    v_mfma_f32_32x32x16_bf16 v[64:79], a[92:95], v[60:63], v[64:79]
    v_mfma_f32_32x32x16_bf16 v[80:95], a[252:255], v[60:63], v[80:95]
    ds_read_b128 v[60:63], v43 offset:768
    s_waitcnt lgkmcnt(3)
    v_mfma_f32_32x32x16_bf16 v[64:79], a[96:99], v[48:51], v[64:79]
    v_mfma_f32_32x32x16_bf16 v[80:95], v[192:195], v[48:51], v[80:95]
    ds_read_b128 v[48:51], v44 offset:768
    s_waitcnt lgkmcnt(3)
    v_mfma_f32_32x32x16_bf16 v[64:79], a[100:103], v[52:55], v[64:79]
    s_add_u32 m0, s38, 6144
    s_nop 0
    buffer_load_dwordx4 v16, s[4:7], s32 offen lds
    v_mfma_f32_32x32x16_bf16 v[80:95], v[196:199], v[52:55], v[80:95]
    ds_read_b128 v[52:55], v45 offset:768
    s_waitcnt lgkmcnt(3)
    v_mfma_f32_32x32x16_bf16 v[64:79], a[104:107], v[56:59], v[64:79]
    v_mfma_f32_32x32x16_bf16 v[80:95], v[200:203], v[56:59], v[80:95]
    ds_read_b128 v[56:59], v46 offset:768
    s_waitcnt lgkmcnt(3)
    v_mfma_f32_32x32x16_bf16 v[64:79], a[108:111], v[60:63], v[64:79]
    v_mfma_f32_32x32x16_bf16 v[80:95], v[204:207], v[60:63], v[80:95]
    ds_read_b128 v[60:63], v47 offset:768
    s_waitcnt lgkmcnt(3)
    v_mfma_f32_32x32x16_bf16 v[64:79], a[112:115], v[48:51], v[64:79]
    v_mfma_f32_32x32x16_bf16 v[80:95], v[208:211], v[48:51], v[80:95]
    ds_read_b128 v[48:51], v40 offset:1024
    s_waitcnt lgkmcnt(3)
    v_mfma_f32_32x32x16_bf16 v[64:79], a[116:119], v[52:55], v[64:79]
    s_add_u32 m0, s38, 7168
    s_nop 0
    buffer_load_dwordx4 v17, s[4:7], s32 offen lds
    v_mfma_f32_32x32x16_bf16 v[80:95], v[212:215], v[52:55], v[80:95]
    ds_read_b128 v[52:55], v41 offset:1024
    s_waitcnt lgkmcnt(3)
    v_mfma_f32_32x32x16_bf16 v[64:79], a[120:123], v[56:59], v[64:79]
    v_mfma_f32_32x32x16_bf16 v[80:95], v[216:219], v[56:59], v[80:95]
    ds_read_b128 v[56:59], v42 offset:1024
    s_waitcnt lgkmcnt(3)
    v_mfma_f32_32x32x16_bf16 v[64:79], a[124:127], v[60:63], v[64:79]
    v_mfma_f32_32x32x16_bf16 v[80:95], v[220:223], v[60:63], v[80:95]
    ds_read_b128 v[60:63], v43 offset:1024
    s_waitcnt lgkmcnt(3)
    v_mfma_f32_32x32x16_bf16 v[64:79], a[128:131], v[48:51], v[64:79]
    v_mfma_f32_32x32x16_bf16 v[80:95], v[224:227], v[48:51], v[80:95]
    ds_read_b128 v[48:51], v44 offset:1024
    s_waitcnt lgkmcnt(3)
    v_mfma_f32_32x32x16_bf16 v[64:79], a[132:135], v[52:55], v[64:79]
    s_add_u32 m0, s38, 8192
    s_nop 0
    buffer_load_dwordx4 v18, s[4:7], s32 offen lds
    v_mfma_f32_32x32x16_bf16 v[80:95], v[228:231], v[52:55], v[80:95]
    ds_read_b128 v[52:55], v45 offset:1024
    s_waitcnt lgkmcnt(3)
    v_mfma_f32_32x32x16_bf16 v[64:79], a[136:139], v[56:59], v[64:79]
    v_mfma_f32_32x32x16_bf16 v[80:95], v[232:235], v[56:59], v[80:95]
    ds_read_b128 v[56:59], v46 offset:1024
    s_waitcnt lgkmcnt(3)
    v_mfma_f32_32x32x16_bf16 v[64:79], a[140:143], v[60:63], v[64:79]
    v_mfma_f32_32x32x16_bf16 v[80:95], v[236:239], v[60:63], v[80:95]
    ds_read_b128 v[60:63], v47 offset:1024
    s_waitcnt lgkmcnt(3)
    v_mfma_f32_32x32x16_bf16 v[64:79], a[144:147], v[48:51], v[64:79]
    v_mfma_f32_32x32x16_bf16 v[80:95], v[240:243], v[48:51], v[80:95]
    s_waitcnt lgkmcnt(2)
    v_mfma_f32_32x32x16_bf16 v[64:79], a[148:151], v[52:55], v[64:79]
    s_add_u32 m0, s38, 9216
    s_nop 0
    buffer_load_dwordx4 v19, s[4:7], s32 offen lds
    v_mfma_f32_32x32x16_bf16 v[80:95], v[244:247], v[52:55], v[80:95]
    s_waitcnt lgkmcnt(1)
    v_mfma_f32_32x32x16_bf16 v[64:79], a[152:155], v[56:59], v[64:79]
    v_mfma_f32_32x32x16_bf16 v[80:95], v[248:251], v[56:59], v[80:95]
    s_waitcnt lgkmcnt(0)
    v_mfma_f32_32x32x16_bf16 v[64:79], a[156:159], v[60:63], v[64:79]
    v_mfma_f32_32x32x16_bf16 v[80:95], v[252:255], v[60:63], v[80:95]
    s_add_u32 s32, s32, 40960
    s_nop 7
    s_nop 3
    v_cvt_pk_bf16_f32 v128, v64, v65
    v_cvt_pk_bf16_f32 v129, v80, v81
    v_lshlrev_b32 v130, 16, v128
    v_and_b32 v131, 0xffff0000, v128
    v_mul_f32 v130, 0xbfb8aa3b, v130
    v_mul_f32 v131, 0xbfb8aa3b, v131
    v_exp_f32 v130, v130
    v_exp_f32 v131, v131
    s_nop 0
    v_add_f32 v130, 1.0, v130
    v_add_f32 v131, 1.0, v131
    v_rcp_f32 v130, v130
    v_rcp_f32 v131, v131
    s_nop 0
    v_cvt_pk_bf16_f32 v128, v130, v131
    v_lshlrev_b32 v130, 16, v128
    v_and_b32 v131, 0xffff0000, v128
    v_lshlrev_b32 v132, 16, v129
    v_and_b32 v133, 0xffff0000, v129
    v_mul_f32 v64, v130, v132
    v_mul_f32 v65, v131, v133
    v_cvt_pk_bf16_f32 v128, v66, v67
    v_cvt_pk_bf16_f32 v129, v82, v83
    v_lshlrev_b32 v130, 16, v128
    v_and_b32 v131, 0xffff0000, v128
    v_mul_f32 v130, 0xbfb8aa3b, v130
    v_mul_f32 v131, 0xbfb8aa3b, v131
    v_exp_f32 v130, v130
    v_exp_f32 v131, v131
    s_nop 0
    v_add_f32 v130, 1.0, v130
    v_add_f32 v131, 1.0, v131
    v_rcp_f32 v130, v130
    v_rcp_f32 v131, v131
    s_nop 0
    v_cvt_pk_bf16_f32 v128, v130, v131
    v_lshlrev_b32 v130, 16, v128
    v_and_b32 v131, 0xffff0000, v128
    v_lshlrev_b32 v132, 16, v129
    v_and_b32 v133, 0xffff0000, v129
    v_mul_f32 v66, v130, v132
    v_mul_f32 v67, v131, v133
    v_cvt_pk_bf16_f32 v128, v68, v69
    v_cvt_pk_bf16_f32 v129, v84, v85
    v_lshlrev_b32 v130, 16, v128
    v_and_b32 v131, 0xffff0000, v128
    v_mul_f32 v130, 0xbfb8aa3b, v130
    v_mul_f32 v131, 0xbfb8aa3b, v131
    v_exp_f32 v130, v130
    v_exp_f32 v131, v131
    s_nop 0
    v_add_f32 v130, 1.0, v130
    v_add_f32 v131, 1.0, v131
    v_rcp_f32 v130, v130
    v_rcp_f32 v131, v131
    s_nop 0
    v_cvt_pk_bf16_f32 v128, v130, v131
    v_lshlrev_b32 v130, 16, v128
    v_and_b32 v131, 0xffff0000, v128
    v_lshlrev_b32 v132, 16, v129
    v_and_b32 v133, 0xffff0000, v129
    v_mul_f32 v68, v130, v132
    v_mul_f32 v69, v131, v133
    v_cvt_pk_bf16_f32 v128, v70, v71
    v_cvt_pk_bf16_f32 v129, v86, v87
    v_lshlrev_b32 v130, 16, v128
    v_and_b32 v131, 0xffff0000, v128
    v_mul_f32 v130, 0xbfb8aa3b, v130
    v_mul_f32 v131, 0xbfb8aa3b, v131
    v_exp_f32 v130, v130
    v_exp_f32 v131, v131
    s_nop 0
    v_add_f32 v130, 1.0, v130
    v_add_f32 v131, 1.0, v131
    v_rcp_f32 v130, v130
    v_rcp_f32 v131, v131
    s_nop 0
    v_cvt_pk_bf16_f32 v128, v130, v131
    v_lshlrev_b32 v130, 16, v128
    v_and_b32 v131, 0xffff0000, v128
    v_lshlrev_b32 v132, 16, v129
    v_and_b32 v133, 0xffff0000, v129
    v_mul_f32 v70, v130, v132
    v_mul_f32 v71, v131, v133
    v_cvt_pk_bf16_f32 v128, v72, v73
    v_cvt_pk_bf16_f32 v129, v88, v89
    v_lshlrev_b32 v130, 16, v128
    v_and_b32 v131, 0xffff0000, v128
    v_mul_f32 v130, 0xbfb8aa3b, v130
    v_mul_f32 v131, 0xbfb8aa3b, v131
    v_exp_f32 v130, v130
    v_exp_f32 v131, v131
    s_nop 0
    v_add_f32 v130, 1.0, v130
    v_add_f32 v131, 1.0, v131
    v_rcp_f32 v130, v130
    v_rcp_f32 v131, v131
    s_nop 0
    v_cvt_pk_bf16_f32 v128, v130, v131
    v_lshlrev_b32 v130, 16, v128
    v_and_b32 v131, 0xffff0000, v128
    v_lshlrev_b32 v132, 16, v129
    v_and_b32 v133, 0xffff0000, v129
    v_mul_f32 v72, v130, v132
    v_mul_f32 v73, v131, v133
    v_cvt_pk_bf16_f32 v128, v74, v75
    v_cvt_pk_bf16_f32 v129, v90, v91
    v_lshlrev_b32 v130, 16, v128
    v_and_b32 v131, 0xffff0000, v128
    v_mul_f32 v130, 0xbfb8aa3b, v130
    v_mul_f32 v131, 0xbfb8aa3b, v131
    v_exp_f32 v130, v130
    v_exp_f32 v131, v131
    s_nop 0
    v_add_f32 v130, 1.0, v130
    v_add_f32 v131, 1.0, v131
    v_rcp_f32 v130, v130
    v_rcp_f32 v131, v131
    s_nop 0
    v_cvt_pk_bf16_f32 v128, v130, v131
    v_lshlrev_b32 v130, 16, v128
    v_and_b32 v131, 0xffff0000, v128
    v_lshlrev_b32 v132, 16, v129
    v_and_b32 v133, 0xffff0000, v129
    v_mul_f32 v74, v130, v132
    v_mul_f32 v75, v131, v133
    v_cvt_pk_bf16_f32 v128, v76, v77
    v_cvt_pk_bf16_f32 v129, v92, v93
    v_lshlrev_b32 v130, 16, v128
    v_and_b32 v131, 0xffff0000, v128
    v_mul_f32 v130, 0xbfb8aa3b, v130
    v_mul_f32 v131, 0xbfb8aa3b, v131
    v_exp_f32 v130, v130
    v_exp_f32 v131, v131
    s_nop 0
    v_add_f32 v130, 1.0, v130
    v_add_f32 v131, 1.0, v131
    v_rcp_f32 v130, v130
    v_rcp_f32 v131, v131
    s_nop 0
    v_cvt_pk_bf16_f32 v128, v130, v131
    v_lshlrev_b32 v130, 16, v128
    v_and_b32 v131, 0xffff0000, v128
    v_lshlrev_b32 v132, 16, v129
    v_and_b32 v133, 0xffff0000, v129
    v_mul_f32 v76, v130, v132
    v_mul_f32 v77, v131, v133
    v_cvt_pk_bf16_f32 v128, v78, v79
    v_cvt_pk_bf16_f32 v129, v94, v95
    v_lshlrev_b32 v130, 16, v128
    v_and_b32 v131, 0xffff0000, v128
    v_mul_f32 v130, 0xbfb8aa3b, v130
    v_mul_f32 v131, 0xbfb8aa3b, v131
    v_exp_f32 v130, v130
    v_exp_f32 v131, v131
    s_nop 0
    v_add_f32 v130, 1.0, v130
    v_add_f32 v131, 1.0, v131
    v_rcp_f32 v130, v130
    v_rcp_f32 v131, v131
    s_nop 0
    v_cvt_pk_bf16_f32 v128, v130, v131
    v_lshlrev_b32 v130, 16, v128
    v_and_b32 v131, 0xffff0000, v128
    v_lshlrev_b32 v132, 16, v129
    v_and_b32 v133, 0xffff0000, v129
    v_mul_f32 v78, v130, v132
    v_mul_f32 v79, v131, v133
    v_cvt_pk_bf16_f32 v136, v64, v65
    v_cvt_pk_bf16_f32 v137, v66, v67
    v_cvt_pk_bf16_f32 v138, v68, v69
    v_cvt_pk_bf16_f32 v139, v70, v71
    v_xor_b32 v134, 0, v28
    v_permlane32_swap_b32 v136, v138
    v_permlane32_swap_b32 v137, v139
    ds_write_b128 v134, v[136:139]
    v_cvt_pk_bf16_f32 v140, v72, v73
    v_cvt_pk_bf16_f32 v141, v74, v75
    v_cvt_pk_bf16_f32 v142, v76, v77
    v_cvt_pk_bf16_f32 v143, v78, v79
    v_xor_b32 v134, 32, v28
    v_permlane32_swap_b32 v140, v142
    v_permlane32_swap_b32 v141, v143
    ds_write_b128 v134, v[140:143]
    s_waitcnt lgkmcnt(0)
    ds_read_b128 v[144:147], v29 offset:0
    ds_read_b128 v[148:151], v29 offset:1024
    s_waitcnt lgkmcnt(1)
    buffer_store_dwordx4 v[144:147], v30, s[4:7], s31 offen offset:0 sc1
    s_waitcnt lgkmcnt(0)
    s_add_u32 s39, s31, 49152
    buffer_store_dwordx4 v[148:151], v30, s[4:7], s39 offen sc1
    s_add_u32 s33, s33, 1
    s_mov_b32 s38, s34
    s_mov_b32 s34, s35
    s_mov_b32 s35, s36
    s_mov_b32 s36, s38
    s_waitcnt vmcnt(0)
    s_barrier
    s_cmp_lg_u32 s16, 0
    s_cbranch_scc1 L_pp_219
    v_mov_b32 v9, s33
    s_mov_b64 exec, 1
    buffer_store_dword v9, v31, s[4:7], 0 offen sc1
    s_mov_b64 exec, -1
L_pp_219:
    s_add_u32 s31, s31, s30
    s_cmp_ge_u32 s33, s19
    s_cbranch_scc1 L_pend_191
    v_add_u32 v40, s34, v20
    v_add_u32 v41, s34, v21
    v_add_u32 v42, s34, v22
    v_add_u32 v43, s34, v23
    v_add_u32 v44, s34, v24
    v_add_u32 v45, s34, v25
    v_add_u32 v46, s34, v26
    v_add_u32 v47, s34, v27
    ds_read_b128 v[48:51], v40 offset:0
    ds_read_b128 v[52:55], v41 offset:0
    ds_read_b128 v[56:59], v42 offset:0
    ds_read_b128 v[60:63], v43 offset:0
    s_waitcnt lgkmcnt(3)
    v_mfma_f32_32x32x16_bf16 v[96:111], a[0:3], v[48:51], 0
    v_mfma_f32_32x32x16_bf16 v[112:127], a[160:163], v[48:51], 0
    ds_read_b128 v[48:51], v44 offset:0
    s_waitcnt lgkmcnt(3)
    v_mfma_f32_32x32x16_bf16 v[96:111], a[4:7], v[52:55], v[96:111]
    s_add_u32 s38, s37, s36
    s_add_u32 m0, s38, 0
    s_nop 0
    buffer_load_dwordx4 v10, s[4:7], s32 offen lds
    v_mfma_f32_32x32x16_bf16 v[112:127], a[164:167], v[52:55], v[112:127]
    ds_read_b128 v[52:55], v45 offset:0
    s_waitcnt lgkmcnt(3)
    v_mfma_f32_32x32x16_bf16 v[96:111], a[8:11], v[56:59], v[96:111]
    v_mfma_f32_32x32x16_bf16 v[112:127], a[168:171], v[56:59], v[112:127]
    ds_read_b128 v[56:59], v46 offset:0
    s_waitcnt lgkmcnt(3)
    v_mfma_f32_32x32x16_bf16 v[96:111], a[12:15], v[60:63], v[96:111]
    v_mfma_f32_32x32x16_bf16 v[112:127], a[172:175], v[60:63], v[112:127]
    ds_read_b128 v[60:63], v47 offset:0
    s_waitcnt lgkmcnt(3)
    v_mfma_f32_32x32x16_bf16 v[96:111], a[16:19], v[48:51], v[96:111]
    v_mfma_f32_32x32x16_bf16 v[112:127], a[176:179], v[48:51], v[112:127]
    ds_read_b128 v[48:51], v40 offset:256
    s_waitcnt lgkmcnt(3)
    v_mfma_f32_32x32x16_bf16 v[96:111], a[20:23], v[52:55], v[96:111]
    s_add_u32 m0, s38, 1024
    s_nop 0
    buffer_load_dwordx4 v11, s[4:7], s32 offen lds
    v_mfma_f32_32x32x16_bf16 v[112:127], a[180:183], v[52:55], v[112:127]
    ds_read_b128 v[52:55], v41 offset:256
    s_waitcnt lgkmcnt(3)
    v_mfma_f32_32x32x16_bf16 v[96:111], a[24:27], v[56:59], v[96:111]
    v_mfma_f32_32x32x16_bf16 v[112:127], a[184:187], v[56:59], v[112:127]
    ds_read_b128 v[56:59], v42 offset:256
    s_waitcnt lgkmcnt(3)
    v_mfma_f32_32x32x16_bf16 v[96:111], a[28:31], v[60:63], v[96:111]
    v_mfma_f32_32x32x16_bf16 v[112:127], a[188:191], v[60:63], v[112:127]
    ds_read_b128 v[60:63], v43 offset:256
    s_waitcnt lgkmcnt(3)
    v_mfma_f32_32x32x16_bf16 v[96:111], a[32:35], v[48:51], v[96:111]
    v_mfma_f32_32x32x16_bf16 v[112:127], a[192:195], v[48:51], v[112:127]
    ds_read_b128 v[48:51], v44 offset:256
    s_waitcnt lgkmcnt(3)
    v_mfma_f32_32x32x16_bf16 v[96:111], a[36:39], v[52:55], v[96:111]
    s_add_u32 m0, s38, 2048
    s_nop 0
    buffer_load_dwordx4 v12, s[4:7], s32 offen lds
    v_mfma_f32_32x32x16_bf16 v[112:127], a[196:199], v[52:55], v[112:127]
    ds_read_b128 v[52:55], v45 offset:256
    s_waitcnt lgkmcnt(3)
    v_mfma_f32_32x32x16_bf16 v[96:111], a[40:43], v[56:59], v[96:111]
    v_mfma_f32_32x32x16_bf16 v[112:127], a[200:203], v[56:59], v[112:127]
    ds_read_b128 v[56:59], v46 offset:256
    s_waitcnt lgkmcnt(3)
    v_mfma_f32_32x32x16_bf16 v[96:111], a[44:47], v[60:63], v[96:111]
    v_mfma_f32_32x32x16_bf16 v[112:127], a[204:207], v[60:63], v[112:127]
    ds_read_b128 v[60:63], v47 offset:256
    s_waitcnt lgkmcnt(3)
    v_mfma_f32_32x32x16_bf16 v[96:111], a[48:51], v[48:51], v[96:111]
    v_mfma_f32_32x32x16_bf16 v[112:127], a[208:211], v[48:51], v[112:127]
    ds_read_b128 v[48:51], v40 offset:512
    s_waitcnt lgkmcnt(3)
    v_mfma_f32_32x32x16_bf16 v[96:111], a[52:55], v[52:55], v[96:111]
    s_add_u32 m0, s38, 3072
    s_nop 0
    buffer_load_dwordx4 v13, s[4:7], s32 offen lds
    v_mfma_f32_32x32x16_bf16 v[112:127], a[212:215], v[52:55], v[112:127]
    ds_read_b128 v[52:55], v41 offset:512
    s_waitcnt lgkmcnt(3)
    v_mfma_f32_32x32x16_bf16 v[96:111], a[56:59], v[56:59], v[96:111]
    v_mfma_f32_32x32x16_bf16 v[112:127], a[216:219], v[56:59], v[112:127]
    ds_read_b128 v[56:59], v42 offset:512
    s_waitcnt lgkmcnt(3)
    v_mfma_f32_32x32x16_bf16 v[96:111], a[60:63], v[60:63], v[96:111]
    v_mfma_f32_32x32x16_bf16 v[112:127], a[220:223], v[60:63], v[112:127]
    ds_read_b128 v[60:63], v43 offset:512
    s_waitcnt lgkmcnt(3)
    v_mfma_f32_32x32x16_bf16 v[96:111], a[64:67], v[48:51], v[96:111]
    v_mfma_f32_32x32x16_bf16 v[112:127], a[224:227], v[48:51], v[112:127]
    ds_read_b128 v[48:51], v44 offset:512
    s_waitcnt lgkmcnt(3)
    v_mfma_f32_32x32x16_bf16 v[96:111], a[68:71], v[52:55], v[96:111]
    s_add_u32 m0, s38, 4096
    s_nop 0
    buffer_load_dwordx4 v14, s[4:7], s32 offen lds
    v_mfma_f32_32x32x16_bf16 v[112:127], a[228:231], v[52:55], v[112:127]
    ds_read_b128 v[52:55], v45 offset:512
    s_waitcnt lgkmcnt(3)
    v_mfma_f32_32x32x16_bf16 v[96:111], a[72:75], v[56:59], v[96:111]
    v_mfma_f32_32x32x16_bf16 v[112:127], a[232:235], v[56:59], v[112:127]
    ds_read_b128 v[56:59], v46 offset:512
    s_waitcnt lgkmcnt(3)
    v_mfma_f32_32x32x16_bf16 v[96:111], a[76:79], v[60:63], v[96:111]
    v_mfma_f32_32x32x16_bf16 v[112:127], a[236:239], v[60:63], v[112:127]
    ds_read_b128 v[60:63], v47 offset:512
    s_waitcnt lgkmcnt(3)
    v_mfma_f32_32x32x16_bf16 v[96:111], a[80:83], v[48:51], v[96:111]
    v_mfma_f32_32x32x16_bf16 v[112:127], a[240:243], v[48:51], v[112:127]
    ds_read_b128 v[48:51], v40 offset:768
    s_waitcnt lgkmcnt(3)
    v_mfma_f32_32x32x16_bf16 v[96:111], a[84:87], v[52:55], v[96:111]
    s_add_u32 m0, s38, 5120
    s_nop 0
    buffer_load_dwordx4 v15, s[4:7], s32 offen lds
    v_mfma_f32_32x32x16_bf16 v[112:127], a[244:247], v[52:55], v[112:127]
    ds_read_b128 v[52:55], v41 offset:768
    s_waitcnt lgkmcnt(3)
    v_mfma_f32_32x32x16_bf16 v[96:111], a[88:91], v[56:59], v[96:111]
    v_mfma_f32_32x32x16_bf16 v[112:127], a[248:251], v[56:59], v[112:127]
    ds_read_b128 v[56:59], v42 offset:768
    s_waitcnt lgkmcnt(3)
    v_mfma_f32_32x32x16_bf16 v[96:111], a[92:95], v[60:63], v[96:111]
    v_mfma_f32_32x32x16_bf16 v[112:127], a[252:255], v[60:63], v[112:127]
    ds_read_b128 v[60:63], v43 offset:768
    s_waitcnt lgkmcnt(3)
    v_mfma_f32_32x32x16_bf16 v[96:111], a[96:99], v[48:51], v[96:111]
    v_mfma_f32_32x32x16_bf16 v[112:127], v[192:195], v[48:51], v[112:127]
    ds_read_b128 v[48:51], v44 offset:768
    s_waitcnt lgkmcnt(3)
    v_mfma_f32_32x32x16_bf16 v[96:111], a[100:103], v[52:55], v[96:111]
    s_add_u32 m0, s38, 6144
    s_nop 0
    buffer_load_dwordx4 v16, s[4:7], s32 offen lds
    v_mfma_f32_32x32x16_bf16 v[112:127], v[196:199], v[52:55], v[112:127]
    ds_read_b128 v[52:55], v45 offset:768
    s_waitcnt lgkmcnt(3)
    v_mfma_f32_32x32x16_bf16 v[96:111], a[104:107], v[56:59], v[96:111]
    v_mfma_f32_32x32x16_bf16 v[112:127], v[200:203], v[56:59], v[112:127]
    ds_read_b128 v[56:59], v46 offset:768
    s_waitcnt lgkmcnt(3)
    v_mfma_f32_32x32x16_bf16 v[96:111], a[108:111], v[60:63], v[96:111]
    v_mfma_f32_32x32x16_bf16 v[112:127], v[204:207], v[60:63], v[112:127]
    ds_read_b128 v[60:63], v47 offset:768
    s_waitcnt lgkmcnt(3)
    v_mfma_f32_32x32x16_bf16 v[96:111], a[112:115], v[48:51], v[96:111]
    v_mfma_f32_32x32x16_bf16 v[112:127], v[208:211], v[48:51], v[112:127]
    ds_read_b128 v[48:51], v40 offset:1024
    s_waitcnt lgkmcnt(3)
    v_mfma_f32_32x32x16_bf16 v[96:111], a[116:119], v[52:55], v[96:111]
    s_add_u32 m0, s38, 7168
    s_nop 0
    buffer_load_dwordx4 v17, s[4:7], s32 offen lds
    v_mfma_f32_32x32x16_bf16 v[112:127], v[212:215], v[52:55], v[112:127]
    ds_read_b128 v[52:55], v41 offset:1024
    s_waitcnt lgkmcnt(3)
    v_mfma_f32_32x32x16_bf16 v[96:111], a[120:123], v[56:59], v[96:111]
    v_mfma_f32_32x32x16_bf16 v[112:127], v[216:219], v[56:59], v[112:127]
    ds_read_b128 v[56:59], v42 offset:1024
    s_waitcnt lgkmcnt(3)
    v_mfma_f32_32x32x16_bf16 v[96:111], a[124:127], v[60:63], v[96:111]
    v_mfma_f32_32x32x16_bf16 v[112:127], v[220:223], v[60:63], v[112:127]
    ds_read_b128 v[60:63], v43 offset:1024
    s_waitcnt lgkmcnt(3)
    v_mfma_f32_32x32x16_bf16 v[96:111], a[128:131], v[48:51], v[96:111]
    v_mfma_f32_32x32x16_bf16 v[112:127], v[224:227], v[48:51], v[112:127]
    ds_read_b128 v[48:51], v44 offset:1024
    s_waitcnt lgkmcnt(3)
    v_mfma_f32_32x32x16_bf16 v[96:111], a[132:135], v[52:55], v[96:111]
    s_add_u32 m0, s38, 8192
    s_nop 0
    buffer_load_dwordx4 v18, s[4:7], s32 offen lds
    v_mfma_f32_32x32x16_bf16 v[112:127], v[228:231], v[52:55], v[112:127]
    ds_read_b128 v[52:55], v45 offset:1024
    s_waitcnt lgkmcnt(3)
    v_mfma_f32_32x32x16_bf16 v[96:111], a[136:139], v[56:59], v[96:111]
    v_mfma_f32_32x32x16_bf16 v[112:127], v[232:235], v[56:59], v[112:127]
    ds_read_b128 v[56:59], v46 offset:1024
    s_waitcnt lgkmcnt(3)
    v_mfma_f32_32x32x16_bf16 v[96:111], a[140:143], v[60:63], v[96:111]
    v_mfma_f32_32x32x16_bf16 v[112:127], v[236:239], v[60:63], v[112:127]
    ds_read_b128 v[60:63], v47 offset:1024
    s_waitcnt lgkmcnt(3)
    v_mfma_f32_32x32x16_bf16 v[96:111], a[144:147], v[48:51], v[96:111]
    v_mfma_f32_32x32x16_bf16 v[112:127], v[240:243], v[48:51], v[112:127]
    s_waitcnt lgkmcnt(2)
    v_mfma_f32_32x32x16_bf16 v[96:111], a[148:151], v[52:55], v[96:111]
    s_add_u32 m0, s38, 9216
    s_nop 0
    buffer_load_dwordx4 v19, s[4:7], s32 offen lds
    v_mfma_f32_32x32x16_bf16 v[112:127], v[244:247], v[52:55], v[112:127]
    s_waitcnt lgkmcnt(1)
    v_mfma_f32_32x32x16_bf16 v[96:111], a[152:155], v[56:59], v[96:111]
    v_mfma_f32_32x32x16_bf16 v[112:127], v[248:251], v[56:59], v[112:127]
    s_waitcnt lgkmcnt(0)
    v_mfma_f32_32x32x16_bf16 v[96:111], a[156:159], v[60:63], v[96:111]
    v_mfma_f32_32x32x16_bf16 v[112:127], v[252:255], v[60:63], v[112:127]
    s_add_u32 s32, s32, 40960
    s_nop 7
    s_nop 3
    v_cvt_pk_bf16_f32 v128, v96, v97
    v_cvt_pk_bf16_f32 v129, v112, v113
    v_lshlrev_b32 v130, 16, v128
    v_and_b32 v131, 0xffff0000, v128
    v_mul_f32 v130, 0xbfb8aa3b, v130
    v_mul_f32 v131, 0xbfb8aa3b, v131
    v_exp_f32 v130, v130
    v_exp_f32 v131, v131
    s_nop 0
    v_add_f32 v130, 1.0, v130
    v_add_f32 v131, 1.0, v131
    v_rcp_f32 v130, v130
    v_rcp_f32 v131, v131
    s_nop 0
    v_cvt_pk_bf16_f32 v128, v130, v131
    v_lshlrev_b32 v130, 16, v128
    v_and_b32 v131, 0xffff0000, v128
    v_lshlrev_b32 v132, 16, v129
    v_and_b32 v133, 0xffff0000, v129
    v_mul_f32 v96, v130, v132
    v_mul_f32 v97, v131, v133
    v_cvt_pk_bf16_f32 v128, v98, v99
    v_cvt_pk_bf16_f32 v129, v114, v115
    v_lshlrev_b32 v130, 16, v128
    v_and_b32 v131, 0xffff0000, v128
    v_mul_f32 v130, 0xbfb8aa3b, v130
    v_mul_f32 v131, 0xbfb8aa3b, v131
    v_exp_f32 v130, v130
    v_exp_f32 v131, v131
    s_nop 0
    v_add_f32 v130, 1.0, v130
    v_add_f32 v131, 1.0, v131
    v_rcp_f32 v130, v130
    v_rcp_f32 v131, v131
    s_nop 0
    v_cvt_pk_bf16_f32 v128, v130, v131
    v_lshlrev_b32 v130, 16, v128
    v_and_b32 v131, 0xffff0000, v128
    v_lshlrev_b32 v132, 16, v129
    v_and_b32 v133, 0xffff0000, v129
    v_mul_f32 v98, v130, v132
    v_mul_f32 v99, v131, v133
    v_cvt_pk_bf16_f32 v128, v100, v101
    v_cvt_pk_bf16_f32 v129, v116, v117
    v_lshlrev_b32 v130, 16, v128
    v_and_b32 v131, 0xffff0000, v128
    v_mul_f32 v130, 0xbfb8aa3b, v130
    v_mul_f32 v131, 0xbfb8aa3b, v131
    v_exp_f32 v130, v130
    v_exp_f32 v131, v131
    s_nop 0
    v_add_f32 v130, 1.0, v130
    v_add_f32 v131, 1.0, v131
    v_rcp_f32 v130, v130
    v_rcp_f32 v131, v131
    s_nop 0
    v_cvt_pk_bf16_f32 v128, v130, v131
    v_lshlrev_b32 v130, 16, v128
    v_and_b32 v131, 0xffff0000, v128
    v_lshlrev_b32 v132, 16, v129
    v_and_b32 v133, 0xffff0000, v129
    v_mul_f32 v100, v130, v132
    v_mul_f32 v101, v131, v133
    v_cvt_pk_bf16_f32 v128, v102, v103
    v_cvt_pk_bf16_f32 v129, v118, v119
    v_lshlrev_b32 v130, 16, v128
    v_and_b32 v131, 0xffff0000, v128
    v_mul_f32 v130, 0xbfb8aa3b, v130
    v_mul_f32 v131, 0xbfb8aa3b, v131
    v_exp_f32 v130, v130
    v_exp_f32 v131, v131
    s_nop 0
    v_add_f32 v130, 1.0, v130
    v_add_f32 v131, 1.0, v131
    v_rcp_f32 v130, v130
    v_rcp_f32 v131, v131
    s_nop 0
    v_cvt_pk_bf16_f32 v128, v130, v131
    v_lshlrev_b32 v130, 16, v128
    v_and_b32 v131, 0xffff0000, v128
    v_lshlrev_b32 v132, 16, v129
    v_and_b32 v133, 0xffff0000, v129
    v_mul_f32 v102, v130, v132
    v_mul_f32 v103, v131, v133
    v_cvt_pk_bf16_f32 v128, v104, v105
    v_cvt_pk_bf16_f32 v129, v120, v121
    v_lshlrev_b32 v130, 16, v128
    v_and_b32 v131, 0xffff0000, v128
    v_mul_f32 v130, 0xbfb8aa3b, v130
    v_mul_f32 v131, 0xbfb8aa3b, v131
    v_exp_f32 v130, v130
    v_exp_f32 v131, v131
    s_nop 0
    v_add_f32 v130, 1.0, v130
    v_add_f32 v131, 1.0, v131
    v_rcp_f32 v130, v130
    v_rcp_f32 v131, v131
    s_nop 0
    v_cvt_pk_bf16_f32 v128, v130, v131
    v_lshlrev_b32 v130, 16, v128
    v_and_b32 v131, 0xffff0000, v128
    v_lshlrev_b32 v132, 16, v129
    v_and_b32 v133, 0xffff0000, v129
    v_mul_f32 v104, v130, v132
    v_mul_f32 v105, v131, v133
    v_cvt_pk_bf16_f32 v128, v106, v107
    v_cvt_pk_bf16_f32 v129, v122, v123
    v_lshlrev_b32 v130, 16, v128
    v_and_b32 v131, 0xffff0000, v128
    v_mul_f32 v130, 0xbfb8aa3b, v130
    v_mul_f32 v131, 0xbfb8aa3b, v131
    v_exp_f32 v130, v130
    v_exp_f32 v131, v131
    s_nop 0
    v_add_f32 v130, 1.0, v130
    v_add_f32 v131, 1.0, v131
    v_rcp_f32 v130, v130
    v_rcp_f32 v131, v131
    s_nop 0
    v_cvt_pk_bf16_f32 v128, v130, v131
    v_lshlrev_b32 v130, 16, v128
    v_and_b32 v131, 0xffff0000, v128
    v_lshlrev_b32 v132, 16, v129
    v_and_b32 v133, 0xffff0000, v129
    v_mul_f32 v106, v130, v132
    v_mul_f32 v107, v131, v133
    v_cvt_pk_bf16_f32 v128, v108, v109
    v_cvt_pk_bf16_f32 v129, v124, v125
    v_lshlrev_b32 v130, 16, v128
    v_and_b32 v131, 0xffff0000, v128
    v_mul_f32 v130, 0xbfb8aa3b, v130
    v_mul_f32 v131, 0xbfb8aa3b, v131
    v_exp_f32 v130, v130
    v_exp_f32 v131, v131
    s_nop 0
    v_add_f32 v130, 1.0, v130
    v_add_f32 v131, 1.0, v131
    v_rcp_f32 v130, v130
    v_rcp_f32 v131, v131
    s_nop 0
    v_cvt_pk_bf16_f32 v128, v130, v131
    v_lshlrev_b32 v130, 16, v128
    v_and_b32 v131, 0xffff0000, v128
    v_lshlrev_b32 v132, 16, v129
    v_and_b32 v133, 0xffff0000, v129
    v_mul_f32 v108, v130, v132
    v_mul_f32 v109, v131, v133
    v_cvt_pk_bf16_f32 v128, v110, v111
    v_cvt_pk_bf16_f32 v129, v126, v127
    v_lshlrev_b32 v130, 16, v128
    v_and_b32 v131, 0xffff0000, v128
    v_mul_f32 v130, 0xbfb8aa3b, v130
    v_mul_f32 v131, 0xbfb8aa3b, v131
    v_exp_f32 v130, v130
    v_exp_f32 v131, v131
    s_nop 0
    v_add_f32 v130, 1.0, v130
    v_add_f32 v131, 1.0, v131
    v_rcp_f32 v130, v130
    v_rcp_f32 v131, v131
    s_nop 0
    v_cvt_pk_bf16_f32 v128, v130, v131
    v_lshlrev_b32 v130, 16, v128
    v_and_b32 v131, 0xffff0000, v128
    v_lshlrev_b32 v132, 16, v129
    v_and_b32 v133, 0xffff0000, v129
    v_mul_f32 v110, v130, v132
    v_mul_f32 v111, v131, v133
    v_cvt_pk_bf16_f32 v136, v96, v97
    v_cvt_pk_bf16_f32 v137, v98, v99
    v_cvt_pk_bf16_f32 v138, v100, v101
    v_cvt_pk_bf16_f32 v139, v102, v103
    v_xor_b32 v134, 0, v28
    v_permlane32_swap_b32 v136, v138
    v_permlane32_swap_b32 v137, v139
    ds_write_b128 v134, v[136:139]
    v_cvt_pk_bf16_f32 v140, v104, v105
    v_cvt_pk_bf16_f32 v141, v106, v107
    v_cvt_pk_bf16_f32 v142, v108, v109
    v_cvt_pk_bf16_f32 v143, v110, v111
    v_xor_b32 v134, 32, v28
    v_permlane32_swap_b32 v140, v142
    v_permlane32_swap_b32 v141, v143
    ds_write_b128 v134, v[140:143]
    s_waitcnt lgkmcnt(0)
    ds_read_b128 v[144:147], v29 offset:0
    ds_read_b128 v[148:151], v29 offset:1024
    s_waitcnt lgkmcnt(1)
    buffer_store_dwordx4 v[144:147], v30, s[4:7], s31 offen offset:0 sc1
    s_waitcnt lgkmcnt(0)
    s_add_u32 s39, s31, 49152
    buffer_store_dwordx4 v[148:151], v30, s[4:7], s39 offen sc1
    s_add_u32 s33, s33, 1
    s_mov_b32 s38, s34
    s_mov_b32 s34, s35
    s_mov_b32 s35, s36
    s_mov_b32 s36, s38
    s_waitcnt vmcnt(0)
    s_barrier
    s_cmp_lg_u32 s16, 0
    s_cbranch_scc1 L_pp_221
    v_mov_b32 v9, s33
    s_mov_b64 exec, 1
    buffer_store_dword v9, v31, s[4:7], 0 offen sc1
    s_mov_b64 exec, -1
L_pp_221:
    v_mov_b32 v2, 80
    s_mov_b32 s38, 0
L_dw_222:
    buffer_load_dword v3, v2, s[12:15], 0 offen sc1
    s_waitcnt vmcnt(0)
    v_cmp_gt_u32 vcc, 24, v3
    s_cbranch_vccz L_dwk_223
    s_sleep 2
    s_add_u32 s38, s38, 1
    s_cmp_lt_u32 s38, 4194304
    s_cbranch_scc1 L_dw_222
    s_branch L_end_1
L_dwk_223:
    s_add_u32 s31, s31, s30
    s_cmp_ge_u32 s33, s19
    s_cbranch_scc1 L_pend_191
    v_add_u32 v40, s34, v20
    v_add_u32 v41, s34, v21
    v_add_u32 v42, s34, v22
    v_add_u32 v43, s34, v23
    v_add_u32 v44, s34, v24
    v_add_u32 v45, s34, v25
    v_add_u32 v46, s34, v26
    v_add_u32 v47, s34, v27
    ds_read_b128 v[48:51], v40 offset:0
    ds_read_b128 v[52:55], v41 offset:0
    ds_read_b128 v[56:59], v42 offset:0
    ds_read_b128 v[60:63], v43 offset:0
    s_waitcnt lgkmcnt(3)
    v_mfma_f32_32x32x16_bf16 v[64:79], a[0:3], v[48:51], 0
    v_mfma_f32_32x32x16_bf16 v[80:95], a[160:163], v[48:51], 0
    ds_read_b128 v[48:51], v44 offset:0
    s_waitcnt lgkmcnt(3)
    v_mfma_f32_32x32x16_bf16 v[64:79], a[4:7], v[52:55], v[64:79]
    s_add_u32 s38, s37, s36
    s_add_u32 m0, s38, 0
    s_nop 0
    buffer_load_dwordx4 v10, s[4:7], s32 offen lds
    v_mfma_f32_32x32x16_bf16 v[80:95], a[164:167], v[52:55], v[80:95]
    ds_read_b128 v[52:55], v45 offset:0
    s_waitcnt lgkmcnt(3)
    v_mfma_f32_32x32x16_bf16 v[64:79], a[8:11], v[56:59], v[64:79]
    v_mfma_f32_32x32x16_bf16 v[80:95], a[168:171], v[56:59], v[80:95]
    ds_read_b128 v[56:59], v46 offset:0
    s_waitcnt lgkmcnt(3)
    v_mfma_f32_32x32x16_bf16 v[64:79], a[12:15], v[60:63], v[64:79]
    v_mfma_f32_32x32x16_bf16 v[80:95], a[172:175], v[60:63], v[80:95]
    ds_read_b128 v[60:63], v47 offset:0
    s_waitcnt lgkmcnt(3)
    v_mfma_f32_32x32x16_bf16 v[64:79], a[16:19], v[48:51], v[64:79]
    v_mfma_f32_32x32x16_bf16 v[80:95], a[176:179], v[48:51], v[80:95]
    ds_read_b128 v[48:51], v40 offset:256
    s_waitcnt lgkmcnt(3)
    v_mfma_f32_32x32x16_bf16 v[64:79], a[20:23], v[52:55], v[64:79]
    s_add_u32 m0, s38, 1024
    s_nop 0
    buffer_load_dwordx4 v11, s[4:7], s32 offen lds
    v_mfma_f32_32x32x16_bf16 v[80:95], a[180:183], v[52:55], v[80:95]
    ds_read_b128 v[52:55], v41 offset:256
    s_waitcnt lgkmcnt(3)
    v_mfma_f32_32x32x16_bf16 v[64:79], a[24:27], v[56:59], v[64:79]
    v_mfma_f32_32x32x16_bf16 v[80:95], a[184:187], v[56:59], v[80:95]
    ds_read_b128 v[56:59], v42 offset:256
    s_waitcnt lgkmcnt(3)
    v_mfma_f32_32x32x16_bf16 v[64:79], a[28:31], v[60:63], v[64:79]
    v_mfma_f32_32x32x16_bf16 v[80:95], a[188:191], v[60:63], v[80:95]
    ds_read_b128 v[60:63], v43 offset:256
    s_waitcnt lgkmcnt(3)
    v_mfma_f32_32x32x16_bf16 v[64:79], a[32:35], v[48:51], v[64:79]
    v_mfma_f32_32x32x16_bf16 v[80:95], a[192:195], v[48:51], v[80:95]
    ds_read_b128 v[48:51], v44 offset:256
    s_waitcnt lgkmcnt(3)
    v_mfma_f32_32x32x16_bf16 v[64:79], a[36:39], v[52:55], v[64:79]
    s_add_u32 m0, s38, 2048
    s_nop 0
    buffer_load_dwordx4 v12, s[4:7], s32 offen lds
    v_mfma_f32_32x32x16_bf16 v[80:95], a[196:199], v[52:55], v[80:95]
    ds_read_b128 v[52:55], v45 offset:256
    s_waitcnt lgkmcnt(3)
    v_mfma_f32_32x32x16_bf16 v[64:79], a[40:43], v[56:59], v[64:79]
    v_mfma_f32_32x32x16_bf16 v[80:95], a[200:203], v[56:59], v[80:95]
    ds_read_b128 v[56:59], v46 offset:256
    s_waitcnt lgkmcnt(3)
    v_mfma_f32_32x32x16_bf16 v[64:79], a[44:47], v[60:63], v[64:79]
    v_mfma_f32_32x32x16_bf16 v[80:95], a[204:207], v[60:63], v[80:95]
    ds_read_b128 v[60:63], v47 offset:256
    s_waitcnt lgkmcnt(3)
    v_mfma_f32_32x32x16_bf16 v[64:79], a[48:51], v[48:51], v[64:79]
    v_mfma_f32_32x32x16_bf16 v[80:95], a[208:211], v[48:51], v[80:95]
    ds_read_b128 v[48:51], v40 offset:512
    s_waitcnt lgkmcnt(3)
    v_mfma_f32_32x32x16_bf16 v[64:79], a[52:55], v[52:55], v[64:79]
    s_add_u32 m0, s38, 3072
    s_nop 0
    buffer_load_dwordx4 v13, s[4:7], s32 offen lds
    v_mfma_f32_32x32x16_bf16 v[80:95], a[212:215], v[52:55], v[80:95]
    ds_read_b128 v[52:55], v41 offset:512
    s_waitcnt lgkmcnt(3)
    v_mfma_f32_32x32x16_bf16 v[64:79], a[56:59], v[56:59], v[64:79]
    v_mfma_f32_32x32x16_bf16 v[80:95], a[216:219], v[56:59], v[80:95]
    ds_read_b128 v[56:59], v42 offset:512
    s_waitcnt lgkmcnt(3)
    v_mfma_f32_32x32x16_bf16 v[64:79], a[60:63], v[60:63], v[64:79]
    v_mfma_f32_32x32x16_bf16 v[80:95], a[220:223], v[60:63], v[80:95]
    ds_read_b128 v[60:63], v43 offset:512
    s_waitcnt lgkmcnt(3)
    v_mfma_f32_32x32x16_bf16 v[64:79], a[64:67], v[48:51], v[64:79]
    v_mfma_f32_32x32x16_bf16 v[80:95], a[224:227], v[48:51], v[80:95]
    ds_read_b128 v[48:51], v44 offset:512
    s_waitcnt lgkmcnt(3)
    v_mfma_f32_32x32x16_bf16 v[64:79], a[68:71], v[52:55], v[64:79]
    s_add_u32 m0, s38, 4096
    s_nop 0
    buffer_load_dwordx4 v14, s[4:7], s32 offen lds
    v_mfma_f32_32x32x16_bf16 v[80:95], a[228:231], v[52:55], v[80:95]
    ds_read_b128 v[52:55], v45 offset:512
    s_waitcnt lgkmcnt(3)
    v_mfma_f32_32x32x16_bf16 v[64:79], a[72:75], v[56:59], v[64:79]
    v_mfma_f32_32x32x16_bf16 v[80:95], a[232:235], v[56:59], v[80:95]
    ds_read_b128 v[56:59], v46 offset:512
    s_waitcnt lgkmcnt(3)
    v_mfma_f32_32x32x16_bf16 v[64:79], a[76:79], v[60:63], v[64:79]
    v_mfma_f32_32x32x16_bf16 v[80:95], a[236:239], v[60:63], v[80:95]
    ds_read_b128 v[60:63], v47 offset:512
    s_waitcnt lgkmcnt(3)
    v_mfma_f32_32x32x16_bf16 v[64:79], a[80:83], v[48:51], v[64:79]
    v_mfma_f32_32x32x16_bf16 v[80:95], a[240:243], v[48:51], v[80:95]
    ds_read_b128 v[48:51], v40 offset:768
    s_waitcnt lgkmcnt(3)
    v_mfma_f32_32x32x16_bf16 v[64:79], a[84:87], v[52:55], v[64:79]
    s_add_u32 m0, s38, 5120
    s_nop 0
    buffer_load_dwordx4 v15, s[4:7], s32 offen lds
    v_mfma_f32_32x32x16_bf16 v[80:95], a[244:247], v[52:55], v[80:95]
    ds_read_b128 v[52:55], v41 offset:768
    s_waitcnt lgkmcnt(3)
    v_mfma_f32_32x32x16_bf16 v[64:79], a[88:91], v[56:59], v[64:79]
    v_mfma_f32_32x32x16_bf16 v[80:95], a[248:251], v[56:59], v[80:95]
    ds_read_b128 v[56:59], v42 offset:768
    s_waitcnt lgkmcnt(3)
    v_mfma_f32_32x32x16_bf16 v[64:79], a[92:95], v[60:63], v[64:79]
    v_mfma_f32_32x32x16_bf16 v[80:95], a[252:255], v[60:63], v[80:95]
    ds_read_b128 v[60:63], v43 offset:768
    s_waitcnt lgkmcnt(3)
    v_mfma_f32_32x32x16_bf16 v[64:79], a[96:99], v[48:51], v[64:79]
    v_mfma_f32_32x32x16_bf16 v[80:95], v[192:195], v[48:51], v[80:95]
    ds_read_b128 v[48:51], v44 offset:768
    s_waitcnt lgkmcnt(3)
    v_mfma_f32_32x32x16_bf16 v[64:79], a[100:103], v[52:55], v[64:79]
    s_add_u32 m0, s38, 6144
    s_nop 0
    buffer_load_dwordx4 v16, s[4:7], s32 offen lds
    v_mfma_f32_32x32x16_bf16 v[80:95], v[196:199], v[52:55], v[80:95]
    ds_read_b128 v[52:55], v45 offset:768
    s_waitcnt lgkmcnt(3)
    v_mfma_f32_32x32x16_bf16 v[64:79], a[104:107], v[56:59], v[64:79]
    v_mfma_f32_32x32x16_bf16 v[80:95], v[200:203], v[56:59], v[80:95]
    ds_read_b128 v[56:59], v46 offset:768
    s_waitcnt lgkmcnt(3)
    v_mfma_f32_32x32x16_bf16 v[64:79], a[108:111], v[60:63], v[64:79]
    v_mfma_f32_32x32x16_bf16 v[80:95], v[204:207], v[60:63], v[80:95]
    ds_read_b128 v[60:63], v47 offset:768
    s_waitcnt lgkmcnt(3)
    v_mfma_f32_32x32x16_bf16 v[64:79], a[112:115], v[48:51], v[64:79]
    v_mfma_f32_32x32x16_bf16 v[80:95], v[208:211], v[48:51], v[80:95]
    ds_read_b128 v[48:51], v40 offset:1024
    s_waitcnt lgkmcnt(3)
    v_mfma_f32_32x32x16_bf16 v[64:79], a[116:119], v[52:55], v[64:79]
    s_add_u32 m0, s38, 7168
    s_nop 0
    buffer_load_dwordx4 v17, s[4:7], s32 offen lds
    v_mfma_f32_32x32x16_bf16 v[80:95], v[212:215], v[52:55], v[80:95]
    ds_read_b128 v[52:55], v41 offset:1024
    s_waitcnt lgkmcnt(3)
    v_mfma_f32_32x32x16_bf16 v[64:79], a[120:123], v[56:59], v[64:79]
    v_mfma_f32_32x32x16_bf16 v[80:95], v[216:219], v[56:59], v[80:95]
    ds_read_b128 v[56:59], v42 offset:1024
    s_waitcnt lgkmcnt(3)
    v_mfma_f32_32x32x16_bf16 v[64:79], a[124:127], v[60:63], v[64:79]
    v_mfma_f32_32x32x16_bf16 v[80:95], v[220:223], v[60:63], v[80:95]
    ds_read_b128 v[60:63], v43 offset:1024
    s_waitcnt lgkmcnt(3)
    v_mfma_f32_32x32x16_bf16 v[64:79], a[128:131], v[48:51], v[64:79]
    v_mfma_f32_32x32x16_bf16 v[80:95], v[224:227], v[48:51], v[80:95]
    ds_read_b128 v[48:51], v44 offset:1024
    s_waitcnt lgkmcnt(3)
    v_mfma_f32_32x32x16_bf16 v[64:79], a[132:135], v[52:55], v[64:79]
    s_add_u32 m0, s38, 8192
    s_nop 0
    buffer_load_dwordx4 v18, s[4:7], s32 offen lds
    v_mfma_f32_32x32x16_bf16 v[80:95], v[228:231], v[52:55], v[80:95]
    ds_read_b128 v[52:55], v45 offset:1024
    s_waitcnt lgkmcnt(3)
    v_mfma_f32_32x32x16_bf16 v[64:79], a[136:139], v[56:59], v[64:79]
    v_mfma_f32_32x32x16_bf16 v[80:95], v[232:235], v[56:59], v[80:95]
    ds_read_b128 v[56:59], v46 offset:1024
    s_waitcnt lgkmcnt(3)
    v_mfma_f32_32x32x16_bf16 v[64:79], a[140:143], v[60:63], v[64:79]
    v_mfma_f32_32x32x16_bf16 v[80:95], v[236:239], v[60:63], v[80:95]
    ds_read_b128 v[60:63], v47 offset:1024
    s_waitcnt lgkmcnt(3)
    v_mfma_f32_32x32x16_bf16 v[64:79], a[144:147], v[48:51], v[64:79]
    v_mfma_f32_32x32x16_bf16 v[80:95], v[240:243], v[48:51], v[80:95]
    s_waitcnt lgkmcnt(2)
    v_mfma_f32_32x32x16_bf16 v[64:79], a[148:151], v[52:55], v[64:79]
    s_add_u32 m0, s38, 9216
    s_nop 0
    buffer_load_dwordx4 v19, s[4:7], s32 offen lds
    v_mfma_f32_32x32x16_bf16 v[80:95], v[244:247], v[52:55], v[80:95]
    s_waitcnt lgkmcnt(1)
    v_mfma_f32_32x32x16_bf16 v[64:79], a[152:155], v[56:59], v[64:79]
    v_mfma_f32_32x32x16_bf16 v[80:95], v[248:251], v[56:59], v[80:95]
    s_waitcnt lgkmcnt(0)
    v_mfma_f32_32x32x16_bf16 v[64:79], a[156:159], v[60:63], v[64:79]
    v_mfma_f32_32x32x16_bf16 v[80:95], v[252:255], v[60:63], v[80:95]
    s_add_u32 s32, s32, 40960
    s_add_u32 s33, s33, 1
    s_mov_b32 s38, s34
    s_mov_b32 s34, s35
    s_mov_b32 s35, s36
    s_mov_b32 s36, s38
    s_cmp_ge_u32 s33, s19
    s_cbranch_scc1 L_pfa_225
    s_waitcnt vmcnt(10)
    s_barrier
L_ploop_224:
    v_add_u32 v40, s34, v20
    v_add_u32 v41, s34, v21
    v_add_u32 v42, s34, v22
    v_add_u32 v43, s34, v23
    v_add_u32 v44, s34, v24
    v_add_u32 v45, s34, v25
    v_add_u32 v46, s34, v26
    v_add_u32 v47, s34, v27
    ds_read_b128 v[48:51], v40 offset:0
    ds_read_b128 v[52:55], v41 offset:0
    ds_read_b128 v[56:59], v42 offset:0
    ds_read_b128 v[60:63], v43 offset:0
    s_waitcnt lgkmcnt(3)
    v_mfma_f32_32x32x16_bf16 v[96:111], a[0:3], v[48:51], 0
    v_mfma_f32_32x32x16_bf16 v[112:127], a[160:163], v[48:51], 0
    ds_read_b128 v[48:51], v44 offset:0
    s_waitcnt lgkmcnt(3)
    v_mfma_f32_32x32x16_bf16 v[96:111], a[4:7], v[52:55], v[96:111]
    s_add_u32 s38, s37, s36
    s_add_u32 m0, s38, 0
    s_nop 0
    buffer_load_dwordx4 v10, s[4:7], s32 offen lds
    v_mfma_f32_32x32x16_bf16 v[112:127], a[164:167], v[52:55], v[112:127]
    ds_read_b128 v[52:55], v45 offset:0
    s_waitcnt lgkmcnt(3)
    v_mfma_f32_32x32x16_bf16 v[96:111], a[8:11], v[56:59], v[96:111]
    v_mfma_f32_32x32x16_bf16 v[112:127], a[168:171], v[56:59], v[112:127]
    ds_read_b128 v[56:59], v46 offset:0
    s_waitcnt lgkmcnt(3)
    v_mfma_f32_32x32x16_bf16 v[96:111], a[12:15], v[60:63], v[96:111]
    v_cvt_pk_bf16_f32 v128, v64, v65
    v_cvt_pk_bf16_f32 v129, v80, v81
    v_lshlrev_b32 v130, 16, v128
    v_and_b32 v131, 0xffff0000, v128
    v_mfma_f32_32x32x16_bf16 v[112:127], a[172:175], v[60:63], v[112:127]
    v_mul_f32 v130, 0xbfb8aa3b, v130
    v_mul_f32 v131, 0xbfb8aa3b, v131
    v_exp_f32 v130, v130
    v_exp_f32 v131, v131
    s_nop 0
    ds_read_b128 v[60:63], v47 offset:0
    s_waitcnt lgkmcnt(3)
    v_mfma_f32_32x32x16_bf16 v[96:111], a[16:19], v[48:51], v[96:111]
    v_add_f32 v130, 1.0, v130
    v_add_f32 v131, 1.0, v131
    v_rcp_f32 v130, v130
    v_rcp_f32 v131, v131
    s_nop 0
    v_mfma_f32_32x32x16_bf16 v[112:127], a[176:179], v[48:51], v[112:127]
    v_cvt_pk_bf16_f32 v128, v130, v131
    v_lshlrev_b32 v130, 16, v128
    v_and_b32 v131, 0xffff0000, v128
    v_lshlrev_b32 v132, 16, v129
    ds_read_b128 v[48:51], v40 offset:256
    s_waitcnt lgkmcnt(3)
    v_mfma_f32_32x32x16_bf16 v[96:111], a[20:23], v[52:55], v[96:111]
    v_and_b32 v133, 0xffff0000, v129
    v_mul_f32 v64, v130, v132
    v_mul_f32 v65, v131, v133
    v_cvt_pk_bf16_f32 v128, v66, v67
    v_cvt_pk_bf16_f32 v129, v82, v83
    v_mfma_f32_32x32x16_bf16 v[112:127], a[180:183], v[52:55], v[112:127]
    v_lshlrev_b32 v130, 16, v128
    v_and_b32 v131, 0xffff0000, v128
    v_mul_f32 v130, 0xbfb8aa3b, v130
    s_add_u32 m0, s38, 1024
    s_nop 0
    buffer_load_dwordx4 v11, s[4:7], s32 offen lds
    ds_read_b128 v[52:55], v41 offset:256
    s_waitcnt lgkmcnt(3)
    v_mfma_f32_32x32x16_bf16 v[96:111], a[24:27], v[56:59], v[96:111]
    v_mul_f32 v131, 0xbfb8aa3b, v131
    v_exp_f32 v130, v130
    v_exp_f32 v131, v131
    s_nop 0
    v_add_f32 v130, 1.0, v130
    v_mfma_f32_32x32x16_bf16 v[112:127], a[184:187], v[56:59], v[112:127]
    v_add_f32 v131, 1.0, v131
    v_rcp_f32 v130, v130
    v_rcp_f32 v131, v131
    s_nop 0
    v_cvt_pk_bf16_f32 v128, v130, v131
    ds_read_b128 v[56:59], v42 offset:256
    s_waitcnt lgkmcnt(3)
    v_mfma_f32_32x32x16_bf16 v[96:111], a[28:31], v[60:63], v[96:111]
    v_lshlrev_b32 v130, 16, v128
    v_and_b32 v131, 0xffff0000, v128
    v_lshlrev_b32 v132, 16, v129
    v_and_b32 v133, 0xffff0000, v129
    v_mfma_f32_32x32x16_bf16 v[112:127], a[188:191], v[60:63], v[112:127]
    v_mul_f32 v66, v130, v132
    v_mul_f32 v67, v131, v133
    v_cvt_pk_bf16_f32 v128, v68, v69
    v_cvt_pk_bf16_f32 v129, v84, v85
    ds_read_b128 v[60:63], v43 offset:256
    s_waitcnt lgkmcnt(3)
    v_mfma_f32_32x32x16_bf16 v[96:111], a[32:35], v[48:51], v[96:111]
    v_lshlrev_b32 v130, 16, v128
    v_and_b32 v131, 0xffff0000, v128
    v_mul_f32 v130, 0xbfb8aa3b, v130
    v_mul_f32 v131, 0xbfb8aa3b, v131
    v_mfma_f32_32x32x16_bf16 v[112:127], a[192:195], v[48:51], v[112:127]
    v_exp_f32 v130, v130
    v_exp_f32 v131, v131
    s_nop 0
    v_add_f32 v130, 1.0, v130
    v_add_f32 v131, 1.0, v131
    ds_read_b128 v[48:51], v44 offset:256
    s_waitcnt lgkmcnt(3)
    v_mfma_f32_32x32x16_bf16 v[96:111], a[36:39], v[52:55], v[96:111]
    v_rcp_f32 v130, v130
    v_rcp_f32 v131, v131
    s_nop 0
    v_cvt_pk_bf16_f32 v128, v130, v131
    v_lshlrev_b32 v130, 16, v128
    v_and_b32 v131, 0xffff0000, v128
    v_mfma_f32_32x32x16_bf16 v[112:127], a[196:199], v[52:55], v[112:127]
    v_lshlrev_b32 v132, 16, v129
    v_and_b32 v133, 0xffff0000, v129
    v_mul_f32 v68, v130, v132
    s_add_u32 m0, s38, 2048
    s_nop 0
    buffer_load_dwordx4 v12, s[4:7], s32 offen lds
    ds_read_b128 v[52:55], v45 offset:256
    s_waitcnt lgkmcnt(3)
    v_mfma_f32_32x32x16_bf16 v[96:111], a[40:43], v[56:59], v[96:111]
    v_mul_f32 v69, v131, v133
    v_cvt_pk_bf16_f32 v128, v70, v71
    v_cvt_pk_bf16_f32 v129, v86, v87
    v_lshlrev_b32 v130, 16, v128
    v_mfma_f32_32x32x16_bf16 v[112:127], a[200:203], v[56:59], v[112:127]
    v_and_b32 v131, 0xffff0000, v128
    v_mul_f32 v130, 0xbfb8aa3b, v130
    v_mul_f32 v131, 0xbfb8aa3b, v131
    v_exp_f32 v130, v130
    ds_read_b128 v[56:59], v46 offset:256
    s_waitcnt lgkmcnt(3)
    v_mfma_f32_32x32x16_bf16 v[96:111], a[44:47], v[60:63], v[96:111]
    v_exp_f32 v131, v131
    s_nop 0
    v_add_f32 v130, 1.0, v130
    v_add_f32 v131, 1.0, v131
    v_rcp_f32 v130, v130
    v_mfma_f32_32x32x16_bf16 v[112:127], a[204:207], v[60:63], v[112:127]
    v_rcp_f32 v131, v131
    s_nop 0
    v_cvt_pk_bf16_f32 v128, v130, v131
    v_lshlrev_b32 v130, 16, v128
    v_and_b32 v131, 0xffff0000, v128
    ds_read_b128 v[60:63], v47 offset:256
    s_waitcnt lgkmcnt(3)
    v_mfma_f32_32x32x16_bf16 v[96:111], a[48:51], v[48:51], v[96:111]
    v_lshlrev_b32 v132, 16, v129
    v_and_b32 v133, 0xffff0000, v129
    v_mul_f32 v70, v130, v132
    v_mul_f32 v71, v131, v133
    v_mfma_f32_32x32x16_bf16 v[112:127], a[208:211], v[48:51], v[112:127]
    v_cvt_pk_bf16_f32 v128, v72, v73
    v_cvt_pk_bf16_f32 v129, v88, v89
    v_lshlrev_b32 v130, 16, v128
    v_and_b32 v131, 0xffff0000, v128
    ds_read_b128 v[48:51], v40 offset:512
    s_waitcnt lgkmcnt(3)
    v_mfma_f32_32x32x16_bf16 v[96:111], a[52:55], v[52:55], v[96:111]
    v_mul_f32 v130, 0xbfb8aa3b, v130
    v_mul_f32 v131, 0xbfb8aa3b, v131
    v_exp_f32 v130, v130
    v_exp_f32 v131, v131
    s_nop 0
    v_add_f32 v130, 1.0, v130
    v_mfma_f32_32x32x16_bf16 v[112:127], a[212:215], v[52:55], v[112:127]
    v_add_f32 v131, 1.0, v131
    v_rcp_f32 v130, v130
    v_rcp_f32 v131, v131
    s_nop 0
    s_add_u32 m0, s38, 3072
    s_nop 0
    buffer_load_dwordx4 v13, s[4:7], s32 offen lds
    ds_read_b128 v[52:55], v41 offset:512
    s_waitcnt lgkmcnt(3)
    v_mfma_f32_32x32x16_bf16 v[96:111], a[56:59], v[56:59], v[96:111]
    v_cvt_pk_bf16_f32 v128, v130, v131
    v_lshlrev_b32 v130, 16, v128
    v_and_b32 v131, 0xffff0000, v128
    v_lshlrev_b32 v132, 16, v129
    v_mfma_f32_32x32x16_bf16 v[112:127], a[216:219], v[56:59], v[112:127]
    v_and_b32 v133, 0xffff0000, v129
    v_mul_f32 v72, v130, v132
    v_mul_f32 v73, v131, v133
    v_cvt_pk_bf16_f32 v128, v74, v75
    ds_read_b128 v[56:59], v42 offset:512
    s_waitcnt lgkmcnt(3)
    v_mfma_f32_32x32x16_bf16 v[96:111], a[60:63], v[60:63], v[96:111]
    v_cvt_pk_bf16_f32 v129, v90, v91
    v_lshlrev_b32 v130, 16, v128
    v_and_b32 v131, 0xffff0000, v128
    v_mul_f32 v130, 0xbfb8aa3b, v130
    v_mfma_f32_32x32x16_bf16 v[112:127], a[220:223], v[60:63], v[112:127]
    v_mul_f32 v131, 0xbfb8aa3b, v131
    v_exp_f32 v130, v130
    v_exp_f32 v131, v131
    s_nop 0
    v_add_f32 v130, 1.0, v130
    ds_read_b128 v[60:63], v43 offset:512
    s_waitcnt lgkmcnt(3)
    v_mfma_f32_32x32x16_bf16 v[96:111], a[64:67], v[48:51], v[96:111]
    v_add_f32 v131, 1.0, v131
    v_rcp_f32 v130, v130
    v_rcp_f32 v131, v131
    s_nop 0
    v_cvt_pk_bf16_f32 v128, v130, v131
    v_mfma_f32_32x32x16_bf16 v[112:127], a[224:227], v[48:51], v[112:127]
    v_lshlrev_b32 v130, 16, v128
    v_and_b32 v131, 0xffff0000, v128
    v_lshlrev_b32 v132, 16, v129
    v_and_b32 v133, 0xffff0000, v129
    ds_read_b128 v[48:51], v44 offset:512
    s_waitcnt lgkmcnt(3)
    v_mfma_f32_32x32x16_bf16 v[96:111], a[68:71], v[52:55], v[96:111]
    v_mul_f32 v74, v130, v132
    v_mul_f32 v75, v131, v133
    v_cvt_pk_bf16_f32 v128, v76, v77
    v_cvt_pk_bf16_f32 v129, v92, v93
    v_lshlrev_b32 v130, 16, v128
    v_mfma_f32_32x32x16_bf16 v[112:127], a[228:231], v[52:55], v[112:127]
    v_and_b32 v131, 0xffff0000, v128
    v_mul_f32 v130, 0xbfb8aa3b, v130
    v_mul_f32 v131, 0xbfb8aa3b, v131
    s_add_u32 m0, s38, 4096
    s_nop 0
    buffer_load_dwordx4 v14, s[4:7], s32 offen lds
    ds_read_b128 v[52:55], v45 offset:512
    s_waitcnt lgkmcnt(3)
    v_mfma_f32_32x32x16_bf16 v[96:111], a[72:75], v[56:59], v[96:111]
    v_exp_f32 v130, v130
    v_exp_f32 v131, v131
    s_nop 0
    v_add_f32 v130, 1.0, v130
    v_add_f32 v131, 1.0, v131
    v_mfma_f32_32x32x16_bf16 v[112:127], a[232:235], v[56:59], v[112:127]
    v_rcp_f32 v130, v130
    v_rcp_f32 v131, v131
    s_nop 0
    v_cvt_pk_bf16_f32 v128, v130, v131
    v_lshlrev_b32 v130, 16, v128
    ds_read_b128 v[56:59], v46 offset:512
    s_waitcnt lgkmcnt(3)
    v_mfma_f32_32x32x16_bf16 v[96:111], a[76:79], v[60:63], v[96:111]
    v_and_b32 v131, 0xffff0000, v128
    v_lshlrev_b32 v132, 16, v129
    v_and_b32 v133, 0xffff0000, v129
    v_mul_f32 v76, v130, v132
    v_mfma_f32_32x32x16_bf16 v[112:127], a[236:239], v[60:63], v[112:127]
    v_mul_f32 v77, v131, v133
    v_cvt_pk_bf16_f32 v128, v78, v79
    v_cvt_pk_bf16_f32 v129, v94, v95
    v_lshlrev_b32 v130, 16, v128
    ds_read_b128 v[60:63], v47 offset:512
    s_waitcnt lgkmcnt(3)
    v_mfma_f32_32x32x16_bf16 v[96:111], a[80:83], v[48:51], v[96:111]
    v_and_b32 v131, 0xffff0000, v128
    v_mul_f32 v130, 0xbfb8aa3b, v130
    v_mul_f32 v131, 0xbfb8aa3b, v131
    v_exp_f32 v130, v130
    v_mfma_f32_32x32x16_bf16 v[112:127], a[240:243], v[48:51], v[112:127]
    v_exp_f32 v131, v131
    s_nop 0
    v_add_f32 v130, 1.0, v130
    v_add_f32 v131, 1.0, v131
    v_rcp_f32 v130, v130
    ds_read_b128 v[48:51], v40 offset:768
    s_waitcnt lgkmcnt(3)
    v_mfma_f32_32x32x16_bf16 v[96:111], a[84:87], v[52:55], v[96:111]
    v_rcp_f32 v131, v131
    s_nop 0
    v_cvt_pk_bf16_f32 v128, v130, v131
    v_lshlrev_b32 v130, 16, v128
    v_and_b32 v131, 0xffff0000, v128
    v_lshlrev_b32 v132, 16, v129
    v_mfma_f32_32x32x16_bf16 v[112:127], a[244:247], v[52:55], v[112:127]
    v_and_b32 v133, 0xffff0000, v129
    v_mul_f32 v78, v130, v132
    v_mul_f32 v79, v131, v133
    s_add_u32 m0, s38, 5120
    s_nop 0
    buffer_load_dwordx4 v15, s[4:7], s32 offen lds
    ds_read_b128 v[52:55], v41 offset:768
    s_waitcnt lgkmcnt(3)
    v_mfma_f32_32x32x16_bf16 v[96:111], a[88:91], v[56:59], v[96:111]
    v_cvt_pk_bf16_f32 v136, v64, v65
    v_cvt_pk_bf16_f32 v137, v66, v67
    v_cvt_pk_bf16_f32 v138, v68, v69
    v_cvt_pk_bf16_f32 v139, v70, v71
    v_mfma_f32_32x32x16_bf16 v[112:127], a[248:251], v[56:59], v[112:127]
    v_xor_b32 v134, 0, v28
    v_permlane32_swap_b32 v136, v138
    v_permlane32_swap_b32 v137, v139
    ds_write_b128 v134, v[136:139]
    v_cvt_pk_bf16_f32 v140, v72, v73
    v_cvt_pk_bf16_f32 v141, v74, v75
    ds_read_b128 v[56:59], v42 offset:768
    s_waitcnt lgkmcnt(4)
    v_mfma_f32_32x32x16_bf16 v[96:111], a[92:95], v[60:63], v[96:111]
    v_cvt_pk_bf16_f32 v142, v76, v77
    v_cvt_pk_bf16_f32 v143, v78, v79
    v_mfma_f32_32x32x16_bf16 v[112:127], a[252:255], v[60:63], v[112:127]
    v_xor_b32 v134, 32, v28
    v_permlane32_swap_b32 v140, v142
    v_permlane32_swap_b32 v141, v143
    ds_write_b128 v134, v[140:143]
    ds_read_b128 v[60:63], v43 offset:768
    s_waitcnt lgkmcnt(5)
    v_mfma_f32_32x32x16_bf16 v[96:111], a[96:99], v[48:51], v[96:111]
    v_mfma_f32_32x32x16_bf16 v[112:127], v[192:195], v[48:51], v[112:127]
    ds_read_b128 v[48:51], v44 offset:768
    s_waitcnt lgkmcnt(5)
    v_mfma_f32_32x32x16_bf16 v[96:111], a[100:103], v[52:55], v[96:111]
    s_add_u32 m0, s38, 6144
    s_nop 0
    buffer_load_dwordx4 v16, s[4:7], s32 offen lds
    v_mfma_f32_32x32x16_bf16 v[112:127], v[196:199], v[52:55], v[112:127]
    ds_read_b128 v[52:55], v45 offset:768
    s_waitcnt lgkmcnt(4)
    v_mfma_f32_32x32x16_bf16 v[96:111], a[104:107], v[56:59], v[96:111]
    s_waitcnt lgkmcnt(3)
    ds_read_b128 v[144:147], v29 offset:0
    v_mfma_f32_32x32x16_bf16 v[112:127], v[200:203], v[56:59], v[112:127]
    ds_read_b128 v[56:59], v46 offset:768
    s_waitcnt lgkmcnt(4)
    v_mfma_f32_32x32x16_bf16 v[96:111], a[108:111], v[60:63], v[96:111]
    v_mfma_f32_32x32x16_bf16 v[112:127], v[204:207], v[60:63], v[112:127]
    ds_read_b128 v[60:63], v47 offset:768
    s_waitcnt lgkmcnt(4)
    v_mfma_f32_32x32x16_bf16 v[96:111], a[112:115], v[48:51], v[96:111]
    ds_read_b128 v[148:151], v29 offset:1024
    v_mfma_f32_32x32x16_bf16 v[112:127], v[208:211], v[48:51], v[112:127]
    ds_read_b128 v[48:51], v40 offset:1024
    s_waitcnt lgkmcnt(5)
    v_mfma_f32_32x32x16_bf16 v[96:111], a[116:119], v[52:55], v[96:111]
    s_add_u32 m0, s38, 7168
    s_nop 0
    buffer_load_dwordx4 v17, s[4:7], s32 offen lds
    v_mfma_f32_32x32x16_bf16 v[112:127], v[212:215], v[52:55], v[112:127]
    ds_read_b128 v[52:55], v41 offset:1024
    s_waitcnt lgkmcnt(4)
    v_mfma_f32_32x32x16_bf16 v[96:111], a[120:123], v[56:59], v[96:111]
    v_mfma_f32_32x32x16_bf16 v[112:127], v[216:219], v[56:59], v[112:127]
    ds_read_b128 v[56:59], v42 offset:1024
    s_waitcnt lgkmcnt(4)
    v_mfma_f32_32x32x16_bf16 v[96:111], a[124:127], v[60:63], v[96:111]
    buffer_store_dwordx4 v[144:147], v30, s[4:7], s31 offen offset:0 sc1
    v_mfma_f32_32x32x16_bf16 v[112:127], v[220:223], v[60:63], v[112:127]
    ds_read_b128 v[60:63], v43 offset:1024
    s_waitcnt lgkmcnt(3)
    v_mfma_f32_32x32x16_bf16 v[96:111], a[128:131], v[48:51], v[96:111]
    v_mfma_f32_32x32x16_bf16 v[112:127], v[224:227], v[48:51], v[112:127]
    ds_read_b128 v[48:51], v44 offset:1024
    s_waitcnt lgkmcnt(3)
    v_mfma_f32_32x32x16_bf16 v[96:111], a[132:135], v[52:55], v[96:111]
    s_add_u32 s39, s31, 49152
    buffer_store_dwordx4 v[148:151], v30, s[4:7], s39 offen sc1
    v_mfma_f32_32x32x16_bf16 v[112:127], v[228:231], v[52:55], v[112:127]
    s_add_u32 m0, s38, 8192
    s_nop 0
    buffer_load_dwordx4 v18, s[4:7], s32 offen lds
    ds_read_b128 v[52:55], v45 offset:1024
    s_waitcnt lgkmcnt(3)
    v_mfma_f32_32x32x16_bf16 v[96:111], a[136:139], v[56:59], v[96:111]
    v_mfma_f32_32x32x16_bf16 v[112:127], v[232:235], v[56:59], v[112:127]
    ds_read_b128 v[56:59], v46 offset:1024
    s_waitcnt lgkmcnt(3)
    v_mfma_f32_32x32x16_bf16 v[96:111], a[140:143], v[60:63], v[96:111]
    v_mfma_f32_32x32x16_bf16 v[112:127], v[236:239], v[60:63], v[112:127]
    ds_read_b128 v[60:63], v47 offset:1024
    s_waitcnt lgkmcnt(3)
    v_mfma_f32_32x32x16_bf16 v[96:111], a[144:147], v[48:51], v[96:111]
    v_mfma_f32_32x32x16_bf16 v[112:127], v[240:243], v[48:51], v[112:127]
    s_waitcnt lgkmcnt(2)
    v_mfma_f32_32x32x16_bf16 v[96:111], a[148:151], v[52:55], v[96:111]
    s_add_u32 m0, s38, 9216
    s_nop 0
    buffer_load_dwordx4 v19, s[4:7], s32 offen lds
    v_mfma_f32_32x32x16_bf16 v[112:127], v[244:247], v[52:55], v[112:127]
    s_waitcnt lgkmcnt(1)
    v_mfma_f32_32x32x16_bf16 v[96:111], a[152:155], v[56:59], v[96:111]
    v_mfma_f32_32x32x16_bf16 v[112:127], v[248:251], v[56:59], v[112:127]
    s_waitcnt lgkmcnt(0)
    v_mfma_f32_32x32x16_bf16 v[96:111], a[156:159], v[60:63], v[96:111]
    v_mfma_f32_32x32x16_bf16 v[112:127], v[252:255], v[60:63], v[112:127]
    s_add_u32 s32, s32, 40960
    s_add_u32 s31, s31, s30
    s_add_u32 s33, s33, 1
    s_mov_b32 s38, s34
    s_mov_b32 s34, s35
    s_mov_b32 s35, s36
    s_mov_b32 s36, s38
    s_cmp_ge_u32 s33, s19
    s_cbranch_scc1 L_pfb_226
    s_waitcnt vmcnt(12)
    s_barrier
    s_sub_u32 s39, s33, 2
    s_cmp_lg_u32 s16, 0
    s_cbranch_scc1 L_pp_227
    v_mov_b32 v9, s39
    s_mov_b64 exec, 1
    buffer_store_dword v9, v31, s[4:7], 0 offen sc1
    s_mov_b64 exec, -1
L_pp_227:
    v_add_u32 v40, s34, v20
    v_add_u32 v41, s34, v21
    v_add_u32 v42, s34, v22
    v_add_u32 v43, s34, v23
    v_add_u32 v44, s34, v24
    v_add_u32 v45, s34, v25
    v_add_u32 v46, s34, v26
    v_add_u32 v47, s34, v27
    ds_read_b128 v[48:51], v40 offset:0
    ds_read_b128 v[52:55], v41 offset:0
    ds_read_b128 v[56:59], v42 offset:0
    ds_read_b128 v[60:63], v43 offset:0
    s_waitcnt lgkmcnt(3)
    v_mfma_f32_32x32x16_bf16 v[64:79], a[0:3], v[48:51], 0
    v_mfma_f32_32x32x16_bf16 v[80:95], a[160:163], v[48:51], 0
    ds_read_b128 v[48:51], v44 offset:0
    s_waitcnt lgkmcnt(3)
    v_mfma_f32_32x32x16_bf16 v[64:79], a[4:7], v[52:55], v[64:79]
    s_add_u32 s38, s37, s36
    s_add_u32 m0, s38, 0
    s_nop 0
    buffer_load_dwordx4 v10, s[4:7], s32 offen lds
    v_mfma_f32_32x32x16_bf16 v[80:95], a[164:167], v[52:55], v[80:95]
    ds_read_b128 v[52:55], v45 offset:0
    s_waitcnt lgkmcnt(3)
    v_mfma_f32_32x32x16_bf16 v[64:79], a[8:11], v[56:59], v[64:79]
    v_mfma_f32_32x32x16_bf16 v[80:95], a[168:171], v[56:59], v[80:95]
    ds_read_b128 v[56:59], v46 offset:0
    s_waitcnt lgkmcnt(3)
    v_mfma_f32_32x32x16_bf16 v[64:79], a[12:15], v[60:63], v[64:79]
    v_cvt_pk_bf16_f32 v128, v96, v97
    v_cvt_pk_bf16_f32 v129, v112, v113
    v_lshlrev_b32 v130, 16, v128
    v_and_b32 v131, 0xffff0000, v128
    v_mfma_f32_32x32x16_bf16 v[80:95], a[172:175], v[60:63], v[80:95]
    v_mul_f32 v130, 0xbfb8aa3b, v130
    v_mul_f32 v131, 0xbfb8aa3b, v131
    v_exp_f32 v130, v130
    v_exp_f32 v131, v131
    s_nop 0
    ds_read_b128 v[60:63], v47 offset:0
    s_waitcnt lgkmcnt(3)
    v_mfma_f32_32x32x16_bf16 v[64:79], a[16:19], v[48:51], v[64:79]
    v_add_f32 v130, 1.0, v130
    v_add_f32 v131, 1.0, v131
    v_rcp_f32 v130, v130
    v_rcp_f32 v131, v131
    s_nop 0
    v_mfma_f32_32x32x16_bf16 v[80:95], a[176:179], v[48:51], v[80:95]
    v_cvt_pk_bf16_f32 v128, v130, v131
    v_lshlrev_b32 v130, 16, v128
    v_and_b32 v131, 0xffff0000, v128
    v_lshlrev_b32 v132, 16, v129
    ds_read_b128 v[48:51], v40 offset:256
    s_waitcnt lgkmcnt(3)
    v_mfma_f32_32x32x16_bf16 v[64:79], a[20:23], v[52:55], v[64:79]
    v_and_b32 v133, 0xffff0000, v129
    v_mul_f32 v96, v130, v132
    v_mul_f32 v97, v131, v133
    v_cvt_pk_bf16_f32 v128, v98, v99
    v_cvt_pk_bf16_f32 v129, v114, v115
    v_mfma_f32_32x32x16_bf16 v[80:95], a[180:183], v[52:55], v[80:95]
    v_lshlrev_b32 v130, 16, v128
    v_and_b32 v131, 0xffff0000, v128
    v_mul_f32 v130, 0xbfb8aa3b, v130
    s_add_u32 m0, s38, 1024
    s_nop 0
    buffer_load_dwordx4 v11, s[4:7], s32 offen lds
    ds_read_b128 v[52:55], v41 offset:256
    s_waitcnt lgkmcnt(3)
    v_mfma_f32_32x32x16_bf16 v[64:79], a[24:27], v[56:59], v[64:79]
    v_mul_f32 v131, 0xbfb8aa3b, v131
    v_exp_f32 v130, v130
    v_exp_f32 v131, v131
    s_nop 0
    v_add_f32 v130, 1.0, v130
    v_mfma_f32_32x32x16_bf16 v[80:95], a[184:187], v[56:59], v[80:95]
    v_add_f32 v131, 1.0, v131
    v_rcp_f32 v130, v130
    v_rcp_f32 v131, v131
    s_nop 0
    v_cvt_pk_bf16_f32 v128, v130, v131
    ds_read_b128 v[56:59], v42 offset:256
    s_waitcnt lgkmcnt(3)
    v_mfma_f32_32x32x16_bf16 v[64:79], a[28:31], v[60:63], v[64:79]
    v_lshlrev_b32 v130, 16, v128
    v_and_b32 v131, 0xffff0000, v128
    v_lshlrev_b32 v132, 16, v129
    v_and_b32 v133, 0xffff0000, v129
    v_mfma_f32_32x32x16_bf16 v[80:95], a[188:191], v[60:63], v[80:95]
    v_mul_f32 v98, v130, v132
    v_mul_f32 v99, v131, v133
    v_cvt_pk_bf16_f32 v128, v100, v101
    v_cvt_pk_bf16_f32 v129, v116, v117
    ds_read_b128 v[60:63], v43 offset:256
    s_waitcnt lgkmcnt(3)
    v_mfma_f32_32x32x16_bf16 v[64:79], a[32:35], v[48:51], v[64:79]
    v_lshlrev_b32 v130, 16, v128
    v_and_b32 v131, 0xffff0000, v128
    v_mul_f32 v130, 0xbfb8aa3b, v130
    v_mul_f32 v131, 0xbfb8aa3b, v131
    v_mfma_f32_32x32x16_bf16 v[80:95], a[192:195], v[48:51], v[80:95]
    v_exp_f32 v130, v130
    v_exp_f32 v131, v131
    s_nop 0
    v_add_f32 v130, 1.0, v130
    v_add_f32 v131, 1.0, v131
    ds_read_b128 v[48:51], v44 offset:256
    s_waitcnt lgkmcnt(3)
    v_mfma_f32_32x32x16_bf16 v[64:79], a[36:39], v[52:55], v[64:79]
    v_rcp_f32 v130, v130
    v_rcp_f32 v131, v131
    s_nop 0
    v_cvt_pk_bf16_f32 v128, v130, v131
    v_lshlrev_b32 v130, 16, v128
    v_and_b32 v131, 0xffff0000, v128
    v_mfma_f32_32x32x16_bf16 v[80:95], a[196:199], v[52:55], v[80:95]
    v_lshlrev_b32 v132, 16, v129
    v_and_b32 v133, 0xffff0000, v129
    v_mul_f32 v100, v130, v132
    s_add_u32 m0, s38, 2048
    s_nop 0
    buffer_load_dwordx4 v12, s[4:7], s32 offen lds
    ds_read_b128 v[52:55], v45 offset:256
    s_waitcnt lgkmcnt(3)
    v_mfma_f32_32x32x16_bf16 v[64:79], a[40:43], v[56:59], v[64:79]
    v_mul_f32 v101, v131, v133
    v_cvt_pk_bf16_f32 v128, v102, v103
    v_cvt_pk_bf16_f32 v129, v118, v119
    v_lshlrev_b32 v130, 16, v128
    v_mfma_f32_32x32x16_bf16 v[80:95], a[200:203], v[56:59], v[80:95]
    v_and_b32 v131, 0xffff0000, v128
    v_mul_f32 v130, 0xbfb8aa3b, v130
    v_mul_f32 v131, 0xbfb8aa3b, v131
    v_exp_f32 v130, v130
    ds_read_b128 v[56:59], v46 offset:256
    s_waitcnt lgkmcnt(3)
    v_mfma_f32_32x32x16_bf16 v[64:79], a[44:47], v[60:63], v[64:79]
    v_exp_f32 v131, v131
    s_nop 0
    v_add_f32 v130, 1.0, v130
    v_add_f32 v131, 1.0, v131
    v_rcp_f32 v130, v130
    v_mfma_f32_32x32x16_bf16 v[80:95], a[204:207], v[60:63], v[80:95]
    v_rcp_f32 v131, v131
    s_nop 0
    v_cvt_pk_bf16_f32 v128, v130, v131
    v_lshlrev_b32 v130, 16, v128
    v_and_b32 v131, 0xffff0000, v128
    ds_read_b128 v[60:63], v47 offset:256
    s_waitcnt lgkmcnt(3)
    v_mfma_f32_32x32x16_bf16 v[64:79], a[48:51], v[48:51], v[64:79]
    v_lshlrev_b32 v132, 16, v129
    v_and_b32 v133, 0xffff0000, v129
    v_mul_f32 v102, v130, v132
    v_mul_f32 v103, v131, v133
    v_mfma_f32_32x32x16_bf16 v[80:95], a[208:211], v[48:51], v[80:95]
    v_cvt_pk_bf16_f32 v128, v104, v105
    v_cvt_pk_bf16_f32 v129, v120, v121
    v_lshlrev_b32 v130, 16, v128
    v_and_b32 v131, 0xffff0000, v128
    ds_read_b128 v[48:51], v40 offset:512
    s_waitcnt lgkmcnt(3)
    v_mfma_f32_32x32x16_bf16 v[64:79], a[52:55], v[52:55], v[64:79]
    v_mul_f32 v130, 0xbfb8aa3b, v130
    v_mul_f32 v131, 0xbfb8aa3b, v131
    v_exp_f32 v130, v130
    v_exp_f32 v131, v131
    s_nop 0
    v_add_f32 v130, 1.0, v130
    v_mfma_f32_32x32x16_bf16 v[80:95], a[212:215], v[52:55], v[80:95]
    v_add_f32 v131, 1.0, v131
    v_rcp_f32 v130, v130
    v_rcp_f32 v131, v131
    s_nop 0
    s_add_u32 m0, s38, 3072
    s_nop 0
    buffer_load_dwordx4 v13, s[4:7], s32 offen lds
    ds_read_b128 v[52:55], v41 offset:512
    s_waitcnt lgkmcnt(3)
    v_mfma_f32_32x32x16_bf16 v[64:79], a[56:59], v[56:59], v[64:79]
    v_cvt_pk_bf16_f32 v128, v130, v131
    v_lshlrev_b32 v130, 16, v128
    v_and_b32 v131, 0xffff0000, v128
    v_lshlrev_b32 v132, 16, v129
    v_mfma_f32_32x32x16_bf16 v[80:95], a[216:219], v[56:59], v[80:95]
    v_and_b32 v133, 0xffff0000, v129
    v_mul_f32 v104, v130, v132
    v_mul_f32 v105, v131, v133
    v_cvt_pk_bf16_f32 v128, v106, v107
    ds_read_b128 v[56:59], v42 offset:512
    s_waitcnt lgkmcnt(3)
    v_mfma_f32_32x32x16_bf16 v[64:79], a[60:63], v[60:63], v[64:79]
    v_cvt_pk_bf16_f32 v129, v122, v123
    v_lshlrev_b32 v130, 16, v128
    v_and_b32 v131, 0xffff0000, v128
    v_mul_f32 v130, 0xbfb8aa3b, v130
    v_mfma_f32_32x32x16_bf16 v[80:95], a[220:223], v[60:63], v[80:95]
    v_mul_f32 v131, 0xbfb8aa3b, v131
    v_exp_f32 v130, v130
    v_exp_f32 v131, v131
    s_nop 0
    v_add_f32 v130, 1.0, v130
    ds_read_b128 v[60:63], v43 offset:512
    s_waitcnt lgkmcnt(3)
    v_mfma_f32_32x32x16_bf16 v[64:79], a[64:67], v[48:51], v[64:79]
    v_add_f32 v131, 1.0, v131
    v_rcp_f32 v130, v130
    v_rcp_f32 v131, v131
    s_nop 0
    v_cvt_pk_bf16_f32 v128, v130, v131
    v_mfma_f32_32x32x16_bf16 v[80:95], a[224:227], v[48:51], v[80:95]
    v_lshlrev_b32 v130, 16, v128
    v_and_b32 v131, 0xffff0000, v128
    v_lshlrev_b32 v132, 16, v129
    v_and_b32 v133, 0xffff0000, v129
    ds_read_b128 v[48:51], v44 offset:512
    s_waitcnt lgkmcnt(3)
    v_mfma_f32_32x32x16_bf16 v[64:79], a[68:71], v[52:55], v[64:79]
    v_mul_f32 v106, v130, v132
    v_mul_f32 v107, v131, v133
    v_cvt_pk_bf16_f32 v128, v108, v109
    v_cvt_pk_bf16_f32 v129, v124, v125
    v_lshlrev_b32 v130, 16, v128
    v_mfma_f32_32x32x16_bf16 v[80:95], a[228:231], v[52:55], v[80:95]
    v_and_b32 v131, 0xffff0000, v128
    v_mul_f32 v130, 0xbfb8aa3b, v130
    v_mul_f32 v131, 0xbfb8aa3b, v131
    s_add_u32 m0, s38, 4096
    s_nop 0
    buffer_load_dwordx4 v14, s[4:7], s32 offen lds
    ds_read_b128 v[52:55], v45 offset:512
    s_waitcnt lgkmcnt(3)
    v_mfma_f32_32x32x16_bf16 v[64:79], a[72:75], v[56:59], v[64:79]
    v_exp_f32 v130, v130
    v_exp_f32 v131, v131
    s_nop 0
    v_add_f32 v130, 1.0, v130
    v_add_f32 v131, 1.0, v131
    v_mfma_f32_32x32x16_bf16 v[80:95], a[232:235], v[56:59], v[80:95]
    v_rcp_f32 v130, v130
    v_rcp_f32 v131, v131
    s_nop 0
    v_cvt_pk_bf16_f32 v128, v130, v131
    v_lshlrev_b32 v130, 16, v128
    ds_read_b128 v[56:59], v46 offset:512
    s_waitcnt lgkmcnt(3)
    v_mfma_f32_32x32x16_bf16 v[64:79], a[76:79], v[60:63], v[64:79]
    v_and_b32 v131, 0xffff0000, v128
    v_lshlrev_b32 v132, 16, v129
    v_and_b32 v133, 0xffff0000, v129
    v_mul_f32 v108, v130, v132
    v_mfma_f32_32x32x16_bf16 v[80:95], a[236:239], v[60:63], v[80:95]
    v_mul_f32 v109, v131, v133
    v_cvt_pk_bf16_f32 v128, v110, v111
    v_cvt_pk_bf16_f32 v129, v126, v127
    v_lshlrev_b32 v130, 16, v128
    ds_read_b128 v[60:63], v47 offset:512
    s_waitcnt lgkmcnt(3)
    v_mfma_f32_32x32x16_bf16 v[64:79], a[80:83], v[48:51], v[64:79]
    v_and_b32 v131, 0xffff0000, v128
    v_mul_f32 v130, 0xbfb8aa3b, v130
    v_mul_f32 v131, 0xbfb8aa3b, v131
    v_exp_f32 v130, v130
    v_mfma_f32_32x32x16_bf16 v[80:95], a[240:243], v[48:51], v[80:95]
    v_exp_f32 v131, v131
    s_nop 0
    v_add_f32 v130, 1.0, v130
    v_add_f32 v131, 1.0, v131
    v_rcp_f32 v130, v130
    ds_read_b128 v[48:51], v40 offset:768
    s_waitcnt lgkmcnt(3)
    v_mfma_f32_32x32x16_bf16 v[64:79], a[84:87], v[52:55], v[64:79]
    v_rcp_f32 v131, v131
    s_nop 0
    v_cvt_pk_bf16_f32 v128, v130, v131
    v_lshlrev_b32 v130, 16, v128
    v_and_b32 v131, 0xffff0000, v128
    v_lshlrev_b32 v132, 16, v129
    v_mfma_f32_32x32x16_bf16 v[80:95], a[244:247], v[52:55], v[80:95]
    v_and_b32 v133, 0xffff0000, v129
    v_mul_f32 v110, v130, v132
    v_mul_f32 v111, v131, v133
    s_add_u32 m0, s38, 5120
    s_nop 0
    buffer_load_dwordx4 v15, s[4:7], s32 offen lds
    ds_read_b128 v[52:55], v41 offset:768
    s_waitcnt lgkmcnt(3)
    v_mfma_f32_32x32x16_bf16 v[64:79], a[88:91], v[56:59], v[64:79]
    v_cvt_pk_bf16_f32 v136, v96, v97
    v_cvt_pk_bf16_f32 v137, v98, v99
    v_cvt_pk_bf16_f32 v138, v100, v101
    v_cvt_pk_bf16_f32 v139, v102, v103
    v_mfma_f32_32x32x16_bf16 v[80:95], a[248:251], v[56:59], v[80:95]
    v_xor_b32 v134, 0, v28
    v_permlane32_swap_b32 v136, v138
    v_permlane32_swap_b32 v137, v139
    ds_write_b128 v134, v[136:139]
    v_cvt_pk_bf16_f32 v140, v104, v105
    v_cvt_pk_bf16_f32 v141, v106, v107
    ds_read_b128 v[56:59], v42 offset:768
    s_waitcnt lgkmcnt(4)
    v_mfma_f32_32x32x16_bf16 v[64:79], a[92:95], v[60:63], v[64:79]
    v_cvt_pk_bf16_f32 v142, v108, v109
    v_cvt_pk_bf16_f32 v143, v110, v111
    v_mfma_f32_32x32x16_bf16 v[80:95], a[252:255], v[60:63], v[80:95]
    v_xor_b32 v134, 32, v28
    v_permlane32_swap_b32 v140, v142
    v_permlane32_swap_b32 v141, v143
    ds_write_b128 v134, v[140:143]
    ds_read_b128 v[60:63], v43 offset:768
    s_waitcnt lgkmcnt(5)
    v_mfma_f32_32x32x16_bf16 v[64:79], a[96:99], v[48:51], v[64:79]
    v_mfma_f32_32x32x16_bf16 v[80:95], v[192:195], v[48:51], v[80:95]
    ds_read_b128 v[48:51], v44 offset:768
    s_waitcnt lgkmcnt(5)
    v_mfma_f32_32x32x16_bf16 v[64:79], a[100:103], v[52:55], v[64:79]
    s_add_u32 m0, s38, 6144
    s_nop 0
    buffer_load_dwordx4 v16, s[4:7], s32 offen lds
    v_mfma_f32_32x32x16_bf16 v[80:95], v[196:199], v[52:55], v[80:95]
    ds_read_b128 v[52:55], v45 offset:768
    s_waitcnt lgkmcnt(4)
    v_mfma_f32_32x32x16_bf16 v[64:79], a[104:107], v[56:59], v[64:79]
    s_waitcnt lgkmcnt(3)
    ds_read_b128 v[144:147], v29 offset:0
    v_mfma_f32_32x32x16_bf16 v[80:95], v[200:203], v[56:59], v[80:95]
    ds_read_b128 v[56:59], v46 offset:768
    s_waitcnt lgkmcnt(4)
    v_mfma_f32_32x32x16_bf16 v[64:79], a[108:111], v[60:63], v[64:79]
    v_mfma_f32_32x32x16_bf16 v[80:95], v[204:207], v[60:63], v[80:95]
    ds_read_b128 v[60:63], v47 offset:768
    s_waitcnt lgkmcnt(4)
    v_mfma_f32_32x32x16_bf16 v[64:79], a[112:115], v[48:51], v[64:79]
    ds_read_b128 v[148:151], v29 offset:1024
    v_mfma_f32_32x32x16_bf16 v[80:95], v[208:211], v[48:51], v[80:95]
    ds_read_b128 v[48:51], v40 offset:1024
    s_waitcnt lgkmcnt(5)
    v_mfma_f32_32x32x16_bf16 v[64:79], a[116:119], v[52:55], v[64:79]
    s_add_u32 m0, s38, 7168
    s_nop 0
    buffer_load_dwordx4 v17, s[4:7], s32 offen lds
    v_mfma_f32_32x32x16_bf16 v[80:95], v[212:215], v[52:55], v[80:95]
    ds_read_b128 v[52:55], v41 offset:1024
    s_waitcnt lgkmcnt(4)
    v_mfma_f32_32x32x16_bf16 v[64:79], a[120:123], v[56:59], v[64:79]
    v_mfma_f32_32x32x16_bf16 v[80:95], v[216:219], v[56:59], v[80:95]
    ds_read_b128 v[56:59], v42 offset:1024
    s_waitcnt lgkmcnt(4)
    v_mfma_f32_32x32x16_bf16 v[64:79], a[124:127], v[60:63], v[64:79]
    buffer_store_dwordx4 v[144:147], v30, s[4:7], s31 offen offset:0 sc1
    v_mfma_f32_32x32x16_bf16 v[80:95], v[220:223], v[60:63], v[80:95]
    ds_read_b128 v[60:63], v43 offset:1024
    s_waitcnt lgkmcnt(3)
    v_mfma_f32_32x32x16_bf16 v[64:79], a[128:131], v[48:51], v[64:79]
    v_mfma_f32_32x32x16_bf16 v[80:95], v[224:227], v[48:51], v[80:95]
    ds_read_b128 v[48:51], v44 offset:1024
    s_waitcnt lgkmcnt(3)
    v_mfma_f32_32x32x16_bf16 v[64:79], a[132:135], v[52:55], v[64:79]
    s_add_u32 s39, s31, 49152
    buffer_store_dwordx4 v[148:151], v30, s[4:7], s39 offen sc1
    v_mfma_f32_32x32x16_bf16 v[80:95], v[228:231], v[52:55], v[80:95]
    s_add_u32 m0, s38, 8192
    s_nop 0
    buffer_load_dwordx4 v18, s[4:7], s32 offen lds
    ds_read_b128 v[52:55], v45 offset:1024
    s_waitcnt lgkmcnt(3)
    v_mfma_f32_32x32x16_bf16 v[64:79], a[136:139], v[56:59], v[64:79]
    v_mfma_f32_32x32x16_bf16 v[80:95], v[232:235], v[56:59], v[80:95]
    ds_read_b128 v[56:59], v46 offset:1024
    s_waitcnt lgkmcnt(3)
    v_mfma_f32_32x32x16_bf16 v[64:79], a[140:143], v[60:63], v[64:79]
    v_mfma_f32_32x32x16_bf16 v[80:95], v[236:239], v[60:63], v[80:95]
    ds_read_b128 v[60:63], v47 offset:1024
    s_waitcnt lgkmcnt(3)
    v_mfma_f32_32x32x16_bf16 v[64:79], a[144:147], v[48:51], v[64:79]
    v_mfma_f32_32x32x16_bf16 v[80:95], v[240:243], v[48:51], v[80:95]
    s_waitcnt lgkmcnt(2)
    v_mfma_f32_32x32x16_bf16 v[64:79], a[148:151], v[52:55], v[64:79]
    s_add_u32 m0, s38, 9216
    s_nop 0
    buffer_load_dwordx4 v19, s[4:7], s32 offen lds
    v_mfma_f32_32x32x16_bf16 v[80:95], v[244:247], v[52:55], v[80:95]
    s_waitcnt lgkmcnt(1)
    v_mfma_f32_32x32x16_bf16 v[64:79], a[152:155], v[56:59], v[64:79]
    v_mfma_f32_32x32x16_bf16 v[80:95], v[248:251], v[56:59], v[80:95]
    s_waitcnt lgkmcnt(0)
    v_mfma_f32_32x32x16_bf16 v[64:79], a[156:159], v[60:63], v[64:79]
    v_mfma_f32_32x32x16_bf16 v[80:95], v[252:255], v[60:63], v[80:95]
    s_add_u32 s32, s32, 40960
    s_add_u32 s31, s31, s30
    s_add_u32 s33, s33, 1
    s_mov_b32 s38, s34
    s_mov_b32 s34, s35
    s_mov_b32 s35, s36
    s_mov_b32 s36, s38
    s_cmp_ge_u32 s33, s19
    s_cbranch_scc1 L_pfa_225
    s_waitcnt vmcnt(12)
    s_barrier
    s_sub_u32 s39, s33, 2
    s_cmp_lg_u32 s16, 0
    s_cbranch_scc1 L_pp_228
    v_mov_b32 v9, s39
    s_mov_b64 exec, 1
    buffer_store_dword v9, v31, s[4:7], 0 offen sc1
    s_mov_b64 exec, -1
L_pp_228:
    s_branch L_ploop_224
L_pfa_225:
    s_nop 7
    s_nop 3
    v_cvt_pk_bf16_f32 v128, v64, v65
    v_cvt_pk_bf16_f32 v129, v80, v81
    v_lshlrev_b32 v130, 16, v128
    v_and_b32 v131, 0xffff0000, v128
    v_mul_f32 v130, 0xbfb8aa3b, v130
    v_mul_f32 v131, 0xbfb8aa3b, v131
    v_exp_f32 v130, v130
    v_exp_f32 v131, v131
    s_nop 0
    v_add_f32 v130, 1.0, v130
    v_add_f32 v131, 1.0, v131
    v_rcp_f32 v130, v130
    v_rcp_f32 v131, v131
    s_nop 0
    v_cvt_pk_bf16_f32 v128, v130, v131
    v_lshlrev_b32 v130, 16, v128
    v_and_b32 v131, 0xffff0000, v128
    v_lshlrev_b32 v132, 16, v129
    v_and_b32 v133, 0xffff0000, v129
    v_mul_f32 v64, v130, v132
    v_mul_f32 v65, v131, v133
    v_cvt_pk_bf16_f32 v128, v66, v67
    v_cvt_pk_bf16_f32 v129, v82, v83
    v_lshlrev_b32 v130, 16, v128
    v_and_b32 v131, 0xffff0000, v128
    v_mul_f32 v130, 0xbfb8aa3b, v130
    v_mul_f32 v131, 0xbfb8aa3b, v131
    v_exp_f32 v130, v130
    v_exp_f32 v131, v131
    s_nop 0
    v_add_f32 v130, 1.0, v130
    v_add_f32 v131, 1.0, v131
    v_rcp_f32 v130, v130
    v_rcp_f32 v131, v131
    s_nop 0
    v_cvt_pk_bf16_f32 v128, v130, v131
    v_lshlrev_b32 v130, 16, v128
    v_and_b32 v131, 0xffff0000, v128
    v_lshlrev_b32 v132, 16, v129
    v_and_b32 v133, 0xffff0000, v129
    v_mul_f32 v66, v130, v132
    v_mul_f32 v67, v131, v133
    v_cvt_pk_bf16_f32 v128, v68, v69
    v_cvt_pk_bf16_f32 v129, v84, v85
    v_lshlrev_b32 v130, 16, v128
    v_and_b32 v131, 0xffff0000, v128
    v_mul_f32 v130, 0xbfb8aa3b, v130
    v_mul_f32 v131, 0xbfb8aa3b, v131
    v_exp_f32 v130, v130
    v_exp_f32 v131, v131
    s_nop 0
    v_add_f32 v130, 1.0, v130
    v_add_f32 v131, 1.0, v131
    v_rcp_f32 v130, v130
    v_rcp_f32 v131, v131
    s_nop 0
    v_cvt_pk_bf16_f32 v128, v130, v131
    v_lshlrev_b32 v130, 16, v128
    v_and_b32 v131, 0xffff0000, v128
    v_lshlrev_b32 v132, 16, v129
    v_and_b32 v133, 0xffff0000, v129
    v_mul_f32 v68, v130, v132
    v_mul_f32 v69, v131, v133
    v_cvt_pk_bf16_f32 v128, v70, v71
    v_cvt_pk_bf16_f32 v129, v86, v87
    v_lshlrev_b32 v130, 16, v128
    v_and_b32 v131, 0xffff0000, v128
    v_mul_f32 v130, 0xbfb8aa3b, v130
    v_mul_f32 v131, 0xbfb8aa3b, v131
    v_exp_f32 v130, v130
    v_exp_f32 v131, v131
    s_nop 0
    v_add_f32 v130, 1.0, v130
    v_add_f32 v131, 1.0, v131
    v_rcp_f32 v130, v130
    v_rcp_f32 v131, v131
    s_nop 0
    v_cvt_pk_bf16_f32 v128, v130, v131
    v_lshlrev_b32 v130, 16, v128
    v_and_b32 v131, 0xffff0000, v128
    v_lshlrev_b32 v132, 16, v129
    v_and_b32 v133, 0xffff0000, v129
    v_mul_f32 v70, v130, v132
    v_mul_f32 v71, v131, v133
    v_cvt_pk_bf16_f32 v128, v72, v73
    v_cvt_pk_bf16_f32 v129, v88, v89
    v_lshlrev_b32 v130, 16, v128
    v_and_b32 v131, 0xffff0000, v128
    v_mul_f32 v130, 0xbfb8aa3b, v130
    v_mul_f32 v131, 0xbfb8aa3b, v131
    v_exp_f32 v130, v130
    v_exp_f32 v131, v131
    s_nop 0
    v_add_f32 v130, 1.0, v130
    v_add_f32 v131, 1.0, v131
    v_rcp_f32 v130, v130
    v_rcp_f32 v131, v131
    s_nop 0
    v_cvt_pk_bf16_f32 v128, v130, v131
    v_lshlrev_b32 v130, 16, v128
    v_and_b32 v131, 0xffff0000, v128
    v_lshlrev_b32 v132, 16, v129
    v_and_b32 v133, 0xffff0000, v129
    v_mul_f32 v72, v130, v132
    v_mul_f32 v73, v131, v133
    v_cvt_pk_bf16_f32 v128, v74, v75
    v_cvt_pk_bf16_f32 v129, v90, v91
    v_lshlrev_b32 v130, 16, v128
    v_and_b32 v131, 0xffff0000, v128
    v_mul_f32 v130, 0xbfb8aa3b, v130
    v_mul_f32 v131, 0xbfb8aa3b, v131
    v_exp_f32 v130, v130
    v_exp_f32 v131, v131
    s_nop 0
    v_add_f32 v130, 1.0, v130
    v_add_f32 v131, 1.0, v131
    v_rcp_f32 v130, v130
    v_rcp_f32 v131, v131
    s_nop 0
    v_cvt_pk_bf16_f32 v128, v130, v131
    v_lshlrev_b32 v130, 16, v128
    v_and_b32 v131, 0xffff0000, v128
    v_lshlrev_b32 v132, 16, v129
    v_and_b32 v133, 0xffff0000, v129
    v_mul_f32 v74, v130, v132
    v_mul_f32 v75, v131, v133
    v_cvt_pk_bf16_f32 v128, v76, v77
    v_cvt_pk_bf16_f32 v129, v92, v93
    v_lshlrev_b32 v130, 16, v128
    v_and_b32 v131, 0xffff0000, v128
    v_mul_f32 v130, 0xbfb8aa3b, v130
    v_mul_f32 v131, 0xbfb8aa3b, v131
    v_exp_f32 v130, v130
    v_exp_f32 v131, v131
    s_nop 0
    v_add_f32 v130, 1.0, v130
    v_add_f32 v131, 1.0, v131
    v_rcp_f32 v130, v130
    v_rcp_f32 v131, v131
    s_nop 0
    v_cvt_pk_bf16_f32 v128, v130, v131
    v_lshlrev_b32 v130, 16, v128
    v_and_b32 v131, 0xffff0000, v128
    v_lshlrev_b32 v132, 16, v129
    v_and_b32 v133, 0xffff0000, v129
    v_mul_f32 v76, v130, v132
    v_mul_f32 v77, v131, v133
    v_cvt_pk_bf16_f32 v128, v78, v79
    v_cvt_pk_bf16_f32 v129, v94, v95
    v_lshlrev_b32 v130, 16, v128
    v_and_b32 v131, 0xffff0000, v128
    v_mul_f32 v130, 0xbfb8aa3b, v130
    v_mul_f32 v131, 0xbfb8aa3b, v131
    v_exp_f32 v130, v130
    v_exp_f32 v131, v131
    s_nop 0
    v_add_f32 v130, 1.0, v130
    v_add_f32 v131, 1.0, v131
    v_rcp_f32 v130, v130
    v_rcp_f32 v131, v131
    s_nop 0
    v_cvt_pk_bf16_f32 v128, v130, v131
    v_lshlrev_b32 v130, 16, v128
    v_and_b32 v131, 0xffff0000, v128
    v_lshlrev_b32 v132, 16, v129
    v_and_b32 v133, 0xffff0000, v129
    v_mul_f32 v78, v130, v132
    v_mul_f32 v79, v131, v133
    v_cvt_pk_bf16_f32 v136, v64, v65
    v_cvt_pk_bf16_f32 v137, v66, v67
    v_cvt_pk_bf16_f32 v138, v68, v69
    v_cvt_pk_bf16_f32 v139, v70, v71
    v_xor_b32 v134, 0, v28
    v_permlane32_swap_b32 v136, v138
    v_permlane32_swap_b32 v137, v139
    ds_write_b128 v134, v[136:139]
    v_cvt_pk_bf16_f32 v140, v72, v73
    v_cvt_pk_bf16_f32 v141, v74, v75
    v_cvt_pk_bf16_f32 v142, v76, v77
    v_cvt_pk_bf16_f32 v143, v78, v79
    v_xor_b32 v134, 32, v28
    v_permlane32_swap_b32 v140, v142
    v_permlane32_swap_b32 v141, v143
    ds_write_b128 v134, v[140:143]
    s_waitcnt lgkmcnt(0)
    ds_read_b128 v[144:147], v29 offset:0
    ds_read_b128 v[148:151], v29 offset:1024
    s_waitcnt lgkmcnt(1)
    buffer_store_dwordx4 v[144:147], v30, s[4:7], s31 offen offset:0 sc1
    s_waitcnt lgkmcnt(0)
    s_add_u32 s39, s31, 49152
    buffer_store_dwordx4 v[148:151], v30, s[4:7], s39 offen sc1
    s_waitcnt vmcnt(0)
    s_barrier
    s_cmp_lg_u32 s16, 0
    s_cbranch_scc1 L_pp_229
    v_mov_b32 v9, s33
    s_mov_b64 exec, 1
    buffer_store_dword v9, v31, s[4:7], 0 offen sc1
    s_mov_b64 exec, -1
L_pp_229:
    s_branch L_pend_191
L_pfb_226:
    s_nop 7
    s_nop 3
    v_cvt_pk_bf16_f32 v128, v96, v97
    v_cvt_pk_bf16_f32 v129, v112, v113
    v_lshlrev_b32 v130, 16, v128
    v_and_b32 v131, 0xffff0000, v128
    v_mul_f32 v130, 0xbfb8aa3b, v130
    v_mul_f32 v131, 0xbfb8aa3b, v131
    v_exp_f32 v130, v130
    v_exp_f32 v131, v131
    s_nop 0
    v_add_f32 v130, 1.0, v130
    v_add_f32 v131, 1.0, v131
    v_rcp_f32 v130, v130
    v_rcp_f32 v131, v131
    s_nop 0
    v_cvt_pk_bf16_f32 v128, v130, v131
    v_lshlrev_b32 v130, 16, v128
    v_and_b32 v131, 0xffff0000, v128
    v_lshlrev_b32 v132, 16, v129
    v_and_b32 v133, 0xffff0000, v129
    v_mul_f32 v96, v130, v132
    v_mul_f32 v97, v131, v133
    v_cvt_pk_bf16_f32 v128, v98, v99
    v_cvt_pk_bf16_f32 v129, v114, v115
    v_lshlrev_b32 v130, 16, v128
    v_and_b32 v131, 0xffff0000, v128
    v_mul_f32 v130, 0xbfb8aa3b, v130
    v_mul_f32 v131, 0xbfb8aa3b, v131
    v_exp_f32 v130, v130
    v_exp_f32 v131, v131
    s_nop 0
    v_add_f32 v130, 1.0, v130
    v_add_f32 v131, 1.0, v131
    v_rcp_f32 v130, v130
    v_rcp_f32 v131, v131
    s_nop 0
    v_cvt_pk_bf16_f32 v128, v130, v131
    v_lshlrev_b32 v130, 16, v128
    v_and_b32 v131, 0xffff0000, v128
    v_lshlrev_b32 v132, 16, v129
    v_and_b32 v133, 0xffff0000, v129
    v_mul_f32 v98, v130, v132
    v_mul_f32 v99, v131, v133
    v_cvt_pk_bf16_f32 v128, v100, v101
    v_cvt_pk_bf16_f32 v129, v116, v117
    v_lshlrev_b32 v130, 16, v128
    v_and_b32 v131, 0xffff0000, v128
    v_mul_f32 v130, 0xbfb8aa3b, v130
    v_mul_f32 v131, 0xbfb8aa3b, v131
    v_exp_f32 v130, v130
    v_exp_f32 v131, v131
    s_nop 0
    v_add_f32 v130, 1.0, v130
    v_add_f32 v131, 1.0, v131
    v_rcp_f32 v130, v130
    v_rcp_f32 v131, v131
    s_nop 0
    v_cvt_pk_bf16_f32 v128, v130, v131
    v_lshlrev_b32 v130, 16, v128
    v_and_b32 v131, 0xffff0000, v128
    v_lshlrev_b32 v132, 16, v129
    v_and_b32 v133, 0xffff0000, v129
    v_mul_f32 v100, v130, v132
    v_mul_f32 v101, v131, v133
    v_cvt_pk_bf16_f32 v128, v102, v103
    v_cvt_pk_bf16_f32 v129, v118, v119
    v_lshlrev_b32 v130, 16, v128
    v_and_b32 v131, 0xffff0000, v128
    v_mul_f32 v130, 0xbfb8aa3b, v130
    v_mul_f32 v131, 0xbfb8aa3b, v131
    v_exp_f32 v130, v130
    v_exp_f32 v131, v131
    s_nop 0
    v_add_f32 v130, 1.0, v130
    v_add_f32 v131, 1.0, v131
    v_rcp_f32 v130, v130
    v_rcp_f32 v131, v131
    s_nop 0
    v_cvt_pk_bf16_f32 v128, v130, v131
    v_lshlrev_b32 v130, 16, v128
    v_and_b32 v131, 0xffff0000, v128
    v_lshlrev_b32 v132, 16, v129
    v_and_b32 v133, 0xffff0000, v129
    v_mul_f32 v102, v130, v132
    v_mul_f32 v103, v131, v133
    v_cvt_pk_bf16_f32 v128, v104, v105
    v_cvt_pk_bf16_f32 v129, v120, v121
    v_lshlrev_b32 v130, 16, v128
    v_and_b32 v131, 0xffff0000, v128
    v_mul_f32 v130, 0xbfb8aa3b, v130
    v_mul_f32 v131, 0xbfb8aa3b, v131
    v_exp_f32 v130, v130
    v_exp_f32 v131, v131
    s_nop 0
    v_add_f32 v130, 1.0, v130
    v_add_f32 v131, 1.0, v131
    v_rcp_f32 v130, v130
    v_rcp_f32 v131, v131
    s_nop 0
    v_cvt_pk_bf16_f32 v128, v130, v131
    v_lshlrev_b32 v130, 16, v128
    v_and_b32 v131, 0xffff0000, v128
    v_lshlrev_b32 v132, 16, v129
    v_and_b32 v133, 0xffff0000, v129
    v_mul_f32 v104, v130, v132
    v_mul_f32 v105, v131, v133
    v_cvt_pk_bf16_f32 v128, v106, v107
    v_cvt_pk_bf16_f32 v129, v122, v123
    v_lshlrev_b32 v130, 16, v128
    v_and_b32 v131, 0xffff0000, v128
    v_mul_f32 v130, 0xbfb8aa3b, v130
    v_mul_f32 v131, 0xbfb8aa3b, v131
    v_exp_f32 v130, v130
    v_exp_f32 v131, v131
    s_nop 0
    v_add_f32 v130, 1.0, v130
    v_add_f32 v131, 1.0, v131
    v_rcp_f32 v130, v130
    v_rcp_f32 v131, v131
    s_nop 0
    v_cvt_pk_bf16_f32 v128, v130, v131
    v_lshlrev_b32 v130, 16, v128
    v_and_b32 v131, 0xffff0000, v128
    v_lshlrev_b32 v132, 16, v129
    v_and_b32 v133, 0xffff0000, v129
    v_mul_f32 v106, v130, v132
    v_mul_f32 v107, v131, v133
    v_cvt_pk_bf16_f32 v128, v108, v109
    v_cvt_pk_bf16_f32 v129, v124, v125
    v_lshlrev_b32 v130, 16, v128
    v_and_b32 v131, 0xffff0000, v128
    v_mul_f32 v130, 0xbfb8aa3b, v130
    v_mul_f32 v131, 0xbfb8aa3b, v131
    v_exp_f32 v130, v130
    v_exp_f32 v131, v131
    s_nop 0
    v_add_f32 v130, 1.0, v130
    v_add_f32 v131, 1.0, v131
    v_rcp_f32 v130, v130
    v_rcp_f32 v131, v131
    s_nop 0
    v_cvt_pk_bf16_f32 v128, v130, v131
    v_lshlrev_b32 v130, 16, v128
    v_and_b32 v131, 0xffff0000, v128
    v_lshlrev_b32 v132, 16, v129
    v_and_b32 v133, 0xffff0000, v129
    v_mul_f32 v108, v130, v132
    v_mul_f32 v109, v131, v133
    v_cvt_pk_bf16_f32 v128, v110, v111
    v_cvt_pk_bf16_f32 v129, v126, v127
    v_lshlrev_b32 v130, 16, v128
    v_and_b32 v131, 0xffff0000, v128
    v_mul_f32 v130, 0xbfb8aa3b, v130
    v_mul_f32 v131, 0xbfb8aa3b, v131
    v_exp_f32 v130, v130
    v_exp_f32 v131, v131
    s_nop 0
    v_add_f32 v130, 1.0, v130
    v_add_f32 v131, 1.0, v131
    v_rcp_f32 v130, v130
    v_rcp_f32 v131, v131
    s_nop 0
    v_cvt_pk_bf16_f32 v128, v130, v131
    v_lshlrev_b32 v130, 16, v128
    v_and_b32 v131, 0xffff0000, v128
    v_lshlrev_b32 v132, 16, v129
    v_and_b32 v133, 0xffff0000, v129
    v_mul_f32 v110, v130, v132
    v_mul_f32 v111, v131, v133
    v_cvt_pk_bf16_f32 v136, v96, v97
    v_cvt_pk_bf16_f32 v137, v98, v99
    v_cvt_pk_bf16_f32 v138, v100, v101
    v_cvt_pk_bf16_f32 v139, v102, v103
    v_xor_b32 v134, 0, v28
    v_permlane32_swap_b32 v136, v138
    v_permlane32_swap_b32 v137, v139
    ds_write_b128 v134, v[136:139]
    v_cvt_pk_bf16_f32 v140, v104, v105
    v_cvt_pk_bf16_f32 v141, v106, v107
    v_cvt_pk_bf16_f32 v142, v108, v109
    v_cvt_pk_bf16_f32 v143, v110, v111
    v_xor_b32 v134, 32, v28
    v_permlane32_swap_b32 v140, v142
    v_permlane32_swap_b32 v141, v143
    ds_write_b128 v134, v[140:143]
    s_waitcnt lgkmcnt(0)
    ds_read_b128 v[144:147], v29 offset:0
    ds_read_b128 v[148:151], v29 offset:1024
    s_waitcnt lgkmcnt(1)
    buffer_store_dwordx4 v[144:147], v30, s[4:7], s31 offen offset:0 sc1
    s_waitcnt lgkmcnt(0)
    s_add_u32 s39, s31, 49152
    buffer_store_dwordx4 v[148:151], v30, s[4:7], s39 offen sc1
    s_waitcnt vmcnt(0)
    s_barrier
    s_cmp_lg_u32 s16, 0
    s_cbranch_scc1 L_pp_230
    v_mov_b32 v9, s33
    s_mov_b64 exec, 1
    buffer_store_dword v9, v31, s[4:7], 0 offen sc1
    s_mov_b64 exec, -1
L_pp_230:
    s_branch L_pend_191
L_pend_191:
    s_branch L_end_1
L_attn_5:
    v_mov_b32 v2, 76
    s_mov_b32 s38, 0
L_dw_231:
    buffer_load_dword v3, v2, s[12:15], 0 offen sc1
    s_waitcnt vmcnt(0)
    v_cmp_gt_u32 vcc, 1, v3
    s_cbranch_vccz L_dwk_232
    s_sleep 2
    s_add_u32 s38, s38, 1
    s_cmp_lt_u32 s38, 4194304
    s_cbranch_scc1 L_dw_231
    s_branch L_end_1
L_dwk_232:
    s_lshl_b32 s44, s18, 1
    s_and_b32 s18, s16, 1
    s_add_u32 s44, s44, s18
    s_lshr_b32 s18, s16, 1
    s_lshl_b32 s45, s17, 7
    s_lshl_b32 s17, s17, 3
    s_add_u32 s17, s17, s44
    s_mov_b32 s19, 2
    v_and_b32 v1, 63, v0
    s_mul_i32 s46, s44, 3
    s_lshr_b32 s47, s45, 7
    s_mul_i32 s47, s47, 24
    s_add_u32 s46, s46, s47
    s_lshl_b32 s46, s46, 7
    s_add_u32 s46, s46, 2107904
    v_lshlrev_b32 v20, 7, v1
    v_add_u32 v20, s46, v20
    s_mul_i32 s46, s17, 192
    s_lshr_b32 s47, s46, 8
    s_add_u32 s46, s46, 191
    s_lshr_b32 s46, s46, 8
    v_lshrrev_b32 v25, 1, v1
    v_mul_u32_u24 v25, 24, v25
    v_mov_b32 v21, s47
    v_mov_b32 v22, s46
    v_and_b32 v26, 1, v1
    v_cmp_eq_u32 vcc, 1, v26
    s_nop 1
    v_cndmask_b32 v21, v21, v22, vcc
    v_add_u32 v25, v25, v21
    v_lshlrev_b32 v25, 7, v25
    v_add_u32 v25, 2097152, v25
    s_lshl_b32 s46, s18, 5
    s_add_u32 s46, s46, s17
    s_lshl_b32 s46, s46, 7
    s_add_u32 s46, s46, 2126592
    v_mov_b32 v21, s46
    s_mov_b32 s49, 0
    v_and_b32 v1, 63, v0
    v_and_b32 v2, 15, v1
    v_lshrrev_b32 v3, 4, v1
    s_mul_i32 s20, s17, 384
    v_mul_u32_u24 v4, 12288, v2
    v_lshlrev_b32 v5, 4, v3
    v_add_u32 v4, v4, v5
    v_add_u32 v4, s20, v4
    v_add_u32 v6, 54525952, v4
    v_add_u32 v7, 54722560, v4
    v_lshrrev_b32 v8, 2, v2
    v_lshlrev_b32 v8, 3, v8
    v_and_b32 v9, 3, v2
    v_add_u32 v8, v8, v9
    v_mul_u32_u24 v8, 12288, v8
    v_add_u32 v8, v8, v5
    v_add_u32 v8, s20, v8
    v_add_u32 v9, 4243456, v8
    v_add_u32 v8, 4194304, v8
    v_and_b32 v10, 7, v2
    v_mul_u32_u24 v10, 12288, v10
    v_add_u32 v10, v10, v5
    v_add_u32 v10, s20, v10
    v_add_u32 v10, 104857600, v10
    s_mul_i32 s21, s17, 12288
    v_lshlrev_b32 v11, 6, v2
    v_add_u32 v11, v11, v5
    v_add_u32 v11, s21, v11
    v_add_u32 v11, 29360128, v11
    v_add_u32 v16, 4096, v11
    v_add_u32 v17, 8192, v11
    s_mul_i32 s21, s17, 3072
    v_lshlrev_b32 v12, 4, v2
    v_and_b32 v13, 1, v3
    v_lshlrev_b32 v13, 3, v13
    v_add_u32 v12, v12, v13
    v_add_u32 v12, s21, v12
    v_add_u32 v12, 111149056, v12
    v_and_b32 v13, 1, v3
    v_lshlrev_b32 v13, 4, v13
    v_add_u32 v13, v13, v2
    v_and_b32 v18, 7, v13
    v_lshrrev_b32 v19, 1, v3
    v_xor_b32 v18, v18, v19
    v_lshlrev_b32 v18, 4, v18
    v_mul_u32_u24 v13, 384, v13
    v_add_u32 v13, v13, v18
    s_mul_i32 s21, s16, 12288
    v_add_u32 v13, s21, v13
    v_lshlrev_b32 v18, 4, v1
    v_add_u32 v18, s21, v18
    v_add_u32 v19, 0, v1
    v_mul_u32_u24 v23, 43691, v19
    v_lshrrev_b32 v23, 20, v23
    v_mul_u32_u24 v24, 24, v23
    v_sub_u32 v19, v19, v24
    v_and_b32 v24, 7, v23
    v_xor_b32 v19, v19, v24
    v_lshlrev_b32 v19, 4, v19
    v_mul_u32_u24 v23, 12288, v23
    v_add_u32 v19, v19, v23
    v_add_u32 v19, s20, v19
    v_add_u32 v224, 79691776, v19
    v_add_u32 v19, 64, v1
    v_mul_u32_u24 v23, 43691, v19
    v_lshrrev_b32 v23, 20, v23
    v_mul_u32_u24 v24, 24, v23
    v_sub_u32 v19, v19, v24
    v_and_b32 v24, 7, v23
    v_xor_b32 v19, v19, v24
    v_lshlrev_b32 v19, 4, v19
    v_mul_u32_u24 v23, 12288, v23
    v_add_u32 v19, v19, v23
    v_add_u32 v19, s20, v19
    v_add_u32 v225, 79691776, v19
    v_add_u32 v19, 128, v1
    v_mul_u32_u24 v23, 43691, v19
    v_lshrrev_b32 v23, 20, v23
    v_mul_u32_u24 v24, 24, v23
    v_sub_u32 v19, v19, v24
    v_and_b32 v24, 7, v23
    v_xor_b32 v19, v19, v24
    v_lshlrev_b32 v19, 4, v19
    v_mul_u32_u24 v23, 12288, v23
    v_add_u32 v19, v19, v23
    v_add_u32 v19, s20, v19
    v_add_u32 v226, 79691776, v19
    v_add_u32 v19, 192, v1
    v_mul_u32_u24 v23, 43691, v19
    v_lshrrev_b32 v23, 20, v23
    v_mul_u32_u24 v24, 24, v23
    v_sub_u32 v19, v19, v24
    v_and_b32 v24, 7, v23
    v_xor_b32 v19, v19, v24
    v_lshlrev_b32 v19, 4, v19
    v_mul_u32_u24 v23, 12288, v23
    v_add_u32 v19, v19, v23
    v_add_u32 v19, s20, v19
    v_add_u32 v227, 79691776, v19
    v_add_u32 v19, 256, v1
    v_mul_u32_u24 v23, 43691, v19
    v_lshrrev_b32 v23, 20, v23
    v_mul_u32_u24 v24, 24, v23
    v_sub_u32 v19, v19, v24
    v_and_b32 v24, 7, v23
    v_xor_b32 v19, v19, v24
    v_lshlrev_b32 v19, 4, v19
    v_mul_u32_u24 v23, 12288, v23
    v_add_u32 v19, v19, v23
    v_add_u32 v19, s20, v19
    v_add_u32 v228, 79691776, v19
    v_add_u32 v19, 320, v1
    v_mul_u32_u24 v23, 43691, v19
    v_lshrrev_b32 v23, 20, v23
    v_mul_u32_u24 v24, 24, v23
    v_sub_u32 v19, v19, v24
    v_and_b32 v24, 7, v23
    v_xor_b32 v19, v19, v24
    v_lshlrev_b32 v19, 4, v19
    v_mul_u32_u24 v23, 12288, v23
    v_add_u32 v19, v19, v23
    v_add_u32 v19, s20, v19
    v_add_u32 v229, 79691776, v19
    v_add_u32 v19, 384, v1
    v_mul_u32_u24 v23, 43691, v19
    v_lshrrev_b32 v23, 20, v23
    v_mul_u32_u24 v24, 24, v23
    v_sub_u32 v19, v19, v24
    v_and_b32 v24, 7, v23
    v_xor_b32 v19, v19, v24
    v_lshlrev_b32 v19, 4, v19
    v_mul_u32_u24 v23, 12288, v23
    v_add_u32 v19, v19, v23
    v_add_u32 v19, s20, v19
    v_add_u32 v230, 79691776, v19
    v_add_u32 v19, 448, v1
    v_mul_u32_u24 v23, 43691, v19
    v_lshrrev_b32 v23, 20, v23
    v_mul_u32_u24 v24, 24, v23
    v_sub_u32 v19, v19, v24
    v_and_b32 v24, 7, v23
    v_xor_b32 v19, v19, v24
    v_lshlrev_b32 v19, 4, v19
    v_mul_u32_u24 v23, 12288, v23
    v_add_u32 v19, v19, v23
    v_add_u32 v19, s20, v19
    v_add_u32 v231, 79691776, v19
    v_add_u32 v19, 512, v1
    v_mul_u32_u24 v23, 43691, v19
    v_lshrrev_b32 v23, 20, v23
    v_mul_u32_u24 v24, 24, v23
    v_sub_u32 v19, v19, v24
    v_and_b32 v24, 7, v23
    v_xor_b32 v19, v19, v24
    v_lshlrev_b32 v19, 4, v19
    v_mul_u32_u24 v23, 12288, v23
    v_add_u32 v19, v19, v23
    v_add_u32 v19, s20, v19
    v_add_u32 v232, 79691776, v19
    v_add_u32 v19, 576, v1
    v_mul_u32_u24 v23, 43691, v19
    v_lshrrev_b32 v23, 20, v23
    v_mul_u32_u24 v24, 24, v23
    v_sub_u32 v19, v19, v24
    v_and_b32 v24, 7, v23
    v_xor_b32 v19, v19, v24
    v_lshlrev_b32 v19, 4, v19
    v_mul_u32_u24 v23, 12288, v23
    v_add_u32 v19, v19, v23
    v_add_u32 v19, s20, v19
    v_add_u32 v233, 79691776, v19
    v_add_u32 v19, 640, v1
    v_mul_u32_u24 v23, 43691, v19
    v_lshrrev_b32 v23, 20, v23
    v_mul_u32_u24 v24, 24, v23
    v_sub_u32 v19, v19, v24
    v_and_b32 v24, 7, v23
    v_xor_b32 v19, v19, v24
    v_lshlrev_b32 v19, 4, v19
    v_mul_u32_u24 v23, 12288, v23
    v_add_u32 v19, v19, v23
    v_add_u32 v19, s20, v19
    v_add_u32 v234, 79691776, v19
    v_add_u32 v19, 704, v1
    v_mul_u32_u24 v23, 43691, v19
    v_lshrrev_b32 v23, 20, v23
    v_mul_u32_u24 v24, 24, v23
    v_sub_u32 v19, v19, v24
    v_and_b32 v24, 7, v23
    v_xor_b32 v19, v19, v24
    v_lshlrev_b32 v19, 4, v19
    v_mul_u32_u24 v23, 12288, v23
    v_add_u32 v19, v19, v23
    v_add_u32 v19, s20, v19
    v_add_u32 v235, 79691776, v19
    v_lshlrev_b32 v14, 3, v3
    v_sub_u32 v14, v2, v14
    v_add_u32 v15, 16, v14
    v_mov_b32 v240, 0x3f803f80
    v_mov_b32 v241, 0x3f803f80
    v_mov_b32 v242, 0x3f803f80
    v_mov_b32 v243, 0x3f803f80
    v_mov_b32 v244, 0x3f803f80
    v_cmp_gt_u32 vcc, 2, v3
    s_nop 1
    v_cndmask_b32 v244, 0, v244, vcc
    v_mov_b32 v245, v244
    v_mov_b32 v246, 0xf149f2ca
    s_mov_b32 s33, 0x3dd53b95
    v_mov_b32 v192, 0
    v_mov_b32 v193, 0
    v_mov_b32 v194, 0
    v_mov_b32 v195, 0
    v_mov_b32 v196, 0
    v_mov_b32 v197, 0
    v_mov_b32 v198, 0
    v_mov_b32 v199, 0
    v_mov_b32 v200, 0
    v_mov_b32 v201, 0
    v_mov_b32 v202, 0
    v_mov_b32 v203, 0
    v_mov_b32 v204, 0
    v_mov_b32 v205, 0
    v_mov_b32 v206, 0
    v_mov_b32 v207, 0
    v_mov_b32 v208, 0
    v_mov_b32 v209, 0
    v_mov_b32 v210, 0
    v_mov_b32 v211, 0
    v_mov_b32 v212, 0
    v_mov_b32 v213, 0
    v_mov_b32 v214, 0
    v_mov_b32 v215, 0
    s_mov_b32 s22, s18
    s_mov_b32 s35, 0
L_at_233:
    s_add_u32 s46, s22, 1
    s_cmp_ge_u32 s49, s46
    s_cbranch_scc1 L_aps_235
    s_mov_b32 s38, 0
    s_mov_b32 exec_lo, 0x3f
    s_mov_b32 exec_hi, 0x0
L_wt_236:
    buffer_load_dword v22, v25, s[4:7], 0 offen sc1
    s_waitcnt vmcnt(0)
    v_cmp_gt_u32 vcc, s46, v22
    s_cbranch_vccz L_wtk_238
    s_sleep 4
    s_add_u32 s38, s38, 1
    s_cmp_lt_u32 s38, 4194304
    s_cbranch_scc1 L_wt_236
    s_mov_b64 exec, -1
    s_branch L_end_1
L_wtk_238:
    s_mov_b64 exec, -1
L_wtd_237:
    s_nop 0
    v_readlane_b32 s50, v22, 0
    v_readlane_b32 s51, v22, 1
    v_readlane_b32 s52, v22, 2
    v_readlane_b32 s53, v22, 3
    v_readlane_b32 s54, v22, 4
    v_readlane_b32 s55, v22, 5
    s_nop 3
    s_min_u32 s49, s50, s51
    s_min_u32 s49, s49, s52
    s_min_u32 s49, s49, s53
    s_min_u32 s49, s49, s54
    s_min_u32 s49, s49, s55
L_aps_235:
    s_mul_i32 s24, s22, 393216
    buffer_load_dwordx4 a[48:51], v6, s[4:7], s24 offen offset:0
    buffer_load_dwordx4 a[52:55], v6, s[4:7], s24 offen offset:64
    buffer_load_dwordx4 a[56:59], v6, s[4:7], s24 offen offset:128
    buffer_load_dwordx4 a[60:63], v6, s[4:7], s24 offen offset:192
    buffer_load_dwordx4 a[64:67], v6, s[4:7], s24 offen offset:256
    buffer_load_dwordx4 a[68:71], v6, s[4:7], s24 offen offset:320
    buffer_load_dwordx4 a[72:75], v7, s[4:7], s24 offen offset:0
    buffer_load_dwordx4 a[76:79], v7, s[4:7], s24 offen offset:64
    buffer_load_dwordx4 a[80:83], v7, s[4:7], s24 offen offset:128
    buffer_load_dwordx4 a[84:87], v7, s[4:7], s24 offen offset:192
    buffer_load_dwordx4 a[88:91], v7, s[4:7], s24 offen offset:256
    buffer_load_dwordx4 a[92:95], v7, s[4:7], s24 offen offset:320
    s_cmp_eq_u32 s35, 0
    s_cbranch_scc1 L_anp_239
    s_waitcnt vmcnt(12)
    s_add_u32 s46, s36, 1
    v_mov_b32 v22, s46
    s_mov_b64 exec, 1
    buffer_store_dword v22, v21, s[4:7], 0 offen sc1
    s_mov_b64 exec, -1
L_anp_239:
    s_mov_b32 s38, 0
    s_mov_b32 exec_lo, 0x7
    s_mov_b32 exec_hi, 0x0
L_wt_240:
    buffer_load_dword v22, v20, s[4:7], 0 offen sc1
    s_waitcnt vmcnt(0)
    v_cmp_gt_u32 vcc, s22, v22
    s_cbranch_vccz L_wtk_242
    s_sleep 4
    s_add_u32 s38, s38, 1
    s_cmp_lt_u32 s38, 4194304
    s_cbranch_scc1 L_wt_240
    s_mov_b64 exec, -1
    s_branch L_end_1
L_wtk_242:
    s_mov_b64 exec, -1
L_wtd_241:
    buffer_load_dwordx4 a[96:99], v8, s[4:7], s24 offen offset:0
    buffer_load_dwordx4 a[100:103], v8, s[4:7], s24 offen offset:64
    buffer_load_dwordx4 a[104:107], v8, s[4:7], s24 offen offset:128
    buffer_load_dwordx4 a[108:111], v8, s[4:7], s24 offen offset:192
    buffer_load_dwordx4 a[112:115], v8, s[4:7], s24 offen offset:256
    buffer_load_dwordx4 a[116:119], v8, s[4:7], s24 offen offset:320
    buffer_load_dwordx4 a[120:123], v9, s[4:7], s24 offen offset:0
    buffer_load_dwordx4 a[124:127], v9, s[4:7], s24 offen offset:64
    buffer_load_dwordx4 a[128:131], v9, s[4:7], s24 offen offset:128
    buffer_load_dwordx4 a[132:135], v9, s[4:7], s24 offen offset:192
    buffer_load_dwordx4 a[136:139], v9, s[4:7], s24 offen offset:256
    buffer_load_dwordx4 a[140:143], v9, s[4:7], s24 offen offset:320
    s_mul_i32 s26, s22, 393216
    buffer_load_dwordx4 a[0:3], v11, s[4:7], s26 offen offset:0
    buffer_load_dwordx4 a[4:7], v11, s[4:7], s26 offen offset:1024
    buffer_load_dwordx4 a[8:11], v11, s[4:7], s26 offen offset:2048
    buffer_load_dwordx4 a[12:15], v11, s[4:7], s26 offen offset:3072
    buffer_load_dwordx4 a[16:19], v16, s[4:7], s26 offen offset:0
    buffer_load_dwordx4 a[20:23], v16, s[4:7], s26 offen offset:1024
    buffer_load_dwordx4 a[24:27], v16, s[4:7], s26 offen offset:2048
    buffer_load_dwordx4 a[28:31], v16, s[4:7], s26 offen offset:3072
    buffer_load_dwordx4 a[32:35], v17, s[4:7], s26 offen offset:0
    buffer_load_dwordx4 a[36:39], v17, s[4:7], s26 offen offset:1024
    buffer_load_dwordx4 a[40:43], v17, s[4:7], s26 offen offset:2048
    buffer_load_dwordx4 a[44:47], v17, s[4:7], s26 offen offset:3072
    s_waitcnt vmcnt(12)
    v_mfma_f32_16x16x32_bf16 v[156:159], a[96:99], a[48:51], 0
    v_mfma_f32_16x16x32_bf16 v[160:163], a[120:123], a[48:51], 0
    v_mfma_f32_16x16x32_bf16 v[168:171], a[96:99], a[72:75], 0
    v_mfma_f32_16x16x32_bf16 v[172:175], a[120:123], a[72:75], 0
    v_mfma_f32_16x16x32_bf16 v[156:159], a[100:103], a[52:55], v[156:159]
    v_mfma_f32_16x16x32_bf16 v[160:163], a[124:127], a[52:55], v[160:163]
    v_mfma_f32_16x16x32_bf16 v[168:171], a[100:103], a[76:79], v[168:171]
    v_mfma_f32_16x16x32_bf16 v[172:175], a[124:127], a[76:79], v[172:175]
    v_mfma_f32_16x16x32_bf16 v[156:159], a[104:107], a[56:59], v[156:159]
    v_mfma_f32_16x16x32_bf16 v[160:163], a[128:131], a[56:59], v[160:163]
    v_mfma_f32_16x16x32_bf16 v[168:171], a[104:107], a[80:83], v[168:171]
    v_mfma_f32_16x16x32_bf16 v[172:175], a[128:131], a[80:83], v[172:175]
    v_mfma_f32_16x16x32_bf16 v[156:159], a[108:111], a[60:63], v[156:159]
    v_mfma_f32_16x16x32_bf16 v[160:163], a[132:135], a[60:63], v[160:163]
    v_mfma_f32_16x16x32_bf16 v[168:171], a[108:111], a[84:87], v[168:171]
    v_mfma_f32_16x16x32_bf16 v[172:175], a[132:135], a[84:87], v[172:175]
    v_mfma_f32_16x16x32_bf16 v[156:159], a[112:115], a[64:67], v[156:159]
    v_mfma_f32_16x16x32_bf16 v[160:163], a[136:139], a[64:67], v[160:163]
    v_mfma_f32_16x16x32_bf16 v[168:171], a[112:115], a[88:91], v[168:171]
    v_mfma_f32_16x16x32_bf16 v[172:175], a[136:139], a[88:91], v[172:175]
    v_mfma_f32_16x16x32_bf16 v[156:159], a[116:119], a[68:71], v[156:159]
    v_mfma_f32_16x16x32_bf16 v[160:163], a[140:143], a[68:71], v[160:163]
    v_mfma_f32_16x16x32_bf16 v[168:171], a[116:119], a[92:95], v[168:171]
    v_mfma_f32_16x16x32_bf16 v[172:175], a[140:143], a[92:95], v[172:175]
    s_nop 7
    v_cmp_gt_i32 vcc, 0, v14
    v_cmp_gt_i32 s[30:31], 4, v14
    s_nop 0
    v_cndmask_b32 v156, v156, v246, vcc
    v_cndmask_b32 v160, v160, v246, s[30:31]
    v_cmp_gt_i32 vcc, 1, v14
    v_cmp_gt_i32 s[30:31], 5, v14
    s_nop 0
    v_cndmask_b32 v157, v157, v246, vcc
    v_cndmask_b32 v161, v161, v246, s[30:31]
    v_cmp_gt_i32 vcc, 2, v14
    v_cmp_gt_i32 s[30:31], 6, v14
    s_nop 0
    v_cndmask_b32 v158, v158, v246, vcc
    v_cndmask_b32 v162, v162, v246, s[30:31]
    v_cmp_gt_i32 vcc, 3, v14
    v_cmp_gt_i32 s[30:31], 7, v14
    s_nop 0
    v_cndmask_b32 v159, v159, v246, vcc
    v_cndmask_b32 v163, v163, v246, s[30:31]
    v_max3_f32 v220, v156, v157, v158
    v_max3_f32 v220, v220, v159, v160
    v_max3_f32 v220, v220, v161, v162
    v_max_f32 v220, v220, v163
    v_cmp_gt_i32 vcc, 0, v15
    v_cmp_gt_i32 s[30:31], 4, v15
    s_nop 0
    v_cndmask_b32 v168, v168, v246, vcc
    v_cndmask_b32 v172, v172, v246, s[30:31]
    v_cmp_gt_i32 vcc, 1, v15
    v_cmp_gt_i32 s[30:31], 5, v15
    s_nop 0
    v_cndmask_b32 v169, v169, v246, vcc
    v_cndmask_b32 v173, v173, v246, s[30:31]
    v_cmp_gt_i32 vcc, 2, v15
    v_cmp_gt_i32 s[30:31], 6, v15
    s_nop 0
    v_cndmask_b32 v170, v170, v246, vcc
    v_cndmask_b32 v174, v174, v246, s[30:31]
    v_cmp_gt_i32 vcc, 3, v15
    v_cmp_gt_i32 s[30:31], 7, v15
    s_nop 0
    v_cndmask_b32 v171, v171, v246, vcc
    v_cndmask_b32 v175, v175, v246, s[30:31]
    v_max3_f32 v221, v168, v169, v170
    v_max3_f32 v221, v221, v171, v172
    v_max3_f32 v221, v221, v173, v174
    v_max_f32 v221, v221, v175
    s_add_u32 s46, s22, 1
    s_mov_b32 s38, 0
    s_mov_b32 exec_lo, 0x7
    s_mov_b32 exec_hi, 0x0
L_wt_243:
    buffer_load_dword v22, v20, s[4:7], 0 offen sc1
    s_waitcnt vmcnt(0)
    v_cmp_gt_u32 vcc, s46, v22
    s_cbranch_vccz L_wtk_245
    s_sleep 2
    s_add_u32 s38, s38, 1
    s_cmp_lt_u32 s38, 4194304
    s_cbranch_scc1 L_wt_243
    s_mov_b64 exec, -1
    s_branch L_end_1
L_wtk_245:
    s_mov_b64 exec, -1
L_wtd_244:
    s_mul_i32 s25, s22, 98304
    s_mul_i32 s27, s22, 98304
    s_mul_i32 s28, s22, 393216
    s_mov_b32 exec_lo, 0x00ff00ff
    s_mov_b32 exec_hi, 0x00ff00ff
    buffer_load_dwordx4 v[128:131], v10, s[4:7], s25 offen offset:0
    buffer_load_dwordx4 v[132:135], v10, s[4:7], s25 offen offset:64
    buffer_load_dwordx4 v[136:139], v10, s[4:7], s25 offen offset:128
    buffer_load_dwordx4 v[140:143], v10, s[4:7], s25 offen offset:192
    buffer_load_dwordx4 v[144:147], v10, s[4:7], s25 offen offset:256
    buffer_load_dwordx4 v[148:151], v10, s[4:7], s25 offen offset:320
    s_mov_b32 exec_lo, -1
    s_mov_b32 exec_hi, 0
    buffer_load_dwordx2 v[192:193], v12, s[4:7], s27 offen offset:0
    buffer_load_dwordx2 v[194:195], v12, s[4:7], s27 offen offset:256
    buffer_load_dwordx2 v[196:197], v12, s[4:7], s27 offen offset:512
    buffer_load_dwordx2 v[198:199], v12, s[4:7], s27 offen offset:768
    buffer_load_dwordx2 v[200:201], v12, s[4:7], s27 offen offset:1024
    buffer_load_dwordx2 v[202:203], v12, s[4:7], s27 offen offset:1280
    buffer_load_dwordx2 v[204:205], v12, s[4:7], s27 offen offset:1536
    buffer_load_dwordx2 v[206:207], v12, s[4:7], s27 offen offset:1792
    buffer_load_dwordx2 v[208:209], v12, s[4:7], s27 offen offset:2048
    buffer_load_dwordx2 v[210:211], v12, s[4:7], s27 offen offset:2304
    buffer_load_dwordx2 v[212:213], v12, s[4:7], s27 offen offset:2560
    buffer_load_dwordx2 v[214:215], v12, s[4:7], s27 offen offset:2816
    s_mov_b64 exec, -1
    s_waitcnt vmcnt(12)
    v_mfma_f32_16x16x32_bf16 v[152:155], v[128:131], a[48:51], 0
    v_mfma_f32_16x16x32_bf16 v[164:167], v[128:131], a[72:75], 0
    v_mfma_f32_16x16x32_bf16 v[152:155], v[132:135], a[52:55], v[152:155]
    v_mfma_f32_16x16x32_bf16 v[164:167], v[132:135], a[76:79], v[164:167]
    v_mfma_f32_16x16x32_bf16 v[152:155], v[136:139], a[56:59], v[152:155]
    v_mfma_f32_16x16x32_bf16 v[164:167], v[136:139], a[80:83], v[164:167]
    v_mfma_f32_16x16x32_bf16 v[152:155], v[140:143], a[60:63], v[152:155]
    v_mfma_f32_16x16x32_bf16 v[164:167], v[140:143], a[84:87], v[164:167]
    v_mfma_f32_16x16x32_bf16 v[152:155], v[144:147], a[64:67], v[152:155]
    v_mfma_f32_16x16x32_bf16 v[164:167], v[144:147], a[88:91], v[164:167]
    v_mfma_f32_16x16x32_bf16 v[152:155], v[148:151], a[68:71], v[152:155]
    v_mfma_f32_16x16x32_bf16 v[164:167], v[148:151], a[92:95], v[164:167]
    s_nop 7
    s_mov_b32 exec_lo, 0
    s_mov_b32 exec_hi, -1
    v_mov_b32 v152, v246
    v_mov_b32 v153, v246
    v_mov_b32 v154, v246
    v_mov_b32 v155, v246
    s_mov_b64 exec, -1
    v_max3_f32 v220, v220, v152, v153
    v_max3_f32 v220, v220, v154, v155
    s_mov_b32 exec_lo, 0
    s_mov_b32 exec_hi, -1
    v_mov_b32 v164, v246
    v_mov_b32 v165, v246
    v_mov_b32 v166, v246
    v_mov_b32 v167, v246
    s_mov_b64 exec, -1
    v_max3_f32 v221, v221, v164, v165
    v_max3_f32 v221, v221, v166, v167
    v_mov_b32 v222, v220
    s_nop 1
    v_permlane16_swap_b32 v220, v222
    v_max_f32 v220, v220, v222
    v_mov_b32 v222, v220
    s_nop 1
    v_permlane32_swap_b32 v220, v222
    v_max_f32 v220, v220, v222
    v_mul_f32 v220, s33, v220
    v_mov_b32 v222, v221
    s_nop 1
    v_permlane16_swap_b32 v221, v222
    v_max_f32 v221, v221, v222
    v_mov_b32 v222, v221
    s_nop 1
    v_permlane32_swap_b32 v221, v222
    v_max_f32 v221, v221, v222
    v_mul_f32 v221, s33, v221
    v_fma_f32 v152, v152, s33, -v220
    v_fma_f32 v153, v153, s33, -v220
    v_fma_f32 v154, v154, s33, -v220
    v_fma_f32 v155, v155, s33, -v220
    v_fma_f32 v156, v156, s33, -v220
    v_fma_f32 v157, v157, s33, -v220
    v_fma_f32 v158, v158, s33, -v220
    v_fma_f32 v159, v159, s33, -v220
    v_fma_f32 v160, v160, s33, -v220
    v_fma_f32 v161, v161, s33, -v220
    v_fma_f32 v162, v162, s33, -v220
    v_fma_f32 v163, v163, s33, -v220
    v_exp_f32 v152, v152
    v_exp_f32 v153, v153
    v_exp_f32 v154, v154
    v_exp_f32 v155, v155
    v_exp_f32 v156, v156
    v_exp_f32 v157, v157
    v_exp_f32 v158, v158
    v_exp_f32 v159, v159
    v_exp_f32 v160, v160
    v_exp_f32 v161, v161
    v_exp_f32 v162, v162
    v_exp_f32 v163, v163
    v_fma_f32 v164, v164, s33, -v221
    v_fma_f32 v165, v165, s33, -v221
    v_fma_f32 v166, v166, s33, -v221
    v_fma_f32 v167, v167, s33, -v221
    v_fma_f32 v168, v168, s33, -v221
    v_fma_f32 v169, v169, s33, -v221
    v_fma_f32 v170, v170, s33, -v221
    v_fma_f32 v171, v171, s33, -v221
    v_fma_f32 v172, v172, s33, -v221
    v_fma_f32 v173, v173, s33, -v221
    v_fma_f32 v174, v174, s33, -v221
    v_fma_f32 v175, v175, s33, -v221
    v_exp_f32 v164, v164
    v_exp_f32 v165, v165
    v_exp_f32 v166, v166
    v_exp_f32 v167, v167
    v_exp_f32 v168, v168
    v_exp_f32 v169, v169
    v_exp_f32 v170, v170
    v_exp_f32 v171, v171
    v_exp_f32 v172, v172
    v_exp_f32 v173, v173
    v_exp_f32 v174, v174
    v_exp_f32 v175, v175
    v_add_f32 v220, v152, v153
    v_add_f32 v220, v220, v154
    v_add_f32 v220, v220, v155
    v_add_f32 v220, v220, v156
    v_add_f32 v220, v220, v157
    v_add_f32 v220, v220, v158
    v_add_f32 v220, v220, v159
    v_add_f32 v220, v220, v160
    v_add_f32 v220, v220, v161
    v_add_f32 v220, v220, v162
    v_add_f32 v220, v220, v163
    v_add_f32 v221, v164, v165
    v_add_f32 v221, v221, v166
    v_add_f32 v221, v221, v167
    v_add_f32 v221, v221, v168
    v_add_f32 v221, v221, v169
    v_add_f32 v221, v221, v170
    v_add_f32 v221, v221, v171
    v_add_f32 v221, v221, v172
    v_add_f32 v221, v221, v173
    v_add_f32 v221, v221, v174
    v_add_f32 v221, v221, v175
    v_mov_b32 v222, v220
    s_nop 1
    v_permlane16_swap_b32 v220, v222
    v_add_f32 v220, v220, v222
    v_mov_b32 v222, v220
    s_nop 1
    v_permlane32_swap_b32 v220, v222
    v_add_f32 v220, v220, v222
    v_rcp_f32 v220, v220
    v_mov_b32 v222, v221
    s_nop 1
    v_permlane16_swap_b32 v221, v222
    v_add_f32 v221, v221, v222
    v_mov_b32 v222, v221
    s_nop 1
    v_permlane32_swap_b32 v221, v222
    v_add_f32 v221, v221, v222
    v_rcp_f32 v221, v221
    s_nop 0
    v_pk_mul_f32 v[152:153], v[152:153], v[220:221] op_sel_hi:[1,0]
    v_pk_mul_f32 v[154:155], v[154:155], v[220:221] op_sel_hi:[1,0]
    v_pk_mul_f32 v[156:157], v[156:157], v[220:221] op_sel_hi:[1,0]
    v_pk_mul_f32 v[158:159], v[158:159], v[220:221] op_sel_hi:[1,0]
    v_pk_mul_f32 v[160:161], v[160:161], v[220:221] op_sel_hi:[1,0]
    v_pk_mul_f32 v[162:163], v[162:163], v[220:221] op_sel_hi:[1,0]
    v_cvt_pk_bf16_f32 v176, v156, v157
    v_cvt_pk_bf16_f32 v177, v158, v159
    v_cvt_pk_bf16_f32 v178, v160, v161
    v_cvt_pk_bf16_f32 v179, v162, v163
    v_cvt_pk_bf16_f32 v180, v152, v153
    v_cvt_pk_bf16_f32 v181, v154, v155
    v_mul_f32 v164, v164, v221
    v_mul_f32 v165, v165, v221
    v_mul_f32 v166, v166, v221
    v_mul_f32 v167, v167, v221
    v_mul_f32 v168, v168, v221
    v_mul_f32 v169, v169, v221
    v_mul_f32 v170, v170, v221
    v_mul_f32 v171, v171, v221
    v_mul_f32 v172, v172, v221
    v_mul_f32 v173, v173, v221
    v_mul_f32 v174, v174, v221
    v_mul_f32 v175, v175, v221
    v_cvt_pk_bf16_f32 v182, v168, v169
    v_cvt_pk_bf16_f32 v183, v170, v171
    v_cvt_pk_bf16_f32 v184, v172, v173
    v_cvt_pk_bf16_f32 v185, v174, v175
    v_cvt_pk_bf16_f32 v186, v164, v165
    v_cvt_pk_bf16_f32 v187, v166, v167
    s_waitcnt vmcnt(0)
    v_mfma_f32_16x16x32_bf16 v[32:35], a[0:3], v[176:179], 0
    v_mfma_f32_16x16x32_bf16 v[36:39], a[0:3], v[182:185], 0
    v_mfma_f32_16x16x16_bf16 v[32:35], v[192:193], v[180:181], v[32:35]
    v_mfma_f32_16x16x16_bf16 v[36:39], v[192:193], v[186:187], v[36:39]
    v_mfma_f32_16x16x32_bf16 v[40:43], a[4:7], v[176:179], 0
    v_mfma_f32_16x16x32_bf16 v[44:47], a[4:7], v[182:185], 0
    v_mfma_f32_16x16x16_bf16 v[40:43], v[194:195], v[180:181], v[40:43]
    v_mfma_f32_16x16x16_bf16 v[44:47], v[194:195], v[186:187], v[44:47]
    v_mfma_f32_16x16x32_bf16 v[48:51], a[8:11], v[176:179], 0
    v_mfma_f32_16x16x32_bf16 v[52:55], a[8:11], v[182:185], 0
    v_mfma_f32_16x16x16_bf16 v[48:51], v[196:197], v[180:181], v[48:51]
    v_mfma_f32_16x16x16_bf16 v[52:55], v[196:197], v[186:187], v[52:55]
    v_cvt_pk_bf16_f32 v188, v32, v33
    v_cvt_pk_bf16_f32 v189, v34, v35
    v_cvt_pk_bf16_f32 v190, v36, v37
    v_cvt_pk_bf16_f32 v191, v38, v39
    v_xor_b32 v222, 0, v13
    v_permlane16_swap_b32 v188, v190
    v_permlane16_swap_b32 v189, v191
    ds_write_b128 v222, v[188:191] offset:0
    v_mfma_f32_16x16x32_bf16 v[56:59], a[12:15], v[176:179], 0
    v_mfma_f32_16x16x32_bf16 v[60:63], a[12:15], v[182:185], 0
    v_mfma_f32_16x16x16_bf16 v[56:59], v[198:199], v[180:181], v[56:59]
    v_mfma_f32_16x16x16_bf16 v[60:63], v[198:199], v[186:187], v[60:63]
    v_cvt_pk_bf16_f32 v160, v40, v41
    v_cvt_pk_bf16_f32 v161, v42, v43
    v_cvt_pk_bf16_f32 v162, v44, v45
    v_cvt_pk_bf16_f32 v163, v46, v47
    v_xor_b32 v222, 32, v13
    v_permlane16_swap_b32 v160, v162
    v_permlane16_swap_b32 v161, v163
    ds_write_b128 v222, v[160:163] offset:0
    v_mfma_f32_16x16x32_bf16 v[64:67], a[16:19], v[176:179], 0
    v_mfma_f32_16x16x32_bf16 v[68:71], a[16:19], v[182:185], 0
    v_mfma_f32_16x16x16_bf16 v[64:67], v[200:201], v[180:181], v[64:67]
    v_mfma_f32_16x16x16_bf16 v[68:71], v[200:201], v[186:187], v[68:71]
    v_cvt_pk_bf16_f32 v188, v48, v49
    v_cvt_pk_bf16_f32 v189, v50, v51
    v_cvt_pk_bf16_f32 v190, v52, v53
    v_cvt_pk_bf16_f32 v191, v54, v55
    v_xor_b32 v222, 64, v13
    v_permlane16_swap_b32 v188, v190
    v_permlane16_swap_b32 v189, v191
    ds_write_b128 v222, v[188:191] offset:0
    v_mfma_f32_16x16x32_bf16 v[72:75], a[20:23], v[176:179], 0
    v_mfma_f32_16x16x32_bf16 v[76:79], a[20:23], v[182:185], 0
    v_mfma_f32_16x16x16_bf16 v[72:75], v[202:203], v[180:181], v[72:75]
    v_mfma_f32_16x16x16_bf16 v[76:79], v[202:203], v[186:187], v[76:79]
    v_cvt_pk_bf16_f32 v160, v56, v57
    v_cvt_pk_bf16_f32 v161, v58, v59
    v_cvt_pk_bf16_f32 v162, v60, v61
    v_cvt_pk_bf16_f32 v163, v62, v63
    v_xor_b32 v222, 96, v13
    v_permlane16_swap_b32 v160, v162
    v_permlane16_swap_b32 v161, v163
    ds_write_b128 v222, v[160:163] offset:0
    v_mfma_f32_16x16x32_bf16 v[80:83], a[24:27], v[176:179], 0
    v_mfma_f32_16x16x32_bf16 v[84:87], a[24:27], v[182:185], 0
    v_mfma_f32_16x16x16_bf16 v[80:83], v[204:205], v[180:181], v[80:83]
    v_mfma_f32_16x16x16_bf16 v[84:87], v[204:205], v[186:187], v[84:87]
    v_cvt_pk_bf16_f32 v188, v64, v65
    v_cvt_pk_bf16_f32 v189, v66, v67
    v_cvt_pk_bf16_f32 v190, v68, v69
    v_cvt_pk_bf16_f32 v191, v70, v71
    v_xor_b32 v222, 0, v13
    v_permlane16_swap_b32 v188, v190
    v_permlane16_swap_b32 v189, v191
    ds_write_b128 v222, v[188:191] offset:128
    v_mfma_f32_16x16x32_bf16 v[88:91], a[28:31], v[176:179], 0
    v_mfma_f32_16x16x32_bf16 v[92:95], a[28:31], v[182:185], 0
    v_mfma_f32_16x16x16_bf16 v[88:91], v[206:207], v[180:181], v[88:91]
    v_mfma_f32_16x16x16_bf16 v[92:95], v[206:207], v[186:187], v[92:95]
    v_cvt_pk_bf16_f32 v160, v72, v73
    v_cvt_pk_bf16_f32 v161, v74, v75
    v_cvt_pk_bf16_f32 v162, v76, v77
    v_cvt_pk_bf16_f32 v163, v78, v79
    v_xor_b32 v222, 32, v13
    v_permlane16_swap_b32 v160, v162
    v_permlane16_swap_b32 v161, v163
    ds_write_b128 v222, v[160:163] offset:128
    v_mfma_f32_16x16x32_bf16 v[96:99], a[32:35], v[176:179], 0
    v_mfma_f32_16x16x32_bf16 v[100:103], a[32:35], v[182:185], 0
    v_mfma_f32_16x16x16_bf16 v[96:99], v[208:209], v[180:181], v[96:99]
    v_mfma_f32_16x16x16_bf16 v[100:103], v[208:209], v[186:187], v[100:103]
    v_cvt_pk_bf16_f32 v188, v80, v81
    v_cvt_pk_bf16_f32 v189, v82, v83
    v_cvt_pk_bf16_f32 v190, v84, v85
    v_cvt_pk_bf16_f32 v191, v86, v87
    v_xor_b32 v222, 64, v13
    v_permlane16_swap_b32 v188, v190
    v_permlane16_swap_b32 v189, v191
    ds_write_b128 v222, v[188:191] offset:128
    v_mfma_f32_16x16x32_bf16 v[104:107], a[36:39], v[176:179], 0
    v_mfma_f32_16x16x32_bf16 v[108:111], a[36:39], v[182:185], 0
    v_mfma_f32_16x16x16_bf16 v[104:107], v[210:211], v[180:181], v[104:107]
    v_mfma_f32_16x16x16_bf16 v[108:111], v[210:211], v[186:187], v[108:111]
    v_cvt_pk_bf16_f32 v160, v88, v89
    v_cvt_pk_bf16_f32 v161, v90, v91
    v_cvt_pk_bf16_f32 v162, v92, v93
    v_cvt_pk_bf16_f32 v163, v94, v95
    v_xor_b32 v222, 96, v13
    v_permlane16_swap_b32 v160, v162
    v_permlane16_swap_b32 v161, v163
    ds_write_b128 v222, v[160:163] offset:128
    v_mfma_f32_16x16x32_bf16 v[112:115], a[40:43], v[176:179], 0
    v_mfma_f32_16x16x32_bf16 v[116:119], a[40:43], v[182:185], 0
    v_mfma_f32_16x16x16_bf16 v[112:115], v[212:213], v[180:181], v[112:115]
    v_mfma_f32_16x16x16_bf16 v[116:119], v[212:213], v[186:187], v[116:119]
    v_cvt_pk_bf16_f32 v188, v96, v97
    v_cvt_pk_bf16_f32 v189, v98, v99
    v_cvt_pk_bf16_f32 v190, v100, v101
    v_cvt_pk_bf16_f32 v191, v102, v103
    v_xor_b32 v222, 0, v13
    v_permlane16_swap_b32 v188, v190
    v_permlane16_swap_b32 v189, v191
    ds_write_b128 v222, v[188:191] offset:256
    v_mfma_f32_16x16x32_bf16 v[120:123], a[44:47], v[176:179], 0
    v_mfma_f32_16x16x32_bf16 v[124:127], a[44:47], v[182:185], 0
    v_mfma_f32_16x16x16_bf16 v[120:123], v[214:215], v[180:181], v[120:123]
    v_mfma_f32_16x16x16_bf16 v[124:127], v[214:215], v[186:187], v[124:127]
    v_cvt_pk_bf16_f32 v160, v104, v105
    v_cvt_pk_bf16_f32 v161, v106, v107
    v_cvt_pk_bf16_f32 v162, v108, v109
    v_cvt_pk_bf16_f32 v163, v110, v111
    v_xor_b32 v222, 32, v13
    v_permlane16_swap_b32 v160, v162
    v_permlane16_swap_b32 v161, v163
    ds_write_b128 v222, v[160:163] offset:256
    s_nop 7
    v_cvt_pk_bf16_f32 v188, v112, v113
    v_cvt_pk_bf16_f32 v189, v114, v115
    v_cvt_pk_bf16_f32 v190, v116, v117
    v_cvt_pk_bf16_f32 v191, v118, v119
    v_xor_b32 v222, 64, v13
    v_permlane16_swap_b32 v188, v190
    v_permlane16_swap_b32 v189, v191
    ds_write_b128 v222, v[188:191] offset:256
    v_cvt_pk_bf16_f32 v160, v120, v121
    v_cvt_pk_bf16_f32 v161, v122, v123
    v_cvt_pk_bf16_f32 v162, v124, v125
    v_cvt_pk_bf16_f32 v163, v126, v127
    v_xor_b32 v222, 96, v13
    v_permlane16_swap_b32 v160, v162
    v_permlane16_swap_b32 v161, v163
    ds_write_b128 v222, v[160:163] offset:256
    s_add_u32 s29, s22, s19
    s_waitcnt lgkmcnt(0)
    ds_read_b128 v[32:35], v18 offset:0
    ds_read_b128 v[36:39], v18 offset:1024
    ds_read_b128 v[40:43], v18 offset:2048
    ds_read_b128 v[44:47], v18 offset:3072
    ds_read_b128 v[48:51], v18 offset:4096
    ds_read_b128 v[52:55], v18 offset:5120
    ds_read_b128 v[56:59], v18 offset:6144
    ds_read_b128 v[60:63], v18 offset:7168
    ds_read_b128 v[64:67], v18 offset:8192
    ds_read_b128 v[68:71], v18 offset:9216
    ds_read_b128 v[72:75], v18 offset:10240
    ds_read_b128 v[76:79], v18 offset:11264
    s_waitcnt lgkmcnt(11)
    buffer_store_dwordx4 v[32:35], v224, s[4:7], s28 offen sc1
    s_waitcnt lgkmcnt(10)
    buffer_store_dwordx4 v[36:39], v225, s[4:7], s28 offen sc1
    s_waitcnt lgkmcnt(9)
    buffer_store_dwordx4 v[40:43], v226, s[4:7], s28 offen sc1
    s_waitcnt lgkmcnt(8)
    buffer_store_dwordx4 v[44:47], v227, s[4:7], s28 offen sc1
    s_waitcnt lgkmcnt(7)
    buffer_store_dwordx4 v[48:51], v228, s[4:7], s28 offen sc1
    s_waitcnt lgkmcnt(6)
    buffer_store_dwordx4 v[52:55], v229, s[4:7], s28 offen sc1
    s_waitcnt lgkmcnt(5)
    buffer_store_dwordx4 v[56:59], v230, s[4:7], s28 offen sc1
    s_waitcnt lgkmcnt(4)
    buffer_store_dwordx4 v[60:63], v231, s[4:7], s28 offen sc1
    s_waitcnt lgkmcnt(3)
    buffer_store_dwordx4 v[64:67], v232, s[4:7], s28 offen sc1
    s_waitcnt lgkmcnt(2)
    buffer_store_dwordx4 v[68:71], v233, s[4:7], s28 offen sc1
    s_waitcnt lgkmcnt(1)
    buffer_store_dwordx4 v[72:75], v234, s[4:7], s28 offen sc1
    s_waitcnt lgkmcnt(0)
    buffer_store_dwordx4 v[76:79], v235, s[4:7], s28 offen sc1
    s_mov_b32 s36, s22
    s_mov_b32 s35, 1
    s_mov_b32 s22, s29
    s_cmp_lt_u32 s22, 64
    s_cbranch_scc1 L_at_233
    s_waitcnt vmcnt(0)
    s_add_u32 s46, s36, 1
    v_mov_b32 v22, s46
    s_mov_b64 exec, 1
    buffer_store_dword v22, v21, s[4:7], 0 offen sc1
    s_mov_b64 exec, -1
L_atend_234:
    s_branch L_end_1
L_wsg_9:
    s_mov_b32 s19, 0
    s_mov_b32 s20, 64
    s_mul_i32 s44, s17, 5
    s_add_u32 s44, s44, s18
    s_cmp_ge_u32 s44, 40
    s_cselect_b32 s45, 64, 0
    s_add_u32 s44, s44, s45
    s_cmp_ge_u32 s44, 64
    s_cbranch_scc1 L_nln_247
    s_load_dwordx2 s[24:25], s[0:1], 0
    s_waitcnt lgkmcnt(0)
    s_mov_b32 s8, s24
    s_and_b32 s9, s25, 0xffff
    s_mov_b32 s10, 2621440
    s_mov_b32 s11, 0x20000
    v_and_b32 v7, 63, v0
    v_lshlrev_b32 v7, 2, v7
    s_lshl_b32 s28, s44, 5
    s_lshl_b32 s29, s16, 3
    s_add_u32 s28, s28, s29
    s_mul_i32 s28, s28, 1280
    buffer_load_dword v40, v7, s[8:11], s28 offen offset:0
    buffer_load_dword v41, v7, s[8:11], s28 offen offset:256
    buffer_load_dword v42, v7, s[8:11], s28 offen offset:512
    buffer_load_dword v43, v7, s[8:11], s28 offen offset:768
    buffer_load_dword v44, v7, s[8:11], s28 offen offset:1024
    s_add_u32 s28, s28, 1280
    buffer_load_dword v45, v7, s[8:11], s28 offen offset:0
    buffer_load_dword v46, v7, s[8:11], s28 offen offset:256
    buffer_load_dword v47, v7, s[8:11], s28 offen offset:512
    buffer_load_dword v48, v7, s[8:11], s28 offen offset:768
    buffer_load_dword v49, v7, s[8:11], s28 offen offset:1024
    s_add_u32 s28, s28, 1280
    buffer_load_dword v50, v7, s[8:11], s28 offen offset:0
    buffer_load_dword v51, v7, s[8:11], s28 offen offset:256
    buffer_load_dword v52, v7, s[8:11], s28 offen offset:512
    buffer_load_dword v53, v7, s[8:11], s28 offen offset:768
    buffer_load_dword v54, v7, s[8:11], s28 offen offset:1024
    s_add_u32 s28, s28, 1280
    buffer_load_dword v55, v7, s[8:11], s28 offen offset:0
    buffer_load_dword v56, v7, s[8:11], s28 offen offset:256
    buffer_load_dword v57, v7, s[8:11], s28 offen offset:512
    buffer_load_dword v58, v7, s[8:11], s28 offen offset:768
    buffer_load_dword v59, v7, s[8:11], s28 offen offset:1024
    s_add_u32 s28, s28, 1280
    buffer_load_dword v60, v7, s[8:11], s28 offen offset:0
    buffer_load_dword v61, v7, s[8:11], s28 offen offset:256
    buffer_load_dword v62, v7, s[8:11], s28 offen offset:512
    buffer_load_dword v63, v7, s[8:11], s28 offen offset:768
    buffer_load_dword v64, v7, s[8:11], s28 offen offset:1024
    s_add_u32 s28, s28, 1280
    buffer_load_dword v65, v7, s[8:11], s28 offen offset:0
    buffer_load_dword v66, v7, s[8:11], s28 offen offset:256
    buffer_load_dword v67, v7, s[8:11], s28 offen offset:512
    buffer_load_dword v68, v7, s[8:11], s28 offen offset:768
    buffer_load_dword v69, v7, s[8:11], s28 offen offset:1024
    s_add_u32 s28, s28, 1280
    buffer_load_dword v70, v7, s[8:11], s28 offen offset:0
    buffer_load_dword v71, v7, s[8:11], s28 offen offset:256
    buffer_load_dword v72, v7, s[8:11], s28 offen offset:512
    buffer_load_dword v73, v7, s[8:11], s28 offen offset:768
    buffer_load_dword v74, v7, s[8:11], s28 offen offset:1024
    s_add_u32 s28, s28, 1280
    buffer_load_dword v75, v7, s[8:11], s28 offen offset:0
    buffer_load_dword v76, v7, s[8:11], s28 offen offset:256
    buffer_load_dword v77, v7, s[8:11], s28 offen offset:512
    buffer_load_dword v78, v7, s[8:11], s28 offen offset:768
    buffer_load_dword v79, v7, s[8:11], s28 offen offset:1024
    s_sub_u32 s28, s28, 8960
    v_add_u32 v6, 117440512, v7
    s_waitcnt vmcnt(35)
    v_lshlrev_b32 v20, 16, v40
    v_and_b32 v21, 0xffff0000, v40
    v_lshlrev_b32 v22, 16, v41
    v_and_b32 v23, 0xffff0000, v41
    v_lshlrev_b32 v24, 16, v42
    v_and_b32 v25, 0xffff0000, v42
    v_lshlrev_b32 v26, 16, v43
    v_and_b32 v27, 0xffff0000, v43
    v_lshlrev_b32 v28, 16, v44
    v_and_b32 v29, 0xffff0000, v44
    v_add_f32 v30, v20, v21
    v_add_f32 v30, v30, v22
    v_add_f32 v30, v30, v23
    v_add_f32 v30, v30, v24
    v_add_f32 v30, v30, v25
    v_add_f32 v30, v30, v26
    v_add_f32 v30, v30, v27
    v_add_f32 v30, v30, v28
    v_add_f32 v30, v30, v29
    s_nop 1
    v_add_f32_dpp v30, v30, v30 row_ror:8 row_mask:0xf bank_mask:0xf
    s_nop 1
    v_add_f32_dpp v30, v30, v30 row_ror:4 row_mask:0xf bank_mask:0xf
    s_nop 1
    v_add_f32_dpp v30, v30, v30 row_ror:2 row_mask:0xf bank_mask:0xf
    s_nop 1
    v_add_f32_dpp v30, v30, v30 row_ror:1 row_mask:0xf bank_mask:0xf
    v_mov_b32 v31, v30
    s_nop 1
    v_permlane16_swap_b32 v30, v31
    v_add_f32 v30, v30, v31
    v_mov_b32 v31, v30
    s_nop 1
    v_permlane32_swap_b32 v30, v31
    v_add_f32 v30, v30, v31
    v_mul_f32 v30, 0x3acccccd, v30
    v_sub_f32 v32, v20, v30
    v_mul_f32 v33, v32, v32
    v_sub_f32 v32, v21, v30
    v_fmac_f32 v33, v32, v32
    v_sub_f32 v32, v22, v30
    v_fmac_f32 v33, v32, v32
    v_sub_f32 v32, v23, v30
    v_fmac_f32 v33, v32, v32
    v_sub_f32 v32, v24, v30
    v_fmac_f32 v33, v32, v32
    v_sub_f32 v32, v25, v30
    v_fmac_f32 v33, v32, v32
    v_sub_f32 v32, v26, v30
    v_fmac_f32 v33, v32, v32
    v_sub_f32 v32, v27, v30
    v_fmac_f32 v33, v32, v32
    v_sub_f32 v32, v28, v30
    v_fmac_f32 v33, v32, v32
    v_sub_f32 v32, v29, v30
    v_fmac_f32 v33, v32, v32
    s_nop 1
    v_add_f32_dpp v33, v33, v33 row_ror:8 row_mask:0xf bank_mask:0xf
    s_nop 1
    v_add_f32_dpp v33, v33, v33 row_ror:4 row_mask:0xf bank_mask:0xf
    s_nop 1
    v_add_f32_dpp v33, v33, v33 row_ror:2 row_mask:0xf bank_mask:0xf
    s_nop 1
    v_add_f32_dpp v33, v33, v33 row_ror:1 row_mask:0xf bank_mask:0xf
    v_mov_b32 v31, v33
    s_nop 1
    v_permlane16_swap_b32 v33, v31
    v_add_f32 v33, v33, v31
    v_mov_b32 v31, v33
    s_nop 1
    v_permlane32_swap_b32 v33, v31
    v_add_f32 v33, v33, v31
    v_mul_f32 v33, 0x3acccccd, v33
    v_cvt_pk_bf16_f32 v30, v30, v30
    v_lshlrev_b32 v30, 16, v30
    v_cvt_pk_bf16_f32 v33, v33, v33
    v_lshlrev_b32 v33, 16, v33
    v_add_f32 v33, 0x3727c5ac, v33
    v_cvt_pk_bf16_f32 v33, v33, v33
    v_lshlrev_b32 v33, 16, v33
    v_sqrt_f32 v33, v33
    s_nop 0
    v_cvt_pk_bf16_f32 v33, v33, v33
    v_lshlrev_b32 v33, 16, v33
    v_rcp_f32 v34, v33
    v_sub_f32 v20, v20, v30
    v_sub_f32 v21, v21, v30
    v_sub_f32 v22, v22, v30
    v_sub_f32 v23, v23, v30
    v_sub_f32 v24, v24, v30
    v_sub_f32 v25, v25, v30
    v_sub_f32 v26, v26, v30
    v_sub_f32 v27, v27, v30
    v_sub_f32 v28, v28, v30
    v_sub_f32 v29, v29, v30
    v_cvt_pk_bf16_f32 v40, v20, v21
    v_lshlrev_b32 v20, 16, v40
    v_and_b32 v21, 0xffff0000, v40
    v_cvt_pk_bf16_f32 v41, v22, v23
    v_lshlrev_b32 v22, 16, v41
    v_and_b32 v23, 0xffff0000, v41
    v_cvt_pk_bf16_f32 v42, v24, v25
    v_lshlrev_b32 v24, 16, v42
    v_and_b32 v25, 0xffff0000, v42
    v_cvt_pk_bf16_f32 v43, v26, v27
    v_lshlrev_b32 v26, 16, v43
    v_and_b32 v27, 0xffff0000, v43
    v_cvt_pk_bf16_f32 v44, v28, v29
    v_lshlrev_b32 v28, 16, v44
    v_and_b32 v29, 0xffff0000, v44
    v_mul_f32 v35, v20, v34
    v_fma_f32 v36, -v35, v33, v20
    v_fma_f32 v20, v36, v34, v35
    v_mul_f32 v35, v21, v34
    v_fma_f32 v36, -v35, v33, v21
    v_fma_f32 v21, v36, v34, v35
    v_mul_f32 v35, v22, v34
    v_fma_f32 v36, -v35, v33, v22
    v_fma_f32 v22, v36, v34, v35
    v_mul_f32 v35, v23, v34
    v_fma_f32 v36, -v35, v33, v23
    v_fma_f32 v23, v36, v34, v35
    v_mul_f32 v35, v24, v34
    v_fma_f32 v36, -v35, v33, v24
    v_fma_f32 v24, v36, v34, v35
    v_mul_f32 v35, v25, v34
    v_fma_f32 v36, -v35, v33, v25
    v_fma_f32 v25, v36, v34, v35
    v_mul_f32 v35, v26, v34
    v_fma_f32 v36, -v35, v33, v26
    v_fma_f32 v26, v36, v34, v35
    v_mul_f32 v35, v27, v34
    v_fma_f32 v36, -v35, v33, v27
    v_fma_f32 v27, v36, v34, v35
    v_mul_f32 v35, v28, v34
    v_fma_f32 v36, -v35, v33, v28
    v_fma_f32 v28, v36, v34, v35
    v_mul_f32 v35, v29, v34
    v_fma_f32 v36, -v35, v33, v29
    v_fma_f32 v29, v36, v34, v35
    v_cvt_pk_bf16_f32 v40, v20, v21
    v_cvt_pk_bf16_f32 v41, v22, v23
    v_cvt_pk_bf16_f32 v42, v24, v25
    v_cvt_pk_bf16_f32 v43, v26, v27
    v_cvt_pk_bf16_f32 v44, v28, v29
    buffer_store_dword v40, v6, s[4:7], s28 offen offset:0 sc1
    buffer_store_dword v41, v6, s[4:7], s28 offen offset:256 sc1
    buffer_store_dword v42, v6, s[4:7], s28 offen offset:512 sc1
    buffer_store_dword v43, v6, s[4:7], s28 offen offset:768 sc1
    buffer_store_dword v44, v6, s[4:7], s28 offen offset:1024 sc1
    s_add_u32 s28, s28, 1280
    s_waitcnt vmcnt(35)
    v_lshlrev_b32 v20, 16, v45
    v_and_b32 v21, 0xffff0000, v45
    v_lshlrev_b32 v22, 16, v46
    v_and_b32 v23, 0xffff0000, v46
    v_lshlrev_b32 v24, 16, v47
    v_and_b32 v25, 0xffff0000, v47
    v_lshlrev_b32 v26, 16, v48
    v_and_b32 v27, 0xffff0000, v48
    v_lshlrev_b32 v28, 16, v49
    v_and_b32 v29, 0xffff0000, v49
    v_add_f32 v30, v20, v21
    v_add_f32 v30, v30, v22
    v_add_f32 v30, v30, v23
    v_add_f32 v30, v30, v24
    v_add_f32 v30, v30, v25
    v_add_f32 v30, v30, v26
    v_add_f32 v30, v30, v27
    v_add_f32 v30, v30, v28
    v_add_f32 v30, v30, v29
    s_nop 1
    v_add_f32_dpp v30, v30, v30 row_ror:8 row_mask:0xf bank_mask:0xf
    s_nop 1
    v_add_f32_dpp v30, v30, v30 row_ror:4 row_mask:0xf bank_mask:0xf
    s_nop 1
    v_add_f32_dpp v30, v30, v30 row_ror:2 row_mask:0xf bank_mask:0xf
    s_nop 1
    v_add_f32_dpp v30, v30, v30 row_ror:1 row_mask:0xf bank_mask:0xf
    v_mov_b32 v31, v30
    s_nop 1
    v_permlane16_swap_b32 v30, v31
    v_add_f32 v30, v30, v31
    v_mov_b32 v31, v30
    s_nop 1
    v_permlane32_swap_b32 v30, v31
    v_add_f32 v30, v30, v31
    v_mul_f32 v30, 0x3acccccd, v30
    v_sub_f32 v32, v20, v30
    v_mul_f32 v33, v32, v32
    v_sub_f32 v32, v21, v30
    v_fmac_f32 v33, v32, v32
    v_sub_f32 v32, v22, v30
    v_fmac_f32 v33, v32, v32
    v_sub_f32 v32, v23, v30
    v_fmac_f32 v33, v32, v32
    v_sub_f32 v32, v24, v30
    v_fmac_f32 v33, v32, v32
    v_sub_f32 v32, v25, v30
    v_fmac_f32 v33, v32, v32
    v_sub_f32 v32, v26, v30
    v_fmac_f32 v33, v32, v32
    v_sub_f32 v32, v27, v30
    v_fmac_f32 v33, v32, v32
    v_sub_f32 v32, v28, v30
    v_fmac_f32 v33, v32, v32
    v_sub_f32 v32, v29, v30
    v_fmac_f32 v33, v32, v32
    s_nop 1
    v_add_f32_dpp v33, v33, v33 row_ror:8 row_mask:0xf bank_mask:0xf
    s_nop 1
    v_add_f32_dpp v33, v33, v33 row_ror:4 row_mask:0xf bank_mask:0xf
    s_nop 1
    v_add_f32_dpp v33, v33, v33 row_ror:2 row_mask:0xf bank_mask:0xf
    s_nop 1
    v_add_f32_dpp v33, v33, v33 row_ror:1 row_mask:0xf bank_mask:0xf
    v_mov_b32 v31, v33
    s_nop 1
    v_permlane16_swap_b32 v33, v31
    v_add_f32 v33, v33, v31
    v_mov_b32 v31, v33
    s_nop 1
    v_permlane32_swap_b32 v33, v31
    v_add_f32 v33, v33, v31
    v_mul_f32 v33, 0x3acccccd, v33
    v_cvt_pk_bf16_f32 v30, v30, v30
    v_lshlrev_b32 v30, 16, v30
    v_cvt_pk_bf16_f32 v33, v33, v33
    v_lshlrev_b32 v33, 16, v33
    v_add_f32 v33, 0x3727c5ac, v33
    v_cvt_pk_bf16_f32 v33, v33, v33
    v_lshlrev_b32 v33, 16, v33
    v_sqrt_f32 v33, v33
    s_nop 0
    v_cvt_pk_bf16_f32 v33, v33, v33
    v_lshlrev_b32 v33, 16, v33
    v_rcp_f32 v34, v33
    v_sub_f32 v20, v20, v30
    v_sub_f32 v21, v21, v30
    v_sub_f32 v22, v22, v30
    v_sub_f32 v23, v23, v30
    v_sub_f32 v24, v24, v30
    v_sub_f32 v25, v25, v30
    v_sub_f32 v26, v26, v30
    v_sub_f32 v27, v27, v30
    v_sub_f32 v28, v28, v30
    v_sub_f32 v29, v29, v30
    v_cvt_pk_bf16_f32 v45, v20, v21
    v_lshlrev_b32 v20, 16, v45
    v_and_b32 v21, 0xffff0000, v45
    v_cvt_pk_bf16_f32 v46, v22, v23
    v_lshlrev_b32 v22, 16, v46
    v_and_b32 v23, 0xffff0000, v46
    v_cvt_pk_bf16_f32 v47, v24, v25
    v_lshlrev_b32 v24, 16, v47
    v_and_b32 v25, 0xffff0000, v47
    v_cvt_pk_bf16_f32 v48, v26, v27
    v_lshlrev_b32 v26, 16, v48
    v_and_b32 v27, 0xffff0000, v48
    v_cvt_pk_bf16_f32 v49, v28, v29
    v_lshlrev_b32 v28, 16, v49
    v_and_b32 v29, 0xffff0000, v49
    v_mul_f32 v35, v20, v34
    v_fma_f32 v36, -v35, v33, v20
    v_fma_f32 v20, v36, v34, v35
    v_mul_f32 v35, v21, v34
    v_fma_f32 v36, -v35, v33, v21
    v_fma_f32 v21, v36, v34, v35
    v_mul_f32 v35, v22, v34
    v_fma_f32 v36, -v35, v33, v22
    v_fma_f32 v22, v36, v34, v35
    v_mul_f32 v35, v23, v34
    v_fma_f32 v36, -v35, v33, v23
    v_fma_f32 v23, v36, v34, v35
    v_mul_f32 v35, v24, v34
    v_fma_f32 v36, -v35, v33, v24
    v_fma_f32 v24, v36, v34, v35
    v_mul_f32 v35, v25, v34
    v_fma_f32 v36, -v35, v33, v25
    v_fma_f32 v25, v36, v34, v35
    v_mul_f32 v35, v26, v34
    v_fma_f32 v36, -v35, v33, v26
    v_fma_f32 v26, v36, v34, v35
    v_mul_f32 v35, v27, v34
    v_fma_f32 v36, -v35, v33, v27
    v_fma_f32 v27, v36, v34, v35
    v_mul_f32 v35, v28, v34
    v_fma_f32 v36, -v35, v33, v28
    v_fma_f32 v28, v36, v34, v35
    v_mul_f32 v35, v29, v34
    v_fma_f32 v36, -v35, v33, v29
    v_fma_f32 v29, v36, v34, v35
    v_cvt_pk_bf16_f32 v45, v20, v21
    v_cvt_pk_bf16_f32 v46, v22, v23
    v_cvt_pk_bf16_f32 v47, v24, v25
    v_cvt_pk_bf16_f32 v48, v26, v27
    v_cvt_pk_bf16_f32 v49, v28, v29
    buffer_store_dword v45, v6, s[4:7], s28 offen offset:0 sc1
    buffer_store_dword v46, v6, s[4:7], s28 offen offset:256 sc1
    buffer_store_dword v47, v6, s[4:7], s28 offen offset:512 sc1
    buffer_store_dword v48, v6, s[4:7], s28 offen offset:768 sc1
    buffer_store_dword v49, v6, s[4:7], s28 offen offset:1024 sc1
    s_add_u32 s28, s28, 1280
    s_waitcnt vmcnt(35)
    v_lshlrev_b32 v20, 16, v50
    v_and_b32 v21, 0xffff0000, v50
    v_lshlrev_b32 v22, 16, v51
    v_and_b32 v23, 0xffff0000, v51
    v_lshlrev_b32 v24, 16, v52
    v_and_b32 v25, 0xffff0000, v52
    v_lshlrev_b32 v26, 16, v53
    v_and_b32 v27, 0xffff0000, v53
    v_lshlrev_b32 v28, 16, v54
    v_and_b32 v29, 0xffff0000, v54
    v_add_f32 v30, v20, v21
    v_add_f32 v30, v30, v22
    v_add_f32 v30, v30, v23
    v_add_f32 v30, v30, v24
    v_add_f32 v30, v30, v25
    v_add_f32 v30, v30, v26
    v_add_f32 v30, v30, v27
    v_add_f32 v30, v30, v28
    v_add_f32 v30, v30, v29
    s_nop 1
    v_add_f32_dpp v30, v30, v30 row_ror:8 row_mask:0xf bank_mask:0xf
    s_nop 1
    v_add_f32_dpp v30, v30, v30 row_ror:4 row_mask:0xf bank_mask:0xf
    s_nop 1
    v_add_f32_dpp v30, v30, v30 row_ror:2 row_mask:0xf bank_mask:0xf
    s_nop 1
    v_add_f32_dpp v30, v30, v30 row_ror:1 row_mask:0xf bank_mask:0xf
    v_mov_b32 v31, v30
    s_nop 1
    v_permlane16_swap_b32 v30, v31
    v_add_f32 v30, v30, v31
    v_mov_b32 v31, v30
    s_nop 1
    v_permlane32_swap_b32 v30, v31
    v_add_f32 v30, v30, v31
    v_mul_f32 v30, 0x3acccccd, v30
    v_sub_f32 v32, v20, v30
    v_mul_f32 v33, v32, v32
    v_sub_f32 v32, v21, v30
    v_fmac_f32 v33, v32, v32
    v_sub_f32 v32, v22, v30
    v_fmac_f32 v33, v32, v32
    v_sub_f32 v32, v23, v30
    v_fmac_f32 v33, v32, v32
    v_sub_f32 v32, v24, v30
    v_fmac_f32 v33, v32, v32
    v_sub_f32 v32, v25, v30
    v_fmac_f32 v33, v32, v32
    v_sub_f32 v32, v26, v30
    v_fmac_f32 v33, v32, v32
    v_sub_f32 v32, v27, v30
    v_fmac_f32 v33, v32, v32
    v_sub_f32 v32, v28, v30
    v_fmac_f32 v33, v32, v32
    v_sub_f32 v32, v29, v30
    v_fmac_f32 v33, v32, v32
    s_nop 1
    v_add_f32_dpp v33, v33, v33 row_ror:8 row_mask:0xf bank_mask:0xf
    s_nop 1
    v_add_f32_dpp v33, v33, v33 row_ror:4 row_mask:0xf bank_mask:0xf
    s_nop 1
    v_add_f32_dpp v33, v33, v33 row_ror:2 row_mask:0xf bank_mask:0xf
    s_nop 1
    v_add_f32_dpp v33, v33, v33 row_ror:1 row_mask:0xf bank_mask:0xf
    v_mov_b32 v31, v33
    s_nop 1
    v_permlane16_swap_b32 v33, v31
    v_add_f32 v33, v33, v31
    v_mov_b32 v31, v33
    s_nop 1
    v_permlane32_swap_b32 v33, v31
    v_add_f32 v33, v33, v31
    v_mul_f32 v33, 0x3acccccd, v33
    v_cvt_pk_bf16_f32 v30, v30, v30
    v_lshlrev_b32 v30, 16, v30
    v_cvt_pk_bf16_f32 v33, v33, v33
    v_lshlrev_b32 v33, 16, v33
    v_add_f32 v33, 0x3727c5ac, v33
    v_cvt_pk_bf16_f32 v33, v33, v33
    v_lshlrev_b32 v33, 16, v33
    v_sqrt_f32 v33, v33
    s_nop 0
    v_cvt_pk_bf16_f32 v33, v33, v33
    v_lshlrev_b32 v33, 16, v33
    v_rcp_f32 v34, v33
    v_sub_f32 v20, v20, v30
    v_sub_f32 v21, v21, v30
    v_sub_f32 v22, v22, v30
    v_sub_f32 v23, v23, v30
    v_sub_f32 v24, v24, v30
    v_sub_f32 v25, v25, v30
    v_sub_f32 v26, v26, v30
    v_sub_f32 v27, v27, v30
    v_sub_f32 v28, v28, v30
    v_sub_f32 v29, v29, v30
    v_cvt_pk_bf16_f32 v50, v20, v21
    v_lshlrev_b32 v20, 16, v50
    v_and_b32 v21, 0xffff0000, v50
    v_cvt_pk_bf16_f32 v51, v22, v23
    v_lshlrev_b32 v22, 16, v51
    v_and_b32 v23, 0xffff0000, v51
    v_cvt_pk_bf16_f32 v52, v24, v25
    v_lshlrev_b32 v24, 16, v52
    v_and_b32 v25, 0xffff0000, v52
    v_cvt_pk_bf16_f32 v53, v26, v27
    v_lshlrev_b32 v26, 16, v53
    v_and_b32 v27, 0xffff0000, v53
    v_cvt_pk_bf16_f32 v54, v28, v29
    v_lshlrev_b32 v28, 16, v54
    v_and_b32 v29, 0xffff0000, v54
    v_mul_f32 v35, v20, v34
    v_fma_f32 v36, -v35, v33, v20
    v_fma_f32 v20, v36, v34, v35
    v_mul_f32 v35, v21, v34
    v_fma_f32 v36, -v35, v33, v21
    v_fma_f32 v21, v36, v34, v35
    v_mul_f32 v35, v22, v34
    v_fma_f32 v36, -v35, v33, v22
    v_fma_f32 v22, v36, v34, v35
    v_mul_f32 v35, v23, v34
    v_fma_f32 v36, -v35, v33, v23
    v_fma_f32 v23, v36, v34, v35
    v_mul_f32 v35, v24, v34
    v_fma_f32 v36, -v35, v33, v24
    v_fma_f32 v24, v36, v34, v35
    v_mul_f32 v35, v25, v34
    v_fma_f32 v36, -v35, v33, v25
    v_fma_f32 v25, v36, v34, v35
    v_mul_f32 v35, v26, v34
    v_fma_f32 v36, -v35, v33, v26
    v_fma_f32 v26, v36, v34, v35
    v_mul_f32 v35, v27, v34
    v_fma_f32 v36, -v35, v33, v27
    v_fma_f32 v27, v36, v34, v35
    v_mul_f32 v35, v28, v34
    v_fma_f32 v36, -v35, v33, v28
    v_fma_f32 v28, v36, v34, v35
    v_mul_f32 v35, v29, v34
    v_fma_f32 v36, -v35, v33, v29
    v_fma_f32 v29, v36, v34, v35
    v_cvt_pk_bf16_f32 v50, v20, v21
    v_cvt_pk_bf16_f32 v51, v22, v23
    v_cvt_pk_bf16_f32 v52, v24, v25
    v_cvt_pk_bf16_f32 v53, v26, v27
    v_cvt_pk_bf16_f32 v54, v28, v29
    buffer_store_dword v50, v6, s[4:7], s28 offen offset:0 sc1
    buffer_store_dword v51, v6, s[4:7], s28 offen offset:256 sc1
    buffer_store_dword v52, v6, s[4:7], s28 offen offset:512 sc1
    buffer_store_dword v53, v6, s[4:7], s28 offen offset:768 sc1
    buffer_store_dword v54, v6, s[4:7], s28 offen offset:1024 sc1
    s_add_u32 s28, s28, 1280
    s_waitcnt vmcnt(35)
    v_lshlrev_b32 v20, 16, v55
    v_and_b32 v21, 0xffff0000, v55
    v_lshlrev_b32 v22, 16, v56
    v_and_b32 v23, 0xffff0000, v56
    v_lshlrev_b32 v24, 16, v57
    v_and_b32 v25, 0xffff0000, v57
    v_lshlrev_b32 v26, 16, v58
    v_and_b32 v27, 0xffff0000, v58
    v_lshlrev_b32 v28, 16, v59
    v_and_b32 v29, 0xffff0000, v59
    v_add_f32 v30, v20, v21
    v_add_f32 v30, v30, v22
    v_add_f32 v30, v30, v23
    v_add_f32 v30, v30, v24
    v_add_f32 v30, v30, v25
    v_add_f32 v30, v30, v26
    v_add_f32 v30, v30, v27
    v_add_f32 v30, v30, v28
    v_add_f32 v30, v30, v29
    s_nop 1
    v_add_f32_dpp v30, v30, v30 row_ror:8 row_mask:0xf bank_mask:0xf
    s_nop 1
    v_add_f32_dpp v30, v30, v30 row_ror:4 row_mask:0xf bank_mask:0xf
    s_nop 1
    v_add_f32_dpp v30, v30, v30 row_ror:2 row_mask:0xf bank_mask:0xf
    s_nop 1
    v_add_f32_dpp v30, v30, v30 row_ror:1 row_mask:0xf bank_mask:0xf
    v_mov_b32 v31, v30
    s_nop 1
    v_permlane16_swap_b32 v30, v31
    v_add_f32 v30, v30, v31
    v_mov_b32 v31, v30
    s_nop 1
    v_permlane32_swap_b32 v30, v31
    v_add_f32 v30, v30, v31
    v_mul_f32 v30, 0x3acccccd, v30
    v_sub_f32 v32, v20, v30
    v_mul_f32 v33, v32, v32
    v_sub_f32 v32, v21, v30
    v_fmac_f32 v33, v32, v32
    v_sub_f32 v32, v22, v30
    v_fmac_f32 v33, v32, v32
    v_sub_f32 v32, v23, v30
    v_fmac_f32 v33, v32, v32
    v_sub_f32 v32, v24, v30
    v_fmac_f32 v33, v32, v32
    v_sub_f32 v32, v25, v30
    v_fmac_f32 v33, v32, v32
    v_sub_f32 v32, v26, v30
    v_fmac_f32 v33, v32, v32
    v_sub_f32 v32, v27, v30
    v_fmac_f32 v33, v32, v32
    v_sub_f32 v32, v28, v30
    v_fmac_f32 v33, v32, v32
    v_sub_f32 v32, v29, v30
    v_fmac_f32 v33, v32, v32
    s_nop 1
    v_add_f32_dpp v33, v33, v33 row_ror:8 row_mask:0xf bank_mask:0xf
    s_nop 1
    v_add_f32_dpp v33, v33, v33 row_ror:4 row_mask:0xf bank_mask:0xf
    s_nop 1
    v_add_f32_dpp v33, v33, v33 row_ror:2 row_mask:0xf bank_mask:0xf
    s_nop 1
    v_add_f32_dpp v33, v33, v33 row_ror:1 row_mask:0xf bank_mask:0xf
    v_mov_b32 v31, v33
    s_nop 1
    v_permlane16_swap_b32 v33, v31
    v_add_f32 v33, v33, v31
    v_mov_b32 v31, v33
    s_nop 1
    v_permlane32_swap_b32 v33, v31
    v_add_f32 v33, v33, v31
    v_mul_f32 v33, 0x3acccccd, v33
    v_cvt_pk_bf16_f32 v30, v30, v30
    v_lshlrev_b32 v30, 16, v30
    v_cvt_pk_bf16_f32 v33, v33, v33
    v_lshlrev_b32 v33, 16, v33
    v_add_f32 v33, 0x3727c5ac, v33
    v_cvt_pk_bf16_f32 v33, v33, v33
    v_lshlrev_b32 v33, 16, v33
    v_sqrt_f32 v33, v33
    s_nop 0
    v_cvt_pk_bf16_f32 v33, v33, v33
    v_lshlrev_b32 v33, 16, v33
    v_rcp_f32 v34, v33
    v_sub_f32 v20, v20, v30
    v_sub_f32 v21, v21, v30
    v_sub_f32 v22, v22, v30
    v_sub_f32 v23, v23, v30
    v_sub_f32 v24, v24, v30
    v_sub_f32 v25, v25, v30
    v_sub_f32 v26, v26, v30
    v_sub_f32 v27, v27, v30
    v_sub_f32 v28, v28, v30
    v_sub_f32 v29, v29, v30
    v_cvt_pk_bf16_f32 v55, v20, v21
    v_lshlrev_b32 v20, 16, v55
    v_and_b32 v21, 0xffff0000, v55
    v_cvt_pk_bf16_f32 v56, v22, v23
    v_lshlrev_b32 v22, 16, v56
    v_and_b32 v23, 0xffff0000, v56
    v_cvt_pk_bf16_f32 v57, v24, v25
    v_lshlrev_b32 v24, 16, v57
    v_and_b32 v25, 0xffff0000, v57
    v_cvt_pk_bf16_f32 v58, v26, v27
    v_lshlrev_b32 v26, 16, v58
    v_and_b32 v27, 0xffff0000, v58
    v_cvt_pk_bf16_f32 v59, v28, v29
    v_lshlrev_b32 v28, 16, v59
    v_and_b32 v29, 0xffff0000, v59
    v_mul_f32 v35, v20, v34
    v_fma_f32 v36, -v35, v33, v20
    v_fma_f32 v20, v36, v34, v35
    v_mul_f32 v35, v21, v34
    v_fma_f32 v36, -v35, v33, v21
    v_fma_f32 v21, v36, v34, v35
    v_mul_f32 v35, v22, v34
    v_fma_f32 v36, -v35, v33, v22
    v_fma_f32 v22, v36, v34, v35
    v_mul_f32 v35, v23, v34
    v_fma_f32 v36, -v35, v33, v23
    v_fma_f32 v23, v36, v34, v35
    v_mul_f32 v35, v24, v34
    v_fma_f32 v36, -v35, v33, v24
    v_fma_f32 v24, v36, v34, v35
    v_mul_f32 v35, v25, v34
    v_fma_f32 v36, -v35, v33, v25
    v_fma_f32 v25, v36, v34, v35
    v_mul_f32 v35, v26, v34
    v_fma_f32 v36, -v35, v33, v26
    v_fma_f32 v26, v36, v34, v35
    v_mul_f32 v35, v27, v34
    v_fma_f32 v36, -v35, v33, v27
    v_fma_f32 v27, v36, v34, v35
    v_mul_f32 v35, v28, v34
    v_fma_f32 v36, -v35, v33, v28
    v_fma_f32 v28, v36, v34, v35
    v_mul_f32 v35, v29, v34
    v_fma_f32 v36, -v35, v33, v29
    v_fma_f32 v29, v36, v34, v35
    v_cvt_pk_bf16_f32 v55, v20, v21
    v_cvt_pk_bf16_f32 v56, v22, v23
    v_cvt_pk_bf16_f32 v57, v24, v25
    v_cvt_pk_bf16_f32 v58, v26, v27
    v_cvt_pk_bf16_f32 v59, v28, v29
    buffer_store_dword v55, v6, s[4:7], s28 offen offset:0 sc1
    buffer_store_dword v56, v6, s[4:7], s28 offen offset:256 sc1
    buffer_store_dword v57, v6, s[4:7], s28 offen offset:512 sc1
    buffer_store_dword v58, v6, s[4:7], s28 offen offset:768 sc1
    buffer_store_dword v59, v6, s[4:7], s28 offen offset:1024 sc1
    s_add_u32 s28, s28, 1280
    s_waitcnt vmcnt(35)
    v_lshlrev_b32 v20, 16, v60
    v_and_b32 v21, 0xffff0000, v60
    v_lshlrev_b32 v22, 16, v61
    v_and_b32 v23, 0xffff0000, v61
    v_lshlrev_b32 v24, 16, v62
    v_and_b32 v25, 0xffff0000, v62
    v_lshlrev_b32 v26, 16, v63
    v_and_b32 v27, 0xffff0000, v63
    v_lshlrev_b32 v28, 16, v64
    v_and_b32 v29, 0xffff0000, v64
    v_add_f32 v30, v20, v21
    v_add_f32 v30, v30, v22
    v_add_f32 v30, v30, v23
    v_add_f32 v30, v30, v24
    v_add_f32 v30, v30, v25
    v_add_f32 v30, v30, v26
    v_add_f32 v30, v30, v27
    v_add_f32 v30, v30, v28
    v_add_f32 v30, v30, v29
    s_nop 1
    v_add_f32_dpp v30, v30, v30 row_ror:8 row_mask:0xf bank_mask:0xf
    s_nop 1
    v_add_f32_dpp v30, v30, v30 row_ror:4 row_mask:0xf bank_mask:0xf
    s_nop 1
    v_add_f32_dpp v30, v30, v30 row_ror:2 row_mask:0xf bank_mask:0xf
    s_nop 1
    v_add_f32_dpp v30, v30, v30 row_ror:1 row_mask:0xf bank_mask:0xf
    v_mov_b32 v31, v30
    s_nop 1
    v_permlane16_swap_b32 v30, v31
    v_add_f32 v30, v30, v31
    v_mov_b32 v31, v30
    s_nop 1
    v_permlane32_swap_b32 v30, v31
    v_add_f32 v30, v30, v31
    v_mul_f32 v30, 0x3acccccd, v30
    v_sub_f32 v32, v20, v30
    v_mul_f32 v33, v32, v32
    v_sub_f32 v32, v21, v30
    v_fmac_f32 v33, v32, v32
    v_sub_f32 v32, v22, v30
    v_fmac_f32 v33, v32, v32
    v_sub_f32 v32, v23, v30
    v_fmac_f32 v33, v32, v32
    v_sub_f32 v32, v24, v30
    v_fmac_f32 v33, v32, v32
    v_sub_f32 v32, v25, v30
    v_fmac_f32 v33, v32, v32
    v_sub_f32 v32, v26, v30
    v_fmac_f32 v33, v32, v32
    v_sub_f32 v32, v27, v30
    v_fmac_f32 v33, v32, v32
    v_sub_f32 v32, v28, v30
    v_fmac_f32 v33, v32, v32
    v_sub_f32 v32, v29, v30
    v_fmac_f32 v33, v32, v32
    s_nop 1
    v_add_f32_dpp v33, v33, v33 row_ror:8 row_mask:0xf bank_mask:0xf
    s_nop 1
    v_add_f32_dpp v33, v33, v33 row_ror:4 row_mask:0xf bank_mask:0xf
    s_nop 1
    v_add_f32_dpp v33, v33, v33 row_ror:2 row_mask:0xf bank_mask:0xf
    s_nop 1
    v_add_f32_dpp v33, v33, v33 row_ror:1 row_mask:0xf bank_mask:0xf
    v_mov_b32 v31, v33
    s_nop 1
    v_permlane16_swap_b32 v33, v31
    v_add_f32 v33, v33, v31
    v_mov_b32 v31, v33
    s_nop 1
    v_permlane32_swap_b32 v33, v31
    v_add_f32 v33, v33, v31
    v_mul_f32 v33, 0x3acccccd, v33
    v_cvt_pk_bf16_f32 v30, v30, v30
    v_lshlrev_b32 v30, 16, v30
    v_cvt_pk_bf16_f32 v33, v33, v33
    v_lshlrev_b32 v33, 16, v33
    v_add_f32 v33, 0x3727c5ac, v33
    v_cvt_pk_bf16_f32 v33, v33, v33
    v_lshlrev_b32 v33, 16, v33
    v_sqrt_f32 v33, v33
    s_nop 0
    v_cvt_pk_bf16_f32 v33, v33, v33
    v_lshlrev_b32 v33, 16, v33
    v_rcp_f32 v34, v33
    v_sub_f32 v20, v20, v30
    v_sub_f32 v21, v21, v30
    v_sub_f32 v22, v22, v30
    v_sub_f32 v23, v23, v30
    v_sub_f32 v24, v24, v30
    v_sub_f32 v25, v25, v30
    v_sub_f32 v26, v26, v30
    v_sub_f32 v27, v27, v30
    v_sub_f32 v28, v28, v30
    v_sub_f32 v29, v29, v30
    v_cvt_pk_bf16_f32 v60, v20, v21
    v_lshlrev_b32 v20, 16, v60
    v_and_b32 v21, 0xffff0000, v60
    v_cvt_pk_bf16_f32 v61, v22, v23
    v_lshlrev_b32 v22, 16, v61
    v_and_b32 v23, 0xffff0000, v61
    v_cvt_pk_bf16_f32 v62, v24, v25
    v_lshlrev_b32 v24, 16, v62
    v_and_b32 v25, 0xffff0000, v62
    v_cvt_pk_bf16_f32 v63, v26, v27
    v_lshlrev_b32 v26, 16, v63
    v_and_b32 v27, 0xffff0000, v63
    v_cvt_pk_bf16_f32 v64, v28, v29
    v_lshlrev_b32 v28, 16, v64
    v_and_b32 v29, 0xffff0000, v64
    v_mul_f32 v35, v20, v34
    v_fma_f32 v36, -v35, v33, v20
    v_fma_f32 v20, v36, v34, v35
    v_mul_f32 v35, v21, v34
    v_fma_f32 v36, -v35, v33, v21
    v_fma_f32 v21, v36, v34, v35
    v_mul_f32 v35, v22, v34
    v_fma_f32 v36, -v35, v33, v22
    v_fma_f32 v22, v36, v34, v35
    v_mul_f32 v35, v23, v34
    v_fma_f32 v36, -v35, v33, v23
    v_fma_f32 v23, v36, v34, v35
    v_mul_f32 v35, v24, v34
    v_fma_f32 v36, -v35, v33, v24
    v_fma_f32 v24, v36, v34, v35
    v_mul_f32 v35, v25, v34
    v_fma_f32 v36, -v35, v33, v25
    v_fma_f32 v25, v36, v34, v35
    v_mul_f32 v35, v26, v34
    v_fma_f32 v36, -v35, v33, v26
    v_fma_f32 v26, v36, v34, v35
    v_mul_f32 v35, v27, v34
    v_fma_f32 v36, -v35, v33, v27
    v_fma_f32 v27, v36, v34, v35
    v_mul_f32 v35, v28, v34
    v_fma_f32 v36, -v35, v33, v28
    v_fma_f32 v28, v36, v34, v35
    v_mul_f32 v35, v29, v34
    v_fma_f32 v36, -v35, v33, v29
    v_fma_f32 v29, v36, v34, v35
    v_cvt_pk_bf16_f32 v60, v20, v21
    v_cvt_pk_bf16_f32 v61, v22, v23
    v_cvt_pk_bf16_f32 v62, v24, v25
    v_cvt_pk_bf16_f32 v63, v26, v27
    v_cvt_pk_bf16_f32 v64, v28, v29
    buffer_store_dword v60, v6, s[4:7], s28 offen offset:0 sc1
    buffer_store_dword v61, v6, s[4:7], s28 offen offset:256 sc1
    buffer_store_dword v62, v6, s[4:7], s28 offen offset:512 sc1
    buffer_store_dword v63, v6, s[4:7], s28 offen offset:768 sc1
    buffer_store_dword v64, v6, s[4:7], s28 offen offset:1024 sc1
    s_add_u32 s28, s28, 1280
    s_waitcnt vmcnt(35)
    v_lshlrev_b32 v20, 16, v65
    v_and_b32 v21, 0xffff0000, v65
    v_lshlrev_b32 v22, 16, v66
    v_and_b32 v23, 0xffff0000, v66
    v_lshlrev_b32 v24, 16, v67
    v_and_b32 v25, 0xffff0000, v67
    v_lshlrev_b32 v26, 16, v68
    v_and_b32 v27, 0xffff0000, v68
    v_lshlrev_b32 v28, 16, v69
    v_and_b32 v29, 0xffff0000, v69
    v_add_f32 v30, v20, v21
    v_add_f32 v30, v30, v22
    v_add_f32 v30, v30, v23
    v_add_f32 v30, v30, v24
    v_add_f32 v30, v30, v25
    v_add_f32 v30, v30, v26
    v_add_f32 v30, v30, v27
    v_add_f32 v30, v30, v28
    v_add_f32 v30, v30, v29
    s_nop 1
    v_add_f32_dpp v30, v30, v30 row_ror:8 row_mask:0xf bank_mask:0xf
    s_nop 1
    v_add_f32_dpp v30, v30, v30 row_ror:4 row_mask:0xf bank_mask:0xf
    s_nop 1
    v_add_f32_dpp v30, v30, v30 row_ror:2 row_mask:0xf bank_mask:0xf
    s_nop 1
    v_add_f32_dpp v30, v30, v30 row_ror:1 row_mask:0xf bank_mask:0xf
    v_mov_b32 v31, v30
    s_nop 1
    v_permlane16_swap_b32 v30, v31
    v_add_f32 v30, v30, v31
    v_mov_b32 v31, v30
    s_nop 1
    v_permlane32_swap_b32 v30, v31
    v_add_f32 v30, v30, v31
    v_mul_f32 v30, 0x3acccccd, v30
    v_sub_f32 v32, v20, v30
    v_mul_f32 v33, v32, v32
    v_sub_f32 v32, v21, v30
    v_fmac_f32 v33, v32, v32
    v_sub_f32 v32, v22, v30
    v_fmac_f32 v33, v32, v32
    v_sub_f32 v32, v23, v30
    v_fmac_f32 v33, v32, v32
    v_sub_f32 v32, v24, v30
    v_fmac_f32 v33, v32, v32
    v_sub_f32 v32, v25, v30
    v_fmac_f32 v33, v32, v32
    v_sub_f32 v32, v26, v30
    v_fmac_f32 v33, v32, v32
    v_sub_f32 v32, v27, v30
    v_fmac_f32 v33, v32, v32
    v_sub_f32 v32, v28, v30
    v_fmac_f32 v33, v32, v32
    v_sub_f32 v32, v29, v30
    v_fmac_f32 v33, v32, v32
    s_nop 1
    v_add_f32_dpp v33, v33, v33 row_ror:8 row_mask:0xf bank_mask:0xf
    s_nop 1
    v_add_f32_dpp v33, v33, v33 row_ror:4 row_mask:0xf bank_mask:0xf
    s_nop 1
    v_add_f32_dpp v33, v33, v33 row_ror:2 row_mask:0xf bank_mask:0xf
    s_nop 1
    v_add_f32_dpp v33, v33, v33 row_ror:1 row_mask:0xf bank_mask:0xf
    v_mov_b32 v31, v33
    s_nop 1
    v_permlane16_swap_b32 v33, v31
    v_add_f32 v33, v33, v31
    v_mov_b32 v31, v33
    s_nop 1
    v_permlane32_swap_b32 v33, v31
    v_add_f32 v33, v33, v31
    v_mul_f32 v33, 0x3acccccd, v33
    v_cvt_pk_bf16_f32 v30, v30, v30
    v_lshlrev_b32 v30, 16, v30
    v_cvt_pk_bf16_f32 v33, v33, v33
    v_lshlrev_b32 v33, 16, v33
    v_add_f32 v33, 0x3727c5ac, v33
    v_cvt_pk_bf16_f32 v33, v33, v33
    v_lshlrev_b32 v33, 16, v33
    v_sqrt_f32 v33, v33
    s_nop 0
    v_cvt_pk_bf16_f32 v33, v33, v33
    v_lshlrev_b32 v33, 16, v33
    v_rcp_f32 v34, v33
    v_sub_f32 v20, v20, v30
    v_sub_f32 v21, v21, v30
    v_sub_f32 v22, v22, v30
    v_sub_f32 v23, v23, v30
    v_sub_f32 v24, v24, v30
    v_sub_f32 v25, v25, v30
    v_sub_f32 v26, v26, v30
    v_sub_f32 v27, v27, v30
    v_sub_f32 v28, v28, v30
    v_sub_f32 v29, v29, v30
    v_cvt_pk_bf16_f32 v65, v20, v21
    v_lshlrev_b32 v20, 16, v65
    v_and_b32 v21, 0xffff0000, v65
    v_cvt_pk_bf16_f32 v66, v22, v23
    v_lshlrev_b32 v22, 16, v66
    v_and_b32 v23, 0xffff0000, v66
    v_cvt_pk_bf16_f32 v67, v24, v25
    v_lshlrev_b32 v24, 16, v67
    v_and_b32 v25, 0xffff0000, v67
    v_cvt_pk_bf16_f32 v68, v26, v27
    v_lshlrev_b32 v26, 16, v68
    v_and_b32 v27, 0xffff0000, v68
    v_cvt_pk_bf16_f32 v69, v28, v29
    v_lshlrev_b32 v28, 16, v69
    v_and_b32 v29, 0xffff0000, v69
    v_mul_f32 v35, v20, v34
    v_fma_f32 v36, -v35, v33, v20
    v_fma_f32 v20, v36, v34, v35
    v_mul_f32 v35, v21, v34
    v_fma_f32 v36, -v35, v33, v21
    v_fma_f32 v21, v36, v34, v35
    v_mul_f32 v35, v22, v34
    v_fma_f32 v36, -v35, v33, v22
    v_fma_f32 v22, v36, v34, v35
    v_mul_f32 v35, v23, v34
    v_fma_f32 v36, -v35, v33, v23
    v_fma_f32 v23, v36, v34, v35
    v_mul_f32 v35, v24, v34
    v_fma_f32 v36, -v35, v33, v24
    v_fma_f32 v24, v36, v34, v35
    v_mul_f32 v35, v25, v34
    v_fma_f32 v36, -v35, v33, v25
    v_fma_f32 v25, v36, v34, v35
    v_mul_f32 v35, v26, v34
    v_fma_f32 v36, -v35, v33, v26
    v_fma_f32 v26, v36, v34, v35
    v_mul_f32 v35, v27, v34
    v_fma_f32 v36, -v35, v33, v27
    v_fma_f32 v27, v36, v34, v35
    v_mul_f32 v35, v28, v34
    v_fma_f32 v36, -v35, v33, v28
    v_fma_f32 v28, v36, v34, v35
    v_mul_f32 v35, v29, v34
    v_fma_f32 v36, -v35, v33, v29
    v_fma_f32 v29, v36, v34, v35
    v_cvt_pk_bf16_f32 v65, v20, v21
    v_cvt_pk_bf16_f32 v66, v22, v23
    v_cvt_pk_bf16_f32 v67, v24, v25
    v_cvt_pk_bf16_f32 v68, v26, v27
    v_cvt_pk_bf16_f32 v69, v28, v29
    buffer_store_dword v65, v6, s[4:7], s28 offen offset:0 sc1
    buffer_store_dword v66, v6, s[4:7], s28 offen offset:256 sc1
    buffer_store_dword v67, v6, s[4:7], s28 offen offset:512 sc1
    buffer_store_dword v68, v6, s[4:7], s28 offen offset:768 sc1
    buffer_store_dword v69, v6, s[4:7], s28 offen offset:1024 sc1
    s_add_u32 s28, s28, 1280
    s_waitcnt vmcnt(35)
    v_lshlrev_b32 v20, 16, v70
    v_and_b32 v21, 0xffff0000, v70
    v_lshlrev_b32 v22, 16, v71
    v_and_b32 v23, 0xffff0000, v71
    v_lshlrev_b32 v24, 16, v72
    v_and_b32 v25, 0xffff0000, v72
    v_lshlrev_b32 v26, 16, v73
    v_and_b32 v27, 0xffff0000, v73
    v_lshlrev_b32 v28, 16, v74
    v_and_b32 v29, 0xffff0000, v74
    v_add_f32 v30, v20, v21
    v_add_f32 v30, v30, v22
    v_add_f32 v30, v30, v23
    v_add_f32 v30, v30, v24
    v_add_f32 v30, v30, v25
    v_add_f32 v30, v30, v26
    v_add_f32 v30, v30, v27
    v_add_f32 v30, v30, v28
    v_add_f32 v30, v30, v29
    s_nop 1
    v_add_f32_dpp v30, v30, v30 row_ror:8 row_mask:0xf bank_mask:0xf
    s_nop 1
    v_add_f32_dpp v30, v30, v30 row_ror:4 row_mask:0xf bank_mask:0xf
    s_nop 1
    v_add_f32_dpp v30, v30, v30 row_ror:2 row_mask:0xf bank_mask:0xf
    s_nop 1
    v_add_f32_dpp v30, v30, v30 row_ror:1 row_mask:0xf bank_mask:0xf
    v_mov_b32 v31, v30
    s_nop 1
    v_permlane16_swap_b32 v30, v31
    v_add_f32 v30, v30, v31
    v_mov_b32 v31, v30
    s_nop 1
    v_permlane32_swap_b32 v30, v31
    v_add_f32 v30, v30, v31
    v_mul_f32 v30, 0x3acccccd, v30
    v_sub_f32 v32, v20, v30
    v_mul_f32 v33, v32, v32
    v_sub_f32 v32, v21, v30
    v_fmac_f32 v33, v32, v32
    v_sub_f32 v32, v22, v30
    v_fmac_f32 v33, v32, v32
    v_sub_f32 v32, v23, v30
    v_fmac_f32 v33, v32, v32
    v_sub_f32 v32, v24, v30
    v_fmac_f32 v33, v32, v32
    v_sub_f32 v32, v25, v30
    v_fmac_f32 v33, v32, v32
    v_sub_f32 v32, v26, v30
    v_fmac_f32 v33, v32, v32
    v_sub_f32 v32, v27, v30
    v_fmac_f32 v33, v32, v32
    v_sub_f32 v32, v28, v30
    v_fmac_f32 v33, v32, v32
    v_sub_f32 v32, v29, v30
    v_fmac_f32 v33, v32, v32
    s_nop 1
    v_add_f32_dpp v33, v33, v33 row_ror:8 row_mask:0xf bank_mask:0xf
    s_nop 1
    v_add_f32_dpp v33, v33, v33 row_ror:4 row_mask:0xf bank_mask:0xf
    s_nop 1
    v_add_f32_dpp v33, v33, v33 row_ror:2 row_mask:0xf bank_mask:0xf
    s_nop 1
    v_add_f32_dpp v33, v33, v33 row_ror:1 row_mask:0xf bank_mask:0xf
    v_mov_b32 v31, v33
    s_nop 1
    v_permlane16_swap_b32 v33, v31
    v_add_f32 v33, v33, v31
    v_mov_b32 v31, v33
    s_nop 1
    v_permlane32_swap_b32 v33, v31
    v_add_f32 v33, v33, v31
    v_mul_f32 v33, 0x3acccccd, v33
    v_cvt_pk_bf16_f32 v30, v30, v30
    v_lshlrev_b32 v30, 16, v30
    v_cvt_pk_bf16_f32 v33, v33, v33
    v_lshlrev_b32 v33, 16, v33
    v_add_f32 v33, 0x3727c5ac, v33
    v_cvt_pk_bf16_f32 v33, v33, v33
    v_lshlrev_b32 v33, 16, v33
    v_sqrt_f32 v33, v33
    s_nop 0
    v_cvt_pk_bf16_f32 v33, v33, v33
    v_lshlrev_b32 v33, 16, v33
    v_rcp_f32 v34, v33
    v_sub_f32 v20, v20, v30
    v_sub_f32 v21, v21, v30
    v_sub_f32 v22, v22, v30
    v_sub_f32 v23, v23, v30
    v_sub_f32 v24, v24, v30
    v_sub_f32 v25, v25, v30
    v_sub_f32 v26, v26, v30
    v_sub_f32 v27, v27, v30
    v_sub_f32 v28, v28, v30
    v_sub_f32 v29, v29, v30
    v_cvt_pk_bf16_f32 v70, v20, v21
    v_lshlrev_b32 v20, 16, v70
    v_and_b32 v21, 0xffff0000, v70
    v_cvt_pk_bf16_f32 v71, v22, v23
    v_lshlrev_b32 v22, 16, v71
    v_and_b32 v23, 0xffff0000, v71
    v_cvt_pk_bf16_f32 v72, v24, v25
    v_lshlrev_b32 v24, 16, v72
    v_and_b32 v25, 0xffff0000, v72
    v_cvt_pk_bf16_f32 v73, v26, v27
    v_lshlrev_b32 v26, 16, v73
    v_and_b32 v27, 0xffff0000, v73
    v_cvt_pk_bf16_f32 v74, v28, v29
    v_lshlrev_b32 v28, 16, v74
    v_and_b32 v29, 0xffff0000, v74
    v_mul_f32 v35, v20, v34
    v_fma_f32 v36, -v35, v33, v20
    v_fma_f32 v20, v36, v34, v35
    v_mul_f32 v35, v21, v34
    v_fma_f32 v36, -v35, v33, v21
    v_fma_f32 v21, v36, v34, v35
    v_mul_f32 v35, v22, v34
    v_fma_f32 v36, -v35, v33, v22
    v_fma_f32 v22, v36, v34, v35
    v_mul_f32 v35, v23, v34
    v_fma_f32 v36, -v35, v33, v23
    v_fma_f32 v23, v36, v34, v35
    v_mul_f32 v35, v24, v34
    v_fma_f32 v36, -v35, v33, v24
    v_fma_f32 v24, v36, v34, v35
    v_mul_f32 v35, v25, v34
    v_fma_f32 v36, -v35, v33, v25
    v_fma_f32 v25, v36, v34, v35
    v_mul_f32 v35, v26, v34
    v_fma_f32 v36, -v35, v33, v26
    v_fma_f32 v26, v36, v34, v35
    v_mul_f32 v35, v27, v34
    v_fma_f32 v36, -v35, v33, v27
    v_fma_f32 v27, v36, v34, v35
    v_mul_f32 v35, v28, v34
    v_fma_f32 v36, -v35, v33, v28
    v_fma_f32 v28, v36, v34, v35
    v_mul_f32 v35, v29, v34
    v_fma_f32 v36, -v35, v33, v29
    v_fma_f32 v29, v36, v34, v35
    v_cvt_pk_bf16_f32 v70, v20, v21
    v_cvt_pk_bf16_f32 v71, v22, v23
    v_cvt_pk_bf16_f32 v72, v24, v25
    v_cvt_pk_bf16_f32 v73, v26, v27
    v_cvt_pk_bf16_f32 v74, v28, v29
    buffer_store_dword v70, v6, s[4:7], s28 offen offset:0 sc1
    buffer_store_dword v71, v6, s[4:7], s28 offen offset:256 sc1
    buffer_store_dword v72, v6, s[4:7], s28 offen offset:512 sc1
    buffer_store_dword v73, v6, s[4:7], s28 offen offset:768 sc1
    buffer_store_dword v74, v6, s[4:7], s28 offen offset:1024 sc1
    s_add_u32 s28, s28, 1280
    s_waitcnt vmcnt(35)
    v_lshlrev_b32 v20, 16, v75
    v_and_b32 v21, 0xffff0000, v75
    v_lshlrev_b32 v22, 16, v76
    v_and_b32 v23, 0xffff0000, v76
    v_lshlrev_b32 v24, 16, v77
    v_and_b32 v25, 0xffff0000, v77
    v_lshlrev_b32 v26, 16, v78
    v_and_b32 v27, 0xffff0000, v78
    v_lshlrev_b32 v28, 16, v79
    v_and_b32 v29, 0xffff0000, v79
    v_add_f32 v30, v20, v21
    v_add_f32 v30, v30, v22
    v_add_f32 v30, v30, v23
    v_add_f32 v30, v30, v24
    v_add_f32 v30, v30, v25
    v_add_f32 v30, v30, v26
    v_add_f32 v30, v30, v27
    v_add_f32 v30, v30, v28
    v_add_f32 v30, v30, v29
    s_nop 1
    v_add_f32_dpp v30, v30, v30 row_ror:8 row_mask:0xf bank_mask:0xf
    s_nop 1
    v_add_f32_dpp v30, v30, v30 row_ror:4 row_mask:0xf bank_mask:0xf
    s_nop 1
    v_add_f32_dpp v30, v30, v30 row_ror:2 row_mask:0xf bank_mask:0xf
    s_nop 1
    v_add_f32_dpp v30, v30, v30 row_ror:1 row_mask:0xf bank_mask:0xf
    v_mov_b32 v31, v30
    s_nop 1
    v_permlane16_swap_b32 v30, v31
    v_add_f32 v30, v30, v31
    v_mov_b32 v31, v30
    s_nop 1
    v_permlane32_swap_b32 v30, v31
    v_add_f32 v30, v30, v31
    v_mul_f32 v30, 0x3acccccd, v30
    v_sub_f32 v32, v20, v30
    v_mul_f32 v33, v32, v32
    v_sub_f32 v32, v21, v30
    v_fmac_f32 v33, v32, v32
    v_sub_f32 v32, v22, v30
    v_fmac_f32 v33, v32, v32
    v_sub_f32 v32, v23, v30
    v_fmac_f32 v33, v32, v32
    v_sub_f32 v32, v24, v30
    v_fmac_f32 v33, v32, v32
    v_sub_f32 v32, v25, v30
    v_fmac_f32 v33, v32, v32
    v_sub_f32 v32, v26, v30
    v_fmac_f32 v33, v32, v32
    v_sub_f32 v32, v27, v30
    v_fmac_f32 v33, v32, v32
    v_sub_f32 v32, v28, v30
    v_fmac_f32 v33, v32, v32
    v_sub_f32 v32, v29, v30
    v_fmac_f32 v33, v32, v32
    s_nop 1
    v_add_f32_dpp v33, v33, v33 row_ror:8 row_mask:0xf bank_mask:0xf
    s_nop 1
    v_add_f32_dpp v33, v33, v33 row_ror:4 row_mask:0xf bank_mask:0xf
    s_nop 1
    v_add_f32_dpp v33, v33, v33 row_ror:2 row_mask:0xf bank_mask:0xf
    s_nop 1
    v_add_f32_dpp v33, v33, v33 row_ror:1 row_mask:0xf bank_mask:0xf
    v_mov_b32 v31, v33
    s_nop 1
    v_permlane16_swap_b32 v33, v31
    v_add_f32 v33, v33, v31
    v_mov_b32 v31, v33
    s_nop 1
    v_permlane32_swap_b32 v33, v31
    v_add_f32 v33, v33, v31
    v_mul_f32 v33, 0x3acccccd, v33
    v_cvt_pk_bf16_f32 v30, v30, v30
    v_lshlrev_b32 v30, 16, v30
    v_cvt_pk_bf16_f32 v33, v33, v33
    v_lshlrev_b32 v33, 16, v33
    v_add_f32 v33, 0x3727c5ac, v33
    v_cvt_pk_bf16_f32 v33, v33, v33
    v_lshlrev_b32 v33, 16, v33
    v_sqrt_f32 v33, v33
    s_nop 0
    v_cvt_pk_bf16_f32 v33, v33, v33
    v_lshlrev_b32 v33, 16, v33
    v_rcp_f32 v34, v33
    v_sub_f32 v20, v20, v30
    v_sub_f32 v21, v21, v30
    v_sub_f32 v22, v22, v30
    v_sub_f32 v23, v23, v30
    v_sub_f32 v24, v24, v30
    v_sub_f32 v25, v25, v30
    v_sub_f32 v26, v26, v30
    v_sub_f32 v27, v27, v30
    v_sub_f32 v28, v28, v30
    v_sub_f32 v29, v29, v30
    v_cvt_pk_bf16_f32 v75, v20, v21
    v_lshlrev_b32 v20, 16, v75
    v_and_b32 v21, 0xffff0000, v75
    v_cvt_pk_bf16_f32 v76, v22, v23
    v_lshlrev_b32 v22, 16, v76
    v_and_b32 v23, 0xffff0000, v76
    v_cvt_pk_bf16_f32 v77, v24, v25
    v_lshlrev_b32 v24, 16, v77
    v_and_b32 v25, 0xffff0000, v77
    v_cvt_pk_bf16_f32 v78, v26, v27
    v_lshlrev_b32 v26, 16, v78
    v_and_b32 v27, 0xffff0000, v78
    v_cvt_pk_bf16_f32 v79, v28, v29
    v_lshlrev_b32 v28, 16, v79
    v_and_b32 v29, 0xffff0000, v79
    v_mul_f32 v35, v20, v34
    v_fma_f32 v36, -v35, v33, v20
    v_fma_f32 v20, v36, v34, v35
    v_mul_f32 v35, v21, v34
    v_fma_f32 v36, -v35, v33, v21
    v_fma_f32 v21, v36, v34, v35
    v_mul_f32 v35, v22, v34
    v_fma_f32 v36, -v35, v33, v22
    v_fma_f32 v22, v36, v34, v35
    v_mul_f32 v35, v23, v34
    v_fma_f32 v36, -v35, v33, v23
    v_fma_f32 v23, v36, v34, v35
    v_mul_f32 v35, v24, v34
    v_fma_f32 v36, -v35, v33, v24
    v_fma_f32 v24, v36, v34, v35
    v_mul_f32 v35, v25, v34
    v_fma_f32 v36, -v35, v33, v25
    v_fma_f32 v25, v36, v34, v35
    v_mul_f32 v35, v26, v34
    v_fma_f32 v36, -v35, v33, v26
    v_fma_f32 v26, v36, v34, v35
    v_mul_f32 v35, v27, v34
    v_fma_f32 v36, -v35, v33, v27
    v_fma_f32 v27, v36, v34, v35
    v_mul_f32 v35, v28, v34
    v_fma_f32 v36, -v35, v33, v28
    v_fma_f32 v28, v36, v34, v35
    v_mul_f32 v35, v29, v34
    v_fma_f32 v36, -v35, v33, v29
    v_fma_f32 v29, v36, v34, v35
    v_cvt_pk_bf16_f32 v75, v20, v21
    v_cvt_pk_bf16_f32 v76, v22, v23
    v_cvt_pk_bf16_f32 v77, v24, v25
    v_cvt_pk_bf16_f32 v78, v26, v27
    v_cvt_pk_bf16_f32 v79, v28, v29
    buffer_store_dword v75, v6, s[4:7], s28 offen offset:0 sc1
    buffer_store_dword v76, v6, s[4:7], s28 offen offset:256 sc1
    buffer_store_dword v77, v6, s[4:7], s28 offen offset:512 sc1
    buffer_store_dword v78, v6, s[4:7], s28 offen offset:768 sc1
    buffer_store_dword v79, v6, s[4:7], s28 offen offset:1024 sc1
    s_add_u32 s28, s28, 1280
    s_waitcnt vmcnt(0)
    s_barrier
    s_cmp_lg_u32 s16, 0
    s_cbranch_scc1 L_lnd_248
    v_mov_b32 v20, 1
    v_mov_b32 v21, 68
    s_mov_b64 exec, 1
    buffer_atomic_add v20, v21, s[12:15], 0 offen sc1
    s_mov_b64 exec, -1
L_lnd_248:
L_nln_247:
    s_cmp_lt_u32 s17, 8
    s_cbranch_scc1 L_dd_249
    s_sleep 127
    s_sleep 127
    s_sleep 127
L_dd_249:
    v_mov_b32 v2, 76
    s_mov_b32 s38, 0
L_dw_250:
    buffer_load_dword v3, v2, s[12:15], 0 offen sc1
    s_waitcnt vmcnt(0)
    v_cmp_gt_u32 vcc, 1, v3
    s_cbranch_vccz L_dwk_251
    s_sleep 2
    s_add_u32 s38, s38, 1
    s_cmp_lt_u32 s38, 4194304
    s_cbranch_scc1 L_dw_250
    s_branch L_end_1
L_dwk_251:
    v_and_b32 v1, 63, v0
    v_lshlrev_b32 v33, 2, v1
    s_cmp_ge_u32 s17, 8
    s_cbranch_scc1 L_w1_252
    s_lshl_b32 s44, s17, 9
    s_add_u32 s44, s44, 2126592
    v_lshlrev_b32 v33, 7, v1
    v_add_u32 v33, s44, v33
    s_mov_b32 s45, 4096
    s_mov_b32 s46, 15
    s_branch L_w2_253
L_w1_252:
    s_sub_u32 s44, s17, 8
    s_mul_i32 s44, s44, 768
    s_add_u32 s44, s44, 2106368
    v_lshlrev_b32 v33, 7, v1
    v_add_u32 v33, s44, v33
    s_mov_b32 s45, 0
    s_mov_b32 s46, 63
L_w2_253:
    s_mul_i32 s44, s17, 5
    s_add_u32 s44, s44, s18
    s_lshl_b32 s44, s44, 7
    s_add_u32 s44, s44, 2120192
    v_mov_b32 v34, s44
    v_and_b32 v1, 63, v0
    s_cmp_ge_u32 s17, 8
    s_cbranch_scc1 L_wh_254
    s_load_dwordx2 s[24:25], s[0:1], 40
    s_waitcnt lgkmcnt(0)
    s_mov_b32 s8, s24
    s_and_b32 s9, s25, 0xffff
    s_mov_b32 s10, 7864320
    s_mov_b32 s11, 0x20000
    s_mul_i32 s21, s17, 983040
    s_mul_i32 s22, s17, 1536
    s_add_u32 s22, s22, 79691776
    s_mov_b32 s23, 12288
    s_branch L_wd_255
L_wh_254:
    s_load_dwordx2 s[24:25], s[0:1], 80
    s_waitcnt lgkmcnt(0)
    s_mov_b32 s8, s24
    s_and_b32 s9, s25, 0xffff
    s_mov_b32 s10, 1966080
    s_mov_b32 s11, 0x20000
    s_sub_u32 s26, s17, 8
    s_mul_i32 s21, s26, 983040
    s_mul_i32 s22, s26, 1536
    s_add_u32 s22, s22, 121634816
    s_mov_b32 s23, 3072
L_wd_255:
    v_lshrrev_b32 v2, 2, v1
    v_mul_u32_u24 v2, 1280, v2
    v_and_b32 v3, 3, v1
    v_lshlrev_b32 v3, 4, v3
    v_add_u32 v2, v2, v3
    s_lshl_b32 s26, s18, 8
    s_lshl_b32 s27, s16, 6
    s_add_u32 s26, s26, s27
    s_add_u32 s27, s26, s21
    v_add_u32 v4, s27, v2
    v_lshrrev_b32 v6, 5, v1
    v_lshlrev_b32 v6, 3, v6
    v_and_b32 v7, 15, v1
    v_lshrrev_b32 v7, 2, v7
    v_add_u32 v6, v6, v7
    v_lshlrev_b32 v6, 6, v6
    v_lshrrev_b32 v7, 4, v1
    v_and_b32 v7, 1, v7
    v_lshlrev_b32 v7, 5, v7
    v_add_u32 v6, v6, v7
    v_and_b32 v7, 3, v1
    v_lshlrev_b32 v7, 3, v7
    v_add_u32 v6, v6, v7
    s_mul_i32 s27, s16, 36864
    v_add_u32 v6, s27, v6
    s_mov_b32 s28, 0
    s_add_u32 s29, s27, 0
    s_mov_b32 m0, s29
    s_nop 0
    buffer_load_dwordx4 v4, s[8:11], s28 offen lds
    s_add_u32 s28, s28, 20480
    s_add_u32 s29, s27, 1024
    s_mov_b32 m0, s29
    s_nop 0
    buffer_load_dwordx4 v4, s[8:11], s28 offen lds
    s_add_u32 s28, s28, 20480
    s_add_u32 s29, s27, 2048
    s_mov_b32 m0, s29
    s_nop 0
    buffer_load_dwordx4 v4, s[8:11], s28 offen lds
    s_add_u32 s28, s28, 20480
    s_add_u32 s29, s27, 3072
    s_mov_b32 m0, s29
    s_nop 0
    buffer_load_dwordx4 v4, s[8:11], s28 offen lds
    s_mov_b32 s28, 81920
    s_add_u32 s29, s27, 4096
    s_mov_b32 m0, s29
    s_nop 0
    buffer_load_dwordx4 v4, s[8:11], s28 offen lds
    s_add_u32 s28, s28, 20480
    s_add_u32 s29, s27, 5120
    s_mov_b32 m0, s29
    s_nop 0
    buffer_load_dwordx4 v4, s[8:11], s28 offen lds
    s_add_u32 s28, s28, 20480
    s_add_u32 s29, s27, 6144
    s_mov_b32 m0, s29
    s_nop 0
    buffer_load_dwordx4 v4, s[8:11], s28 offen lds
    s_add_u32 s28, s28, 20480
    s_add_u32 s29, s27, 7168
    s_mov_b32 m0, s29
    s_nop 0
    buffer_load_dwordx4 v4, s[8:11], s28 offen lds
    s_mov_b32 s28, 163840
    s_add_u32 s29, s27, 8192
    s_mov_b32 m0, s29
    s_nop 0
    buffer_load_dwordx4 v4, s[8:11], s28 offen lds
    s_add_u32 s28, s28, 20480
    s_add_u32 s29, s27, 9216
    s_mov_b32 m0, s29
    s_nop 0
    buffer_load_dwordx4 v4, s[8:11], s28 offen lds
    s_add_u32 s28, s28, 20480
    s_add_u32 s29, s27, 10240
    s_mov_b32 m0, s29
    s_nop 0
    buffer_load_dwordx4 v4, s[8:11], s28 offen lds
    s_add_u32 s28, s28, 20480
    s_add_u32 s29, s27, 11264
    s_mov_b32 m0, s29
    s_nop 0
    buffer_load_dwordx4 v4, s[8:11], s28 offen lds
    s_mov_b32 s28, 245760
    s_add_u32 s29, s27, 12288
    s_mov_b32 m0, s29
    s_nop 0
    buffer_load_dwordx4 v4, s[8:11], s28 offen lds
    s_add_u32 s28, s28, 20480
    s_add_u32 s29, s27, 13312
    s_mov_b32 m0, s29
    s_nop 0
    buffer_load_dwordx4 v4, s[8:11], s28 offen lds
    s_add_u32 s28, s28, 20480
    s_add_u32 s29, s27, 14336
    s_mov_b32 m0, s29
    s_nop 0
    buffer_load_dwordx4 v4, s[8:11], s28 offen lds
    s_add_u32 s28, s28, 20480
    s_add_u32 s29, s27, 15360
    s_mov_b32 m0, s29
    s_nop 0
    buffer_load_dwordx4 v4, s[8:11], s28 offen lds
    s_mov_b32 s28, 327680
    s_add_u32 s29, s27, 16384
    s_mov_b32 m0, s29
    s_nop 0
    buffer_load_dwordx4 v4, s[8:11], s28 offen lds
    s_add_u32 s28, s28, 20480
    s_add_u32 s29, s27, 17408
    s_mov_b32 m0, s29
    s_nop 0
    buffer_load_dwordx4 v4, s[8:11], s28 offen lds
    s_add_u32 s28, s28, 20480
    s_add_u32 s29, s27, 18432
    s_mov_b32 m0, s29
    s_nop 0
    buffer_load_dwordx4 v4, s[8:11], s28 offen lds
    s_add_u32 s28, s28, 20480
    s_add_u32 s29, s27, 19456
    s_mov_b32 m0, s29
    s_nop 0
    buffer_load_dwordx4 v4, s[8:11], s28 offen lds
    s_mov_b32 s28, 409600
    s_add_u32 s29, s27, 20480
    s_mov_b32 m0, s29
    s_nop 0
    buffer_load_dwordx4 v4, s[8:11], s28 offen lds
    s_add_u32 s28, s28, 20480
    s_add_u32 s29, s27, 21504
    s_mov_b32 m0, s29
    s_nop 0
    buffer_load_dwordx4 v4, s[8:11], s28 offen lds
    s_add_u32 s28, s28, 20480
    s_add_u32 s29, s27, 22528
    s_mov_b32 m0, s29
    s_nop 0
    buffer_load_dwordx4 v4, s[8:11], s28 offen lds
    s_add_u32 s28, s28, 20480
    s_add_u32 s29, s27, 23552
    s_mov_b32 m0, s29
    s_nop 0
    buffer_load_dwordx4 v4, s[8:11], s28 offen lds
    s_waitcnt vmcnt(0)
    ds_read_b64_tr_b16 a[0:1], v6 offset:0
    ds_read_b64_tr_b16 a[2:3], v6 offset:256
    ds_read_b64_tr_b16 a[4:5], v6 offset:1024
    ds_read_b64_tr_b16 a[6:7], v6 offset:1280
    ds_read_b64_tr_b16 a[8:9], v6 offset:2048
    ds_read_b64_tr_b16 a[10:11], v6 offset:2304
    ds_read_b64_tr_b16 a[12:13], v6 offset:3072
    ds_read_b64_tr_b16 a[14:15], v6 offset:3328
    s_waitcnt lgkmcnt(0)
    ds_read_b64_tr_b16 a[16:17], v6 offset:4096
    ds_read_b64_tr_b16 a[18:19], v6 offset:4352
    ds_read_b64_tr_b16 a[20:21], v6 offset:5120
    ds_read_b64_tr_b16 a[22:23], v6 offset:5376
    ds_read_b64_tr_b16 a[24:25], v6 offset:6144
    ds_read_b64_tr_b16 a[26:27], v6 offset:6400
    ds_read_b64_tr_b16 a[28:29], v6 offset:7168
    ds_read_b64_tr_b16 a[30:31], v6 offset:7424
    s_waitcnt lgkmcnt(0)
    ds_read_b64_tr_b16 a[32:33], v6 offset:8192
    ds_read_b64_tr_b16 a[34:35], v6 offset:8448
    ds_read_b64_tr_b16 a[36:37], v6 offset:9216
    ds_read_b64_tr_b16 a[38:39], v6 offset:9472
    ds_read_b64_tr_b16 a[40:41], v6 offset:10240
    ds_read_b64_tr_b16 a[42:43], v6 offset:10496
    ds_read_b64_tr_b16 a[44:45], v6 offset:11264
    ds_read_b64_tr_b16 a[46:47], v6 offset:11520
    s_waitcnt lgkmcnt(0)
    ds_read_b64_tr_b16 a[48:49], v6 offset:12288
    ds_read_b64_tr_b16 a[50:51], v6 offset:12544
    ds_read_b64_tr_b16 a[52:53], v6 offset:13312
    ds_read_b64_tr_b16 a[54:55], v6 offset:13568
    ds_read_b64_tr_b16 a[56:57], v6 offset:14336
    ds_read_b64_tr_b16 a[58:59], v6 offset:14592
    ds_read_b64_tr_b16 a[60:61], v6 offset:15360
    ds_read_b64_tr_b16 a[62:63], v6 offset:15616
    s_waitcnt lgkmcnt(0)
    ds_read_b64_tr_b16 a[64:65], v6 offset:16384
    ds_read_b64_tr_b16 a[66:67], v6 offset:16640
    ds_read_b64_tr_b16 a[68:69], v6 offset:17408
    ds_read_b64_tr_b16 a[70:71], v6 offset:17664
    ds_read_b64_tr_b16 a[72:73], v6 offset:18432
    ds_read_b64_tr_b16 a[74:75], v6 offset:18688
    ds_read_b64_tr_b16 a[76:77], v6 offset:19456
    ds_read_b64_tr_b16 a[78:79], v6 offset:19712
    s_waitcnt lgkmcnt(0)
    ds_read_b64_tr_b16 a[80:81], v6 offset:20480
    ds_read_b64_tr_b16 a[82:83], v6 offset:20736
    ds_read_b64_tr_b16 a[84:85], v6 offset:21504
    ds_read_b64_tr_b16 a[86:87], v6 offset:21760
    ds_read_b64_tr_b16 a[88:89], v6 offset:22528
    ds_read_b64_tr_b16 a[90:91], v6 offset:22784
    ds_read_b64_tr_b16 a[92:93], v6 offset:23552
    ds_read_b64_tr_b16 a[94:95], v6 offset:23808
    s_waitcnt lgkmcnt(0)
    s_mov_b32 s28, 491520
    s_add_u32 s29, s27, 0
    s_mov_b32 m0, s29
    s_nop 0
    buffer_load_dwordx4 v4, s[8:11], s28 offen lds
    s_add_u32 s28, s28, 20480
    s_add_u32 s29, s27, 1024
    s_mov_b32 m0, s29
    s_nop 0
    buffer_load_dwordx4 v4, s[8:11], s28 offen lds
    s_add_u32 s28, s28, 20480
    s_add_u32 s29, s27, 2048
    s_mov_b32 m0, s29
    s_nop 0
    buffer_load_dwordx4 v4, s[8:11], s28 offen lds
    s_add_u32 s28, s28, 20480
    s_add_u32 s29, s27, 3072
    s_mov_b32 m0, s29
    s_nop 0
    buffer_load_dwordx4 v4, s[8:11], s28 offen lds
    s_mov_b32 s28, 573440
    s_add_u32 s29, s27, 4096
    s_mov_b32 m0, s29
    s_nop 0
    buffer_load_dwordx4 v4, s[8:11], s28 offen lds
    s_add_u32 s28, s28, 20480
    s_add_u32 s29, s27, 5120
    s_mov_b32 m0, s29
    s_nop 0
    buffer_load_dwordx4 v4, s[8:11], s28 offen lds
    s_add_u32 s28, s28, 20480
    s_add_u32 s29, s27, 6144
    s_mov_b32 m0, s29
    s_nop 0
    buffer_load_dwordx4 v4, s[8:11], s28 offen lds
    s_add_u32 s28, s28, 20480
    s_add_u32 s29, s27, 7168
    s_mov_b32 m0, s29
    s_nop 0
    buffer_load_dwordx4 v4, s[8:11], s28 offen lds
    s_mov_b32 s28, 655360
    s_add_u32 s29, s27, 8192
    s_mov_b32 m0, s29
    s_nop 0
    buffer_load_dwordx4 v4, s[8:11], s28 offen lds
    s_add_u32 s28, s28, 20480
    s_add_u32 s29, s27, 9216
    s_mov_b32 m0, s29
    s_nop 0
    buffer_load_dwordx4 v4, s[8:11], s28 offen lds
    s_add_u32 s28, s28, 20480
    s_add_u32 s29, s27, 10240
    s_mov_b32 m0, s29
    s_nop 0
    buffer_load_dwordx4 v4, s[8:11], s28 offen lds
    s_add_u32 s28, s28, 20480
    s_add_u32 s29, s27, 11264
    s_mov_b32 m0, s29
    s_nop 0
    buffer_load_dwordx4 v4, s[8:11], s28 offen lds
    s_mov_b32 s28, 737280
    s_add_u32 s29, s27, 12288
    s_mov_b32 m0, s29
    s_nop 0
    buffer_load_dwordx4 v4, s[8:11], s28 offen lds
    s_add_u32 s28, s28, 20480
    s_add_u32 s29, s27, 13312
    s_mov_b32 m0, s29
    s_nop 0
    buffer_load_dwordx4 v4, s[8:11], s28 offen lds
    s_add_u32 s28, s28, 20480
    s_add_u32 s29, s27, 14336
    s_mov_b32 m0, s29
    s_nop 0
    buffer_load_dwordx4 v4, s[8:11], s28 offen lds
    s_add_u32 s28, s28, 20480
    s_add_u32 s29, s27, 15360
    s_mov_b32 m0, s29
    s_nop 0
    buffer_load_dwordx4 v4, s[8:11], s28 offen lds
    s_mov_b32 s28, 819200
    s_add_u32 s29, s27, 16384
    s_mov_b32 m0, s29
    s_nop 0
    buffer_load_dwordx4 v4, s[8:11], s28 offen lds
    s_add_u32 s28, s28, 20480
    s_add_u32 s29, s27, 17408
    s_mov_b32 m0, s29
    s_nop 0
    buffer_load_dwordx4 v4, s[8:11], s28 offen lds
    s_add_u32 s28, s28, 20480
    s_add_u32 s29, s27, 18432
    s_mov_b32 m0, s29
    s_nop 0
    buffer_load_dwordx4 v4, s[8:11], s28 offen lds
    s_add_u32 s28, s28, 20480
    s_add_u32 s29, s27, 19456
    s_mov_b32 m0, s29
    s_nop 0
    buffer_load_dwordx4 v4, s[8:11], s28 offen lds
    s_mov_b32 s28, 901120
    s_add_u32 s29, s27, 20480
    s_mov_b32 m0, s29
    s_nop 0
    buffer_load_dwordx4 v4, s[8:11], s28 offen lds
    s_add_u32 s28, s28, 20480
    s_add_u32 s29, s27, 21504
    s_mov_b32 m0, s29
    s_nop 0
    buffer_load_dwordx4 v4, s[8:11], s28 offen lds
    s_add_u32 s28, s28, 20480
    s_add_u32 s29, s27, 22528
    s_mov_b32 m0, s29
    s_nop 0
    buffer_load_dwordx4 v4, s[8:11], s28 offen lds
    s_add_u32 s28, s28, 20480
    s_add_u32 s29, s27, 23552
    s_mov_b32 m0, s29
    s_nop 0
    buffer_load_dwordx4 v4, s[8:11], s28 offen lds
    s_waitcnt vmcnt(0)
    ds_read_b64_tr_b16 a[96:97], v6 offset:0
    ds_read_b64_tr_b16 a[98:99], v6 offset:256
    ds_read_b64_tr_b16 a[100:101], v6 offset:1024
    ds_read_b64_tr_b16 a[102:103], v6 offset:1280
    ds_read_b64_tr_b16 a[104:105], v6 offset:2048
    ds_read_b64_tr_b16 a[106:107], v6 offset:2304
    ds_read_b64_tr_b16 a[108:109], v6 offset:3072
    ds_read_b64_tr_b16 a[110:111], v6 offset:3328
    s_waitcnt lgkmcnt(0)
    ds_read_b64_tr_b16 a[112:113], v6 offset:4096
    ds_read_b64_tr_b16 a[114:115], v6 offset:4352
    ds_read_b64_tr_b16 a[116:117], v6 offset:5120
    ds_read_b64_tr_b16 a[118:119], v6 offset:5376
    ds_read_b64_tr_b16 a[120:121], v6 offset:6144
    ds_read_b64_tr_b16 a[122:123], v6 offset:6400
    ds_read_b64_tr_b16 a[124:125], v6 offset:7168
    ds_read_b64_tr_b16 a[126:127], v6 offset:7424
    s_waitcnt lgkmcnt(0)
    ds_read_b64_tr_b16 a[128:129], v6 offset:8192
    ds_read_b64_tr_b16 a[130:131], v6 offset:8448
    ds_read_b64_tr_b16 a[132:133], v6 offset:9216
    ds_read_b64_tr_b16 a[134:135], v6 offset:9472
    ds_read_b64_tr_b16 a[136:137], v6 offset:10240
    ds_read_b64_tr_b16 a[138:139], v6 offset:10496
    ds_read_b64_tr_b16 a[140:141], v6 offset:11264
    ds_read_b64_tr_b16 a[142:143], v6 offset:11520
    s_waitcnt lgkmcnt(0)
    ds_read_b64_tr_b16 a[144:145], v6 offset:12288
    ds_read_b64_tr_b16 a[146:147], v6 offset:12544
    ds_read_b64_tr_b16 a[148:149], v6 offset:13312
    ds_read_b64_tr_b16 a[150:151], v6 offset:13568
    ds_read_b64_tr_b16 a[152:153], v6 offset:14336
    ds_read_b64_tr_b16 a[154:155], v6 offset:14592
    ds_read_b64_tr_b16 a[156:157], v6 offset:15360
    ds_read_b64_tr_b16 a[158:159], v6 offset:15616
    s_waitcnt lgkmcnt(0)
    ds_read_b64_tr_b16 a[160:161], v6 offset:16384
    ds_read_b64_tr_b16 a[162:163], v6 offset:16640
    ds_read_b64_tr_b16 a[164:165], v6 offset:17408
    ds_read_b64_tr_b16 a[166:167], v6 offset:17664
    ds_read_b64_tr_b16 a[168:169], v6 offset:18432
    ds_read_b64_tr_b16 a[170:171], v6 offset:18688
    ds_read_b64_tr_b16 a[172:173], v6 offset:19456
    ds_read_b64_tr_b16 a[174:175], v6 offset:19712
    s_waitcnt lgkmcnt(0)
    ds_read_b64_tr_b16 a[176:177], v6 offset:20480
    ds_read_b64_tr_b16 a[178:179], v6 offset:20736
    ds_read_b64_tr_b16 a[180:181], v6 offset:21504
    ds_read_b64_tr_b16 a[182:183], v6 offset:21760
    ds_read_b64_tr_b16 a[184:185], v6 offset:22528
    ds_read_b64_tr_b16 a[186:187], v6 offset:22784
    ds_read_b64_tr_b16 a[188:189], v6 offset:23552
    ds_read_b64_tr_b16 a[190:191], v6 offset:23808
    s_waitcnt lgkmcnt(0)
    s_barrier
    s_mul_i32 s28, s16, 768
    s_add_u32 s28, s28, 0
    v_add_u32 v2, s28, v1
    v_mul_u32_u24 v3, 43691, v2
    v_lshrrev_b32 v3, 22, v3
    v_mul_u32_u24 v7, 96, v3
    v_sub_u32 v2, v2, v7
    v_and_b32 v7, 15, v3
    v_xor_b32 v2, v2, v7
    v_lshlrev_b32 v2, 4, v2
    v_mul_lo_u32 v3, v3, s23
    v_add_u32 v10, v2, v3
    v_add_u32 v10, s22, v10
    s_mul_i32 s28, s16, 768
    s_add_u32 s28, s28, 64
    v_add_u32 v2, s28, v1
    v_mul_u32_u24 v3, 43691, v2
    v_lshrrev_b32 v3, 22, v3
    v_mul_u32_u24 v7, 96, v3
    v_sub_u32 v2, v2, v7
    v_and_b32 v7, 15, v3
    v_xor_b32 v2, v2, v7
    v_lshlrev_b32 v2, 4, v2
    v_mul_lo_u32 v3, v3, s23
    v_add_u32 v11, v2, v3
    v_add_u32 v11, s22, v11
    s_mul_i32 s28, s16, 768
    s_add_u32 s28, s28, 128
    v_add_u32 v2, s28, v1
    v_mul_u32_u24 v3, 43691, v2
    v_lshrrev_b32 v3, 22, v3
    v_mul_u32_u24 v7, 96, v3
    v_sub_u32 v2, v2, v7
    v_and_b32 v7, 15, v3
    v_xor_b32 v2, v2, v7
    v_lshlrev_b32 v2, 4, v2
    v_mul_lo_u32 v3, v3, s23
    v_add_u32 v12, v2, v3
    v_add_u32 v12, s22, v12
    s_mul_i32 s28, s16, 768
    s_add_u32 s28, s28, 192
    v_add_u32 v2, s28, v1
    v_mul_u32_u24 v3, 43691, v2
    v_lshrrev_b32 v3, 22, v3
    v_mul_u32_u24 v7, 96, v3
    v_sub_u32 v2, v2, v7
    v_and_b32 v7, 15, v3
    v_xor_b32 v2, v2, v7
    v_lshlrev_b32 v2, 4, v2
    v_mul_lo_u32 v3, v3, s23
    v_add_u32 v13, v2, v3
    v_add_u32 v13, s22, v13
    s_mul_i32 s28, s16, 768
    s_add_u32 s28, s28, 256
    v_add_u32 v2, s28, v1
    v_mul_u32_u24 v3, 43691, v2
    v_lshrrev_b32 v3, 22, v3
    v_mul_u32_u24 v7, 96, v3
    v_sub_u32 v2, v2, v7
    v_and_b32 v7, 15, v3
    v_xor_b32 v2, v2, v7
    v_lshlrev_b32 v2, 4, v2
    v_mul_lo_u32 v3, v3, s23
    v_add_u32 v14, v2, v3
    v_add_u32 v14, s22, v14
    s_mul_i32 s28, s16, 768
    s_add_u32 s28, s28, 320
    v_add_u32 v2, s28, v1
    v_mul_u32_u24 v3, 43691, v2
    v_lshrrev_b32 v3, 22, v3
    v_mul_u32_u24 v7, 96, v3
    v_sub_u32 v2, v2, v7
    v_and_b32 v7, 15, v3
    v_xor_b32 v2, v2, v7
    v_lshlrev_b32 v2, 4, v2
    v_mul_lo_u32 v3, v3, s23
    v_add_u32 v15, v2, v3
    v_add_u32 v15, s22, v15
    s_mul_i32 s28, s16, 768
    s_add_u32 s28, s28, 384
    v_add_u32 v2, s28, v1
    v_mul_u32_u24 v3, 43691, v2
    v_lshrrev_b32 v3, 22, v3
    v_mul_u32_u24 v7, 96, v3
    v_sub_u32 v2, v2, v7
    v_and_b32 v7, 15, v3
    v_xor_b32 v2, v2, v7
    v_lshlrev_b32 v2, 4, v2
    v_mul_lo_u32 v3, v3, s23
    v_add_u32 v16, v2, v3
    v_add_u32 v16, s22, v16
    s_mul_i32 s28, s16, 768
    s_add_u32 s28, s28, 448
    v_add_u32 v2, s28, v1
    v_mul_u32_u24 v3, 43691, v2
    v_lshrrev_b32 v3, 22, v3
    v_mul_u32_u24 v7, 96, v3
    v_sub_u32 v2, v2, v7
    v_and_b32 v7, 15, v3
    v_xor_b32 v2, v2, v7
    v_lshlrev_b32 v2, 4, v2
    v_mul_lo_u32 v3, v3, s23
    v_add_u32 v17, v2, v3
    v_add_u32 v17, s22, v17
    s_mul_i32 s28, s16, 768
    s_add_u32 s28, s28, 512
    v_add_u32 v2, s28, v1
    v_mul_u32_u24 v3, 43691, v2
    v_lshrrev_b32 v3, 22, v3
    v_mul_u32_u24 v7, 96, v3
    v_sub_u32 v2, v2, v7
    v_and_b32 v7, 15, v3
    v_xor_b32 v2, v2, v7
    v_lshlrev_b32 v2, 4, v2
    v_mul_lo_u32 v3, v3, s23
    v_add_u32 v18, v2, v3
    v_add_u32 v18, s22, v18
    s_mul_i32 s28, s16, 768
    s_add_u32 s28, s28, 576
    v_add_u32 v2, s28, v1
    v_mul_u32_u24 v3, 43691, v2
    v_lshrrev_b32 v3, 22, v3
    v_mul_u32_u24 v7, 96, v3
    v_sub_u32 v2, v2, v7
    v_and_b32 v7, 15, v3
    v_xor_b32 v2, v2, v7
    v_lshlrev_b32 v2, 4, v2
    v_mul_lo_u32 v3, v3, s23
    v_add_u32 v19, v2, v3
    v_add_u32 v19, s22, v19
    s_mul_i32 s28, s16, 768
    s_add_u32 s28, s28, 640
    v_add_u32 v2, s28, v1
    v_mul_u32_u24 v3, 43691, v2
    v_lshrrev_b32 v3, 22, v3
    v_mul_u32_u24 v7, 96, v3
    v_sub_u32 v2, v2, v7
    v_and_b32 v7, 15, v3
    v_xor_b32 v2, v2, v7
    v_lshlrev_b32 v2, 4, v2
    v_mul_lo_u32 v3, v3, s23
    v_add_u32 v20, v2, v3
    v_add_u32 v20, s22, v20
    s_mul_i32 s28, s16, 768
    s_add_u32 s28, s28, 704
    v_add_u32 v2, s28, v1
    v_mul_u32_u24 v3, 43691, v2
    v_lshrrev_b32 v3, 22, v3
    v_mul_u32_u24 v7, 96, v3
    v_sub_u32 v2, v2, v7
    v_and_b32 v7, 15, v3
    v_xor_b32 v2, v2, v7
    v_lshlrev_b32 v2, 4, v2
    v_mul_lo_u32 v3, v3, s23
    v_add_u32 v21, v2, v3
    v_add_u32 v21, s22, v21
    v_and_b32 v2, 31, v1
    v_lshrrev_b32 v3, 5, v1
    v_and_b32 v7, 15, v2
    v_mul_u32_u24 v2, 96, v2
    v_add_u32 v8, 0, v3
    v_xor_b32 v8, v8, v7
    v_add_u32 v8, v8, v2
    v_lshlrev_b32 v24, 4, v8
    v_add_u32 v8, 2, v3
    v_xor_b32 v8, v8, v7
    v_add_u32 v8, v8, v2
    v_lshlrev_b32 v25, 4, v8
    v_add_u32 v8, 4, v3
    v_xor_b32 v8, v8, v7
    v_add_u32 v8, v8, v2
    v_lshlrev_b32 v26, 4, v8
    v_add_u32 v8, 6, v3
    v_xor_b32 v8, v8, v7
    v_add_u32 v8, v8, v2
    v_lshlrev_b32 v27, 4, v8
    v_add_u32 v8, 8, v3
    v_xor_b32 v8, v8, v7
    v_add_u32 v8, v8, v2
    v_lshlrev_b32 v28, 4, v8
    v_add_u32 v8, 10, v3
    v_xor_b32 v8, v8, v7
    v_add_u32 v8, v8, v2
    v_lshlrev_b32 v29, 4, v8
    v_add_u32 v8, 12, v3
    v_xor_b32 v8, v8, v7
    v_add_u32 v8, v8, v2
    v_lshlrev_b32 v30, 4, v8
    v_add_u32 v8, 14, v3
    v_xor_b32 v8, v8, v7
    v_add_u32 v8, v8, v2
    v_lshlrev_b32 v31, 4, v8
    s_mul_i32 s28, s17, 2621440
    s_add_u32 s28, s28, 134217728
    s_add_u32 s28, s28, s26
    v_and_b32 v2, 31, v1
    v_mul_u32_u24 v32, 1280, v2
    v_lshrrev_b32 v3, 5, v1
    v_lshlrev_b32 v3, 4, v3
    v_add_u32 v32, v32, v3
    v_add_u32 v32, s28, v32
    v_and_b32 v2, 31, v1
    v_lshrrev_b32 v3, 5, v1
    s_lshl_b32 s29, s16, 2
    v_add_u32 v3, s29, v3
    v_and_b32 v7, 7, v2
    v_xor_b32 v3, v3, v7
    v_lshlrev_b32 v3, 4, v3
    v_lshlrev_b32 v37, 8, v2
    v_add_u32 v37, v37, v3
    v_add_u32 v37, 98304, v37
    s_lshl_b32 s29, s16, 11
    s_add_u32 s29, s29, 98304
    v_lshlrev_b32 v38, 4, v1
    v_add_u32 v38, s29, v38
    s_lshl_b32 s29, s16, 3
    v_lshrrev_b32 v2, 4, v1
    v_add_u32 v2, s29, v2
    v_and_b32 v3, 15, v1
    v_and_b32 v7, 7, v2
    v_xor_b32 v3, v3, v7
    v_lshlrev_b32 v3, 4, v3
    v_mul_u32_u24 v39, 1280, v2
    v_add_u32 v39, v39, v3
    s_mul_i32 s29, s17, 2621440
    s_add_u32 s29, s29, 134217728
    s_lshl_b32 s28, s18, 8
    s_add_u32 s29, s29, s28
    v_add_u32 v39, s29, v39
    s_lshl_b32 s28, s16, 3
    s_add_u32 s28, s28, 4
    v_lshrrev_b32 v2, 4, v1
    v_add_u32 v2, s28, v2
    v_and_b32 v3, 15, v1
    v_and_b32 v7, 7, v2
    v_xor_b32 v3, v3, v7
    v_lshlrev_b32 v3, 4, v3
    v_mul_u32_u24 v22, 1280, v2
    v_add_u32 v22, v22, v3
    v_add_u32 v22, s29, v22
    s_lshl_b32 s30, s23, 5
    s_mul_i32 s31, s19, 40960
    s_mov_b32 s33, s19
    s_mul_i32 s32, s19, s30
    s_mov_b32 s34, 0
    s_mov_b32 s35, 49152
    s_mov_b32 s36, 98304
    s_mul_i32 s37, s16, 12288
    s_mov_b32 s39, 0
    v_mov_b32 v23, 106496
    s_and_b32 s47, s33, 1
    s_mul_i32 s47, s47, s45
    v_add_u32 v35, s47, v33
    s_add_u32 s47, s33, 1
    s_mov_b32 s49, 0
    s_mov_b32 exec_lo, s46
    s_mov_b32 exec_hi, 0
L_ww_258:
    buffer_load_dword v36, v35, s[4:7], 0 offen sc1
    s_waitcnt vmcnt(0)
    v_cmp_gt_u32 vcc, s47, v36
    s_cbranch_vccz L_wwk_259
    s_sleep 4
    s_add_u32 s49, s49, 1
    s_cmp_lt_u32 s49, 4194304
    s_cbranch_scc1 L_ww_258
    s_mov_b64 exec, -1
    s_branch L_end_1
L_wwk_259:
    s_mov_b64 exec, -1
    s_add_u32 s38, s37, s34
    s_add_u32 m0, s38, 0
    s_nop 0
    buffer_load_dwordx4 v10, s[4:7], s32 offen sc1 lds
    s_add_u32 m0, s38, 1024
    s_nop 0
    buffer_load_dwordx4 v11, s[4:7], s32 offen sc1 lds
    s_add_u32 m0, s38, 2048
    s_nop 0
    buffer_load_dwordx4 v12, s[4:7], s32 offen sc1 lds
    s_add_u32 m0, s38, 3072
    s_nop 0
    buffer_load_dwordx4 v13, s[4:7], s32 offen sc1 lds
    s_add_u32 m0, s38, 4096
    s_nop 0
    buffer_load_dwordx4 v14, s[4:7], s32 offen sc1 lds
    s_add_u32 m0, s38, 5120
    s_nop 0
    buffer_load_dwordx4 v15, s[4:7], s32 offen sc1 lds
    s_add_u32 m0, s38, 6144
    s_nop 0
    buffer_load_dwordx4 v16, s[4:7], s32 offen sc1 lds
    s_add_u32 m0, s38, 7168
    s_nop 0
    buffer_load_dwordx4 v17, s[4:7], s32 offen sc1 lds
    s_add_u32 m0, s38, 8192
    s_nop 0
    buffer_load_dwordx4 v18, s[4:7], s32 offen sc1 lds
    s_add_u32 m0, s38, 9216
    s_nop 0
    buffer_load_dwordx4 v19, s[4:7], s32 offen sc1 lds
    s_add_u32 m0, s38, 10240
    s_nop 0
    buffer_load_dwordx4 v20, s[4:7], s32 offen sc1 lds
    s_add_u32 m0, s38, 11264
    s_nop 0
    buffer_load_dwordx4 v21, s[4:7], s32 offen sc1 lds
    s_add_u32 s32, s32, s30
    s_add_u32 s42, s33, 1
    s_and_b32 s47, s42, 1
    s_mul_i32 s47, s47, s45
    v_add_u32 v35, s47, v33
    s_add_u32 s47, s42, 1
    s_mov_b32 s48, s47
    s_mov_b32 exec_lo, s46
    s_mov_b32 exec_hi, 0
    buffer_load_dword v36, v35, s[4:7], 0 offen sc1
    s_mov_b64 exec, -1
L_wtile_257:
    s_waitcnt vmcnt(0)
    s_cmp_lg_u32 s16, 0
    s_cbranch_scc1 L_w0_260
    s_mov_b32 exec_lo, s46
    s_mov_b32 exec_hi, 0
    v_cmp_gt_u32 vcc, s48, v36
    s_mov_b64 exec, -1
    s_nop 0
    s_cmp_eq_u64 vcc, 0
    s_cselect_b32 s43, 1, 0
    s_add_u32 s42, s33, 1
    s_cmp_ge_u32 s42, s20
    s_cselect_b32 s43, 0, s43
    v_mov_b32 v104, s43
    ds_write_b32 v23, v104
    s_waitcnt lgkmcnt(0)
L_w0_260:
    s_barrier
    ds_read_b32 v104, v23
    s_cmp_eq_u32 s39, 0
    s_cbranch_scc1 L_nq_262
    s_cmp_lg_u32 s16, 0
    s_cbranch_scc1 L_wp_263
    v_mov_b32 v36, s33
    s_mov_b64 exec, 1
    buffer_store_dword v36, v34, s[4:7], 0 offen sc1
    s_mov_b64 exec, -1
L_wp_263:
L_nq_262:
    s_waitcnt lgkmcnt(0)
    s_nop 0
    v_readfirstlane_b32 s43, v104
    s_nop 3
    s_cmp_eq_u32 s43, 0
    s_cbranch_scc1 L_np_261
    s_add_u32 s38, s37, s35
    s_add_u32 m0, s38, 0
    s_nop 0
    buffer_load_dwordx4 v10, s[4:7], s32 offen sc1 lds
    s_add_u32 m0, s38, 1024
    s_nop 0
    buffer_load_dwordx4 v11, s[4:7], s32 offen sc1 lds
    s_add_u32 m0, s38, 2048
    s_nop 0
    buffer_load_dwordx4 v12, s[4:7], s32 offen sc1 lds
    s_add_u32 m0, s38, 3072
    s_nop 0
    buffer_load_dwordx4 v13, s[4:7], s32 offen sc1 lds
    s_add_u32 m0, s38, 4096
    s_nop 0
    buffer_load_dwordx4 v14, s[4:7], s32 offen sc1 lds
    s_add_u32 m0, s38, 5120
    s_nop 0
    buffer_load_dwordx4 v15, s[4:7], s32 offen sc1 lds
    s_add_u32 m0, s38, 6144
    s_nop 0
    buffer_load_dwordx4 v16, s[4:7], s32 offen sc1 lds
    s_add_u32 m0, s38, 7168
    s_nop 0
    buffer_load_dwordx4 v17, s[4:7], s32 offen sc1 lds
    s_add_u32 m0, s38, 8192
    s_nop 0
    buffer_load_dwordx4 v18, s[4:7], s32 offen sc1 lds
    s_add_u32 m0, s38, 9216
    s_nop 0
    buffer_load_dwordx4 v19, s[4:7], s32 offen sc1 lds
    s_add_u32 m0, s38, 10240
    s_nop 0
    buffer_load_dwordx4 v20, s[4:7], s32 offen sc1 lds
    s_add_u32 m0, s38, 11264
    s_nop 0
    buffer_load_dwordx4 v21, s[4:7], s32 offen sc1 lds
    s_add_u32 s32, s32, s30
L_np_261:
    v_add_u32 v40, s34, v24
    v_add_u32 v41, s34, v25
    v_add_u32 v42, s34, v26
    v_add_u32 v43, s34, v27
    v_add_u32 v44, s34, v28
    v_add_u32 v45, s34, v29
    v_add_u32 v46, s34, v30
    v_add_u32 v47, s34, v31
    ds_read_b128 v[48:51], v40 offset:0
    ds_read_b128 v[52:55], v41 offset:0
    ds_read_b128 v[56:59], v42 offset:0
    ds_read_b128 v[60:63], v43 offset:0
    s_waitcnt lgkmcnt(3)
    v_mfma_f32_32x32x16_bf16 v[64:79], a[0:3], v[48:51], 0
    ds_read_b128 v[48:51], v44 offset:0
    s_waitcnt lgkmcnt(3)
    v_mfma_f32_32x32x16_bf16 v[64:79], a[4:7], v[52:55], v[64:79]
    ds_read_b128 v[52:55], v45 offset:0
    s_waitcnt lgkmcnt(3)
    v_mfma_f32_32x32x16_bf16 v[64:79], a[8:11], v[56:59], v[64:79]
    ds_read_b128 v[56:59], v46 offset:0
    s_waitcnt lgkmcnt(3)
    v_mfma_f32_32x32x16_bf16 v[64:79], a[12:15], v[60:63], v[64:79]
    ds_read_b128 v[60:63], v47 offset:0
    s_waitcnt lgkmcnt(3)
    v_mfma_f32_32x32x16_bf16 v[64:79], a[16:19], v[48:51], v[64:79]
    ds_read_b128 v[48:51], v40 offset:256
    s_waitcnt lgkmcnt(3)
    v_mfma_f32_32x32x16_bf16 v[64:79], a[20:23], v[52:55], v[64:79]
    ds_read_b128 v[52:55], v41 offset:256
    s_waitcnt lgkmcnt(3)
    v_mfma_f32_32x32x16_bf16 v[64:79], a[24:27], v[56:59], v[64:79]
    ds_read_b128 v[56:59], v42 offset:256
    s_waitcnt lgkmcnt(3)
    v_mfma_f32_32x32x16_bf16 v[64:79], a[28:31], v[60:63], v[64:79]
    ds_read_b128 v[60:63], v43 offset:256
    s_waitcnt lgkmcnt(3)
    v_mfma_f32_32x32x16_bf16 v[64:79], a[32:35], v[48:51], v[64:79]
    ds_read_b128 v[48:51], v44 offset:256
    s_waitcnt lgkmcnt(3)
    v_mfma_f32_32x32x16_bf16 v[64:79], a[36:39], v[52:55], v[64:79]
    ds_read_b128 v[52:55], v45 offset:256
    s_waitcnt lgkmcnt(3)
    v_mfma_f32_32x32x16_bf16 v[64:79], a[40:43], v[56:59], v[64:79]
    ds_read_b128 v[56:59], v46 offset:256
    s_waitcnt lgkmcnt(3)
    v_mfma_f32_32x32x16_bf16 v[64:79], a[44:47], v[60:63], v[64:79]
    ds_read_b128 v[60:63], v47 offset:256
    s_waitcnt lgkmcnt(3)
    v_mfma_f32_32x32x16_bf16 v[64:79], a[48:51], v[48:51], v[64:79]
    ds_read_b128 v[48:51], v40 offset:512
    s_waitcnt lgkmcnt(3)
    v_mfma_f32_32x32x16_bf16 v[64:79], a[52:55], v[52:55], v[64:79]
    ds_read_b128 v[52:55], v41 offset:512
    s_waitcnt lgkmcnt(3)
    v_mfma_f32_32x32x16_bf16 v[64:79], a[56:59], v[56:59], v[64:79]
    ds_read_b128 v[56:59], v42 offset:512
    s_waitcnt lgkmcnt(3)
    v_mfma_f32_32x32x16_bf16 v[64:79], a[60:63], v[60:63], v[64:79]
    ds_read_b128 v[60:63], v43 offset:512
    s_waitcnt lgkmcnt(3)
    v_mfma_f32_32x32x16_bf16 v[64:79], a[64:67], v[48:51], v[64:79]
    ds_read_b128 v[48:51], v44 offset:512
    s_waitcnt lgkmcnt(3)
    v_mfma_f32_32x32x16_bf16 v[64:79], a[68:71], v[52:55], v[64:79]
    ds_read_b128 v[52:55], v45 offset:512
    s_waitcnt lgkmcnt(3)
    v_mfma_f32_32x32x16_bf16 v[64:79], a[72:75], v[56:59], v[64:79]
    ds_read_b128 v[56:59], v46 offset:512
    s_waitcnt lgkmcnt(3)
    v_mfma_f32_32x32x16_bf16 v[64:79], a[76:79], v[60:63], v[64:79]
    ds_read_b128 v[60:63], v47 offset:512
    s_waitcnt lgkmcnt(3)
    v_mfma_f32_32x32x16_bf16 v[64:79], a[80:83], v[48:51], v[64:79]
    ds_read_b128 v[48:51], v40 offset:768
    s_waitcnt lgkmcnt(3)
    v_mfma_f32_32x32x16_bf16 v[64:79], a[84:87], v[52:55], v[64:79]
    ds_read_b128 v[52:55], v41 offset:768
    s_waitcnt lgkmcnt(3)
    v_mfma_f32_32x32x16_bf16 v[64:79], a[88:91], v[56:59], v[64:79]
    ds_read_b128 v[56:59], v42 offset:768
    s_waitcnt lgkmcnt(3)
    v_mfma_f32_32x32x16_bf16 v[64:79], a[92:95], v[60:63], v[64:79]
    ds_read_b128 v[60:63], v43 offset:768
    s_waitcnt lgkmcnt(3)
    v_mfma_f32_32x32x16_bf16 v[64:79], a[96:99], v[48:51], v[64:79]
    ds_read_b128 v[48:51], v44 offset:768
    s_waitcnt lgkmcnt(3)
    v_mfma_f32_32x32x16_bf16 v[64:79], a[100:103], v[52:55], v[64:79]
    ds_read_b128 v[52:55], v45 offset:768
    s_waitcnt lgkmcnt(3)
    v_mfma_f32_32x32x16_bf16 v[64:79], a[104:107], v[56:59], v[64:79]
    ds_read_b128 v[56:59], v46 offset:768
    s_waitcnt lgkmcnt(3)
    v_mfma_f32_32x32x16_bf16 v[64:79], a[108:111], v[60:63], v[64:79]
    ds_read_b128 v[60:63], v47 offset:768
    s_waitcnt lgkmcnt(3)
    v_mfma_f32_32x32x16_bf16 v[64:79], a[112:115], v[48:51], v[64:79]
    ds_read_b128 v[48:51], v40 offset:1024
    s_waitcnt lgkmcnt(3)
    v_mfma_f32_32x32x16_bf16 v[64:79], a[116:119], v[52:55], v[64:79]
    ds_read_b128 v[52:55], v41 offset:1024
    s_waitcnt lgkmcnt(3)
    v_mfma_f32_32x32x16_bf16 v[64:79], a[120:123], v[56:59], v[64:79]
    ds_read_b128 v[56:59], v42 offset:1024
    s_waitcnt lgkmcnt(3)
    v_mfma_f32_32x32x16_bf16 v[64:79], a[124:127], v[60:63], v[64:79]
    ds_read_b128 v[60:63], v43 offset:1024
    s_waitcnt lgkmcnt(3)
    v_mfma_f32_32x32x16_bf16 v[64:79], a[128:131], v[48:51], v[64:79]
    ds_read_b128 v[48:51], v44 offset:1024
    s_waitcnt lgkmcnt(3)
    v_mfma_f32_32x32x16_bf16 v[64:79], a[132:135], v[52:55], v[64:79]
    ds_read_b128 v[52:55], v45 offset:1024
    s_waitcnt lgkmcnt(3)
    v_mfma_f32_32x32x16_bf16 v[64:79], a[136:139], v[56:59], v[64:79]
    ds_read_b128 v[56:59], v46 offset:1024
    s_waitcnt lgkmcnt(3)
    v_mfma_f32_32x32x16_bf16 v[64:79], a[140:143], v[60:63], v[64:79]
    ds_read_b128 v[60:63], v47 offset:1024
    s_waitcnt lgkmcnt(3)
    v_mfma_f32_32x32x16_bf16 v[64:79], a[144:147], v[48:51], v[64:79]
    ds_read_b128 v[48:51], v40 offset:1280
    s_waitcnt lgkmcnt(3)
    v_mfma_f32_32x32x16_bf16 v[64:79], a[148:151], v[52:55], v[64:79]
    ds_read_b128 v[52:55], v41 offset:1280
    s_waitcnt lgkmcnt(3)
    v_mfma_f32_32x32x16_bf16 v[64:79], a[152:155], v[56:59], v[64:79]
    ds_read_b128 v[56:59], v42 offset:1280
    s_waitcnt lgkmcnt(3)
    v_mfma_f32_32x32x16_bf16 v[64:79], a[156:159], v[60:63], v[64:79]
    ds_read_b128 v[60:63], v43 offset:1280
    s_waitcnt lgkmcnt(3)
    v_mfma_f32_32x32x16_bf16 v[64:79], a[160:163], v[48:51], v[64:79]
    ds_read_b128 v[48:51], v44 offset:1280
    s_waitcnt lgkmcnt(3)
    v_mfma_f32_32x32x16_bf16 v[64:79], a[164:167], v[52:55], v[64:79]
    ds_read_b128 v[52:55], v45 offset:1280
    s_waitcnt lgkmcnt(3)
    v_mfma_f32_32x32x16_bf16 v[64:79], a[168:171], v[56:59], v[64:79]
    ds_read_b128 v[56:59], v46 offset:1280
    s_waitcnt lgkmcnt(3)
    v_mfma_f32_32x32x16_bf16 v[64:79], a[172:175], v[60:63], v[64:79]
    ds_read_b128 v[60:63], v47 offset:1280
    s_waitcnt lgkmcnt(3)
    v_mfma_f32_32x32x16_bf16 v[64:79], a[176:179], v[48:51], v[64:79]
    s_waitcnt lgkmcnt(2)
    v_mfma_f32_32x32x16_bf16 v[64:79], a[180:183], v[52:55], v[64:79]
    s_waitcnt lgkmcnt(1)
    v_mfma_f32_32x32x16_bf16 v[64:79], a[184:187], v[56:59], v[64:79]
    s_waitcnt lgkmcnt(0)
    v_mfma_f32_32x32x16_bf16 v[64:79], a[188:191], v[60:63], v[64:79]
    s_nop 7
    s_nop 3
    v_cvt_pk_bf16_f32 v96, v64, v65
    v_cvt_pk_bf16_f32 v97, v66, v67
    v_cvt_pk_bf16_f32 v98, v68, v69
    v_cvt_pk_bf16_f32 v99, v70, v71
    v_xor_b32 v104, 0, v37
    v_permlane32_swap_b32 v96, v98
    v_permlane32_swap_b32 v97, v99
    ds_write_b128 v104, v[96:99]
    v_cvt_pk_bf16_f32 v100, v72, v73
    v_cvt_pk_bf16_f32 v101, v74, v75
    v_cvt_pk_bf16_f32 v102, v76, v77
    v_cvt_pk_bf16_f32 v103, v78, v79
    v_xor_b32 v104, 32, v37
    v_permlane32_swap_b32 v100, v102
    v_permlane32_swap_b32 v101, v103
    ds_write_b128 v104, v[100:103]
    s_waitcnt lgkmcnt(0)
    s_barrier
    ds_read_b128 v[96:99], v38
    ds_read_b128 v[100:103], v38 offset:1024
    s_waitcnt lgkmcnt(1)
    buffer_store_dwordx4 v[96:99], v39, s[4:7], s31 offen sc1
    s_waitcnt lgkmcnt(0)
    buffer_store_dwordx4 v[100:103], v22, s[4:7], s31 offen sc1
    s_add_u32 s31, s31, 40960
    s_add_u32 s33, s33, 1
    s_mov_b32 s38, s34
    s_mov_b32 s34, s35
    s_mov_b32 s35, s38
    s_mov_b32 s39, 1
    s_cmp_ge_u32 s33, s20
    s_cbranch_scc1 L_wfin_264
    s_cmp_lg_u32 s43, 0
    s_cbranch_scc1 L_wpf_265
    s_waitcnt vmcnt(0)
    s_barrier
    s_cmp_lg_u32 s16, 0
    s_cbranch_scc1 L_wp_266
    v_mov_b32 v36, s33
    s_mov_b64 exec, 1
    buffer_store_dword v36, v34, s[4:7], 0 offen sc1
    s_mov_b64 exec, -1
L_wp_266:
    s_mov_b32 s39, 0
    s_and_b32 s47, s33, 1
    s_mul_i32 s47, s47, s45
    v_add_u32 v35, s47, v33
    s_add_u32 s47, s33, 1
    s_mov_b32 s49, 0
    s_mov_b32 exec_lo, s46
    s_mov_b32 exec_hi, 0
L_ww_267:
    buffer_load_dword v36, v35, s[4:7], 0 offen sc1
    s_waitcnt vmcnt(0)
    v_cmp_gt_u32 vcc, s47, v36
    s_cbranch_vccz L_wwk_268
    s_sleep 4
    s_add_u32 s49, s49, 1
    s_cmp_lt_u32 s49, 4194304
    s_cbranch_scc1 L_ww_267
    s_mov_b64 exec, -1
    s_branch L_end_1
L_wwk_268:
    s_mov_b64 exec, -1
    s_add_u32 s38, s37, s34
    s_add_u32 m0, s38, 0
    s_nop 0
    buffer_load_dwordx4 v10, s[4:7], s32 offen sc1 lds
    s_add_u32 m0, s38, 1024
    s_nop 0
    buffer_load_dwordx4 v11, s[4:7], s32 offen sc1 lds
    s_add_u32 m0, s38, 2048
    s_nop 0
    buffer_load_dwordx4 v12, s[4:7], s32 offen sc1 lds
    s_add_u32 m0, s38, 3072
    s_nop 0
    buffer_load_dwordx4 v13, s[4:7], s32 offen sc1 lds
    s_add_u32 m0, s38, 4096
    s_nop 0
    buffer_load_dwordx4 v14, s[4:7], s32 offen sc1 lds
    s_add_u32 m0, s38, 5120
    s_nop 0
    buffer_load_dwordx4 v15, s[4:7], s32 offen sc1 lds
    s_add_u32 m0, s38, 6144
    s_nop 0
    buffer_load_dwordx4 v16, s[4:7], s32 offen sc1 lds
    s_add_u32 m0, s38, 7168
    s_nop 0
    buffer_load_dwordx4 v17, s[4:7], s32 offen sc1 lds
    s_add_u32 m0, s38, 8192
    s_nop 0
    buffer_load_dwordx4 v18, s[4:7], s32 offen sc1 lds
    s_add_u32 m0, s38, 9216
    s_nop 0
    buffer_load_dwordx4 v19, s[4:7], s32 offen sc1 lds
    s_add_u32 m0, s38, 10240
    s_nop 0
    buffer_load_dwordx4 v20, s[4:7], s32 offen sc1 lds
    s_add_u32 m0, s38, 11264
    s_nop 0
    buffer_load_dwordx4 v21, s[4:7], s32 offen sc1 lds
    s_add_u32 s32, s32, s30
L_wpf_265:
    s_add_u32 s42, s33, 1
    s_and_b32 s47, s42, 1
    s_mul_i32 s47, s47, s45
    v_add_u32 v35, s47, v33
    s_add_u32 s47, s42, 1
    s_mov_b32 s48, s47
    s_mov_b32 exec_lo, s46
    s_mov_b32 exec_hi, 0
    buffer_load_dword v36, v35, s[4:7], 0 offen sc1
    s_mov_b64 exec, -1
    s_branch L_wtile_257
L_wfin_264:
    s_waitcnt vmcnt(0)
    s_barrier
    s_cmp_lg_u32 s16, 0
    s_cbranch_scc1 L_wp_269
    v_mov_b32 v36, s33
    s_mov_b64 exec, 1
    buffer_store_dword v36, v34, s[4:7], 0 offen sc1
    s_mov_b64 exec, -1
L_wp_269:
L_wend_256:
    s_branch L_end_1
L_final_10:
    v_mov_b32 v2, 76
    s_mov_b32 s38, 0
L_dw_270:
    buffer_load_dword v3, v2, s[12:15], 0 offen sc1
    s_waitcnt vmcnt(0)
    v_cmp_gt_u32 vcc, 1, v3
    s_cbranch_vccz L_dwk_271
    s_sleep 2
    s_add_u32 s38, s38, 1
    s_cmp_lt_u32 s38, 4194304
    s_cbranch_scc1 L_dw_270
    s_branch L_end_1
L_dwk_271:
    s_mov_b32 s18, 0
    s_mov_b32 s19, 1
    v_and_b32 v1, 63, v0
    v_lshlrev_b32 v12, 7, v1
    v_add_u32 v12, 2120192, v12
    s_load_dwordx2 s[24:25], s[0:1], 0
    s_load_dwordx2 s[26:27], s[0:1], 88
    s_waitcnt lgkmcnt(0)
    s_mov_b32 s8, s24
    s_and_b32 s9, s25, 0xffff
    s_mov_b32 s10, 2621440
    s_mov_b32 s11, 0x20000
    s_mov_b32 s12, s26
    s_and_b32 s13, s27, 0xffff
    s_mov_b32 s14, 2621440
    s_mov_b32 s15, 0x20000
    v_lshlrev_b32 v2, 4, v0
    s_mul_i32 s28, s17, 4096
    v_add_u32 v2, s28, v2
    v_mov_b32 v14, 0x00003f80
    v_mov_b32 v15, 0x3f800000
    s_mov_b32 s22, s18
L_f_272:
    s_cmp_ge_u32 s22, 64
    s_cbranch_scc1 L_fend_273
    s_add_u32 s46, s22, 1
    s_mov_b32 s38, 0
    s_mov_b32 exec_lo, 0xffffffff
    s_mov_b32 exec_hi, 0x3ffff
L_wt_274:
    buffer_load_dword v13, v12, s[4:7], 0 offen sc1
    s_waitcnt vmcnt(0)
    v_cmp_gt_u32 vcc, s46, v13
    s_cbranch_vccz L_wtk_276
    s_sleep 4
    s_add_u32 s38, s38, 1
    s_cmp_lt_u32 s38, 4194304
    s_cbranch_scc1 L_wt_274
    s_mov_b64 exec, -1
    s_branch L_end_1
L_wtk_276:
    s_mov_b64 exec, -1
L_wtd_275:
    s_mul_i32 s23, s22, 40960
    s_add_u32 s28, s23, 0
    buffer_load_dwordx4 v[16:19], v2, s[8:11], s28 offen
    s_add_u32 s28, s28, 134217728
    buffer_load_dwordx4 v[40:43], v2, s[4:7], s28 offen sc1
    s_add_u32 s28, s28, 2621440
    buffer_load_dwordx4 v[44:47], v2, s[4:7], s28 offen sc1
    s_add_u32 s28, s28, 2621440
    buffer_load_dwordx4 v[48:51], v2, s[4:7], s28 offen sc1
    s_add_u32 s28, s28, 2621440
    buffer_load_dwordx4 v[52:55], v2, s[4:7], s28 offen sc1
    s_add_u32 s28, s28, 2621440
    buffer_load_dwordx4 v[56:59], v2, s[4:7], s28 offen sc1
    s_add_u32 s28, s28, 2621440
    buffer_load_dwordx4 v[60:63], v2, s[4:7], s28 offen sc1
    s_add_u32 s28, s28, 2621440
    buffer_load_dwordx4 v[64:67], v2, s[4:7], s28 offen sc1
    s_add_u32 s28, s28, 2621440
    buffer_load_dwordx4 v[68:71], v2, s[4:7], s28 offen sc1
    s_add_u32 s28, s28, 2621440
    buffer_load_dwordx4 v[72:75], v2, s[4:7], s28 offen sc1
    s_add_u32 s28, s28, 2621440
    buffer_load_dwordx4 v[76:79], v2, s[4:7], s28 offen sc1
    s_waitcnt vmcnt(0)
    v_dot2_f32_bf16 v4, v40, v14, 0
    v_dot2_f32_bf16 v5, v40, v15, 0
    v_dot2_f32_bf16 v4, v44, v14, v4
    v_dot2_f32_bf16 v5, v44, v15, v5
    v_dot2_f32_bf16 v4, v48, v14, v4
    v_dot2_f32_bf16 v5, v48, v15, v5
    v_dot2_f32_bf16 v4, v52, v14, v4
    v_dot2_f32_bf16 v5, v52, v15, v5
    v_dot2_f32_bf16 v4, v56, v14, v4
    v_dot2_f32_bf16 v5, v56, v15, v5
    v_dot2_f32_bf16 v4, v60, v14, v4
    v_dot2_f32_bf16 v5, v60, v15, v5
    v_dot2_f32_bf16 v4, v64, v14, v4
    v_dot2_f32_bf16 v5, v64, v15, v5
    v_dot2_f32_bf16 v4, v68, v14, v4
    v_dot2_f32_bf16 v5, v68, v15, v5
    v_dot2_f32_bf16 v8, v72, v14, 0
    v_dot2_f32_bf16 v9, v72, v15, 0
    v_dot2_f32_bf16 v8, v76, v14, v8
    v_dot2_f32_bf16 v9, v76, v15, v9
    s_nop 2
    v_cvt_pk_bf16_f32 v10, v4, v5
    v_cvt_pk_bf16_f32 v11, v8, v9
    v_lshlrev_b32 v4, 16, v10
    v_and_b32 v5, 0xffff0000, v10
    v_lshlrev_b32 v8, 16, v11
    v_and_b32 v9, 0xffff0000, v11
    v_mul_f32 v6, 0xbfb8aa3b, v8
    v_mul_f32 v7, 0xbfb8aa3b, v9
    v_exp_f32 v6, v6
    v_exp_f32 v7, v7
    s_nop 0
    v_add_f32 v6, 1.0, v6
    v_add_f32 v7, 1.0, v7
    v_rcp_f32 v6, v6
    v_rcp_f32 v7, v7
    s_nop 0
    v_mul_f32 v8, v8, v6
    v_mul_f32 v9, v9, v7
    v_cvt_pk_bf16_f32 v11, v8, v9
    v_lshlrev_b32 v8, 16, v11
    v_and_b32 v9, 0xffff0000, v11
    v_mul_f32 v4, v4, v8
    v_mul_f32 v5, v5, v9
    v_cvt_pk_bf16_f32 v10, v4, v5
    v_lshlrev_b32 v4, 16, v10
    v_and_b32 v5, 0xffff0000, v10
    v_lshlrev_b32 v6, 16, v16
    v_and_b32 v7, 0xffff0000, v16
    v_add_f32 v4, v4, v6
    v_add_f32 v5, v5, v7
    v_cvt_pk_bf16_f32 v16, v4, v5
    v_dot2_f32_bf16 v4, v41, v14, 0
    v_dot2_f32_bf16 v5, v41, v15, 0
    v_dot2_f32_bf16 v4, v45, v14, v4
    v_dot2_f32_bf16 v5, v45, v15, v5
    v_dot2_f32_bf16 v4, v49, v14, v4
    v_dot2_f32_bf16 v5, v49, v15, v5
    v_dot2_f32_bf16 v4, v53, v14, v4
    v_dot2_f32_bf16 v5, v53, v15, v5
    v_dot2_f32_bf16 v4, v57, v14, v4
    v_dot2_f32_bf16 v5, v57, v15, v5
    v_dot2_f32_bf16 v4, v61, v14, v4
    v_dot2_f32_bf16 v5, v61, v15, v5
    v_dot2_f32_bf16 v4, v65, v14, v4
    v_dot2_f32_bf16 v5, v65, v15, v5
    v_dot2_f32_bf16 v4, v69, v14, v4
    v_dot2_f32_bf16 v5, v69, v15, v5
    v_dot2_f32_bf16 v8, v73, v14, 0
    v_dot2_f32_bf16 v9, v73, v15, 0
    v_dot2_f32_bf16 v8, v77, v14, v8
    v_dot2_f32_bf16 v9, v77, v15, v9
    s_nop 2
    v_cvt_pk_bf16_f32 v10, v4, v5
    v_cvt_pk_bf16_f32 v11, v8, v9
    v_lshlrev_b32 v4, 16, v10
    v_and_b32 v5, 0xffff0000, v10
    v_lshlrev_b32 v8, 16, v11
    v_and_b32 v9, 0xffff0000, v11
    v_mul_f32 v6, 0xbfb8aa3b, v8
    v_mul_f32 v7, 0xbfb8aa3b, v9
    v_exp_f32 v6, v6
    v_exp_f32 v7, v7
    s_nop 0
    v_add_f32 v6, 1.0, v6
    v_add_f32 v7, 1.0, v7
    v_rcp_f32 v6, v6
    v_rcp_f32 v7, v7
    s_nop 0
    v_mul_f32 v8, v8, v6
    v_mul_f32 v9, v9, v7
    v_cvt_pk_bf16_f32 v11, v8, v9
    v_lshlrev_b32 v8, 16, v11
    v_and_b32 v9, 0xffff0000, v11
    v_mul_f32 v4, v4, v8
    v_mul_f32 v5, v5, v9
    v_cvt_pk_bf16_f32 v10, v4, v5
    v_lshlrev_b32 v4, 16, v10
    v_and_b32 v5, 0xffff0000, v10
    v_lshlrev_b32 v6, 16, v17
    v_and_b32 v7, 0xffff0000, v17
    v_add_f32 v4, v4, v6
    v_add_f32 v5, v5, v7
    v_cvt_pk_bf16_f32 v17, v4, v5
    v_dot2_f32_bf16 v4, v42, v14, 0
    v_dot2_f32_bf16 v5, v42, v15, 0
    v_dot2_f32_bf16 v4, v46, v14, v4
    v_dot2_f32_bf16 v5, v46, v15, v5
    v_dot2_f32_bf16 v4, v50, v14, v4
    v_dot2_f32_bf16 v5, v50, v15, v5
    v_dot2_f32_bf16 v4, v54, v14, v4
    v_dot2_f32_bf16 v5, v54, v15, v5
    v_dot2_f32_bf16 v4, v58, v14, v4
    v_dot2_f32_bf16 v5, v58, v15, v5
    v_dot2_f32_bf16 v4, v62, v14, v4
    v_dot2_f32_bf16 v5, v62, v15, v5
    v_dot2_f32_bf16 v4, v66, v14, v4
    v_dot2_f32_bf16 v5, v66, v15, v5
    v_dot2_f32_bf16 v4, v70, v14, v4
    v_dot2_f32_bf16 v5, v70, v15, v5
    v_dot2_f32_bf16 v8, v74, v14, 0
    v_dot2_f32_bf16 v9, v74, v15, 0
    v_dot2_f32_bf16 v8, v78, v14, v8
    v_dot2_f32_bf16 v9, v78, v15, v9
    s_nop 2
    v_cvt_pk_bf16_f32 v10, v4, v5
    v_cvt_pk_bf16_f32 v11, v8, v9
    v_lshlrev_b32 v4, 16, v10
    v_and_b32 v5, 0xffff0000, v10
    v_lshlrev_b32 v8, 16, v11
    v_and_b32 v9, 0xffff0000, v11
    v_mul_f32 v6, 0xbfb8aa3b, v8
    v_mul_f32 v7, 0xbfb8aa3b, v9
    v_exp_f32 v6, v6
    v_exp_f32 v7, v7
    s_nop 0
    v_add_f32 v6, 1.0, v6
    v_add_f32 v7, 1.0, v7
    v_rcp_f32 v6, v6
    v_rcp_f32 v7, v7
    s_nop 0
    v_mul_f32 v8, v8, v6
    v_mul_f32 v9, v9, v7
    v_cvt_pk_bf16_f32 v11, v8, v9
    v_lshlrev_b32 v8, 16, v11
    v_and_b32 v9, 0xffff0000, v11
    v_mul_f32 v4, v4, v8
    v_mul_f32 v5, v5, v9
    v_cvt_pk_bf16_f32 v10, v4, v5
    v_lshlrev_b32 v4, 16, v10
    v_and_b32 v5, 0xffff0000, v10
    v_lshlrev_b32 v6, 16, v18
    v_and_b32 v7, 0xffff0000, v18
    v_add_f32 v4, v4, v6
    v_add_f32 v5, v5, v7
    v_cvt_pk_bf16_f32 v18, v4, v5
    v_dot2_f32_bf16 v4, v43, v14, 0
    v_dot2_f32_bf16 v5, v43, v15, 0
    v_dot2_f32_bf16 v4, v47, v14, v4
    v_dot2_f32_bf16 v5, v47, v15, v5
    v_dot2_f32_bf16 v4, v51, v14, v4
    v_dot2_f32_bf16 v5, v51, v15, v5
    v_dot2_f32_bf16 v4, v55, v14, v4
    v_dot2_f32_bf16 v5, v55, v15, v5
    v_dot2_f32_bf16 v4, v59, v14, v4
    v_dot2_f32_bf16 v5, v59, v15, v5
    v_dot2_f32_bf16 v4, v63, v14, v4
    v_dot2_f32_bf16 v5, v63, v15, v5
    v_dot2_f32_bf16 v4, v67, v14, v4
    v_dot2_f32_bf16 v5, v67, v15, v5
    v_dot2_f32_bf16 v4, v71, v14, v4
    v_dot2_f32_bf16 v5, v71, v15, v5
    v_dot2_f32_bf16 v8, v75, v14, 0
    v_dot2_f32_bf16 v9, v75, v15, 0
    v_dot2_f32_bf16 v8, v79, v14, v8
    v_dot2_f32_bf16 v9, v79, v15, v9
    s_nop 2
    v_cvt_pk_bf16_f32 v10, v4, v5
    v_cvt_pk_bf16_f32 v11, v8, v9
    v_lshlrev_b32 v4, 16, v10
    v_and_b32 v5, 0xffff0000, v10
    v_lshlrev_b32 v8, 16, v11
    v_and_b32 v9, 0xffff0000, v11
    v_mul_f32 v6, 0xbfb8aa3b, v8
    v_mul_f32 v7, 0xbfb8aa3b, v9
    v_exp_f32 v6, v6
    v_exp_f32 v7, v7
    s_nop 0
    v_add_f32 v6, 1.0, v6
    v_add_f32 v7, 1.0, v7
    v_rcp_f32 v6, v6
    v_rcp_f32 v7, v7
    s_nop 0
    v_mul_f32 v8, v8, v6
    v_mul_f32 v9, v9, v7
    v_cvt_pk_bf16_f32 v11, v8, v9
    v_lshlrev_b32 v8, 16, v11
    v_and_b32 v9, 0xffff0000, v11
    v_mul_f32 v4, v4, v8
    v_mul_f32 v5, v5, v9
    v_cvt_pk_bf16_f32 v10, v4, v5
    v_lshlrev_b32 v4, 16, v10
    v_and_b32 v5, 0xffff0000, v10
    v_lshlrev_b32 v6, 16, v19
    v_and_b32 v7, 0xffff0000, v19
    v_add_f32 v4, v4, v6
    v_add_f32 v5, v5, v7
    v_cvt_pk_bf16_f32 v19, v4, v5
    s_add_u32 s28, s23, 0
    buffer_store_dwordx4 v[16:19], v2, s[12:15], s28 offen
    s_waitcnt vmcnt(0)
    s_add_u32 s22, s22, s19
    s_branch L_f_272
L_fend_273:
L_end_1:
L_end0_3:
    s_endpgm
.section .rodata,"a"
.p2align 6
.amdhsa_kernel recurrent_scan__memory_aug_recurrent_mem_tr__glu_gated_glu__prompt_kernel
  .amdhsa_next_free_vgpr 512
  .amdhsa_next_free_sgpr 102
  .amdhsa_accum_offset 256
  .amdhsa_group_segment_fixed_size 0
  .amdhsa_kernarg_size 112
  .amdhsa_user_sgpr_count 2
  .amdhsa_user_sgpr_kernarg_segment_ptr 1
  .amdhsa_system_sgpr_workgroup_id_x 1
.end_amdhsa_kernel
```
